```python
import torch

def _softmax(x, axis=-1):
    return torch.softmax(x, dim=axis)
def _gelu(x):
    return torch.nn.functional.gelu(x, approximate="tanh")
def _silu(x):
    return torch.nn.functional.silu(x)
def _sigmoid(x):
    return torch.sigmoid(x)
def _layernorm(x, axis=-1, eps=1e-5):
    m = x.mean(dim=axis, keepdim=True)
    v = x.var(dim=axis, keepdim=True, unbiased=False)
    return (x - m) / torch.sqrt(v + eps)
def _scatter_add(tgt, idx, src, axis=0):
    return tgt.clone().index_add_(axis, idx, src)
def _segment_sum(src, seg, n):
    out = torch.zeros((n,) + src.shape[1:], dtype=src.dtype)
    return out.index_add_(0, seg, src)
def _pad(x, pw):
    flat = tuple(v for pair in reversed(pw) for v in pair)
    return torch.nn.functional.pad(x, flat)

kernel_name = 'standalone__memory_aug_memorizing_tr__prompt'

def setup_inputs():

    _w = (lambda a: (lambda t: t.to(torch.bfloat16) if t.is_floating_point() else t)(torch.as_tensor(a)))
    B, H, S, D = 1, 32, 2048, 192
    M, K = 2048, 8
    return {
        "q": _w((lambda *s: torch.randn(*s, dtype=torch.bfloat16) * 0.8)(B, H, S, D)),
        "k": _w((lambda *s: torch.randn(*s, dtype=torch.bfloat16) * 0.8)(B, H, S, D)),
        "v": _w((lambda *s: torch.randn(*s, dtype=torch.bfloat16) * 0.05)(B, H, S, D)),
        "mem_k": _w((lambda *s: torch.randn(*s, dtype=torch.bfloat16) * 0.8)(B, H, M, D)),
        "mem_v": _w((lambda *s: torch.randn(*s, dtype=torch.bfloat16) * 0.05)(B, H, M, D)),
        "idx": _w(torch.randint(0, M, (B, H, S, K)).to(torch.int64)),
        "gate_bias": _w((lambda *s: torch.randn(*s, dtype=torch.bfloat16) * 0.2)(H)),
    }

def reference(q, k, v, mem_k, mem_v, idx, gate_bias):
    B, H, S, D = q.shape
    K = idx.shape[-1]
    scale = D ** -0.5
    sl = torch.einsum("bhqd,bhkd->bhqk", q, k) * scale
    cm = torch.tril(torch.ones((S, S), dtype=q.dtype))
    sl = torch.where(cm[None, None] > 0, sl, -1e9)
    pl = _softmax(sl, axis=-1)
    ol = torch.einsum("bhqk,bhkd->bhqd", pl, v)
    idx_e = (lambda x, n, axis: torch.repeat_interleave(x, n, dim=axis))(idx.reshape(B, H, S * K)[..., None], D, axis=-1)
    mk = (lambda x, i, axis: torch.take_along_dim(x, i, dim=axis))(mem_k, idx_e, axis=2).reshape(B, H, S, K, D)
    mv = (lambda x, i, axis: torch.take_along_dim(x, i, dim=axis))(mem_v, idx_e, axis=2).reshape(B, H, S, K, D)
    sm = torch.einsum("bhqd,bhqkd->bhqk", q, mk) * scale
    pm = _softmax(sm, axis=-1)
    om = torch.einsum("bhqk,bhqkd->bhqd", pm, mv)
    g = _sigmoid(gate_bias)[None, :, None, None]
    return g * om + (1 - g) * ol
```

```asm
; @launch grid=(256,1,1) block=(256,1,1) lds=163840
.amdgcn_target "amdgcn-amd-amdhsa--gfx950"
.text
.globl standalone__memory_aug_memorizing_tr__prompt_kernel
.p2align 8
.type standalone__memory_aug_memorizing_tr__prompt_kernel,@function
standalone__memory_aug_memorizing_tr__prompt_kernel:
  s_cmp_ge_u32 s2, 256
  s_cbranch_scc1 AT_END
  s_load_dwordx4 s[4:7], s[0:1], 0
  s_load_dwordx2 s[42:43], s[0:1], 16
  s_load_dwordx4 s[68:71], s[0:1], 24
  s_load_dwordx4 s[44:47], s[0:1], 40
  s_load_dwordx2 s[48:49], s[0:1], 56
  s_load_dwordx2 s[72:73], s[0:1], 72
  v_and_b32 v1, 63, v0
  v_lshrrev_b32 v0, 6, v0
  s_nop 0
  v_readfirstlane_b32 s28, v0
  s_and_b32 s3, s2, 7
  s_lshr_b32 s96, s2, 3
  s_and_b32 s29, s96, 7
  s_lshr_b32 s96, s96, 3
  s_lshl_b32 s3, s3, 2
  s_add_u32 s30, s3, s96
  s_lshl_b32 s3, s29, 2
  s_sub_u32 s31, 64, s3
  s_mov_b32 s36, s3
  s_sub_u32 s37, s31, 4
  s_lshl_b32 s38, s29, 1
  s_add_u32 s38, s38, 1
  s_add_u32 s3, s29, s30
  s_mul_i32 s96, s3, 43
  s_lshr_b32 s96, s96, 7
  s_mul_i32 s96, s96, 3
  s_sub_u32 s3, s3, s96
  s_add_u32 s3, s3, 12
  s_add_u32 s96, s38, 1
  s_max_u32 s3, s3, s96
  s_min_u32 s39, s3, 15
  s_mov_b32 s39, 15
  s_mul_i32 s97, s30, 786432
  s_waitcnt lgkmcnt(0)
  s_add_u32 s16, s4, s97
  s_addc_u32 s17, s5, 0
  s_and_b32 s17, s17, 0xffff
  s_mov_b32 s18, 786432
  s_mov_b32 s19, 0x20000
  s_add_u32 s8, s6, s97
  s_addc_u32 s9, s7, 0
  s_and_b32 s9, s9, 0xffff
  s_mov_b32 s10, 786432
  s_mov_b32 s11, 0x20000
  s_add_u32 s12, s42, s97
  s_addc_u32 s13, s43, 0
  s_and_b32 s13, s13, 0xffff
  s_mov_b32 s14, 786432
  s_mov_b32 s15, 0x20000
  s_add_u32 s20, s48, s97
  s_addc_u32 s21, s49, 0
  s_and_b32 s21, s21, 0xffff
  s_mov_b32 s22, 786432
  s_mov_b32 s23, 0x20000
  s_add_u32 s24, s72, s97
  s_addc_u32 s25, s73, 0
  s_and_b32 s25, s25, 0xffff
  s_mov_b32 s26, 786432
  s_mov_b32 s27, 0x20000
  s_add_u32 s68, s68, s97
  s_addc_u32 s69, s69, 0
  s_add_u32 s70, s70, s97
  s_addc_u32 s71, s71, 0
  s_lshl_b32 s3, s30, 16
  s_add_u32 s76, s44, s3
  s_addc_u32 s77, s45, 0
  s_and_b32 s77, s77, 0xffff
  s_mov_b32 s78, 65536
  s_mov_b32 s79, 0x20000
  s_lshl_b32 s3, s30, 1
  s_and_b32 s96, s3, 0xfffffffc
  s_add_u32 s46, s46, s96
  s_addc_u32 s47, s47, 0
  s_load_dword s96, s[46:47], 0
  v_lshrrev_b32 v16, 3, v1
  v_and_b32 v17, 7, v1
  v_and_b32 v18, 15, v1
  v_lshrrev_b32 v19, 4, v1
  v_add_u32 v20, 0, v16
  v_mul_u32_u24 v20, 0xAAAB, v20
  v_lshrrev_b32 v20, 17, v20
  v_and_b32 v20, 6, v20
  v_xor_b32 v20, v20, v17
  v_lshlrev_b32 v20, 4, v20
  v_lshl_add_u32 v8, v16, 7, v20
  v_add_u32 v20, 8, v16
  v_mul_u32_u24 v20, 0xAAAB, v20
  v_lshrrev_b32 v20, 17, v20
  v_and_b32 v20, 6, v20
  v_xor_b32 v20, v20, v17
  v_lshlrev_b32 v20, 4, v20
  v_lshl_add_u32 v9, v16, 7, v20
  v_add_u32 v20, 16, v16
  v_mul_u32_u24 v20, 0xAAAB, v20
  v_lshrrev_b32 v20, 17, v20
  v_and_b32 v20, 6, v20
  v_xor_b32 v20, v20, v17
  v_lshlrev_b32 v20, 4, v20
  v_lshl_add_u32 v10, v16, 7, v20
  v_lshlrev_b32 v13, 4, v1
  s_lshl_b32 s3, s29, 7
  s_lshl_b32 s4, s28, 5
  s_add_u32 s58, s3, s4
  s_sub_u32 s5, 1920, s3
  s_add_u32 s59, s5, s4
  s_lshl_b32 s3, s28, 11
  s_add_u32 s6, s3, 147456
  s_mov_b32 m0, s6
  s_lshl_b32 s4, s58, 5
  buffer_load_dwordx4 v13, s[76:79], s4 offen nt lds
  s_add_u32 m0, s6, 1024
  s_lshl_b32 s4, s59, 5
  buffer_load_dwordx4 v13, s[76:79], s4 offen nt lds
  s_mul_i32 s58, s58, 384
  s_mul_i32 s59, s59, 384
  s_getpc_b64 s[44:45]
L_CP:
  s_sub_u32 s44, s44, L_CP-standalone__memory_aug_memorizing_tr__prompt_kernel
  s_subb_u32 s45, s45, 0
  s_and_b32 s45, s45, 0xffff
  s_mov_b32 s46, TILETAB-standalone__memory_aug_memorizing_tr__prompt_kernel
  s_mov_b32 s47, 0x20000
  s_lshr_b32 s3, s2, 3
  s_lshl_b32 s3, s3, 12
  s_lshl_b32 s5, s28, 10
  s_add_u32 s3, s3, s5
  v_and_b32 v20, 7, v1
  v_lshlrev_b32 v20, 7, v20
  s_mov_b32 m0, 160768
  s_nop 0
  buffer_load_dword v20, s[44:47], s3 offen lds
  s_getpc_b64 s[98:99]
L_TT:
  s_add_u32 s98, s98, TILETAB-L_TT
  s_addc_u32 s99, s99, 0
  s_lshl_b32 s3, s29, 6
  v_add_u32 v20, s3, v1
  global_load_ubyte v0, v20, s[98:99]
  s_mov_b32 s7, 73728
  s_cmp_eq_u32 s28, 1
  s_cselect_b32 s7, 86016, s7
  s_cmp_eq_u32 s28, 2
  s_cselect_b32 s7, 24576, s7
  s_cmp_eq_u32 s28, 3
  s_cselect_b32 s7, 36864, s7
  s_mul_i32 s4, s28, 3072
  s_add_u32 s51, s4, 0
  s_add_u32 s52, s4, 49152
  s_mul_i32 s53, s28, 12288
  s_add_u32 s53, s53, 98304
  s_add_u32 m0, s7, 0
  s_add_u32 s3, s59, 0
  buffer_load_dwordx4 v8, s[16:19], s3 offen offset:0 nt lds
  s_mov_b32 s75, s4
  v_and_b32 v20, 6, v18
  v_xor_b32 v20, v20, v19
  v_lshlrev_b32 v20, 4, v20
  v_mul_u32_u24 v2, 384, v18
  v_add_u32 v2, v2, v20
  v_xor_b32 v3, 64, v2
  v_add_u32 v22, s7, v2
  v_xor_b32 v23, 64, v22
  v_add_u32 v24, s53, v2
  v_xor_b32 v25, 64, v24
  v_mov_b32 v64, 0
  v_mov_b32 v65, 0
  v_mov_b32 v66, 0
  v_mov_b32 v67, 0
  buffer_load_dwordx4 v9, s[16:19], s3 offen offset:1024 nt lds
  v_mov_b32 v68, 0
  v_mov_b32 v69, 0
  v_mov_b32 v70, 0
  v_mov_b32 v71, 0
  v_mov_b32 v26, 0x3dd53b95
  v_mov_b32 v27, 0x3dd53b95
  s_mov_b32 s54, 0x3dd53b95
  s_mov_b32 s55, 0xffff0000
  s_mov_b32 s50, 0x49800000
  s_mov_b32 s60, 128
  s_mov_b32 s61, 256
  v_mov_b32 v28, 0
  v_mov_b32 v29, 0
  v_mov_b32 v30, 0
  v_mov_b32 v31, 0
  buffer_load_dwordx4 v10, s[16:19], s3 offen offset:2048 nt lds
  v_add_u32 v20, 159744, v13
  ds_write_b128 v20, v[28:31]
  v_mfma_f32_32x32x16_bf16 a[0:15], v[28:31], v[28:31], 0
  v_mfma_f32_32x32x16_bf16 a[16:31], v[28:31], v[28:31], 0
  v_mfma_f32_32x32x16_bf16 a[32:47], v[28:31], v[28:31], 0
  v_mfma_f32_32x32x16_bf16 a[48:63], v[28:31], v[28:31], 0
  v_mfma_f32_32x32x16_bf16 a[64:79], v[28:31], v[28:31], 0
  v_mfma_f32_32x32x16_bf16 a[80:95], v[28:31], v[28:31], 0
  v_mfma_f32_32x32x16_bf16 a[96:111], v[28:31], v[28:31], 0
  v_mfma_f32_32x32x16_bf16 a[112:127], v[28:31], v[28:31], 0
  v_mfma_f32_32x32x16_bf16 a[128:143], v[28:31], v[28:31], 0
  v_mfma_f32_32x32x16_bf16 a[144:159], v[28:31], v[28:31], 0
  v_mfma_f32_32x32x16_bf16 a[160:175], v[28:31], v[28:31], 0
  v_mfma_f32_32x32x16_bf16 a[176:191], v[28:31], v[28:31], 0
  v_bfe_u32 v20, v1, 2, 2
  s_add_u32 m0, s7, 3072
  s_add_u32 s3, s59, 3072
  buffer_load_dwordx4 v8, s[16:19], s3 offen offset:0 nt lds
  v_lshl_add_u32 v20, v19, 2, v20
  v_mul_u32_u24 v4, 384, v20
  v_and_b32 v20, 6, v20
  v_bfe_u32 v21, v1, 1, 1
  v_xor_b32 v20, v20, v21
  v_lshl_add_u32 v4, v20, 4, v4
  v_and_b32 v20, 1, v1
  v_lshl_add_u32 v4, v20, 3, v4
  v_add_u32 v4, 49152, v4
  v_xor_b32 v5, 32, v4
  v_xor_b32 v6, 64, v4
  v_xor_b32 v7, 96, v4
  v_lshlrev_b32 v20, 2, v19
  v_sub_u32 v11, v18, v20
  v_mov_b32 v12, 0xff800000
  buffer_load_dwordx4 v9, s[16:19], s3 offen offset:1024 nt lds
  v_lshlrev_b32 v15, 7, v1
  v_and_b32 v20, 2, v16
  v_xor_b32 v20, v20, v17
  v_lshlrev_b32 v20, 4, v20
  v_mov_b32 v201, v20
  v_xor_b32 v203, 64, v20
  v_mov_b32 v205, v20
  v_xor_b32 v207, 64, v20
  v_and_b32 v20, 7, v18
  v_lshrrev_b32 v21, 3, v18
  v_lshlrev_b32 v250, 7, v20
  v_lshl_add_u32 v250, v21, 10, v250
  v_and_b32 v20, 2, v20
  v_xor_b32 v20, v20, v19
  v_lshlrev_b32 v21, 2, v21
  buffer_load_dwordx4 v10, s[16:19], s3 offen offset:2048 nt lds
  v_xor_b32 v20, v20, v21
  v_lshl_add_u32 v250, v20, 4, v250
  v_add_u32 v250, s53, v250
  v_xor_b32 v251, 64, v250
  v_lshlrev_b32 v20, 6, v19
  v_bfe_u32 v21, v1, 3, 1
  v_lshl_add_u32 v20, v21, 4, v20
  v_lshl_add_u32 v20, v17, 1, v20
  s_lshl_b32 s5, s28, 10
  s_add_u32 s5, s5, 155648
  v_add_u32 v252, s5, v20
  s_mov_b32 s80, 0xff
  s_mov_b32 s81, 0x0
  s_mov_b32 s82, 0xff00
  s_mov_b32 s83, 0x0
  s_add_u32 m0, s7, 6144
  s_add_u32 s3, s59, 6144
  buffer_load_dwordx4 v8, s[16:19], s3 offen offset:0 nt lds
  s_mov_b32 s84, 0xff0000
  s_mov_b32 s85, 0x0
  s_mov_b32 s86, 0xff000000
  s_mov_b32 s87, 0x0
  s_mov_b32 s88, 0x0
  s_mov_b32 s89, 0xff
  s_mov_b32 s90, 0x0
  s_mov_b32 s91, 0xff00
  s_mov_b32 s92, 0x0
  s_mov_b32 s93, 0xff0000
  s_mov_b32 s94, 0x0
  s_mov_b32 s95, 0xff000000
  v_mov_b32 v112, 0x3f803f80
  v_mov_b32 v113, 0x3f803f80
  v_mov_b32 v114, 0x3f803f80
  buffer_load_dwordx4 v9, s[16:19], s3 offen offset:1024 nt lds
  v_mov_b32 v115, 0x3f803f80
  v_mov_b32 v96, 0
  v_mov_b32 v80, 0
  v_mov_b32 v97, 0
  v_mov_b32 v81, 0
  v_mov_b32 v98, 0
  v_mov_b32 v82, 0
  v_mov_b32 v99, 0
  v_mov_b32 v83, 0
  v_mov_b32 v100, 0
  v_mov_b32 v84, 0
  v_mov_b32 v101, 0
  v_mov_b32 v85, 0
  v_mov_b32 v102, 0
  v_mov_b32 v86, 0
  buffer_load_dwordx4 v10, s[16:19], s3 offen offset:2048 nt lds
  v_mov_b32 v103, 0
  v_mov_b32 v87, 0
  v_mov_b32 v104, 0
  v_mov_b32 v88, 0
  v_mov_b32 v105, 0
  v_mov_b32 v89, 0
  v_mov_b32 v106, 0
  v_mov_b32 v90, 0
  v_mov_b32 v107, 0
  v_mov_b32 v91, 0
  v_mov_b32 v108, 0
  v_mov_b32 v92, 0
  v_mov_b32 v109, 0
  v_mov_b32 v93, 0
  v_mov_b32 v110, 0
  s_add_u32 m0, s7, 9216
  s_add_u32 s3, s59, 9216
  buffer_load_dwordx4 v8, s[16:19], s3 offen offset:0 nt lds
  v_mov_b32 v94, 0
  v_mov_b32 v111, 0
  v_mov_b32 v95, 0
  v_mov_b32 v192, 0
  v_mov_b32 v193, 0
  v_mov_b32 v194, 0
  v_mov_b32 v195, 0
  v_mov_b32 v196, 0
  v_mov_b32 v197, 0
  v_mov_b32 v198, 0
  v_mov_b32 v199, 0
  v_mov_b32 v116, 0
  v_mov_b32 v117, 0
  v_mov_b32 v118, 0
  v_mov_b32 v119, 0
  buffer_load_dwordx4 v9, s[16:19], s3 offen offset:1024 nt lds
  v_lshlrev_b32 v1, 2, v16
  v_add_u32 v1, s6, v1
  s_waitcnt lgkmcnt(0)
  s_lshl_b32 s5, s30, 1
  s_and_b32 s5, s5, 2
  s_lshl_b32 s5, s5, 3
  s_lshr_b32 s96, s96, s5
  s_lshl_b32 s96, s96, 16
  v_mov_b32 v20, s96
  v_mul_f32 v20, 0x3fb8aa3b, v20
  v_exp_f32 v20, v20
  s_nop 0
  v_add_f32 v20, 1.0, v20
  v_rcp_f32 v20, v20
  s_nop 0
  buffer_load_dwordx4 v10, s[16:19], s3 offen offset:2048 nt lds
  v_sub_f32 v21, 1.0, v20
  v_readfirstlane_b32 s56, v20
  s_nop 0
  v_readfirstlane_b32 s57, v21
  s_add_u32 m0, s51, 0
  s_add_u32 s3, s4, 393216
  buffer_load_dwordx4 v8, s[8:11], s3 offen offset:0  lds
  buffer_load_dwordx4 v9, s[8:11], s3 offen offset:1024  lds
  s_waitcnt vmcnt(8)
  ds_read_b128 v[152:155], v22 offset:0
  ds_read_b128 v[156:159], v23 offset:0
  ds_read_b128 v[160:163], v22 offset:128
  ds_read_b128 v[164:167], v23 offset:128
  ds_read_b128 v[168:171], v22 offset:256
  ds_read_b128 v[172:175], v23 offset:256
  buffer_load_dwordx4 v10, s[8:11], s3 offen offset:2048  lds
  s_waitcnt lgkmcnt(5)
  v_lshlrev_b32 v32, 16, v152
  v_and_b32 v33, s55, v152
  v_lshlrev_b32 v34, 16, v153
  v_and_b32 v35, s55, v153
  v_lshlrev_b32 v36, 16, v154
  v_and_b32 v37, s55, v154
  v_lshlrev_b32 v38, 16, v155
  v_and_b32 v39, s55, v155
  v_pk_mul_f32 v[32:33], v[32:33], v[26:27]
  v_pk_mul_f32 v[34:35], v[34:35], v[26:27]
  v_pk_mul_f32 v[36:37], v[36:37], v[26:27]
  v_pk_mul_f32 v[38:39], v[38:39], v[26:27]
  v_cvt_pk_bf16_f32 v40, v32, v33
  v_cvt_pk_bf16_f32 v41, v34, v35
  v_cvt_pk_bf16_f32 v42, v36, v37
  v_cvt_pk_bf16_f32 v43, v38, v39
  v_accvgpr_write_b32 a192, v40
  v_accvgpr_write_b32 a193, v41
  v_accvgpr_write_b32 a194, v42
  v_accvgpr_write_b32 a195, v43
  s_add_u32 m0, s52, 0
  s_add_u32 s3, s4, 393216
  buffer_load_dwordx4 v8, s[12:15], s3 offen offset:0  lds
  s_waitcnt lgkmcnt(4)
  v_lshlrev_b32 v32, 16, v156
  v_and_b32 v33, s55, v156
  v_lshlrev_b32 v34, 16, v157
  v_and_b32 v35, s55, v157
  v_lshlrev_b32 v36, 16, v158
  v_and_b32 v37, s55, v158
  v_lshlrev_b32 v38, 16, v159
  v_and_b32 v39, s55, v159
  v_pk_mul_f32 v[32:33], v[32:33], v[26:27]
  v_pk_mul_f32 v[34:35], v[34:35], v[26:27]
  v_pk_mul_f32 v[36:37], v[36:37], v[26:27]
  v_pk_mul_f32 v[38:39], v[38:39], v[26:27]
  v_cvt_pk_bf16_f32 v40, v32, v33
  v_cvt_pk_bf16_f32 v41, v34, v35
  v_cvt_pk_bf16_f32 v42, v36, v37
  v_cvt_pk_bf16_f32 v43, v38, v39
  v_accvgpr_write_b32 a196, v40
  v_accvgpr_write_b32 a197, v41
  v_accvgpr_write_b32 a198, v42
  v_accvgpr_write_b32 a199, v43
  buffer_load_dwordx4 v9, s[12:15], s3 offen offset:1024  lds
  s_waitcnt lgkmcnt(3)
  v_lshlrev_b32 v32, 16, v160
  v_and_b32 v33, s55, v160
  v_lshlrev_b32 v34, 16, v161
  v_and_b32 v35, s55, v161
  v_lshlrev_b32 v36, 16, v162
  v_and_b32 v37, s55, v162
  v_lshlrev_b32 v38, 16, v163
  v_and_b32 v39, s55, v163
  v_pk_mul_f32 v[32:33], v[32:33], v[26:27]
  v_pk_mul_f32 v[34:35], v[34:35], v[26:27]
  v_pk_mul_f32 v[36:37], v[36:37], v[26:27]
  v_pk_mul_f32 v[38:39], v[38:39], v[26:27]
  v_cvt_pk_bf16_f32 v40, v32, v33
  v_cvt_pk_bf16_f32 v41, v34, v35
  v_cvt_pk_bf16_f32 v42, v36, v37
  v_cvt_pk_bf16_f32 v43, v38, v39
  v_accvgpr_write_b32 a200, v40
  v_accvgpr_write_b32 a201, v41
  v_accvgpr_write_b32 a202, v42
  v_accvgpr_write_b32 a203, v43
  buffer_load_dwordx4 v10, s[12:15], s3 offen offset:2048  lds
  s_waitcnt lgkmcnt(2)
  v_lshlrev_b32 v32, 16, v164
  v_and_b32 v33, s55, v164
  v_lshlrev_b32 v34, 16, v165
  v_and_b32 v35, s55, v165
  v_lshlrev_b32 v36, 16, v166
  v_and_b32 v37, s55, v166
  v_lshlrev_b32 v38, 16, v167
  v_and_b32 v39, s55, v167
  v_pk_mul_f32 v[32:33], v[32:33], v[26:27]
  v_pk_mul_f32 v[34:35], v[34:35], v[26:27]
  v_pk_mul_f32 v[36:37], v[36:37], v[26:27]
  v_pk_mul_f32 v[38:39], v[38:39], v[26:27]
  v_cvt_pk_bf16_f32 v40, v32, v33
  v_cvt_pk_bf16_f32 v41, v34, v35
  v_cvt_pk_bf16_f32 v42, v36, v37
  v_cvt_pk_bf16_f32 v43, v38, v39
  v_accvgpr_write_b32 a204, v40
  v_accvgpr_write_b32 a205, v41
  v_accvgpr_write_b32 a206, v42
  v_accvgpr_write_b32 a207, v43
  s_add_u32 m0, s51, 12288
  s_add_u32 s3, s4, 405504
  buffer_load_dwordx4 v8, s[8:11], s3 offen offset:0  lds
  s_waitcnt lgkmcnt(1)
  v_lshlrev_b32 v32, 16, v168
  v_and_b32 v33, s55, v168
  v_lshlrev_b32 v34, 16, v169
  v_and_b32 v35, s55, v169
  v_lshlrev_b32 v36, 16, v170
  v_and_b32 v37, s55, v170
  v_lshlrev_b32 v38, 16, v171
  v_and_b32 v39, s55, v171
  v_pk_mul_f32 v[32:33], v[32:33], v[26:27]
  v_pk_mul_f32 v[34:35], v[34:35], v[26:27]
  v_pk_mul_f32 v[36:37], v[36:37], v[26:27]
  v_pk_mul_f32 v[38:39], v[38:39], v[26:27]
  v_cvt_pk_bf16_f32 v40, v32, v33
  v_cvt_pk_bf16_f32 v41, v34, v35
  v_cvt_pk_bf16_f32 v42, v36, v37
  v_cvt_pk_bf16_f32 v43, v38, v39
  v_accvgpr_write_b32 a208, v40
  v_accvgpr_write_b32 a209, v41
  v_accvgpr_write_b32 a210, v42
  v_accvgpr_write_b32 a211, v43
  buffer_load_dwordx4 v9, s[8:11], s3 offen offset:1024  lds
  s_waitcnt lgkmcnt(0)
  v_lshlrev_b32 v32, 16, v172
  v_and_b32 v33, s55, v172
  v_lshlrev_b32 v34, 16, v173
  v_and_b32 v35, s55, v173
  v_lshlrev_b32 v36, 16, v174
  v_and_b32 v37, s55, v174
  v_lshlrev_b32 v38, 16, v175
  v_and_b32 v39, s55, v175
  v_pk_mul_f32 v[32:33], v[32:33], v[26:27]
  v_pk_mul_f32 v[34:35], v[34:35], v[26:27]
  v_pk_mul_f32 v[36:37], v[36:37], v[26:27]
  v_pk_mul_f32 v[38:39], v[38:39], v[26:27]
  v_cvt_pk_bf16_f32 v40, v32, v33
  v_cvt_pk_bf16_f32 v41, v34, v35
  v_cvt_pk_bf16_f32 v42, v36, v37
  v_cvt_pk_bf16_f32 v43, v38, v39
  v_accvgpr_write_b32 a212, v40
  v_accvgpr_write_b32 a213, v41
  v_accvgpr_write_b32 a214, v42
  v_accvgpr_write_b32 a215, v43
  s_waitcnt vmcnt(8)
  ds_read_b128 v[152:155], v22 offset:6144
  ds_read_b128 v[156:159], v23 offset:6144
  ds_read_b128 v[160:163], v22 offset:6272
  ds_read_b128 v[164:167], v23 offset:6272
  ds_read_b128 v[168:171], v22 offset:6400
  ds_read_b128 v[172:175], v23 offset:6400
  buffer_load_dwordx4 v10, s[8:11], s3 offen offset:2048  lds
  s_waitcnt lgkmcnt(5)
  v_lshlrev_b32 v32, 16, v152
  v_and_b32 v33, s55, v152
  v_lshlrev_b32 v34, 16, v153
  v_and_b32 v35, s55, v153
  v_lshlrev_b32 v36, 16, v154
  v_and_b32 v37, s55, v154
  v_lshlrev_b32 v38, 16, v155
  v_and_b32 v39, s55, v155
  v_pk_mul_f32 v[32:33], v[32:33], v[26:27]
  v_pk_mul_f32 v[34:35], v[34:35], v[26:27]
  v_pk_mul_f32 v[36:37], v[36:37], v[26:27]
  v_pk_mul_f32 v[38:39], v[38:39], v[26:27]
  v_cvt_pk_bf16_f32 v40, v32, v33
  v_cvt_pk_bf16_f32 v41, v34, v35
  v_cvt_pk_bf16_f32 v42, v36, v37
  v_cvt_pk_bf16_f32 v43, v38, v39
  v_accvgpr_write_b32 a216, v40
  v_accvgpr_write_b32 a217, v41
  v_accvgpr_write_b32 a218, v42
  v_accvgpr_write_b32 a219, v43
  s_waitcnt lgkmcnt(4)
  v_lshlrev_b32 v32, 16, v156
  v_and_b32 v33, s55, v156
  v_lshlrev_b32 v34, 16, v157
  v_and_b32 v35, s55, v157
  v_lshlrev_b32 v36, 16, v158
  v_and_b32 v37, s55, v158
  v_lshlrev_b32 v38, 16, v159
  v_and_b32 v39, s55, v159
  v_pk_mul_f32 v[32:33], v[32:33], v[26:27]
  v_pk_mul_f32 v[34:35], v[34:35], v[26:27]
  v_pk_mul_f32 v[36:37], v[36:37], v[26:27]
  v_pk_mul_f32 v[38:39], v[38:39], v[26:27]
  v_cvt_pk_bf16_f32 v40, v32, v33
  v_cvt_pk_bf16_f32 v41, v34, v35
  v_cvt_pk_bf16_f32 v42, v36, v37
  v_cvt_pk_bf16_f32 v43, v38, v39
  v_accvgpr_write_b32 a220, v40
  v_accvgpr_write_b32 a221, v41
  v_accvgpr_write_b32 a222, v42
  v_accvgpr_write_b32 a223, v43
  s_waitcnt lgkmcnt(3)
  v_lshlrev_b32 v32, 16, v160
  v_and_b32 v33, s55, v160
  v_lshlrev_b32 v34, 16, v161
  v_and_b32 v35, s55, v161
  v_lshlrev_b32 v36, 16, v162
  v_and_b32 v37, s55, v162
  v_lshlrev_b32 v38, 16, v163
  v_and_b32 v39, s55, v163
  v_pk_mul_f32 v[32:33], v[32:33], v[26:27]
  v_pk_mul_f32 v[34:35], v[34:35], v[26:27]
  v_pk_mul_f32 v[36:37], v[36:37], v[26:27]
  v_pk_mul_f32 v[38:39], v[38:39], v[26:27]
  v_cvt_pk_bf16_f32 v40, v32, v33
  v_cvt_pk_bf16_f32 v41, v34, v35
  v_cvt_pk_bf16_f32 v42, v36, v37
  v_cvt_pk_bf16_f32 v43, v38, v39
  v_accvgpr_write_b32 a224, v40
  v_accvgpr_write_b32 a225, v41
  v_accvgpr_write_b32 a226, v42
  v_accvgpr_write_b32 a227, v43
  s_waitcnt lgkmcnt(2)
  v_lshlrev_b32 v32, 16, v164
  v_and_b32 v33, s55, v164
  v_lshlrev_b32 v34, 16, v165
  v_and_b32 v35, s55, v165
  v_lshlrev_b32 v36, 16, v166
  v_and_b32 v37, s55, v166
  v_lshlrev_b32 v38, 16, v167
  v_and_b32 v39, s55, v167
  v_pk_mul_f32 v[32:33], v[32:33], v[26:27]
  v_pk_mul_f32 v[34:35], v[34:35], v[26:27]
  v_pk_mul_f32 v[36:37], v[36:37], v[26:27]
  v_pk_mul_f32 v[38:39], v[38:39], v[26:27]
  v_cvt_pk_bf16_f32 v40, v32, v33
  v_cvt_pk_bf16_f32 v41, v34, v35
  v_cvt_pk_bf16_f32 v42, v36, v37
  v_cvt_pk_bf16_f32 v43, v38, v39
  v_accvgpr_write_b32 a228, v40
  v_accvgpr_write_b32 a229, v41
  v_accvgpr_write_b32 a230, v42
  v_accvgpr_write_b32 a231, v43
  s_waitcnt lgkmcnt(1)
  v_lshlrev_b32 v32, 16, v168
  v_and_b32 v33, s55, v168
  v_lshlrev_b32 v34, 16, v169
  v_and_b32 v35, s55, v169
  v_lshlrev_b32 v36, 16, v170
  v_and_b32 v37, s55, v170
  v_lshlrev_b32 v38, 16, v171
  v_and_b32 v39, s55, v171
  v_pk_mul_f32 v[32:33], v[32:33], v[26:27]
  v_pk_mul_f32 v[34:35], v[34:35], v[26:27]
  v_pk_mul_f32 v[36:37], v[36:37], v[26:27]
  v_pk_mul_f32 v[38:39], v[38:39], v[26:27]
  v_cvt_pk_bf16_f32 v40, v32, v33
  v_cvt_pk_bf16_f32 v41, v34, v35
  v_cvt_pk_bf16_f32 v42, v36, v37
  v_cvt_pk_bf16_f32 v43, v38, v39
  v_accvgpr_write_b32 a232, v40
  v_accvgpr_write_b32 a233, v41
  v_accvgpr_write_b32 a234, v42
  v_accvgpr_write_b32 a235, v43
  s_waitcnt lgkmcnt(0)
  v_lshlrev_b32 v32, 16, v172
  v_and_b32 v33, s55, v172
  v_lshlrev_b32 v34, 16, v173
  v_and_b32 v35, s55, v173
  v_lshlrev_b32 v36, 16, v174
  v_and_b32 v37, s55, v174
  v_lshlrev_b32 v38, 16, v175
  v_and_b32 v39, s55, v175
  v_pk_mul_f32 v[32:33], v[32:33], v[26:27]
  v_pk_mul_f32 v[34:35], v[34:35], v[26:27]
  v_pk_mul_f32 v[36:37], v[36:37], v[26:27]
  v_pk_mul_f32 v[38:39], v[38:39], v[26:27]
  v_cvt_pk_bf16_f32 v40, v32, v33
  v_cvt_pk_bf16_f32 v41, v34, v35
  v_cvt_pk_bf16_f32 v42, v36, v37
  v_cvt_pk_bf16_f32 v43, v38, v39
  v_accvgpr_write_b32 a236, v40
  v_accvgpr_write_b32 a237, v41
  v_accvgpr_write_b32 a238, v42
  v_accvgpr_write_b32 a239, v43
  s_mov_b32 s32, 0
  s_waitcnt vmcnt(6)
  s_barrier
  s_mov_b32 s77, 32
  s_cmp_ge_u32 s77, s37
  s_cbranch_scc0 S0_NM
  s_call_b64 s[72:73], MASK_p2
S0_NM:
  s_mov_b32 s76, 32
  s_mov_b32 s77, 33
  s_mov_b32 s78, 34
  s_mov_b32 s79, 35
  v_readlane_b32 s74, v0, 4
  ds_read_b128 v[152:155], v2 offset:0
  ds_read_b128 v[156:159], v3 offset:0
  ds_read_b128 v[160:163], v2 offset:128
  ds_read_b128 v[164:167], v3 offset:128
  ds_read_b128 v[168:171], v2 offset:256
  ds_read_b128 v[172:175], v3 offset:256
  s_waitcnt lgkmcnt(5)
  v_mfma_f32_16x16x32_bf16 v[24:27], v[152:155], a[192:195], v[88:91]
  v_mfma_f32_16x16x32_bf16 v[28:31], v[152:155], a[216:219], v[92:95]
  s_add_u32 m0, s52, 12288
  s_add_u32 s3, s75, 405504
  buffer_load_dwordx4 v8, s[12:15], s3 offen offset:0  lds
  s_waitcnt lgkmcnt(4)
  v_mfma_f32_16x16x32_bf16 v[24:27], v[156:159], a[196:199], v[24:27]
  v_mfma_f32_16x16x32_bf16 v[28:31], v[156:159], a[220:223], v[28:31]
  s_add_u32 m0, s52, 12288
  s_add_u32 s3, s75, 405504
  buffer_load_dwordx4 v9, s[12:15], s3 offen offset:1024  lds
  s_waitcnt lgkmcnt(3)
  v_mfma_f32_16x16x32_bf16 v[24:27], v[160:163], a[200:203], v[24:27]
  v_mfma_f32_16x16x32_bf16 v[28:31], v[160:163], a[224:227], v[28:31]
  s_add_u32 m0, s52, 12288
  s_add_u32 s3, s75, 405504
  buffer_load_dwordx4 v10, s[12:15], s3 offen offset:2048  lds
  s_waitcnt lgkmcnt(2)
  v_mfma_f32_16x16x32_bf16 v[24:27], v[164:167], a[204:207], v[24:27]
  v_mfma_f32_16x16x32_bf16 v[28:31], v[164:167], a[228:231], v[28:31]
  s_add_u32 m0, s51, 24576
  s_add_u32 s3, s75, 417792
  buffer_load_dwordx4 v8, s[8:11], s3 offen offset:0  lds
  s_waitcnt lgkmcnt(1)
  v_mfma_f32_16x16x32_bf16 v[24:27], v[168:171], a[208:211], v[24:27]
  v_mfma_f32_16x16x32_bf16 v[28:31], v[168:171], a[232:235], v[28:31]
  s_add_u32 m0, s51, 24576
  s_add_u32 s3, s75, 417792
  buffer_load_dwordx4 v9, s[8:11], s3 offen offset:1024  lds
  s_waitcnt lgkmcnt(0)
  v_mfma_f32_16x16x32_bf16 v[24:27], v[172:175], a[212:215], v[24:27]
  v_mfma_f32_16x16x32_bf16 v[28:31], v[172:175], a[236:239], v[28:31]
  ds_read_b128 v[152:155], v2 offset:6144
  ds_read_b128 v[156:159], v3 offset:6144
  ds_read_b128 v[160:163], v2 offset:6272
  ds_read_b128 v[164:167], v3 offset:6272
  ds_read_b128 v[168:171], v2 offset:6400
  ds_read_b128 v[172:175], v3 offset:6400
  s_waitcnt lgkmcnt(5)
  v_mfma_f32_16x16x32_bf16 v[40:43], v[152:155], a[192:195], v[192:195]
  v_mfma_f32_16x16x32_bf16 v[44:47], v[152:155], a[216:219], v[196:199]
  s_add_u32 m0, s51, 24576
  s_add_u32 s3, s75, 417792
  buffer_load_dwordx4 v10, s[8:11], s3 offen offset:2048  lds
  s_waitcnt lgkmcnt(4)
  v_mfma_f32_16x16x32_bf16 v[40:43], v[156:159], a[196:199], v[40:43]
  v_mfma_f32_16x16x32_bf16 v[44:47], v[156:159], a[220:223], v[44:47]
  s_add_u32 m0, s51, 36864
  s_add_u32 s3, s75, 430080
  buffer_load_dwordx4 v8, s[8:11], s3 offen offset:0  lds
  s_waitcnt lgkmcnt(3)
  v_mfma_f32_16x16x32_bf16 v[40:43], v[160:163], a[200:203], v[40:43]
  v_mfma_f32_16x16x32_bf16 v[44:47], v[160:163], a[224:227], v[44:47]
  s_add_u32 m0, s51, 36864
  s_add_u32 s3, s75, 430080
  buffer_load_dwordx4 v9, s[8:11], s3 offen offset:1024  lds
  s_waitcnt lgkmcnt(2)
  v_mfma_f32_16x16x32_bf16 v[40:43], v[164:167], a[204:207], v[40:43]
  v_mfma_f32_16x16x32_bf16 v[44:47], v[164:167], a[228:231], v[44:47]
  s_add_u32 m0, s51, 36864
  s_add_u32 s3, s75, 430080
  buffer_load_dwordx4 v10, s[8:11], s3 offen offset:2048  lds
  s_waitcnt lgkmcnt(1)
  v_mfma_f32_16x16x32_bf16 v[40:43], v[168:171], a[208:211], v[40:43]
  v_mfma_f32_16x16x32_bf16 v[44:47], v[168:171], a[232:235], v[44:47]
  s_waitcnt lgkmcnt(0)
  v_mfma_f32_16x16x32_bf16 v[40:43], v[172:175], a[212:215], v[40:43]
  v_mfma_f32_16x16x32_bf16 v[44:47], v[172:175], a[236:239], v[44:47]
  s_waitcnt vmcnt(9)
  s_barrier
  s_mul_i32 s4, s74, 12288
  s_add_u32 s4, s4, s75
  ds_read_b128 v[152:155], v2 offset:12288
  ds_read_b128 v[156:159], v3 offset:12288
  ds_read_b128 v[160:163], v2 offset:12416
  ds_read_b128 v[164:167], v3 offset:12416
  s_nop 3
  v_max3_f32 v188, v24, v25, v26
  v_max3_f32 v188, v188, v27, v40
  v_max3_f32 v188, v188, v41, v42
  v_max_f32 v188, v188, v43
  v_mov_b32 v190, v188
  s_nop 1
  v_permlane16_swap_b32 v188, v190
  s_nop 1
  v_max_f32 v188, v188, v190
  v_mov_b32 v190, v188
  s_nop 1
  v_permlane32_swap_b32 v188, v190
  s_nop 1
  v_max_f32 v188, v188, v190
  s_add_u32 m0, s52, 24576
  s_add_u32 s3, s75, 417792
  buffer_load_dwordx4 v8, s[12:15], s3 offen offset:0  lds
  v_sub_f32 v24, v24, v188
  v_sub_f32 v25, v25, v188
  v_sub_f32 v26, v26, v188
  v_sub_f32 v27, v27, v188
  v_sub_f32 v40, v40, v188
  v_sub_f32 v41, v41, v188
  v_sub_f32 v42, v42, v188
  s_add_u32 m0, s52, 24576
  s_add_u32 s3, s75, 417792
  buffer_load_dwordx4 v9, s[12:15], s3 offen offset:1024  lds
  v_sub_f32 v43, v43, v188
  v_sub_f32 v118, 0, v188
  v_sub_f32 v88, 0, v188
  v_sub_f32 v89, 0, v188
  v_sub_f32 v90, 0, v188
  v_sub_f32 v91, 0, v188
  v_sub_f32 v192, 0, v188
  s_add_u32 m0, s52, 24576
  s_add_u32 s3, s75, 417792
  buffer_load_dwordx4 v10, s[12:15], s3 offen offset:2048  lds
  v_sub_f32 v193, 0, v188
  v_sub_f32 v194, 0, v188
  v_sub_f32 v195, 0, v188
  v_exp_f32 v184, v24
  v_exp_f32 v185, v25
  s_nop 0
  v_cvt_pk_bf16_f32 v56, v184, v185
  s_add_u32 m0, s51, 0
  s_nop 0
  buffer_load_dwordx4 v8, s[8:11], s4 offen offset:0 lds
  v_exp_f32 v184, v26
  v_exp_f32 v185, v27
  s_nop 0
  v_cvt_pk_bf16_f32 v57, v184, v185
  v_exp_f32 v184, v40
  v_exp_f32 v185, v41
  s_nop 0
  v_cvt_pk_bf16_f32 v58, v184, v185
  v_exp_f32 v184, v42
  v_exp_f32 v185, v43
  s_nop 0
  v_cvt_pk_bf16_f32 v59, v184, v185
  v_max3_f32 v188, v28, v29, v30
  v_max3_f32 v188, v188, v31, v44
  s_add_u32 m0, s51, 0
  s_nop 0
  buffer_load_dwordx4 v9, s[8:11], s4 offen offset:1024 lds
  v_max3_f32 v188, v188, v45, v46
  v_max_f32 v188, v188, v47
  v_mov_b32 v190, v188
  s_nop 1
  v_permlane16_swap_b32 v188, v190
  s_nop 1
  v_max_f32 v188, v188, v190
  s_add_u32 m0, s51, 0
  s_nop 0
  buffer_load_dwordx4 v10, s[8:11], s4 offen offset:2048 lds
  v_mov_b32 v190, v188
  s_nop 1
  v_permlane32_swap_b32 v188, v190
  s_nop 1
  v_max_f32 v188, v188, v190
  v_sub_f32 v28, v28, v188
  v_sub_f32 v29, v29, v188
  s_add_u32 m0, s53, 0
  s_add_u32 s35, s58, 0
  buffer_load_dwordx4 v8, s[16:19], s35 offen offset:0 nt lds
  v_sub_f32 v30, v30, v188
  v_sub_f32 v31, v31, v188
  v_sub_f32 v44, v44, v188
  v_sub_f32 v45, v45, v188
  v_sub_f32 v46, v46, v188
  v_sub_f32 v47, v47, v188
  v_sub_f32 v119, 0, v188
  s_add_u32 m0, s53, 0
  s_add_u32 s35, s58, 0
  buffer_load_dwordx4 v9, s[16:19], s35 offen offset:1024 nt lds
  v_sub_f32 v92, 0, v188
  v_sub_f32 v93, 0, v188
  v_sub_f32 v94, 0, v188
  v_sub_f32 v95, 0, v188
  v_sub_f32 v196, 0, v188
  v_sub_f32 v197, 0, v188
  v_sub_f32 v198, 0, v188
  s_add_u32 m0, s53, 0
  s_add_u32 s35, s58, 0
  buffer_load_dwordx4 v10, s[16:19], s35 offen offset:2048 nt lds
  v_sub_f32 v199, 0, v188
  v_exp_f32 v184, v28
  v_exp_f32 v185, v29
  s_nop 0
  v_cvt_pk_bf16_f32 v60, v184, v185
  v_exp_f32 v184, v30
  v_exp_f32 v185, v31
  s_nop 0
  v_cvt_pk_bf16_f32 v61, v184, v185
  v_exp_f32 v184, v44
  v_exp_f32 v185, v45
  s_nop 0
  v_cvt_pk_bf16_f32 v62, v184, v185
  v_exp_f32 v184, v46
  v_exp_f32 v185, v47
  s_nop 0
  v_cvt_pk_bf16_f32 v63, v184, v185
  s_add_u32 m0, s53, 3072
  s_add_u32 s35, s58, 3072
  buffer_load_dwordx4 v8, s[16:19], s35 offen offset:0 nt lds
  s_add_u32 m0, s53, 3072
  s_add_u32 s35, s58, 3072
  buffer_load_dwordx4 v9, s[16:19], s35 offen offset:1024 nt lds
  s_add_u32 m0, s53, 3072
  s_add_u32 s35, s58, 3072
  buffer_load_dwordx4 v10, s[16:19], s35 offen offset:2048 nt lds
  s_nop 1
  v_mfma_f32_16x16x32_bf16 v[104:107], v[112:115], v[56:59], v[104:107]
  v_mfma_f32_16x16x32_bf16 v[108:111], v[112:115], v[60:63], v[108:111]
  s_mov_b32 s32, 1
  s_cmp_ge_u32 s77, s37
  s_cbranch_scc0 S1_NM
  s_call_b64 s[72:73], MASK_p2
S1_NM:
  s_waitcnt lgkmcnt(2)
  v_mfma_f32_16x16x32_bf16 v[24:27], v[152:155], a[192:195], v[88:91]
  ds_read_b128 v[168:171], v2 offset:12544
  ds_read_b128 v[172:175], v3 offset:12544
  v_mfma_f32_16x16x32_bf16 v[28:31], v[152:155], a[216:219], v[92:95]
  s_mov_b32 s76, s77
  v_mfma_f32_16x16x32_bf16 v[24:27], v[156:159], a[196:199], v[24:27]
  ds_read_b128 v[176:179], v2 offset:18432
  v_mfma_f32_16x16x32_bf16 v[28:31], v[156:159], a[220:223], v[28:31]
  s_waitcnt lgkmcnt(3)
  s_mov_b32 s77, s78
  s_mov_b32 s78, s79
  v_mfma_f32_16x16x32_bf16 v[24:27], v[160:163], a[200:203], v[24:27]
  s_mov_b32 s79, s74
  s_add_u32 s40, s32, 4
  ds_read_b128 v[180:183], v3 offset:18432
  v_mfma_f32_16x16x32_bf16 v[28:31], v[160:163], a[224:227], v[28:31]
  ds_read_b128 v[152:155], v2 offset:18560
  v_mfma_f32_16x16x32_bf16 v[24:27], v[164:167], a[204:207], v[24:27]
  ds_read_b128 v[156:159], v3 offset:18560
  v_readlane_b32 s74, v0, s40
  v_mfma_f32_16x16x32_bf16 v[28:31], v[164:167], a[228:231], v[28:31]
  s_waitcnt lgkmcnt(4)
  v_mfma_f32_16x16x32_bf16 v[24:27], v[168:171], a[208:211], v[24:27]
  s_mul_i32 s7, s78, 12288
  ds_read_b128 v[160:163], v2 offset:18688
  v_mfma_f32_16x16x32_bf16 v[28:31], v[168:171], a[232:235], v[28:31]
  ds_read_b64_tr_b16 v[168:169], v4 offset:0
  v_mfma_f32_16x16x32_bf16 v[24:27], v[172:175], a[212:215], v[24:27]
  s_add_u32 s7, s7, s75
  ds_read_b64_tr_b16 v[170:171], v4 offset:6144
  v_mfma_f32_16x16x32_bf16 v[28:31], v[172:175], a[236:239], v[28:31]
  s_waitcnt lgkmcnt(5)
  ds_read_b64_tr_b16 v[172:173], v5 offset:0
  ds_read_b64_tr_b16 v[174:175], v5 offset:6144
  v_mfma_f32_16x16x32_bf16 v[40:43], v[176:179], a[192:195], v[192:195]
  v_mfma_f32_16x16x32_bf16 v[44:47], v[176:179], a[216:219], v[196:199]
  s_mul_i32 s6, s74, 12288
  ds_read_b128 v[164:167], v3 offset:18688
  ds_read_b64_tr_b16 v[176:177], v6 offset:0
  v_mfma_f32_16x16x32_bf16 v[40:43], v[180:183], a[196:199], v[40:43]
  s_add_u32 s6, s6, s75
  v_exp_f32 v184, v24
  v_mfma_f32_16x16x32_bf16 v[44:47], v[180:183], a[220:223], v[44:47]
  s_waitcnt lgkmcnt(7)
  v_exp_f32 v185, v25
  v_mfma_f32_16x16x32_bf16 v[40:43], v[152:155], a[200:203], v[40:43]
  ds_read_b64_tr_b16 v[178:179], v6 offset:6144
  ds_read_b64_tr_b16 v[180:181], v7 offset:0
  v_mfma_f32_16x16x32_bf16 v[44:47], v[152:155], a[224:227], v[44:47]
  v_exp_f32 v186, v26
  v_cvt_pk_bf16_f32 v72, v184, v185
  v_mfma_f32_16x16x32_bf16 v[40:43], v[156:159], a[204:207], v[40:43]
  v_exp_f32 v187, v27
  v_mfma_f32_16x16x32_bf16 v[44:47], v[156:159], a[228:231], v[44:47]
  s_waitcnt lgkmcnt(3)
  ds_read_b64_tr_b16 v[182:183], v7 offset:6144
  v_exp_f32 v188, v28
  v_cvt_pk_bf16_f32 v73, v186, v187
  v_mfma_f32_16x16x32_bf16 v[40:43], v[160:163], a[208:211], v[40:43]
  ds_read_b64_tr_b16 v[152:153], v4 offset:128
  v_exp_f32 v189, v29
  v_mfma_f32_16x16x32_bf16 v[44:47], v[160:163], a[232:235], v[44:47]
  v_exp_f32 v190, v30
  v_mfma_f32_16x16x32_bf16 v[40:43], v[164:167], a[212:215], v[40:43]
  s_waitcnt vmcnt(15)
  s_barrier
  v_cvt_pk_bf16_f32 v76, v188, v189
  v_mfma_f32_16x16x32_bf16 v[44:47], v[164:167], a[236:239], v[44:47]
  ds_read_b64_tr_b16 v[154:155], v4 offset:6272
  ds_read_b64_tr_b16 v[156:157], v5 offset:128
  v_mfma_f32_16x16x32_bf16 a[96:99], v[168:171], v[56:59], a[96:99]
  s_add_u32 m0, s51, 12288
  ds_read_b64_tr_b16 v[158:159], v5 offset:6272
  v_exp_f32 v191, v31
  v_mfma_f32_16x16x32_bf16 a[144:147], v[168:171], v[60:63], a[144:147]
  s_add_u32 s32, s32, 1
  ds_read_b64_tr_b16 v[160:161], v6 offset:128
  buffer_load_dwordx4 v8, s[8:11], s6 offen offset:0  lds
  v_mfma_f32_16x16x32_bf16 a[100:103], v[172:175], v[56:59], a[100:103]
  ds_read_b64_tr_b16 v[162:163], v6 offset:6272
  ds_read_b64_tr_b16 v[164:165], v7 offset:128
  v_mfma_f32_16x16x32_bf16 a[148:151], v[172:175], v[60:63], a[148:151]
  s_waitcnt lgkmcnt(7)
  ds_read_b64_tr_b16 v[166:167], v7 offset:6272
  v_cvt_pk_bf16_f32 v77, v190, v191
  v_mfma_f32_16x16x32_bf16 a[104:107], v[176:179], v[56:59], a[104:107]
  s_add_u32 m0, s51, 12288
  ds_read_b64_tr_b16 v[168:169], v4 offset:256
  v_exp_f32 v184, v40
  v_mfma_f32_16x16x32_bf16 a[152:155], v[176:179], v[60:63], a[152:155]
  buffer_load_dwordx4 v9, s[8:11], s6 offen offset:1024  lds
  v_mfma_f32_16x16x32_bf16 a[108:111], v[180:183], v[56:59], a[108:111]
  s_add_u32 m0, s51, 12288
  v_exp_f32 v185, v41
  v_mfma_f32_16x16x32_bf16 a[156:159], v[180:183], v[60:63], a[156:159]
  s_waitcnt lgkmcnt(5)
  ds_read_b64_tr_b16 v[170:171], v4 offset:6400
  v_exp_f32 v186, v42
  v_mfma_f32_16x16x32_bf16 a[112:115], v[152:155], v[56:59], a[112:115]
  ds_read_b64_tr_b16 v[172:173], v5 offset:256
  ds_read_b64_tr_b16 v[174:175], v5 offset:6400
  v_mfma_f32_16x16x32_bf16 a[160:163], v[152:155], v[60:63], a[160:163]
  buffer_load_dwordx4 v10, s[8:11], s6 offen offset:2048  lds
  v_cvt_pk_bf16_f32 v74, v184, v185
  v_mfma_f32_16x16x32_bf16 a[116:119], v[156:159], v[56:59], a[116:119]
  ds_read_b64_tr_b16 v[176:177], v6 offset:256
  v_exp_f32 v187, v43
  v_mfma_f32_16x16x32_bf16 a[164:167], v[156:159], v[60:63], a[164:167]
  s_waitcnt lgkmcnt(5)
  v_exp_f32 v188, v44
  v_mfma_f32_16x16x32_bf16 a[120:123], v[160:163], v[56:59], a[120:123]
  s_add_u32 m0, s52, 36864
  v_cvt_pk_bf16_f32 v75, v186, v187
  v_exp_f32 v189, v45
  v_mfma_f32_16x16x32_bf16 a[168:171], v[160:163], v[60:63], a[168:171]
  ds_read_b64_tr_b16 v[178:179], v6 offset:6400
  ds_read_b64_tr_b16 v[180:181], v7 offset:256
  buffer_load_dwordx4 v8, s[12:15], s7 offen offset:0  lds
  v_mfma_f32_16x16x32_bf16 a[124:127], v[164:167], v[56:59], a[124:127]
  ds_read_b64_tr_b16 v[182:183], v7 offset:6400
  v_exp_f32 v190, v46
  v_mfma_f32_16x16x32_bf16 a[172:175], v[164:167], v[60:63], a[172:175]
  s_waitcnt lgkmcnt(4)
  v_cvt_pk_bf16_f32 v78, v188, v189
  v_exp_f32 v191, v47
  v_mfma_f32_16x16x32_bf16 a[128:131], v[168:171], v[56:59], a[128:131]
  s_add_u32 m0, s52, 36864
  ds_read_b128 v[152:155], v2 offset:24576
  v_cvt_pk_bf16_f32 v79, v190, v191
  v_mfma_f32_16x16x32_bf16 a[176:179], v[168:171], v[60:63], a[176:179]
  buffer_load_dwordx4 v9, s[12:15], s7 offen offset:1024  lds
  v_mfma_f32_16x16x32_bf16 v[104:107], v[112:115], v[72:75], v[104:107]
  s_max_u32 s40, s76, s77
  v_mfma_f32_16x16x32_bf16 v[108:111], v[112:115], v[76:79], v[108:111]
  ds_read_b128 v[156:159], v3 offset:24576
  v_mfma_f32_16x16x32_bf16 a[132:135], v[172:175], v[56:59], a[132:135]
  s_cmp_ge_u32 s40, s37
  s_cselect_b64 s[66:67], -1, 0
  s_add_u32 m0, s52, 36864
  v_mfma_f32_16x16x32_bf16 a[180:183], v[172:175], v[60:63], a[180:183]
  s_waitcnt lgkmcnt(2)
  buffer_load_dwordx4 v10, s[12:15], s7 offen offset:2048  lds
  v_mfma_f32_16x16x32_bf16 a[136:139], v[176:179], v[56:59], a[136:139]
  ds_read_b128 v[160:163], v2 offset:24704
  v_mfma_f32_16x16x32_bf16 a[184:187], v[176:179], v[60:63], a[184:187]
  s_add_u32 m0, s53, 6144
  s_add_u32 s35, s58, 6144
  v_max_f32 v14, v104, v108
  v_mfma_f32_16x16x32_bf16 a[140:143], v[180:183], v[56:59], a[140:143]
  ds_read_b128 v[164:167], v3 offset:24704
  v_cmp_nge_f32 s[64:65], s50, v14
  v_mfma_f32_16x16x32_bf16 a[188:191], v[180:183], v[60:63], a[188:191]
  s_waitcnt lgkmcnt(2)
  buffer_load_dwordx4 v8, s[16:19], s35 offen offset:0 nt lds
  s_or_b64 vcc, s[64:65], s[66:67]
  s_cbranch_vccnz P2N0s0_SLOW
P2N0s0_SLOWB:
  v_mfma_f32_16x16x32_bf16 v[24:27], v[152:155], a[192:195], v[88:91]
  s_mov_b32 s76, s77
  ds_read_b128 v[168:171], v2 offset:24832
  ds_read_b128 v[172:175], v3 offset:24832
  v_mfma_f32_16x16x32_bf16 v[28:31], v[152:155], a[216:219], v[92:95]
  s_mov_b32 s77, s78
  s_add_u32 m0, s53, 6144
  s_add_u32 s35, s58, 6144
  v_mfma_f32_16x16x32_bf16 v[24:27], v[156:159], a[196:199], v[24:27]
  s_mov_b32 s78, s79
  s_mov_b32 s79, s74
  ds_read_b128 v[176:179], v2 offset:30720
  v_mfma_f32_16x16x32_bf16 v[28:31], v[156:159], a[220:223], v[28:31]
  s_waitcnt lgkmcnt(3)
  buffer_load_dwordx4 v9, s[16:19], s35 offen offset:1024 nt lds
  v_mfma_f32_16x16x32_bf16 v[24:27], v[160:163], a[200:203], v[24:27]
  s_add_u32 s40, s32, 4
  ds_read_b128 v[180:183], v3 offset:30720
  v_mfma_f32_16x16x32_bf16 v[28:31], v[160:163], a[224:227], v[28:31]
  s_add_u32 m0, s53, 6144
  s_add_u32 s35, s58, 6144
  ds_read_b128 v[152:155], v2 offset:30848
  v_mfma_f32_16x16x32_bf16 v[24:27], v[164:167], a[204:207], v[24:27]
  ds_read_b128 v[156:159], v3 offset:30848
  v_readlane_b32 s74, v0, s40
  v_mfma_f32_16x16x32_bf16 v[28:31], v[164:167], a[228:231], v[28:31]
  s_waitcnt lgkmcnt(4)
  buffer_load_dwordx4 v10, s[16:19], s35 offen offset:2048 nt lds
  v_mfma_f32_16x16x32_bf16 v[24:27], v[168:171], a[208:211], v[24:27]
  s_add_u32 m0, s53, 9216
  s_add_u32 s35, s58, 9216
  ds_read_b128 v[160:163], v2 offset:30976
  v_mfma_f32_16x16x32_bf16 v[28:31], v[168:171], a[232:235], v[28:31]
  ds_read_b64_tr_b16 v[168:169], v4 offset:12288
  v_mfma_f32_16x16x32_bf16 v[24:27], v[172:175], a[212:215], v[24:27]
  ds_read_b128 v[164:167], v3 offset:30976
  ds_read_b64_tr_b16 v[170:171], v4 offset:18432
  v_mfma_f32_16x16x32_bf16 v[28:31], v[172:175], a[236:239], v[28:31]
  s_waitcnt lgkmcnt(6)
  buffer_load_dwordx4 v8, s[16:19], s35 offen offset:0 nt lds
  v_mfma_f32_16x16x32_bf16 v[40:43], v[176:179], a[192:195], v[192:195]
  s_add_u32 m0, s53, 9216
  s_add_u32 s35, s58, 9216
  ds_read_b64_tr_b16 v[172:173], v5 offset:12288
  v_mfma_f32_16x16x32_bf16 v[44:47], v[176:179], a[216:219], v[196:199]
  ds_read_b64_tr_b16 v[174:175], v5 offset:18432
  ds_read_b64_tr_b16 v[176:177], v6 offset:12288
  v_mfma_f32_16x16x32_bf16 v[40:43], v[180:183], a[196:199], v[40:43]
  s_mul_i32 s63, s78, 12288
  ds_read_b64_tr_b16 v[178:179], v6 offset:18432
  v_exp_f32 v184, v24
  v_exp_f32 v185, v25
  v_mfma_f32_16x16x32_bf16 v[44:47], v[180:183], a[220:223], v[44:47]
  s_waitcnt lgkmcnt(8)
  ds_read_b64_tr_b16 v[180:181], v7 offset:12288
  buffer_load_dwordx4 v9, s[16:19], s35 offen offset:1024 nt lds
  v_exp_f32 v186, v26
  v_mfma_f32_16x16x32_bf16 v[40:43], v[152:155], a[200:203], v[40:43]
  s_add_u32 s63, s63, s75
  v_cvt_pk_bf16_f32 v56, v184, v185
  v_exp_f32 v187, v27
  v_mfma_f32_16x16x32_bf16 v[44:47], v[152:155], a[224:227], v[44:47]
  ds_read_b64_tr_b16 v[182:183], v7 offset:18432
  v_exp_f32 v188, v28
  v_cvt_pk_bf16_f32 v57, v186, v187
  v_mfma_f32_16x16x32_bf16 v[40:43], v[156:159], a[204:207], v[40:43]
  s_add_u32 m0, s53, 9216
  s_add_u32 s35, s58, 9216
  v_exp_f32 v189, v29
  v_mfma_f32_16x16x32_bf16 v[44:47], v[156:159], a[228:231], v[44:47]
  s_waitcnt lgkmcnt(7)
  ds_read_b64_tr_b16 v[152:153], v4 offset:12416
  ds_read_b64_tr_b16 v[154:155], v4 offset:18560
  v_mfma_f32_16x16x32_bf16 v[40:43], v[160:163], a[208:211], v[40:43]
  s_mul_i32 s62, s74, 12288
  buffer_load_dwordx4 v10, s[16:19], s35 offen offset:2048 nt lds
  v_mfma_f32_16x16x32_bf16 v[44:47], v[160:163], a[232:235], v[44:47]
  s_add_u32 s62, s62, s75
  v_exp_f32 v190, v30
  v_mfma_f32_16x16x32_bf16 v[40:43], v[164:167], a[212:215], v[40:43]
  s_waitcnt vmcnt(18)
  s_barrier
  v_cvt_pk_bf16_f32 v60, v188, v189
  v_mfma_f32_16x16x32_bf16 v[44:47], v[164:167], a[236:239], v[44:47]
  s_waitcnt lgkmcnt(6)
  v_exp_f32 v191, v31
  v_mfma_f32_16x16x32_bf16 a[96:99], v[168:171], v[72:75], a[96:99]
  s_add_u32 m0, s51, 24576
  ds_read_b64_tr_b16 v[156:157], v5 offset:12416
  ds_read_b64_tr_b16 v[158:159], v5 offset:18560
  ds_read_b64_tr_b16 v[160:161], v6 offset:12416
  v_mfma_f32_16x16x32_bf16 a[144:147], v[168:171], v[76:79], a[144:147]
  s_add_u32 s32, s32, 1
  buffer_load_dwordx4 v8, s[8:11], s62 offen offset:0  lds
  v_mfma_f32_16x16x32_bf16 a[100:103], v[172:175], v[72:75], a[100:103]
  s_add_u32 m0, s51, 24576
  ds_read_b64_tr_b16 v[162:163], v6 offset:18560
  v_cvt_pk_bf16_f32 v61, v190, v191
  v_mfma_f32_16x16x32_bf16 a[148:151], v[172:175], v[76:79], a[148:151]
  s_waitcnt lgkmcnt(6)
  v_exp_f32 v184, v40
  v_mfma_f32_16x16x32_bf16 a[104:107], v[176:179], v[72:75], a[104:107]
  ds_read_b64_tr_b16 v[164:165], v7 offset:12416
  v_exp_f32 v185, v41
  v_mfma_f32_16x16x32_bf16 a[152:155], v[176:179], v[76:79], a[152:155]
  ds_read_b64_tr_b16 v[166:167], v7 offset:18560
  buffer_load_dwordx4 v9, s[8:11], s62 offen offset:1024  lds
  v_mfma_f32_16x16x32_bf16 a[108:111], v[180:183], v[72:75], a[108:111]
  ds_read_b64_tr_b16 v[168:169], v4 offset:12544
  ds_read_b64_tr_b16 v[170:171], v4 offset:18688
  v_mfma_f32_16x16x32_bf16 a[156:159], v[180:183], v[76:79], a[156:159]
  s_waitcnt lgkmcnt(6)
  v_exp_f32 v186, v42
  v_mfma_f32_16x16x32_bf16 a[112:115], v[152:155], v[72:75], a[112:115]
  s_add_u32 m0, s51, 24576
  ds_read_b64_tr_b16 v[172:173], v5 offset:12544
  v_cvt_pk_bf16_f32 v58, v184, v185
  v_exp_f32 v187, v43
  v_mfma_f32_16x16x32_bf16 a[160:163], v[152:155], v[76:79], a[160:163]
  ds_read_b64_tr_b16 v[174:175], v5 offset:18688
  buffer_load_dwordx4 v10, s[8:11], s62 offen offset:2048  lds
  v_mfma_f32_16x16x32_bf16 a[116:119], v[156:159], v[72:75], a[116:119]
  v_exp_f32 v188, v44
  v_mfma_f32_16x16x32_bf16 a[164:167], v[156:159], v[76:79], a[164:167]
  s_waitcnt lgkmcnt(4)
  ds_read_b64_tr_b16 v[176:177], v6 offset:12544
  v_cvt_pk_bf16_f32 v59, v186, v187
  v_mfma_f32_16x16x32_bf16 a[120:123], v[160:163], v[72:75], a[120:123]
  v_exp_f32 v189, v45
  v_mfma_f32_16x16x32_bf16 a[168:171], v[160:163], v[76:79], a[168:171]
  v_exp_f32 v190, v46
  v_cvt_pk_bf16_f32 v62, v188, v189
  v_mfma_f32_16x16x32_bf16 a[124:127], v[164:167], v[72:75], a[124:127]
  ds_read_b64_tr_b16 v[178:179], v6 offset:18688
  ds_read_b64_tr_b16 v[180:181], v7 offset:12544
  ds_read_b64_tr_b16 v[182:183], v7 offset:18688
  v_mfma_f32_16x16x32_bf16 a[172:175], v[164:167], v[76:79], a[172:175]
  s_waitcnt lgkmcnt(4)
  v_exp_f32 v191, v47
  v_mfma_f32_16x16x32_bf16 a[128:131], v[168:171], v[72:75], a[128:131]
  s_add_u32 m0, s52, 0
  ds_read_b128 v[152:155], v2 offset:36864
  v_cvt_pk_bf16_f32 v63, v190, v191
  v_mfma_f32_16x16x32_bf16 a[176:179], v[168:171], v[76:79], a[176:179]
  s_max_u32 s40, s76, s77
  buffer_load_dwordx4 v8, s[12:15], s63 offen offset:0  lds
  v_mfma_f32_16x16x32_bf16 v[104:107], v[112:115], v[56:59], v[104:107]
  ds_read_b128 v[156:159], v3 offset:36864
  v_mfma_f32_16x16x32_bf16 v[108:111], v[112:115], v[60:63], v[108:111]
  s_cmp_ge_u32 s40, s37
  s_cselect_b64 s[66:67], -1, 0
  s_add_u32 m0, s52, 0
  v_mfma_f32_16x16x32_bf16 a[132:135], v[172:175], v[72:75], a[132:135]
  ds_read_b128 v[160:163], v2 offset:36992
  v_mfma_f32_16x16x32_bf16 a[180:183], v[172:175], v[76:79], a[180:183]
  s_waitcnt lgkmcnt(3)
  buffer_load_dwordx4 v9, s[12:15], s63 offen offset:1024  lds
  v_mfma_f32_16x16x32_bf16 a[136:139], v[176:179], v[72:75], a[136:139]
  s_add_u32 m0, s52, 0
  v_mfma_f32_16x16x32_bf16 a[184:187], v[176:179], v[76:79], a[184:187]
  v_max_f32 v14, v104, v108
  v_cmp_nge_f32 s[64:65], s50, v14
  v_mfma_f32_16x16x32_bf16 a[140:143], v[180:183], v[72:75], a[140:143]
  ds_read_b128 v[164:167], v3 offset:36992
  v_mfma_f32_16x16x32_bf16 a[188:191], v[180:183], v[76:79], a[188:191]
  buffer_load_dwordx4 v10, s[12:15], s63 offen offset:2048  lds
  s_or_b64 vcc, s[64:65], s[66:67]
  s_cbranch_vccnz P2N0s1_SLOW
P2N0s1_SLOWB:
  s_waitcnt vmcnt(6) lgkmcnt(0)
  v_add_u32 v16, s53, v2
  v_xor_b32 v17, 64, v16
  v_mov_b32 v22, s54
  v_mov_b32 v23, s54
  ds_read_b128 v[168:171], v16 offset:0
  ds_read_b128 v[172:175], v17 offset:0
  ds_read_b128 v[176:179], v16 offset:128
  ds_read_b128 v[180:183], v17 offset:128
  s_waitcnt lgkmcnt(3)
  v_lshlrev_b32 v32, 16, v168
  v_and_b32 v33, s55, v168
  v_lshlrev_b32 v34, 16, v169
  v_and_b32 v35, s55, v169
  v_lshlrev_b32 v36, 16, v170
  v_and_b32 v37, s55, v170
  v_lshlrev_b32 v38, 16, v171
  v_and_b32 v39, s55, v171
  v_pk_mul_f32 v[32:33], v[32:33], v[22:23]
  v_pk_mul_f32 v[34:35], v[34:35], v[22:23]
  v_pk_mul_f32 v[36:37], v[36:37], v[22:23]
  v_pk_mul_f32 v[38:39], v[38:39], v[22:23]
  v_cvt_pk_bf16_f32 v18, v32, v33
  v_cvt_pk_bf16_f32 v19, v34, v35
  v_cvt_pk_bf16_f32 v20, v36, v37
  v_cvt_pk_bf16_f32 v21, v38, v39
  v_accvgpr_write_b32 a240, v18
  v_accvgpr_write_b32 a241, v19
  v_accvgpr_write_b32 a242, v20
  v_accvgpr_write_b32 a243, v21
  s_waitcnt lgkmcnt(2)
  v_lshlrev_b32 v32, 16, v172
  v_and_b32 v33, s55, v172
  v_lshlrev_b32 v34, 16, v173
  v_and_b32 v35, s55, v173
  v_lshlrev_b32 v36, 16, v174
  v_and_b32 v37, s55, v174
  v_lshlrev_b32 v38, 16, v175
  v_and_b32 v39, s55, v175
  v_pk_mul_f32 v[32:33], v[32:33], v[22:23]
  v_pk_mul_f32 v[34:35], v[34:35], v[22:23]
  v_pk_mul_f32 v[36:37], v[36:37], v[22:23]
  v_pk_mul_f32 v[38:39], v[38:39], v[22:23]
  v_cvt_pk_bf16_f32 v18, v32, v33
  v_cvt_pk_bf16_f32 v19, v34, v35
  v_cvt_pk_bf16_f32 v20, v36, v37
  v_cvt_pk_bf16_f32 v21, v38, v39
  v_accvgpr_write_b32 a244, v18
  v_accvgpr_write_b32 a245, v19
  v_accvgpr_write_b32 a246, v20
  v_accvgpr_write_b32 a247, v21
  s_waitcnt lgkmcnt(1)
  v_lshlrev_b32 v32, 16, v176
  v_and_b32 v33, s55, v176
  v_lshlrev_b32 v34, 16, v177
  v_and_b32 v35, s55, v177
  v_lshlrev_b32 v36, 16, v178
  v_and_b32 v37, s55, v178
  v_lshlrev_b32 v38, 16, v179
  v_and_b32 v39, s55, v179
  v_pk_mul_f32 v[32:33], v[32:33], v[22:23]
  v_pk_mul_f32 v[34:35], v[34:35], v[22:23]
  v_pk_mul_f32 v[36:37], v[36:37], v[22:23]
  v_pk_mul_f32 v[38:39], v[38:39], v[22:23]
  v_cvt_pk_bf16_f32 v18, v32, v33
  v_cvt_pk_bf16_f32 v19, v34, v35
  v_cvt_pk_bf16_f32 v20, v36, v37
  v_cvt_pk_bf16_f32 v21, v38, v39
  v_accvgpr_write_b32 a248, v18
  v_accvgpr_write_b32 a249, v19
  v_accvgpr_write_b32 a250, v20
  v_accvgpr_write_b32 a251, v21
  s_waitcnt lgkmcnt(0)
  v_lshlrev_b32 v32, 16, v180
  v_and_b32 v33, s55, v180
  v_lshlrev_b32 v34, 16, v181
  v_and_b32 v35, s55, v181
  v_lshlrev_b32 v36, 16, v182
  v_and_b32 v37, s55, v182
  v_lshlrev_b32 v38, 16, v183
  v_and_b32 v39, s55, v183
  v_pk_mul_f32 v[32:33], v[32:33], v[22:23]
  v_pk_mul_f32 v[34:35], v[34:35], v[22:23]
  v_pk_mul_f32 v[36:37], v[36:37], v[22:23]
  v_pk_mul_f32 v[38:39], v[38:39], v[22:23]
  v_cvt_pk_bf16_f32 v18, v32, v33
  v_cvt_pk_bf16_f32 v19, v34, v35
  v_cvt_pk_bf16_f32 v20, v36, v37
  v_cvt_pk_bf16_f32 v21, v38, v39
  v_accvgpr_write_b32 a252, v18
  v_accvgpr_write_b32 a253, v19
  v_accvgpr_write_b32 a254, v20
  v_accvgpr_write_b32 a255, v21
  ds_read_b128 v[168:171], v16 offset:256
  ds_read_b128 v[172:175], v17 offset:256
  s_waitcnt lgkmcnt(1)
  v_lshlrev_b32 v32, 16, v168
  v_and_b32 v33, s55, v168
  v_lshlrev_b32 v34, 16, v169
  v_and_b32 v35, s55, v169
  v_lshlrev_b32 v36, 16, v170
  v_and_b32 v37, s55, v170
  v_lshlrev_b32 v38, 16, v171
  v_and_b32 v39, s55, v171
  v_pk_mul_f32 v[32:33], v[32:33], v[22:23]
  v_pk_mul_f32 v[34:35], v[34:35], v[22:23]
  v_pk_mul_f32 v[36:37], v[36:37], v[22:23]
  v_pk_mul_f32 v[38:39], v[38:39], v[22:23]
  v_cvt_pk_bf16_f32 v120, v32, v33
  v_cvt_pk_bf16_f32 v121, v34, v35
  v_cvt_pk_bf16_f32 v122, v36, v37
  v_cvt_pk_bf16_f32 v123, v38, v39
  s_waitcnt lgkmcnt(0)
  v_lshlrev_b32 v32, 16, v172
  v_and_b32 v33, s55, v172
  v_lshlrev_b32 v34, 16, v173
  v_and_b32 v35, s55, v173
  v_lshlrev_b32 v36, 16, v174
  v_and_b32 v37, s55, v174
  v_lshlrev_b32 v38, 16, v175
  v_and_b32 v39, s55, v175
  v_pk_mul_f32 v[32:33], v[32:33], v[22:23]
  v_pk_mul_f32 v[34:35], v[34:35], v[22:23]
  v_pk_mul_f32 v[36:37], v[36:37], v[22:23]
  v_pk_mul_f32 v[38:39], v[38:39], v[22:23]
  v_cvt_pk_bf16_f32 v124, v32, v33
  v_cvt_pk_bf16_f32 v125, v34, v35
  v_cvt_pk_bf16_f32 v126, v36, v37
  v_cvt_pk_bf16_f32 v127, v38, v39
  v_mov_b32 v22, s54
  v_mov_b32 v23, s54
  ds_read_b128 v[168:171], v16 offset:6144
  ds_read_b128 v[172:175], v17 offset:6144
  ds_read_b128 v[176:179], v16 offset:6272
  ds_read_b128 v[180:183], v17 offset:6272
  s_waitcnt lgkmcnt(3)
  v_lshlrev_b32 v32, 16, v168
  v_and_b32 v33, s55, v168
  v_lshlrev_b32 v34, 16, v169
  v_and_b32 v35, s55, v169
  v_lshlrev_b32 v36, 16, v170
  v_and_b32 v37, s55, v170
  v_lshlrev_b32 v38, 16, v171
  v_and_b32 v39, s55, v171
  v_pk_mul_f32 v[32:33], v[32:33], v[22:23]
  v_pk_mul_f32 v[34:35], v[34:35], v[22:23]
  v_pk_mul_f32 v[36:37], v[36:37], v[22:23]
  v_pk_mul_f32 v[38:39], v[38:39], v[22:23]
  v_cvt_pk_bf16_f32 v128, v32, v33
  v_cvt_pk_bf16_f32 v129, v34, v35
  v_cvt_pk_bf16_f32 v130, v36, v37
  v_cvt_pk_bf16_f32 v131, v38, v39
  s_waitcnt lgkmcnt(2)
  v_lshlrev_b32 v32, 16, v172
  v_and_b32 v33, s55, v172
  v_lshlrev_b32 v34, 16, v173
  v_and_b32 v35, s55, v173
  v_lshlrev_b32 v36, 16, v174
  v_and_b32 v37, s55, v174
  v_lshlrev_b32 v38, 16, v175
  v_and_b32 v39, s55, v175
  v_pk_mul_f32 v[32:33], v[32:33], v[22:23]
  v_pk_mul_f32 v[34:35], v[34:35], v[22:23]
  v_pk_mul_f32 v[36:37], v[36:37], v[22:23]
  v_pk_mul_f32 v[38:39], v[38:39], v[22:23]
  v_cvt_pk_bf16_f32 v132, v32, v33
  v_cvt_pk_bf16_f32 v133, v34, v35
  v_cvt_pk_bf16_f32 v134, v36, v37
  v_cvt_pk_bf16_f32 v135, v38, v39
  s_waitcnt lgkmcnt(1)
  v_lshlrev_b32 v32, 16, v176
  v_and_b32 v33, s55, v176
  v_lshlrev_b32 v34, 16, v177
  v_and_b32 v35, s55, v177
  v_lshlrev_b32 v36, 16, v178
  v_and_b32 v37, s55, v178
  v_lshlrev_b32 v38, 16, v179
  v_and_b32 v39, s55, v179
  v_pk_mul_f32 v[32:33], v[32:33], v[22:23]
  v_pk_mul_f32 v[34:35], v[34:35], v[22:23]
  v_pk_mul_f32 v[36:37], v[36:37], v[22:23]
  v_pk_mul_f32 v[38:39], v[38:39], v[22:23]
  v_cvt_pk_bf16_f32 v136, v32, v33
  v_cvt_pk_bf16_f32 v137, v34, v35
  v_cvt_pk_bf16_f32 v138, v36, v37
  v_cvt_pk_bf16_f32 v139, v38, v39
  s_waitcnt lgkmcnt(0)
  v_lshlrev_b32 v32, 16, v180
  v_and_b32 v33, s55, v180
  v_lshlrev_b32 v34, 16, v181
  v_and_b32 v35, s55, v181
  v_lshlrev_b32 v36, 16, v182
  v_and_b32 v37, s55, v182
  v_lshlrev_b32 v38, 16, v183
  v_and_b32 v39, s55, v183
  v_pk_mul_f32 v[32:33], v[32:33], v[22:23]
  v_pk_mul_f32 v[34:35], v[34:35], v[22:23]
  v_pk_mul_f32 v[36:37], v[36:37], v[22:23]
  v_pk_mul_f32 v[38:39], v[38:39], v[22:23]
  v_cvt_pk_bf16_f32 v140, v32, v33
  v_cvt_pk_bf16_f32 v141, v34, v35
  v_cvt_pk_bf16_f32 v142, v36, v37
  v_cvt_pk_bf16_f32 v143, v38, v39
  ds_read_b128 v[168:171], v16 offset:6400
  ds_read_b128 v[172:175], v17 offset:6400
  s_waitcnt lgkmcnt(1)
  v_lshlrev_b32 v32, 16, v168
  v_and_b32 v33, s55, v168
  v_lshlrev_b32 v34, 16, v169
  v_and_b32 v35, s55, v169
  v_lshlrev_b32 v36, 16, v170
  v_and_b32 v37, s55, v170
  v_lshlrev_b32 v38, 16, v171
  v_and_b32 v39, s55, v171
  v_pk_mul_f32 v[32:33], v[32:33], v[22:23]
  v_pk_mul_f32 v[34:35], v[34:35], v[22:23]
  v_pk_mul_f32 v[36:37], v[36:37], v[22:23]
  v_pk_mul_f32 v[38:39], v[38:39], v[22:23]
  v_cvt_pk_bf16_f32 v144, v32, v33
  v_cvt_pk_bf16_f32 v145, v34, v35
  v_cvt_pk_bf16_f32 v146, v36, v37
  v_cvt_pk_bf16_f32 v147, v38, v39
  s_waitcnt lgkmcnt(0)
  v_lshlrev_b32 v32, 16, v172
  v_and_b32 v33, s55, v172
  v_lshlrev_b32 v34, 16, v173
  v_and_b32 v35, s55, v173
  v_lshlrev_b32 v36, 16, v174
  v_and_b32 v37, s55, v174
  v_lshlrev_b32 v38, 16, v175
  v_and_b32 v39, s55, v175
  v_pk_mul_f32 v[32:33], v[32:33], v[22:23]
  v_pk_mul_f32 v[34:35], v[34:35], v[22:23]
  v_pk_mul_f32 v[36:37], v[36:37], v[22:23]
  v_pk_mul_f32 v[38:39], v[38:39], v[22:23]
  v_cvt_pk_bf16_f32 v148, v32, v33
  v_cvt_pk_bf16_f32 v149, v34, v35
  v_cvt_pk_bf16_f32 v150, v36, v37
  v_cvt_pk_bf16_f32 v151, v38, v39
  s_mov_b32 s16, s68
  s_and_b32 s17, s69, 0xffff
  s_or_b32 s17, s17, 0x01800000
  s_mov_b32 s18, 2048
  s_mov_b32 s19, 0x20000
  s_mov_b32 s68, s70
  s_and_b32 s69, s71, 0xffff
  s_mov_b32 s70, 786432
  s_mov_b32 s71, 0x20000
  s_mul_i32 s97, s29, 98304
  s_mul_i32 s5, s28, 24576
  s_add_u32 s97, s97, s5
  s_mov_b32 s96, 0
  ds_read_b32 v200, v1 offset:0
  ds_read_b32 v202, v1 offset:32
  ds_read_b32 v204, v1 offset:64
  ds_read_b32 v206, v1 offset:96
  s_waitcnt lgkmcnt(0)
  s_add_u32 m0, s53, 0
  s_nop 0
  buffer_load_dwordx4 v[200:201], s[16:19], 0 idxen offen lds
  s_add_u32 m0, s53, 1024
  s_nop 0
  buffer_load_dwordx4 v[202:203], s[16:19], 0 idxen offen lds
  s_add_u32 m0, s53, 2048
  s_nop 0
  buffer_load_dwordx4 v[204:205], s[16:19], 0 idxen offen lds
  s_add_u32 m0, s53, 3072
  s_nop 0
  buffer_load_dwordx4 v[206:207], s[16:19], 0 idxen offen lds
  s_add_u32 m0, s53, 4096
  s_nop 0
  buffer_load_dwordx4 v[200:201], s[16:19], s60 idxen offen lds
  s_add_u32 m0, s53, 5120
  s_nop 0
  buffer_load_dwordx4 v[202:203], s[16:19], s60 idxen offen lds
  s_add_u32 m0, s53, 6144
  s_nop 0
  buffer_load_dwordx4 v[204:205], s[16:19], s60 idxen offen lds
  s_add_u32 m0, s53, 7168
  s_nop 0
  buffer_load_dwordx4 v[206:207], s[16:19], s60 idxen offen lds
  s_call_b64 s[72:73], CPQ_0
  s_waitcnt lgkmcnt(2)
  v_mfma_f32_16x16x32_bf16 v[24:27], v[152:155], a[192:195], v[88:91]
  ds_read_b128 v[168:171], v2 offset:37120
  ds_read_b128 v[172:175], v3 offset:37120
  v_mfma_f32_16x16x32_bf16 v[28:31], v[152:155], a[216:219], v[92:95]
  v_mfma_f32_16x16x32_bf16 v[24:27], v[156:159], a[196:199], v[24:27]
  ds_read_b128 v[176:179], v2 offset:43008
  v_mfma_f32_16x16x32_bf16 v[28:31], v[156:159], a[220:223], v[28:31]
  s_waitcnt lgkmcnt(3)
  s_mov_b32 s76, s77
  s_mov_b32 s77, s78
  v_mfma_f32_16x16x32_bf16 v[24:27], v[160:163], a[200:203], v[24:27]
  s_mov_b32 s78, s79
  ds_read_b128 v[180:183], v3 offset:43008
  v_mfma_f32_16x16x32_bf16 v[28:31], v[160:163], a[224:227], v[28:31]
  s_mov_b32 s79, s74
  ds_read_b128 v[152:155], v2 offset:43136
  v_mfma_f32_16x16x32_bf16 v[24:27], v[164:167], a[204:207], v[24:27]
  s_add_u32 s40, s32, 4
  v_mfma_f32_16x16x32_bf16 v[28:31], v[164:167], a[228:231], v[28:31]
  s_waitcnt lgkmcnt(3)
  ds_read_b128 v[156:159], v3 offset:43136
  v_readlane_b32 s74, v0, s40
  v_mfma_f32_16x16x32_bf16 v[24:27], v[168:171], a[208:211], v[24:27]
  s_mul_i32 s7, s78, 12288
  s_add_u32 s7, s7, s75
  ds_read_b128 v[160:163], v2 offset:43264
  v_mfma_f32_16x16x32_bf16 v[28:31], v[168:171], a[232:235], v[28:31]
  ds_read_b64_tr_b16 v[168:169], v4 offset:24576
  v_mfma_f32_16x16x32_bf16 v[24:27], v[172:175], a[212:215], v[24:27]
  ds_read_b64_tr_b16 v[170:171], v4 offset:30720
  v_mfma_f32_16x16x32_bf16 v[28:31], v[172:175], a[236:239], v[28:31]
  s_waitcnt lgkmcnt(5)
  ds_read_b128 v[164:167], v3 offset:43264
  v_mfma_f32_16x16x32_bf16 v[40:43], v[176:179], a[192:195], v[192:195]
  ds_read_b64_tr_b16 v[172:173], v5 offset:24576
  v_mfma_f32_16x16x32_bf16 v[44:47], v[176:179], a[216:219], v[196:199]
  ds_read_b64_tr_b16 v[174:175], v5 offset:30720
  ds_read_b64_tr_b16 v[176:177], v6 offset:24576
  v_mfma_f32_16x16x32_bf16 v[40:43], v[180:183], a[196:199], v[40:43]
  v_exp_f32 v184, v24
  v_mfma_f32_16x16x32_bf16 v[44:47], v[180:183], a[220:223], v[44:47]
  s_waitcnt lgkmcnt(7)
  ds_read_b64_tr_b16 v[178:179], v6 offset:30720
  ds_read_b64_tr_b16 v[180:181], v7 offset:24576
  v_mfma_f32_16x16x32_bf16 v[40:43], v[152:155], a[200:203], v[40:43]
  s_mul_i32 s6, s74, 12288
  v_exp_f32 v185, v25
  v_mfma_f32_16x16x32_bf16 v[44:47], v[152:155], a[224:227], v[44:47]
  v_exp_f32 v186, v26
  v_mfma_f32_16x16x32_bf16 v[40:43], v[156:159], a[204:207], v[40:43]
  s_add_u32 s6, s6, s75
  ds_read_b64_tr_b16 v[182:183], v7 offset:30720
  ds_read_b64_tr_b16 v[152:153], v4 offset:24704
  v_mfma_f32_16x16x32_bf16 v[44:47], v[156:159], a[228:231], v[44:47]
  s_waitcnt lgkmcnt(7)
  v_cvt_pk_bf16_f32 v72, v184, v185
  v_exp_f32 v187, v27
  v_mfma_f32_16x16x32_bf16 v[40:43], v[160:163], a[208:211], v[40:43]
  s_add_u32 s32, s32, 1
  v_exp_f32 v188, v28
  v_cvt_pk_bf16_f32 v73, v186, v187
  v_mfma_f32_16x16x32_bf16 v[44:47], v[160:163], a[232:235], v[44:47]
  s_max_u32 s40, s76, s77
  ds_read_b64_tr_b16 v[154:155], v4 offset:30848
  ds_read_b64_tr_b16 v[156:157], v5 offset:24704
  v_mfma_f32_16x16x32_bf16 v[40:43], v[164:167], a[212:215], v[40:43]
  s_waitcnt vmcnt(20)
  s_barrier
  ds_read_b64_tr_b16 v[158:159], v5 offset:30848
  v_exp_f32 v189, v29
  v_mfma_f32_16x16x32_bf16 v[44:47], v[164:167], a[236:239], v[44:47]
  v_exp_f32 v190, v30
  v_mfma_f32_16x16x32_bf16 a[96:99], v[168:171], v[56:59], a[96:99]
  s_add_u32 m0, s51, 36864
  ds_read_b64_tr_b16 v[160:161], v6 offset:24704
  ds_read_b64_tr_b16 v[162:163], v6 offset:30848
  v_mfma_f32_16x16x32_bf16 a[144:147], v[168:171], v[60:63], a[144:147]
  s_waitcnt lgkmcnt(10)
  buffer_load_dwordx4 v8, s[8:11], s6 offen offset:0  lds
  v_cvt_pk_bf16_f32 v76, v188, v189
  v_mfma_f32_16x16x32_bf16 a[100:103], v[172:175], v[56:59], a[100:103]
  ds_read_b64_tr_b16 v[164:165], v7 offset:24704
  ds_read_b64_tr_b16 v[166:167], v7 offset:30848
  v_exp_f32 v191, v31
  v_mfma_f32_16x16x32_bf16 a[148:151], v[172:175], v[60:63], a[148:151]
  s_waitcnt lgkmcnt(8)
  ds_read_b64_tr_b16 v[168:169], v4 offset:24832
  v_cvt_pk_bf16_f32 v77, v190, v191
  v_mfma_f32_16x16x32_bf16 a[104:107], v[176:179], v[56:59], a[104:107]
  s_add_u32 m0, s51, 36864
  v_exp_f32 v184, v40
  v_mfma_f32_16x16x32_bf16 a[152:155], v[176:179], v[60:63], a[152:155]
  buffer_load_dwordx4 v9, s[8:11], s6 offen offset:1024  lds
  v_exp_f32 v185, v41
  v_mfma_f32_16x16x32_bf16 a[108:111], v[180:183], v[56:59], a[108:111]
  s_add_u32 m0, s51, 36864
  ds_read_b64_tr_b16 v[170:171], v4 offset:30976
  ds_read_b64_tr_b16 v[172:173], v5 offset:24832
  v_mfma_f32_16x16x32_bf16 a[156:159], v[180:183], v[60:63], a[156:159]
  s_waitcnt lgkmcnt(7)
  v_exp_f32 v186, v42
  v_mfma_f32_16x16x32_bf16 a[112:115], v[152:155], v[56:59], a[112:115]
  ds_read_b64_tr_b16 v[174:175], v5 offset:30976
  ds_read_b64_tr_b16 v[176:177], v6 offset:24832
  v_cvt_pk_bf16_f32 v74, v184, v185
  v_mfma_f32_16x16x32_bf16 a[160:163], v[152:155], v[60:63], a[160:163]
  ds_read_b64_tr_b16 v[178:179], v6 offset:30976
  buffer_load_dwordx4 v10, s[8:11], s6 offen offset:2048  lds
  v_mfma_f32_16x16x32_bf16 a[116:119], v[156:159], v[56:59], a[116:119]
  v_exp_f32 v187, v43
  v_mfma_f32_16x16x32_bf16 a[164:167], v[156:159], v[60:63], a[164:167]
  s_waitcnt lgkmcnt(6)
  v_exp_f32 v188, v44
  v_mfma_f32_16x16x32_bf16 a[120:123], v[160:163], v[56:59], a[120:123]
  ds_read_b64_tr_b16 v[180:181], v7 offset:24832
  v_cvt_pk_bf16_f32 v75, v186, v187
  v_mfma_f32_16x16x32_bf16 a[168:171], v[160:163], v[60:63], a[168:171]
  s_add_u32 m0, s52, 12288
  v_exp_f32 v189, v45
  v_mfma_f32_16x16x32_bf16 a[124:127], v[164:167], v[56:59], a[124:127]
  v_exp_f32 v190, v46
  v_cvt_pk_bf16_f32 v78, v188, v189
  v_mfma_f32_16x16x32_bf16 a[172:175], v[164:167], v[60:63], a[172:175]
  s_waitcnt lgkmcnt(3)
  ds_read_b64_tr_b16 v[182:183], v7 offset:30976
  v_exp_f32 v191, v47
  v_mfma_f32_16x16x32_bf16 a[128:131], v[168:171], v[56:59], a[128:131]
  ds_read_b128 v[152:155], v2 offset:0
  v_cvt_pk_bf16_f32 v79, v190, v191
  v_mfma_f32_16x16x32_bf16 a[176:179], v[168:171], v[60:63], a[176:179]
  buffer_load_dwordx4 v8, s[12:15], s7 offen offset:0  lds
  v_mfma_f32_16x16x32_bf16 v[104:107], v[112:115], v[72:75], v[104:107]
  s_add_u32 m0, s52, 12288
  v_mfma_f32_16x16x32_bf16 v[108:111], v[112:115], v[76:79], v[108:111]
  v_mfma_f32_16x16x32_bf16 a[132:135], v[172:175], v[56:59], a[132:135]
  s_cmp_ge_u32 s40, s37
  s_cselect_b64 s[66:67], -1, 0
  ds_read_b128 v[156:159], v3 offset:0
  v_mfma_f32_16x16x32_bf16 a[180:183], v[172:175], v[60:63], a[180:183]
  s_waitcnt lgkmcnt(2)
  buffer_load_dwordx4 v9, s[12:15], s7 offen offset:1024  lds
  v_mfma_f32_16x16x32_bf16 a[136:139], v[176:179], v[56:59], a[136:139]
  s_add_u32 m0, s52, 12288
  ds_read_b128 v[160:163], v2 offset:128
  v_mfma_f32_16x16x32_bf16 a[184:187], v[176:179], v[60:63], a[184:187]
  v_max_f32 v14, v104, v108
  v_mfma_f32_16x16x32_bf16 a[140:143], v[180:183], v[56:59], a[140:143]
  ds_read_b128 v[164:167], v3 offset:128
  v_cmp_nge_f32 s[64:65], s50, v14
  v_mfma_f32_16x16x32_bf16 a[188:191], v[180:183], v[60:63], a[188:191]
  buffer_load_dwordx4 v10, s[12:15], s7 offen offset:2048  lds
  s_or_b64 vcc, s[64:65], s[66:67]
  s_cbranch_vccnz P2N1s0_SLOW
P2N1s0_SLOWB:
  s_call_b64 s[72:73], MASK_p1
  s_mov_b32 s33, 0
  s_mov_b32 s34, 1
  s_mov_b32 s35, 0
  s_branch P1K0
.p2align 6
P1K0:
  s_waitcnt lgkmcnt(3)
  v_mfma_f32_16x16x32_bf16 v[16:19], v[152:155], a[240:243], v[80:83]
  ds_read_b128 v[168:171], v2 offset:256
  v_mfma_f32_16x16x32_bf16 v[20:23], v[152:155], v[128:131], v[84:87]
  s_add_u32 m0, s53, 8192
  v_mfma_f32_16x16x32_bf16 v[24:27], v[152:155], a[192:195], v[88:91]
  ds_read_b128 v[172:175], v3 offset:256
  v_mfma_f32_16x16x32_bf16 v[28:31], v[152:155], a[216:219], v[92:95]
  s_waitcnt lgkmcnt(4)
  buffer_load_dwordx4 v[200:201], s[16:19], s61 idxen offen  lds
  v_mfma_f32_16x16x32_bf16 v[16:19], v[156:159], a[244:247], v[16:19]
  s_waitcnt vmcnt(11)
  s_mov_b32 s76, s77
  v_mfma_f32_16x16x32_bf16 v[20:23], v[156:159], v[132:135], v[20:23]
  s_mov_b32 s77, s78
  s_mov_b32 s78, s79
  ds_read_b128 v[176:179], v2 offset:6144
  v_mfma_f32_16x16x32_bf16 v[24:27], v[156:159], a[196:199], v[24:27]
  v_mfma_f32_16x16x32_bf16 v[28:31], v[156:159], a[220:223], v[28:31]
  s_waitcnt lgkmcnt(4)
  s_add_u32 m0, s53, 9216
  ds_read_b128 v[208:211], v250 offset:0
  v_mfma_f32_16x16x32_bf16 v[16:19], v[160:163], a[248:251], v[16:19]
  buffer_load_dwordx4 v[202:203], s[16:19], s61 idxen offen  lds
  v_mfma_f32_16x16x32_bf16 v[20:23], v[160:163], v[136:139], v[20:23]
  ds_read_b128 v[212:215], v251 offset:0
  v_mfma_f32_16x16x32_bf16 v[24:27], v[160:163], a[200:203], v[24:27]
  s_mov_b32 s79, s74
  v_mfma_f32_16x16x32_bf16 v[28:31], v[160:163], a[224:227], v[28:31]
  s_waitcnt lgkmcnt(5)
  s_add_u32 s40, s32, 4
  s_add_u32 m0, s53, 10240
  v_mfma_f32_16x16x32_bf16 v[16:19], v[164:167], a[252:255], v[16:19]
  ds_read_b128 v[180:183], v3 offset:6144
  v_mfma_f32_16x16x32_bf16 v[20:23], v[164:167], v[140:143], v[20:23]
  s_waitcnt lgkmcnt(2)
  buffer_load_dwordx4 v[204:205], s[16:19], s61 idxen offen  lds
  v_mfma_f32_16x16x32_bf16 v[240:243], v[216:219], v[208:211], 0
  ds_read_b128 v[152:155], v2 offset:6272
  v_mfma_f32_16x16x32_bf16 v[24:27], v[164:167], a[204:207], v[24:27]
  v_readlane_b32 s74, v0, s40
  v_mfma_f32_16x16x32_bf16 v[28:31], v[164:167], a[228:231], v[28:31]
  ds_read_b128 v[208:211], v250 offset:2048
  v_mfma_f32_16x16x32_bf16 v[16:19], v[168:171], v[120:123], v[16:19]
  v_mfma_f32_16x16x32_bf16 v[20:23], v[168:171], v[144:147], v[20:23]
  s_add_u32 m0, s53, 11264
  ds_read_b128 v[156:159], v3 offset:6272
  v_mfma_f32_16x16x32_bf16 v[24:27], v[168:171], a[208:211], v[24:27]
  buffer_load_dwordx4 v[206:207], s[16:19], s61 idxen offen  lds
  v_mfma_f32_16x16x32_bf16 v[28:31], v[168:171], a[232:235], v[28:31]
  ds_read_b128 v[160:163], v2 offset:6400
  v_mfma_f32_16x16x32_bf16 v[16:19], v[172:175], v[124:127], v[16:19]
  s_waitcnt lgkmcnt(5)
  v_mfma_f32_16x16x32_bf16 v[240:243], v[220:223], v[212:215], v[240:243]
  ds_read_b32 v200, v1 offset:128
  v_mfma_f32_16x16x32_bf16 v[20:23], v[172:175], v[148:151], v[20:23]
  s_mul_i32 s63, s78, 12288
  ds_read_b64_tr_b16 v[168:169], v4 offset:36864
  v_mfma_f32_16x16x32_bf16 v[24:27], v[172:175], a[212:215], v[24:27]
  ds_read_b64_tr_b16 v[170:171], v4 offset:43008
  ds_read_b32 v202, v1 offset:160
  v_mfma_f32_16x16x32_bf16 v[28:31], v[172:175], a[236:239], v[28:31]
  v_exp_f32 v184, v16
  v_mfma_f32_16x16x32_bf16 v[32:35], v[176:179], a[240:243], v[192:195]
  s_add_u32 s63, s63, s75
  ds_read_b64_tr_b16 v[172:173], v5 offset:36864
  ds_read_b128 v[212:215], v251 offset:2048
  v_mfma_f32_16x16x32_bf16 v[36:39], v[176:179], v[128:131], v[196:199]
  v_exp_f32 v185, v17
  v_mfma_f32_16x16x32_bf16 v[40:43], v[176:179], a[192:195], v[88:91]
  v_exp_f32 v186, v18
  v_mfma_f32_16x16x32_bf16 v[44:47], v[176:179], a[216:219], v[92:95]
  s_waitcnt lgkmcnt(10)
  ds_read_b64_tr_b16 v[174:175], v5 offset:43008
  v_cvt_pk_bf16_f32 v48, v184, v185
  v_mfma_f32_16x16x32_bf16 v[32:35], v[180:183], a[244:247], v[32:35]
  s_waitcnt lgkmcnt(9)
  v_exp_f32 v187, v19
  v_mfma_f32_16x16x32_bf16 v[244:247], v[216:219], v[208:211], 0
  ds_read_b128 v[164:167], v3 offset:6400
  ds_read_b32 v204, v1 offset:192
  v_mfma_f32_16x16x32_bf16 v[36:39], v[180:183], v[132:135], v[36:39]
  v_exp_f32 v188, v20
  v_mfma_f32_16x16x32_bf16 v[40:43], v[180:183], a[196:199], v[40:43]
  ds_read_b64_tr_b16 v[176:177], v6 offset:36864
  v_cvt_pk_bf16_f32 v49, v186, v187
  v_mfma_f32_16x16x32_bf16 v[44:47], v[180:183], a[220:223], v[44:47]
  v_exp_f32 v189, v21
  v_mfma_f32_16x16x32_bf16 v[32:35], v[152:155], a[248:251], v[32:35]
  s_mul_i32 s62, s74, 12288
  ds_read_b32 v206, v1 offset:224
  v_mfma_f32_16x16x32_bf16 v[36:39], v[152:155], v[136:139], v[36:39]
  ds_read_b64_tr_b16 v[178:179], v6 offset:43008
  ds_read_b64_tr_b16 v[180:181], v7 offset:36864
  v_mfma_f32_16x16x32_bf16 v[40:43], v[152:155], a[200:203], v[40:43]
  v_exp_f32 v190, v22
  v_mfma_f32_16x16x32_bf16 v[44:47], v[152:155], a[224:227], v[44:47]
  s_waitcnt lgkmcnt(7)
  s_waitcnt vmcnt(7)
  v_cvt_pk_bf16_f32 v52, v188, v189
  v_mfma_f32_16x16x32_bf16 v[244:247], v[220:223], v[212:215], v[244:247]
  ds_read_b64_tr_b16 v[182:183], v7 offset:43008
  ds_read_b128 v[208:211], v250 offset:4096
  v_mfma_f32_16x16x32_bf16 v[32:35], v[156:159], a[252:255], v[32:35]
  s_add_u32 m0, s53, 0
  v_exp_f32 v191, v23
  v_mfma_f32_16x16x32_bf16 v[36:39], v[156:159], v[140:143], v[36:39]
  ds_read_b64_tr_b16 v[152:153], v4 offset:36992
  ds_read_b64_tr_b16 v[154:155], v4 offset:43136
  v_mfma_f32_16x16x32_bf16 v[40:43], v[156:159], a[204:207], v[40:43]
  s_add_u32 s62, s62, s75
  buffer_load_dwordx4 v[200:201], s[16:19], 0 idxen offen  lds
  v_mfma_f32_16x16x32_bf16 v[44:47], v[156:159], a[228:231], v[44:47]
  v_exp_f32 v184, v24
  v_mfma_f32_16x16x32_bf16 v[32:35], v[160:163], v[120:123], v[32:35]
  v_cvt_pk_bf16_f32 v53, v190, v191
  v_mfma_f32_16x16x32_bf16 v[36:39], v[160:163], v[144:147], v[36:39]
  v_exp_f32 v185, v25
  v_mfma_f32_16x16x32_bf16 v[40:43], v[160:163], a[208:211], v[40:43]
  s_add_u32 m0, s53, 1024
  v_exp_f32 v186, v26
  v_mfma_f32_16x16x32_bf16 v[44:47], v[160:163], a[232:235], v[44:47]
  s_waitcnt lgkmcnt(2)
  ds_read_b64_tr_b16 v[156:157], v5 offset:36992
  ds_read_b64_tr_b16 v[158:159], v5 offset:43136
  v_mfma_f32_16x16x32_bf16 v[240:243], v[224:227], v[208:211], v[240:243]
  buffer_load_dwordx4 v[202:203], s[16:19], 0 idxen offen  lds
  v_mfma_f32_16x16x32_bf16 v[32:35], v[164:167], v[124:127], v[32:35]
  ds_read_b128 v[212:215], v251 offset:4096
  v_cvt_pk_bf16_f32 v56, v184, v185
  v_mfma_f32_16x16x32_bf16 v[36:39], v[164:167], v[148:151], v[36:39]
  s_add_u32 m0, s53, 2048
  v_exp_f32 v187, v27
  v_mfma_f32_16x16x32_bf16 v[40:43], v[164:167], a[212:215], v[40:43]
  s_waitcnt vmcnt(17)
  s_barrier
  ds_read_b64_tr_b16 v[160:161], v6 offset:36992
  v_mfma_f32_16x16x32_bf16 v[44:47], v[164:167], a[236:239], v[44:47]
  buffer_load_dwordx4 v[204:205], s[16:19], 0 idxen offen  lds
  v_mfma_f32_16x16x32_bf16 a[0:3], v[168:171], v[64:67], a[0:3]
  v_exp_f32 v188, v28
  v_mfma_f32_16x16x32_bf16 a[48:51], v[168:171], v[68:71], a[48:51]
  ds_read_b64_tr_b16 v[162:163], v6 offset:43136
  v_cvt_pk_bf16_f32 v57, v186, v187
  v_mfma_f32_16x16x32_bf16 a[96:99], v[168:171], v[72:75], a[96:99]
  s_waitcnt lgkmcnt(2)
  v_exp_f32 v189, v29
  v_mfma_f32_16x16x32_bf16 v[240:243], v[228:231], v[212:215], v[240:243]
  s_add_u32 m0, s53, 3072
  v_exp_f32 v190, v30
  v_mfma_f32_16x16x32_bf16 a[144:147], v[168:171], v[76:79], a[144:147]
  ds_read_b128 v[208:211], v250 offset:6144
  v_cvt_pk_bf16_f32 v60, v188, v189
  v_mfma_f32_16x16x32_bf16 a[4:7], v[172:175], v[64:67], a[4:7]
  buffer_load_dwordx4 v[206:207], s[16:19], 0 idxen offen  lds
  v_mfma_f32_16x16x32_bf16 a[52:55], v[172:175], v[68:71], a[52:55]
  s_add_u32 s32, s32, 1
  v_exp_f32 v191, v31
  v_mfma_f32_16x16x32_bf16 a[100:103], v[172:175], v[72:75], a[100:103]
  ds_read_b128 v[212:215], v251 offset:6144
  v_cvt_pk_bf16_f32 v61, v190, v191
  v_mfma_f32_16x16x32_bf16 a[148:151], v[172:175], v[76:79], a[148:151]
  v_exp_f32 v184, v32
  v_mfma_f32_16x16x32_bf16 a[8:11], v[176:179], v[64:67], a[8:11]
  v_exp_f32 v185, v33
  v_mfma_f32_16x16x32_bf16 a[56:59], v[176:179], v[68:71], a[56:59]
  s_add_u32 m0, s51, 0
  v_exp_f32 v186, v34
  v_mfma_f32_16x16x32_bf16 a[104:107], v[176:179], v[72:75], a[104:107]
  s_waitcnt lgkmcnt(1)
  buffer_load_dwordx4 v8, s[8:11], s62 offen offset:0  lds
  v_mfma_f32_16x16x32_bf16 v[244:247], v[224:227], v[208:211], v[244:247]
  ds_read_b64_tr_b16 v[164:165], v7 offset:36992
  v_cvt_pk_bf16_f32 v50, v184, v185
  v_mfma_f32_16x16x32_bf16 a[152:155], v[176:179], v[76:79], a[152:155]
  v_exp_f32 v187, v35
  v_mfma_f32_16x16x32_bf16 a[12:15], v[180:183], v[64:67], a[12:15]
  v_exp_f32 v188, v36
  v_mfma_f32_16x16x32_bf16 a[60:63], v[180:183], v[68:71], a[60:63]
  ds_read_b64_tr_b16 v[166:167], v7 offset:43136
  v_cvt_pk_bf16_f32 v51, v186, v187
  v_mfma_f32_16x16x32_bf16 a[108:111], v[180:183], v[72:75], a[108:111]
  v_exp_f32 v189, v37
  v_mfma_f32_16x16x32_bf16 a[156:159], v[180:183], v[76:79], a[156:159]
  ds_read_b64_tr_b16 v[168:169], v4 offset:37120
  ds_read_b64_tr_b16 v[170:171], v4 offset:43264
  v_mfma_f32_16x16x32_bf16 a[16:19], v[152:155], v[64:67], a[16:19]
  v_exp_f32 v190, v38
  v_mfma_f32_16x16x32_bf16 a[64:67], v[152:155], v[68:71], a[64:67]
  s_waitcnt lgkmcnt(4)
  s_waitcnt vmcnt(5)
  ds_read_b64_tr_b16 v[172:173], v5 offset:37120
  v_mfma_f32_16x16x32_bf16 v[244:247], v[228:231], v[212:215], v[244:247]
  s_add_u32 m0, s53, 4096
  ds_read_b128 v[208:211], v250 offset:8192
  v_cvt_pk_bf16_f32 v54, v188, v189
  v_mfma_f32_16x16x32_bf16 a[112:115], v[152:155], v[72:75], a[112:115]
  buffer_load_dwordx4 v[200:201], s[16:19], s60 idxen offen  lds
  v_mfma_f32_16x16x32_bf16 a[160:163], v[152:155], v[76:79], a[160:163]
  v_exp_f32 v191, v39
  v_mfma_f32_16x16x32_bf16 a[20:23], v[156:159], v[64:67], a[20:23]
  s_add_u32 m0, s51, 0
  v_exp_f32 v184, v40
  v_mfma_f32_16x16x32_bf16 a[68:71], v[156:159], v[68:71], a[68:71]
  ds_read_b128 v[212:215], v251 offset:8192
  v_cvt_pk_bf16_f32 v55, v190, v191
  v_mfma_f32_16x16x32_bf16 a[116:119], v[156:159], v[72:75], a[116:119]
  buffer_load_dwordx4 v9, s[8:11], s62 offen offset:1024  lds
  v_mfma_f32_16x16x32_bf16 a[164:167], v[156:159], v[76:79], a[164:167]
  v_exp_f32 v185, v41
  v_mfma_f32_16x16x32_bf16 a[24:27], v[160:163], v[64:67], a[24:27]
  v_exp_f32 v186, v42
  v_mfma_f32_16x16x32_bf16 a[72:75], v[160:163], v[68:71], a[72:75]
  s_waitcnt lgkmcnt(1)
  ds_read_b128 v[152:155], v2 offset:12288
  v_cvt_pk_bf16_f32 v58, v184, v185
  v_mfma_f32_16x16x32_bf16 v[240:243], v[232:235], v[208:211], v[240:243]
  s_add_u32 m0, s53, 5120
  v_exp_f32 v187, v43
  v_mfma_f32_16x16x32_bf16 a[120:123], v[160:163], v[72:75], a[120:123]
  v_exp_f32 v188, v44
  v_mfma_f32_16x16x32_bf16 a[168:171], v[160:163], v[76:79], a[168:171]
  ds_read_b64_tr_b16 v[174:175], v5 offset:43264
  v_cvt_pk_bf16_f32 v59, v186, v187
  v_mfma_f32_16x16x32_bf16 a[28:31], v[164:167], v[64:67], a[28:31]
  buffer_load_dwordx4 v[202:203], s[16:19], s60 idxen offen  lds
  v_mfma_f32_16x16x32_bf16 a[76:79], v[164:167], v[68:71], a[76:79]
  v_exp_f32 v189, v45
  v_mfma_f32_16x16x32_bf16 a[124:127], v[164:167], v[72:75], a[124:127]
  s_add_u32 m0, s53, 6144
  v_exp_f32 v190, v46
  v_mfma_f32_16x16x32_bf16 a[172:175], v[164:167], v[76:79], a[172:175]
  ds_read_b128 v[208:211], v250 offset:10240
  v_cvt_pk_bf16_f32 v62, v188, v189
  v_mfma_f32_16x16x32_bf16 a[32:35], v[168:171], v[64:67], a[32:35]
  s_waitcnt lgkmcnt(3)
  v_exp_f32 v191, v47
  v_mfma_f32_16x16x32_bf16 v[240:243], v[236:239], v[212:215], v[240:243]
  buffer_load_dwordx4 v[204:205], s[16:19], s60 idxen offen  lds
  v_mfma_f32_16x16x32_bf16 a[80:83], v[168:171], v[68:71], a[80:83]
  s_add_u32 m0, s53, 7168
  ds_read_b128 v[156:159], v3 offset:12288
  v_cvt_pk_bf16_f32 v63, v190, v191
  v_mfma_f32_16x16x32_bf16 a[128:131], v[168:171], v[72:75], a[128:131]
  v_mfma_f32_16x16x32_bf16 a[176:179], v[168:171], v[76:79], a[176:179]
  ds_read_b128 v[212:215], v251 offset:10240
  v_mfma_f32_16x16x32_bf16 v[96:99], v[112:115], v[48:51], v[96:99]
  buffer_load_dwordx4 v[206:207], s[16:19], s60 idxen offen  lds
  v_mfma_f32_16x16x32_bf16 v[100:103], v[112:115], v[52:55], v[100:103]
  ds_read_b64_tr_b16 v[176:177], v6 offset:37120
  v_mfma_f32_16x16x32_bf16 v[104:107], v[112:115], v[56:59], v[104:107]
  s_add_u32 m0, s51, 0
  ds_read_b64_tr_b16 v[178:179], v6 offset:43264
  ds_read_b64_tr_b16 v[180:181], v7 offset:37120
  v_mfma_f32_16x16x32_bf16 v[108:111], v[112:115], v[60:63], v[108:111]
  s_waitcnt lgkmcnt(6)
  ds_read_b64_tr_b16 v[182:183], v7 offset:43264
  v_mfma_f32_16x16x32_bf16 a[36:39], v[172:175], v[64:67], a[36:39]
  s_waitcnt lgkmcnt(6)
  v_mfma_f32_16x16x32_bf16 v[244:247], v[232:235], v[208:211], v[244:247]
  buffer_load_dwordx4 v10, s[8:11], s62 offen offset:2048  lds
  v_mfma_f32_16x16x32_bf16 a[84:87], v[172:175], v[68:71], a[84:87]
  v_mfma_f32_16x16x32_bf16 a[132:135], v[172:175], v[72:75], a[132:135]
  ds_read_b128 v[160:163], v2 offset:12416
  v_mfma_f32_16x16x32_bf16 a[180:183], v[172:175], v[76:79], a[180:183]
  s_waitcnt lgkmcnt(3)
  v_cndmask_b32 v248, v248, v240, s[80:81]
  v_mfma_f32_16x16x32_bf16 a[40:43], v[176:179], v[64:67], a[40:43]
  ds_read_b128 v[164:167], v3 offset:12416
  v_max3_f32 v14, v96, v100, v104
  v_mfma_f32_16x16x32_bf16 a[88:91], v[176:179], v[68:71], a[88:91]
  s_cmp_ge_u32 s77, s36
  s_cselect_b64 s[66:67], -1, 0
  v_max_f32 v14, v14, v108
  v_mfma_f32_16x16x32_bf16 a[136:139], v[176:179], v[72:75], a[136:139]
  v_mfma_f32_16x16x32_bf16 a[184:187], v[176:179], v[76:79], a[184:187]
  s_waitcnt vmcnt(7)
  v_mfma_f32_16x16x32_bf16 v[244:247], v[236:239], v[212:215], v[244:247]
  s_waitcnt lgkmcnt(2)
  s_add_u32 m0, s53, 8192
  ds_read_b128 v[208:211], v250 offset:0
  v_mfma_f32_16x16x32_bf16 a[44:47], v[180:183], v[64:67], a[44:47]
  buffer_load_dwordx4 v[200:201], s[16:19], s61 idxen offen  lds
  v_mfma_f32_16x16x32_bf16 a[92:95], v[180:183], v[68:71], a[92:95]
  v_cmp_nge_f32 s[64:65], s50, v14
  v_mfma_f32_16x16x32_bf16 a[140:143], v[180:183], v[72:75], a[140:143]
  s_cmp_eq_u32 s32, 5
  s_cselect_b64 s[66:67], -1, s[66:67]
  v_mfma_f32_16x16x32_bf16 a[188:191], v[180:183], v[76:79], a[188:191]
  v_cndmask_b32 v248, v248, v241, s[82:83]
  v_cndmask_b32 v249, v249, v246, s[80:81]
  s_or_b64 vcc, s[64:65], s[66:67]
  s_cbranch_vccnz P1K0s0_SLOW
P1K0s0_SLOWB:
  v_mfma_f32_16x16x32_bf16 v[16:19], v[152:155], a[240:243], v[80:83]
  s_add_u32 m0, s53, 9216
  ds_read_b128 v[212:215], v251 offset:0
  v_mfma_f32_16x16x32_bf16 v[20:23], v[152:155], v[128:131], v[84:87]
  buffer_load_dwordx4 v[202:203], s[16:19], s61 idxen offen  lds
  v_mfma_f32_16x16x32_bf16 v[24:27], v[152:155], a[192:195], v[88:91]
  ds_read_b128 v[168:171], v2 offset:12544
  v_mfma_f32_16x16x32_bf16 v[28:31], v[152:155], a[216:219], v[92:95]
  s_waitcnt lgkmcnt(2)
  s_add_u32 m0, s52, 24576
  v_cndmask_b32 v249, v249, v247, s[82:83]
  v_mfma_f32_16x16x32_bf16 v[240:243], v[216:219], v[208:211], 0
  ds_read_b128 v[208:211], v250 offset:2048
  v_mfma_f32_16x16x32_bf16 v[16:19], v[156:159], a[244:247], v[16:19]
  s_mov_b32 s76, s77
  s_mov_b32 s77, s78
  v_mfma_f32_16x16x32_bf16 v[20:23], v[156:159], v[132:135], v[20:23]
  s_mov_b32 s78, s79
  buffer_load_dwordx4 v8, s[12:15], s63 offen offset:0  lds
  v_mfma_f32_16x16x32_bf16 v[24:27], v[156:159], a[196:199], v[24:27]
  ds_read_b128 v[172:175], v3 offset:12544
  v_mfma_f32_16x16x32_bf16 v[28:31], v[156:159], a[220:223], v[28:31]
  s_mov_b32 s79, s74
  s_add_u32 m0, s53, 10240
  v_mfma_f32_16x16x32_bf16 v[16:19], v[160:163], a[248:251], v[16:19]
  ds_read_b128 v[176:179], v2 offset:18432
  v_mfma_f32_16x16x32_bf16 v[20:23], v[160:163], v[136:139], v[20:23]
  buffer_load_dwordx4 v[204:205], s[16:19], s61 idxen offen  lds
  v_mfma_f32_16x16x32_bf16 v[24:27], v[160:163], a[200:203], v[24:27]
  s_waitcnt lgkmcnt(4)
  s_add_u32 s40, s32, 4
  ds_read_b128 v[180:183], v3 offset:18432
  v_mfma_f32_16x16x32_bf16 v[240:243], v[220:223], v[212:215], v[240:243]
  v_mfma_f32_16x16x32_bf16 v[28:31], v[160:163], a[224:227], v[28:31]
  s_add_u32 m0, s53, 11264
  ds_read_b128 v[152:155], v2 offset:18560
  v_mfma_f32_16x16x32_bf16 v[16:19], v[164:167], a[252:255], v[16:19]
  v_mfma_f32_16x16x32_bf16 v[20:23], v[164:167], v[140:143], v[20:23]
  ds_read_b128 v[156:159], v3 offset:18560
  v_mfma_f32_16x16x32_bf16 v[24:27], v[164:167], a[204:207], v[24:27]
  buffer_load_dwordx4 v[206:207], s[16:19], s61 idxen offen  lds
  v_mfma_f32_16x16x32_bf16 v[28:31], v[164:167], a[228:231], v[28:31]
  s_waitcnt lgkmcnt(6)
  ds_read_b128 v[212:215], v251 offset:2048
  ds_read_b32 v200, v1 offset:256
  v_mfma_f32_16x16x32_bf16 v[16:19], v[168:171], v[120:123], v[16:19]
  v_mfma_f32_16x16x32_bf16 v[20:23], v[168:171], v[144:147], v[20:23]
  ds_read_b32 v202, v1 offset:288
  v_mfma_f32_16x16x32_bf16 v[24:27], v[168:171], a[208:211], v[24:27]
  s_waitcnt lgkmcnt(8)
  ds_read_b32 v204, v1 offset:320
  v_readlane_b32 s74, v0, s40
  v_mfma_f32_16x16x32_bf16 v[244:247], v[216:219], v[208:211], 0
  s_add_u32 m0, s52, 24576
  v_mfma_f32_16x16x32_bf16 v[28:31], v[168:171], a[232:235], v[28:31]
  s_waitcnt lgkmcnt(8)
  s_mul_i32 s7, s78, 12288
  ds_read_b128 v[160:163], v2 offset:18688
  v_mfma_f32_16x16x32_bf16 v[16:19], v[172:175], v[124:127], v[16:19]
  ds_read_b64_tr_b16 v[168:169], v4 offset:0
  v_mfma_f32_16x16x32_bf16 v[20:23], v[172:175], v[148:151], v[20:23]
  ds_read_b64_tr_b16 v[170:171], v4 offset:6144
  ds_read_b32 v206, v1 offset:352
  v_mfma_f32_16x16x32_bf16 v[24:27], v[172:175], a[212:215], v[24:27]
  s_add_u32 s7, s7, s75
  buffer_load_dwordx4 v9, s[12:15], s63 offen offset:1024  lds
  v_mfma_f32_16x16x32_bf16 v[28:31], v[172:175], a[236:239], v[28:31]
  s_waitcnt lgkmcnt(11)
  ds_read_b128 v[164:167], v3 offset:18688
  ds_read_b64_tr_b16 v[172:173], v5 offset:0
  v_mfma_f32_16x16x32_bf16 v[32:35], v[176:179], a[240:243], v[192:195]
  v_exp_f32 v184, v16
  v_mfma_f32_16x16x32_bf16 v[36:39], v[176:179], v[128:131], v[196:199]
  s_waitcnt lgkmcnt(9)
  s_waitcnt vmcnt(7)
  v_exp_f32 v185, v17
  v_mfma_f32_16x16x32_bf16 v[244:247], v[220:223], v[212:215], v[244:247]
  s_add_u32 m0, s53, 0
  v_exp_f32 v186, v18
  v_mfma_f32_16x16x32_bf16 v[40:43], v[176:179], a[192:195], v[88:91]
  s_mul_i32 s6, s74, 12288
  ds_read_b128 v[208:211], v250 offset:4096
  v_cvt_pk_bf16_f32 v64, v184, v185
  v_mfma_f32_16x16x32_bf16 v[44:47], v[176:179], a[216:219], v[92:95]
  s_waitcnt lgkmcnt(9)
  buffer_load_dwordx4 v[200:201], s[16:19], 0 idxen offen  lds
  v_mfma_f32_16x16x32_bf16 v[32:35], v[180:183], a[244:247], v[32:35]
  s_add_u32 s6, s6, s75
  v_exp_f32 v187, v19
  v_mfma_f32_16x16x32_bf16 v[36:39], v[180:183], v[132:135], v[36:39]
  s_add_u32 m0, s53, 1024
  v_exp_f32 v188, v20
  v_mfma_f32_16x16x32_bf16 v[40:43], v[180:183], a[196:199], v[40:43]
  ds_read_b128 v[212:215], v251 offset:4096
  v_cvt_pk_bf16_f32 v65, v186, v187
  v_mfma_f32_16x16x32_bf16 v[44:47], v[180:183], a[220:223], v[44:47]
  s_waitcnt lgkmcnt(9)
  buffer_load_dwordx4 v[202:203], s[16:19], 0 idxen offen  lds
  v_mfma_f32_16x16x32_bf16 v[32:35], v[152:155], a[248:251], v[32:35]
  s_add_u32 m0, s53, 2048
  v_exp_f32 v189, v21
  v_mfma_f32_16x16x32_bf16 v[36:39], v[152:155], v[136:139], v[36:39]
  s_waitcnt lgkmcnt(1)
  v_exp_f32 v190, v22
  v_mfma_f32_16x16x32_bf16 v[240:243], v[224:227], v[208:211], v[240:243]
  ds_read_b64_tr_b16 v[174:175], v5 offset:6144
  v_cvt_pk_bf16_f32 v68, v188, v189
  v_mfma_f32_16x16x32_bf16 v[40:43], v[152:155], a[200:203], v[40:43]
  buffer_load_dwordx4 v[204:205], s[16:19], 0 idxen offen  lds
  v_mfma_f32_16x16x32_bf16 v[44:47], v[152:155], a[224:227], v[44:47]
  v_exp_f32 v191, v23
  v_mfma_f32_16x16x32_bf16 v[32:35], v[156:159], a[252:255], v[32:35]
  ds_read_b64_tr_b16 v[176:177], v6 offset:0
  ds_read_b128 v[208:211], v250 offset:6144
  v_mfma_f32_16x16x32_bf16 v[36:39], v[156:159], v[140:143], v[36:39]
  s_add_u32 m0, s52, 24576
  v_exp_f32 v184, v24
  v_mfma_f32_16x16x32_bf16 v[40:43], v[156:159], a[204:207], v[40:43]
  ds_read_b64_tr_b16 v[178:179], v6 offset:6144
  v_cvt_pk_bf16_f32 v69, v190, v191
  v_mfma_f32_16x16x32_bf16 v[44:47], v[156:159], a[228:231], v[44:47]
  buffer_load_dwordx4 v10, s[12:15], s63 offen offset:2048  lds
  v_mfma_f32_16x16x32_bf16 v[32:35], v[160:163], v[120:123], v[32:35]
  s_waitcnt lgkmcnt(4)
  v_exp_f32 v185, v25
  v_mfma_f32_16x16x32_bf16 v[240:243], v[228:231], v[212:215], v[240:243]
  v_exp_f32 v186, v26
  v_mfma_f32_16x16x32_bf16 v[36:39], v[160:163], v[144:147], v[36:39]
  ds_read_b64_tr_b16 v[180:181], v7 offset:0
  v_cvt_pk_bf16_f32 v72, v184, v185
  v_mfma_f32_16x16x32_bf16 v[40:43], v[160:163], a[208:211], v[40:43]
  s_add_u32 m0, s53, 3072
  v_exp_f32 v187, v27
  v_mfma_f32_16x16x32_bf16 v[44:47], v[160:163], a[232:235], v[44:47]
  buffer_load_dwordx4 v[206:207], s[16:19], 0 idxen offen  lds
  v_mfma_f32_16x16x32_bf16 v[32:35], v[164:167], v[124:127], v[32:35]
  v_exp_f32 v188, v28
  v_mfma_f32_16x16x32_bf16 v[36:39], v[164:167], v[148:151], v[36:39]
  ds_read_b128 v[212:215], v251 offset:6144
  v_cvt_pk_bf16_f32 v73, v186, v187
  v_mfma_f32_16x16x32_bf16 v[40:43], v[164:167], a[212:215], v[40:43]
  s_waitcnt vmcnt(26)
  s_barrier
  ds_read_b64_tr_b16 v[182:183], v7 offset:6144
  v_mfma_f32_16x16x32_bf16 v[44:47], v[164:167], a[236:239], v[44:47]
  s_add_u32 m0, s51, 12288
  ds_read_b64_tr_b16 v[152:153], v4 offset:128
  v_mfma_f32_16x16x32_bf16 a[0:3], v[168:171], v[48:51], a[0:3]
  s_waitcnt lgkmcnt(5)
  v_exp_f32 v189, v29
  v_mfma_f32_16x16x32_bf16 v[244:247], v[224:227], v[208:211], v[244:247]
  buffer_load_dwordx4 v8, s[8:11], s6 offen offset:0  lds
  v_mfma_f32_16x16x32_bf16 a[48:51], v[168:171], v[52:55], a[48:51]
  v_exp_f32 v190, v30
  v_mfma_f32_16x16x32_bf16 a[96:99], v[168:171], v[56:59], a[96:99]
  ds_read_b64_tr_b16 v[154:155], v4 offset:6272
  v_cvt_pk_bf16_f32 v76, v188, v189
  v_mfma_f32_16x16x32_bf16 a[144:147], v[168:171], v[60:63], a[144:147]
  v_exp_f32 v191, v31
  v_mfma_f32_16x16x32_bf16 a[4:7], v[172:175], v[48:51], a[4:7]
  ds_read_b64_tr_b16 v[156:157], v5 offset:128
  v_cvt_pk_bf16_f32 v77, v190, v191
  v_mfma_f32_16x16x32_bf16 a[52:55], v[172:175], v[52:55], a[52:55]
  v_exp_f32 v184, v32
  v_mfma_f32_16x16x32_bf16 a[100:103], v[172:175], v[56:59], a[100:103]
  v_exp_f32 v185, v33
  v_mfma_f32_16x16x32_bf16 a[148:151], v[172:175], v[60:63], a[148:151]
  s_waitcnt lgkmcnt(4)
  s_waitcnt vmcnt(7)
  ds_read_b64_tr_b16 v[158:159], v5 offset:6272
  v_mfma_f32_16x16x32_bf16 v[244:247], v[228:231], v[212:215], v[244:247]
  s_add_u32 m0, s53, 4096
  ds_read_b128 v[208:211], v250 offset:8192
  v_mfma_f32_16x16x32_bf16 a[8:11], v[176:179], v[48:51], a[8:11]
  buffer_load_dwordx4 v[200:201], s[16:19], s60 idxen offen  lds
  v_mfma_f32_16x16x32_bf16 a[56:59], v[176:179], v[52:55], a[56:59]
  s_add_u32 m0, s51, 12288
  v_exp_f32 v186, v34
  v_mfma_f32_16x16x32_bf16 a[104:107], v[176:179], v[56:59], a[104:107]
  ds_read_b64_tr_b16 v[160:161], v6 offset:128
  v_cvt_pk_bf16_f32 v66, v184, v185
  v_mfma_f32_16x16x32_bf16 a[152:155], v[176:179], v[60:63], a[152:155]
  s_waitcnt lgkmcnt(6)
  ds_read_b64_tr_b16 v[162:163], v6 offset:6272
  ds_read_b64_tr_b16 v[164:165], v7 offset:128
  v_mfma_f32_16x16x32_bf16 a[12:15], v[180:183], v[48:51], a[12:15]
  buffer_load_dwordx4 v9, s[8:11], s6 offen offset:1024  lds
  v_mfma_f32_16x16x32_bf16 a[60:63], v[180:183], v[52:55], a[60:63]
  s_add_u32 m0, s53, 5120
  v_exp_f32 v187, v35
  v_mfma_f32_16x16x32_bf16 a[108:111], v[180:183], v[56:59], a[108:111]
  ds_read_b128 v[212:215], v251 offset:8192
  v_exp_f32 v188, v36
  v_mfma_f32_16x16x32_bf16 a[156:159], v[180:183], v[60:63], a[156:159]
  s_waitcnt lgkmcnt(4)
  ds_read_b64_tr_b16 v[166:167], v7 offset:6272
  v_cvt_pk_bf16_f32 v67, v186, v187
  v_mfma_f32_16x16x32_bf16 v[240:243], v[232:235], v[208:211], v[240:243]
  buffer_load_dwordx4 v[202:203], s[16:19], s60 idxen offen  lds
  v_mfma_f32_16x16x32_bf16 a[16:19], v[152:155], v[48:51], a[16:19]
  v_exp_f32 v189, v37
  v_mfma_f32_16x16x32_bf16 a[64:67], v[152:155], v[52:55], a[64:67]
  s_add_u32 m0, s53, 6144
  v_exp_f32 v190, v38
  v_mfma_f32_16x16x32_bf16 a[112:115], v[152:155], v[56:59], a[112:115]
  s_add_u32 s32, s32, 1
  ds_read_b64_tr_b16 v[168:169], v4 offset:256
  v_cvt_pk_bf16_f32 v70, v188, v189
  v_mfma_f32_16x16x32_bf16 a[160:163], v[152:155], v[60:63], a[160:163]
  buffer_load_dwordx4 v[204:205], s[16:19], s60 idxen offen  lds
  v_mfma_f32_16x16x32_bf16 a[20:23], v[156:159], v[48:51], a[20:23]
  v_exp_f32 v191, v39
  v_mfma_f32_16x16x32_bf16 a[68:71], v[156:159], v[52:55], a[68:71]
  s_add_u32 m0, s51, 12288
  v_exp_f32 v184, v40
  v_mfma_f32_16x16x32_bf16 a[116:119], v[156:159], v[56:59], a[116:119]
  s_waitcnt lgkmcnt(2)
  ds_read_b128 v[208:211], v250 offset:10240
  v_cvt_pk_bf16_f32 v71, v190, v191
  v_mfma_f32_16x16x32_bf16 v[240:243], v[236:239], v[212:215], v[240:243]
  buffer_load_dwordx4 v10, s[8:11], s6 offen offset:2048  lds
  v_mfma_f32_16x16x32_bf16 a[164:167], v[156:159], v[60:63], a[164:167]
  v_exp_f32 v185, v41
  v_mfma_f32_16x16x32_bf16 a[24:27], v[160:163], v[48:51], a[24:27]
  v_exp_f32 v186, v42
  v_mfma_f32_16x16x32_bf16 a[72:75], v[160:163], v[52:55], a[72:75]
  s_add_u32 m0, s53, 7168
  ds_read_b64_tr_b16 v[170:171], v4 offset:6400
  v_cvt_pk_bf16_f32 v74, v184, v185
  v_mfma_f32_16x16x32_bf16 a[120:123], v[160:163], v[56:59], a[120:123]
  buffer_load_dwordx4 v[206:207], s[16:19], s60 idxen offen  lds
  v_mfma_f32_16x16x32_bf16 a[168:171], v[160:163], v[60:63], a[168:171]
  s_waitcnt lgkmcnt(3)
  v_exp_f32 v187, v43
  v_mfma_f32_16x16x32_bf16 a[28:31], v[164:167], v[48:51], a[28:31]
  v_exp_f32 v188, v44
  v_mfma_f32_16x16x32_bf16 a[76:79], v[164:167], v[52:55], a[76:79]
  s_add_u32 m0, s52, 36864
  ds_read_b128 v[212:215], v251 offset:10240
  v_cvt_pk_bf16_f32 v75, v186, v187
  v_mfma_f32_16x16x32_bf16 a[124:127], v[164:167], v[56:59], a[124:127]
  s_waitcnt lgkmcnt(2)
  v_exp_f32 v189, v45
  v_mfma_f32_16x16x32_bf16 v[244:247], v[232:235], v[208:211], v[244:247]
  v_exp_f32 v190, v46
  v_mfma_f32_16x16x32_bf16 a[172:175], v[164:167], v[60:63], a[172:175]
  s_waitcnt lgkmcnt(1)
  ds_read_b64_tr_b16 v[172:173], v5 offset:256
  v_cvt_pk_bf16_f32 v78, v188, v189
  v_mfma_f32_16x16x32_bf16 a[32:35], v[168:171], v[48:51], a[32:35]
  v_exp_f32 v191, v47
  v_mfma_f32_16x16x32_bf16 a[80:83], v[168:171], v[52:55], a[80:83]
  v_cvt_pk_bf16_f32 v79, v190, v191
  v_mfma_f32_16x16x32_bf16 a[128:131], v[168:171], v[56:59], a[128:131]
  ds_read_b64_tr_b16 v[174:175], v5 offset:6400
  ds_read_b64_tr_b16 v[176:177], v6 offset:256
  v_mfma_f32_16x16x32_bf16 a[176:179], v[168:171], v[60:63], a[176:179]
  ds_read_b64_tr_b16 v[178:179], v6 offset:6400
  v_cndmask_b32 v248, v248, v240, s[84:85]
  v_mfma_f32_16x16x32_bf16 v[96:99], v[112:115], v[64:67], v[96:99]
  buffer_load_dwordx4 v8, s[12:15], s7 offen offset:0  lds
  v_mfma_f32_16x16x32_bf16 v[100:103], v[112:115], v[68:71], v[100:103]
  s_waitcnt lgkmcnt(4)
  ds_read_b64_tr_b16 v[180:181], v7 offset:256
  v_cndmask_b32 v248, v248, v241, s[86:87]
  v_mfma_f32_16x16x32_bf16 v[244:247], v[236:239], v[212:215], v[244:247]
  v_mfma_f32_16x16x32_bf16 v[104:107], v[112:115], v[72:75], v[104:107]
  ds_read_b64_tr_b16 v[182:183], v7 offset:6400
  v_mfma_f32_16x16x32_bf16 v[108:111], v[112:115], v[76:79], v[108:111]
  s_waitcnt lgkmcnt(4)
  v_mfma_f32_16x16x32_bf16 a[36:39], v[172:175], v[48:51], a[36:39]
  s_cmp_ge_u32 s77, s36
  s_cselect_b64 s[66:67], -1, 0
  ds_read_b128 v[152:155], v2 offset:24576
  v_mfma_f32_16x16x32_bf16 a[84:87], v[172:175], v[52:55], a[84:87]
  v_mfma_f32_16x16x32_bf16 a[132:135], v[172:175], v[56:59], a[132:135]
  ds_read_b128 v[156:159], v3 offset:24576
  v_cndmask_b32 v249, v249, v246, s[84:85]
  v_mfma_f32_16x16x32_bf16 a[180:183], v[172:175], v[60:63], a[180:183]
  s_waitcnt lgkmcnt(4)
  v_max3_f32 v14, v96, v100, v104
  v_add_u32 v1, 256, v1
  v_mfma_f32_16x16x32_bf16 a[40:43], v[176:179], v[48:51], a[40:43]
  v_mfma_f32_16x16x32_bf16 a[88:91], v[176:179], v[52:55], a[88:91]
  s_add_u32 m0, s52, 36864
  v_max_f32 v14, v14, v108
  v_cndmask_b32 v249, v249, v247, s[86:87]
  v_mfma_f32_16x16x32_bf16 a[136:139], v[176:179], v[56:59], a[136:139]
  buffer_load_dwordx4 v9, s[12:15], s7 offen offset:1024  lds
  v_mfma_f32_16x16x32_bf16 a[184:187], v[176:179], v[60:63], a[184:187]
  s_waitcnt lgkmcnt(2)
  ds_read_b128 v[160:163], v2 offset:24704
  v_mfma_f32_16x16x32_bf16 a[44:47], v[180:183], v[48:51], a[44:47]
  s_add_u32 m0, s52, 36864
  v_mfma_f32_16x16x32_bf16 a[92:95], v[180:183], v[52:55], a[92:95]
  v_cmp_nge_f32 s[64:65], s50, v14
  v_mfma_f32_16x16x32_bf16 a[140:143], v[180:183], v[56:59], a[140:143]
  buffer_load_dwordx4 v10, s[12:15], s7 offen offset:2048  lds
  v_mfma_f32_16x16x32_bf16 a[188:191], v[180:183], v[60:63], a[188:191]
  ds_read_b128 v[164:167], v3 offset:24704
  s_or_b64 vcc, s[64:65], s[66:67]
  s_cbranch_vccnz P1K0s1_SLOW
P1K0s1_SLOWB:
  s_add_u32 s3, s33, s29
  s_and_b32 s3, s3, 1
  s_cmp_lg_u32 s3, 0
  s_cbranch_scc1 P1K0_NT
  s_cmp_lt_u32 s33, 1
  s_cbranch_scc1 P1K0_NT
  s_cmp_ge_u32 s96, 3
  s_cbranch_scc1 P1K0_NT
  s_mov_b32 m0, 160768
  s_nop 0
  buffer_load_dword v15, s[68:71], s97 offen  lds
  s_add_u32 s97, s97, 8192
  s_add_u32 s96, s96, 1
P1K0_NT:
  s_add_u32 s33, s33, 1
  s_branch P1K1
.p2align 6
P1K1:
  s_waitcnt lgkmcnt(3)
  v_mfma_f32_16x16x32_bf16 v[16:19], v[152:155], a[240:243], v[80:83]
  s_add_u32 m0, s53, 8192
  v_mfma_f32_16x16x32_bf16 v[20:23], v[152:155], v[128:131], v[84:87]
  ds_read_b128 v[168:171], v2 offset:24832
  v_mfma_f32_16x16x32_bf16 v[24:27], v[152:155], a[192:195], v[88:91]
  s_mov_b32 s76, s77
  buffer_load_dwordx4 v[200:201], s[16:19], s61 idxen offen  lds
  v_mfma_f32_16x16x32_bf16 v[28:31], v[152:155], a[216:219], v[92:95]
  s_waitcnt lgkmcnt(3)
  ds_read_b128 v[172:175], v3 offset:24832
  v_mfma_f32_16x16x32_bf16 v[16:19], v[156:159], a[244:247], v[16:19]
  s_waitcnt vmcnt(11)
  s_add_u32 m0, s53, 9216
  v_mfma_f32_16x16x32_bf16 v[20:23], v[156:159], v[132:135], v[20:23]
  s_mov_b32 s77, s78
  ds_read_b128 v[208:211], v250 offset:0
  v_mfma_f32_16x16x32_bf16 v[24:27], v[156:159], a[196:199], v[24:27]
  buffer_load_dwordx4 v[202:203], s[16:19], s61 idxen offen  lds
  v_mfma_f32_16x16x32_bf16 v[28:31], v[156:159], a[220:223], v[28:31]
  s_waitcnt lgkmcnt(4)
  ds_read_b128 v[212:215], v251 offset:0
  v_mfma_f32_16x16x32_bf16 v[16:19], v[160:163], a[248:251], v[16:19]
  s_mov_b32 s78, s79
  v_mfma_f32_16x16x32_bf16 v[20:23], v[160:163], v[136:139], v[20:23]
  s_mov_b32 s79, s74
  ds_read_b128 v[176:179], v2 offset:30720
  v_mfma_f32_16x16x32_bf16 v[24:27], v[160:163], a[200:203], v[24:27]
  s_add_u32 m0, s53, 10240
  v_mfma_f32_16x16x32_bf16 v[28:31], v[160:163], a[224:227], v[28:31]
  s_waitcnt lgkmcnt(5)
  ds_read_b128 v[180:183], v3 offset:30720
  v_mfma_f32_16x16x32_bf16 v[16:19], v[164:167], a[252:255], v[16:19]
  v_mfma_f32_16x16x32_bf16 v[20:23], v[164:167], v[140:143], v[20:23]
  s_waitcnt lgkmcnt(3)
  buffer_load_dwordx4 v[204:205], s[16:19], s61 idxen offen  lds
  v_mfma_f32_16x16x32_bf16 v[240:243], v[216:219], v[208:211], 0
  ds_read_b128 v[152:155], v2 offset:30848
  v_mfma_f32_16x16x32_bf16 v[24:27], v[164:167], a[204:207], v[24:27]
  v_mfma_f32_16x16x32_bf16 v[28:31], v[164:167], a[228:231], v[28:31]
  s_add_u32 m0, s53, 11264
  ds_read_b128 v[208:211], v250 offset:2048
  v_mfma_f32_16x16x32_bf16 v[16:19], v[168:171], v[120:123], v[16:19]
  s_add_u32 s40, s32, 4
  buffer_load_dwordx4 v[206:207], s[16:19], s61 idxen offen  lds
  v_mfma_f32_16x16x32_bf16 v[20:23], v[168:171], v[144:147], v[20:23]
  ds_read_b128 v[156:159], v3 offset:30848
  v_mfma_f32_16x16x32_bf16 v[24:27], v[168:171], a[208:211], v[24:27]
  v_mfma_f32_16x16x32_bf16 v[28:31], v[168:171], a[232:235], v[28:31]
  ds_read_b128 v[160:163], v2 offset:30976
  v_mfma_f32_16x16x32_bf16 v[16:19], v[172:175], v[124:127], v[16:19]
  s_waitcnt lgkmcnt(6)
  ds_read_b64_tr_b16 v[168:169], v4 offset:12288
  v_readlane_b32 s74, v0, s40
  v_mfma_f32_16x16x32_bf16 v[240:243], v[220:223], v[212:215], v[240:243]
  ds_read_b32 v200, v1 offset:128
  v_mfma_f32_16x16x32_bf16 v[20:23], v[172:175], v[148:151], v[20:23]
  v_mfma_f32_16x16x32_bf16 v[24:27], v[172:175], a[212:215], v[24:27]
  ds_read_b64_tr_b16 v[170:171], v4 offset:18432
  ds_read_b128 v[212:215], v251 offset:2048
  v_mfma_f32_16x16x32_bf16 v[28:31], v[172:175], a[236:239], v[28:31]
  s_waitcnt lgkmcnt(9)
  v_exp_f32 v184, v16
  v_mfma_f32_16x16x32_bf16 v[32:35], v[176:179], a[240:243], v[192:195]
  ds_read_b64_tr_b16 v[172:173], v5 offset:12288
  ds_read_b64_tr_b16 v[174:175], v5 offset:18432
  v_mfma_f32_16x16x32_bf16 v[36:39], v[176:179], v[128:131], v[196:199]
  v_exp_f32 v185, v17
  v_mfma_f32_16x16x32_bf16 v[40:43], v[176:179], a[192:195], v[88:91]
  s_mul_i32 s63, s78, 12288
  ds_read_b128 v[164:167], v3 offset:30976
  ds_read_b32 v202, v1 offset:160
  v_mfma_f32_16x16x32_bf16 v[44:47], v[176:179], a[216:219], v[92:95]
  s_waitcnt lgkmcnt(12)
  v_exp_f32 v186, v18
  v_mfma_f32_16x16x32_bf16 v[32:35], v[180:183], a[244:247], v[32:35]
  s_waitcnt lgkmcnt(10)
  ds_read_b32 v204, v1 offset:192
  v_cvt_pk_bf16_f32 v48, v184, v185
  v_mfma_f32_16x16x32_bf16 v[244:247], v[216:219], v[208:211], 0
  s_add_u32 s63, s63, s75
  v_exp_f32 v187, v19
  v_mfma_f32_16x16x32_bf16 v[36:39], v[180:183], v[132:135], v[36:39]
  v_exp_f32 v188, v20
  v_mfma_f32_16x16x32_bf16 v[40:43], v[180:183], a[196:199], v[40:43]
  ds_read_b64_tr_b16 v[176:177], v6 offset:12288
  ds_read_b32 v206, v1 offset:224
  v_mfma_f32_16x16x32_bf16 v[44:47], v[180:183], a[220:223], v[44:47]
  ds_read_b64_tr_b16 v[178:179], v6 offset:18432
  v_cvt_pk_bf16_f32 v49, v186, v187
  v_mfma_f32_16x16x32_bf16 v[32:35], v[152:155], a[248:251], v[32:35]
  ds_read_b64_tr_b16 v[180:181], v7 offset:12288
  v_mfma_f32_16x16x32_bf16 v[36:39], v[152:155], v[136:139], v[36:39]
  v_exp_f32 v189, v21
  v_mfma_f32_16x16x32_bf16 v[40:43], v[152:155], a[200:203], v[40:43]
  v_exp_f32 v190, v22
  v_mfma_f32_16x16x32_bf16 v[44:47], v[152:155], a[224:227], v[44:47]
  s_waitcnt lgkmcnt(9)
  s_waitcnt vmcnt(7)
  v_mfma_f32_16x16x32_bf16 v[244:247], v[220:223], v[212:215], v[244:247]
  ds_read_b128 v[208:211], v250 offset:4096
  v_cvt_pk_bf16_f32 v52, v188, v189
  v_mfma_f32_16x16x32_bf16 v[32:35], v[156:159], a[252:255], v[32:35]
  s_add_u32 m0, s53, 0
  v_exp_f32 v191, v23
  v_mfma_f32_16x16x32_bf16 v[36:39], v[156:159], v[140:143], v[36:39]
  s_mul_i32 s62, s74, 12288
  buffer_load_dwordx4 v[200:201], s[16:19], 0 idxen offen  lds
  v_mfma_f32_16x16x32_bf16 v[40:43], v[156:159], a[204:207], v[40:43]
  ds_read_b64_tr_b16 v[182:183], v7 offset:18432
  ds_read_b64_tr_b16 v[152:153], v4 offset:12416
  v_mfma_f32_16x16x32_bf16 v[44:47], v[156:159], a[228:231], v[44:47]
  v_exp_f32 v184, v24
  v_mfma_f32_16x16x32_bf16 v[32:35], v[160:163], v[120:123], v[32:35]
  s_add_u32 m0, s53, 1024
  ds_read_b64_tr_b16 v[154:155], v4 offset:18560
  v_cvt_pk_bf16_f32 v53, v190, v191
  v_mfma_f32_16x16x32_bf16 v[36:39], v[160:163], v[144:147], v[36:39]
  v_exp_f32 v185, v25
  v_mfma_f32_16x16x32_bf16 v[40:43], v[160:163], a[208:211], v[40:43]
  s_waitcnt lgkmcnt(9)
  buffer_load_dwordx4 v[202:203], s[16:19], 0 idxen offen  lds
  v_mfma_f32_16x16x32_bf16 v[44:47], v[160:163], a[232:235], v[44:47]
  s_waitcnt lgkmcnt(3)
  v_exp_f32 v186, v26
  v_mfma_f32_16x16x32_bf16 v[240:243], v[224:227], v[208:211], v[240:243]
  v_cvt_pk_bf16_f32 v56, v184, v185
  v_mfma_f32_16x16x32_bf16 v[32:35], v[164:167], v[124:127], v[32:35]
  s_add_u32 s62, s62, s75
  ds_read_b64_tr_b16 v[156:157], v5 offset:12416
  ds_read_b128 v[212:215], v251 offset:4096
  v_mfma_f32_16x16x32_bf16 v[36:39], v[164:167], v[148:151], v[36:39]
  s_add_u32 m0, s53, 2048
  v_exp_f32 v187, v27
  v_mfma_f32_16x16x32_bf16 v[40:43], v[164:167], a[212:215], v[40:43]
  s_waitcnt vmcnt(17)
  s_barrier
  ds_read_b64_tr_b16 v[158:159], v5 offset:18560
  v_mfma_f32_16x16x32_bf16 v[44:47], v[164:167], a[236:239], v[44:47]
  ds_read_b64_tr_b16 v[160:161], v6 offset:12416
  ds_read_b64_tr_b16 v[162:163], v6 offset:18560
  v_mfma_f32_16x16x32_bf16 a[0:3], v[168:171], v[64:67], a[0:3]
  v_exp_f32 v188, v28
  v_mfma_f32_16x16x32_bf16 a[48:51], v[168:171], v[68:71], a[48:51]
  ds_read_b64_tr_b16 v[164:165], v7 offset:12416
  v_cvt_pk_bf16_f32 v57, v186, v187
  v_mfma_f32_16x16x32_bf16 a[96:99], v[168:171], v[72:75], a[96:99]
  s_waitcnt lgkmcnt(4)
  buffer_load_dwordx4 v[204:205], s[16:19], 0 idxen offen  lds
  v_mfma_f32_16x16x32_bf16 v[240:243], v[228:231], v[212:215], v[240:243]
  v_exp_f32 v189, v29
  v_mfma_f32_16x16x32_bf16 a[144:147], v[168:171], v[76:79], a[144:147]
  v_exp_f32 v190, v30
  v_mfma_f32_16x16x32_bf16 a[4:7], v[172:175], v[64:67], a[4:7]
  s_add_u32 m0, s53, 3072
  ds_read_b128 v[208:211], v250 offset:6144
  v_cvt_pk_bf16_f32 v60, v188, v189
  v_mfma_f32_16x16x32_bf16 a[52:55], v[172:175], v[68:71], a[52:55]
  s_add_u32 s32, s32, 1
  buffer_load_dwordx4 v[206:207], s[16:19], 0 idxen offen  lds
  v_mfma_f32_16x16x32_bf16 a[100:103], v[172:175], v[72:75], a[100:103]
  v_exp_f32 v191, v31
  v_mfma_f32_16x16x32_bf16 a[148:151], v[172:175], v[76:79], a[148:151]
  v_cvt_pk_bf16_f32 v61, v190, v191
  v_mfma_f32_16x16x32_bf16 a[8:11], v[176:179], v[64:67], a[8:11]
  v_exp_f32 v184, v32
  v_mfma_f32_16x16x32_bf16 a[56:59], v[176:179], v[68:71], a[56:59]
  v_exp_f32 v185, v33
  v_mfma_f32_16x16x32_bf16 a[104:107], v[176:179], v[72:75], a[104:107]
  s_waitcnt lgkmcnt(0)
  v_exp_f32 v186, v34
  v_mfma_f32_16x16x32_bf16 v[244:247], v[224:227], v[208:211], v[244:247]
  s_add_u32 m0, s51, 24576
  ds_read_b128 v[212:215], v251 offset:6144
  v_cvt_pk_bf16_f32 v50, v184, v185
  v_mfma_f32_16x16x32_bf16 a[152:155], v[176:179], v[76:79], a[152:155]
  v_exp_f32 v187, v35
  v_mfma_f32_16x16x32_bf16 a[12:15], v[180:183], v[64:67], a[12:15]
  v_exp_f32 v188, v36
  v_mfma_f32_16x16x32_bf16 a[60:63], v[180:183], v[68:71], a[60:63]
  buffer_load_dwordx4 v8, s[8:11], s62 offen offset:0  lds
  v_mfma_f32_16x16x32_bf16 a[108:111], v[180:183], v[72:75], a[108:111]
  ds_read_b64_tr_b16 v[166:167], v7 offset:18560
  v_cvt_pk_bf16_f32 v51, v186, v187
  v_mfma_f32_16x16x32_bf16 a[156:159], v[180:183], v[76:79], a[156:159]
  v_exp_f32 v189, v37
  v_mfma_f32_16x16x32_bf16 a[16:19], v[152:155], v[64:67], a[16:19]
  v_exp_f32 v190, v38
  v_mfma_f32_16x16x32_bf16 a[64:67], v[152:155], v[68:71], a[64:67]
  s_waitcnt lgkmcnt(1)
  s_waitcnt vmcnt(5)
  ds_read_b64_tr_b16 v[168:169], v4 offset:12544
  v_mfma_f32_16x16x32_bf16 v[244:247], v[228:231], v[212:215], v[244:247]
  ds_read_b64_tr_b16 v[170:171], v4 offset:18688
  v_cvt_pk_bf16_f32 v54, v188, v189
  v_mfma_f32_16x16x32_bf16 a[112:115], v[152:155], v[72:75], a[112:115]
  s_add_u32 m0, s53, 4096
  ds_read_b128 v[208:211], v250 offset:8192
  v_mfma_f32_16x16x32_bf16 a[160:163], v[152:155], v[76:79], a[160:163]
  buffer_load_dwordx4 v[200:201], s[16:19], s60 idxen offen  lds
  v_mfma_f32_16x16x32_bf16 a[20:23], v[156:159], v[64:67], a[20:23]
  v_exp_f32 v191, v39
  v_mfma_f32_16x16x32_bf16 a[68:71], v[156:159], v[68:71], a[68:71]
  s_add_u32 m0, s51, 24576
  v_exp_f32 v184, v40
  v_mfma_f32_16x16x32_bf16 a[116:119], v[156:159], v[72:75], a[116:119]
  ds_read_b128 v[212:215], v251 offset:8192
  v_cvt_pk_bf16_f32 v55, v190, v191
  v_mfma_f32_16x16x32_bf16 a[164:167], v[156:159], v[76:79], a[164:167]
  buffer_load_dwordx4 v9, s[8:11], s62 offen offset:1024  lds
  v_mfma_f32_16x16x32_bf16 a[24:27], v[160:163], v[64:67], a[24:27]
  s_add_u32 m0, s53, 5120
  v_exp_f32 v185, v41
  v_mfma_f32_16x16x32_bf16 a[72:75], v[160:163], v[68:71], a[72:75]
  s_waitcnt lgkmcnt(1)
  v_exp_f32 v186, v42
  v_mfma_f32_16x16x32_bf16 v[240:243], v[232:235], v[208:211], v[240:243]
  ds_read_b64_tr_b16 v[172:173], v5 offset:12544
  v_cvt_pk_bf16_f32 v58, v184, v185
  v_mfma_f32_16x16x32_bf16 a[120:123], v[160:163], v[72:75], a[120:123]
  v_exp_f32 v187, v43
  v_mfma_f32_16x16x32_bf16 a[168:171], v[160:163], v[76:79], a[168:171]
  buffer_load_dwordx4 v[202:203], s[16:19], s60 idxen offen  lds
  v_mfma_f32_16x16x32_bf16 a[28:31], v[164:167], v[64:67], a[28:31]
  v_exp_f32 v188, v44
  v_mfma_f32_16x16x32_bf16 a[76:79], v[164:167], v[68:71], a[76:79]
  ds_read_b128 v[208:211], v250 offset:10240
  v_cvt_pk_bf16_f32 v59, v186, v187
  v_mfma_f32_16x16x32_bf16 a[124:127], v[164:167], v[72:75], a[124:127]
  s_add_u32 m0, s53, 6144
  v_exp_f32 v189, v45
  v_mfma_f32_16x16x32_bf16 a[172:175], v[164:167], v[76:79], a[172:175]
  v_exp_f32 v190, v46
  v_mfma_f32_16x16x32_bf16 a[32:35], v[168:171], v[64:67], a[32:35]
  s_waitcnt lgkmcnt(2)
  buffer_load_dwordx4 v[204:205], s[16:19], s60 idxen offen  lds
  v_mfma_f32_16x16x32_bf16 v[240:243], v[236:239], v[212:215], v[240:243]
  ds_read_b64_tr_b16 v[174:175], v5 offset:18688
  v_cvt_pk_bf16_f32 v62, v188, v189
  v_mfma_f32_16x16x32_bf16 a[80:83], v[168:171], v[68:71], a[80:83]
  s_add_u32 m0, s53, 7168
  v_exp_f32 v191, v47
  v_mfma_f32_16x16x32_bf16 a[128:131], v[168:171], v[72:75], a[128:131]
  ds_read_b128 v[152:155], v2 offset:36864
  v_cvt_pk_bf16_f32 v63, v190, v191
  v_mfma_f32_16x16x32_bf16 a[176:179], v[168:171], v[76:79], a[176:179]
  buffer_load_dwordx4 v[206:207], s[16:19], s60 idxen offen  lds
  v_mfma_f32_16x16x32_bf16 v[96:99], v[112:115], v[48:51], v[96:99]
  v_mfma_f32_16x16x32_bf16 v[100:103], v[112:115], v[52:55], v[100:103]
  ds_read_b64_tr_b16 v[176:177], v6 offset:12544
  v_mfma_f32_16x16x32_bf16 v[104:107], v[112:115], v[56:59], v[104:107]
  ds_read_b64_tr_b16 v[178:179], v6 offset:18688
  v_mfma_f32_16x16x32_bf16 v[108:111], v[112:115], v[60:63], v[108:111]
  s_waitcnt lgkmcnt(3)
  ds_read_b64_tr_b16 v[180:181], v7 offset:12544
  v_mfma_f32_16x16x32_bf16 a[36:39], v[172:175], v[64:67], a[36:39]
  s_add_u32 m0, s51, 24576
  ds_read_b128 v[212:215], v251 offset:10240
  v_mfma_f32_16x16x32_bf16 v[244:247], v[232:235], v[208:211], v[244:247]
  buffer_load_dwordx4 v10, s[8:11], s62 offen offset:2048  lds
  v_mfma_f32_16x16x32_bf16 a[84:87], v[172:175], v[68:71], a[84:87]
  ds_read_b64_tr_b16 v[182:183], v7 offset:18688
  ds_read_b128 v[156:159], v3 offset:36864
  v_mfma_f32_16x16x32_bf16 a[132:135], v[172:175], v[72:75], a[132:135]
  v_cndmask_b32 v248, v248, v240, s[88:89]
  v_cndmask_b32 v248, v248, v241, s[90:91]
  v_mfma_f32_16x16x32_bf16 a[180:183], v[172:175], v[76:79], a[180:183]
  s_waitcnt lgkmcnt(4)
  v_max3_f32 v14, v96, v100, v104
  v_max_f32 v14, v14, v108
  v_mfma_f32_16x16x32_bf16 a[40:43], v[176:179], v[64:67], a[40:43]
  ds_read_b128 v[160:163], v2 offset:36992
  v_mfma_f32_16x16x32_bf16 a[88:91], v[176:179], v[68:71], a[88:91]
  v_mfma_f32_16x16x32_bf16 a[136:139], v[176:179], v[72:75], a[136:139]
  ds_read_b128 v[164:167], v3 offset:36992
  v_mfma_f32_16x16x32_bf16 a[184:187], v[176:179], v[76:79], a[184:187]
  s_waitcnt lgkmcnt(4)
  s_waitcnt vmcnt(7)
  v_mfma_f32_16x16x32_bf16 v[244:247], v[236:239], v[212:215], v[244:247]
  s_waitcnt lgkmcnt(3)
  ds_read_b128 v[208:211], v250 offset:0
  v_cmp_nge_f32 s[64:65], s50, v14
  v_mfma_f32_16x16x32_bf16 a[44:47], v[180:183], v[64:67], a[44:47]
  v_mfma_f32_16x16x32_bf16 a[92:95], v[180:183], v[68:71], a[92:95]
  s_cmp_ge_u32 s77, s36
  s_cselect_b64 s[66:67], -1, 0
  s_add_u32 m0, s53, 8192
  v_mfma_f32_16x16x32_bf16 a[140:143], v[180:183], v[72:75], a[140:143]
  buffer_load_dwordx4 v[200:201], s[16:19], s61 idxen offen  lds
  v_mfma_f32_16x16x32_bf16 a[188:191], v[180:183], v[76:79], a[188:191]
  s_add_u32 m0, s53, 9216
  ds_read_b128 v[212:215], v251 offset:0
  s_or_b64 vcc, s[64:65], s[66:67]
  s_cbranch_vccnz P1K1s0_SLOW
P1K1s0_SLOWB:
  v_mfma_f32_16x16x32_bf16 v[16:19], v[152:155], a[240:243], v[80:83]
  s_mov_b32 s76, s77
  v_mfma_f32_16x16x32_bf16 v[20:23], v[152:155], v[128:131], v[84:87]
  ds_read_b128 v[168:171], v2 offset:37120
  v_mfma_f32_16x16x32_bf16 v[24:27], v[152:155], a[192:195], v[88:91]
  buffer_load_dwordx4 v[202:203], s[16:19], s61 idxen offen  lds
  v_mfma_f32_16x16x32_bf16 v[28:31], v[152:155], a[216:219], v[92:95]
  s_waitcnt lgkmcnt(2)
  s_mov_b32 s77, s78
  s_add_u32 m0, s52, 0
  v_mfma_f32_16x16x32_bf16 v[240:243], v[216:219], v[208:211], 0
  ds_read_b128 v[172:175], v3 offset:37120
  v_mfma_f32_16x16x32_bf16 v[16:19], v[156:159], a[244:247], v[16:19]
  v_cndmask_b32 v249, v249, v246, s[88:89]
  v_cndmask_b32 v249, v249, v247, s[90:91]
  v_mfma_f32_16x16x32_bf16 v[20:23], v[156:159], v[132:135], v[20:23]
  buffer_load_dwordx4 v8, s[12:15], s63 offen offset:0  lds
  v_mfma_f32_16x16x32_bf16 v[24:27], v[156:159], a[196:199], v[24:27]
  s_add_u32 m0, s53, 10240
  ds_read_b128 v[176:179], v2 offset:43008
  v_mfma_f32_16x16x32_bf16 v[28:31], v[156:159], a[220:223], v[28:31]
  v_mfma_f32_16x16x32_bf16 v[16:19], v[160:163], a[248:251], v[16:19]
  ds_read_b128 v[180:183], v3 offset:43008
  v_mfma_f32_16x16x32_bf16 v[20:23], v[160:163], v[136:139], v[20:23]
  buffer_load_dwordx4 v[204:205], s[16:19], s61 idxen offen  lds
  v_mfma_f32_16x16x32_bf16 v[24:27], v[160:163], a[200:203], v[24:27]
  s_waitcnt lgkmcnt(4)
  v_mfma_f32_16x16x32_bf16 v[240:243], v[220:223], v[212:215], v[240:243]
  ds_read_b128 v[152:155], v2 offset:43136
  v_mfma_f32_16x16x32_bf16 v[28:31], v[160:163], a[224:227], v[28:31]
  s_mov_b32 s78, s79
  v_mfma_f32_16x16x32_bf16 v[16:19], v[164:167], a[252:255], v[16:19]
  s_add_u32 m0, s53, 11264
  ds_read_b128 v[208:211], v250 offset:2048
  v_mfma_f32_16x16x32_bf16 v[20:23], v[164:167], v[140:143], v[20:23]
  buffer_load_dwordx4 v[206:207], s[16:19], s61 idxen offen  lds
  v_mfma_f32_16x16x32_bf16 v[24:27], v[164:167], a[204:207], v[24:27]
  s_mov_b32 s79, s74
  s_add_u32 s40, s32, 4
  ds_read_b128 v[212:215], v251 offset:2048
  v_mfma_f32_16x16x32_bf16 v[28:31], v[164:167], a[228:231], v[28:31]
  s_waitcnt lgkmcnt(6)
  s_add_u32 m0, s52, 0
  v_mfma_f32_16x16x32_bf16 v[16:19], v[168:171], v[120:123], v[16:19]
  ds_read_b128 v[156:159], v3 offset:43136
  ds_read_b32 v200, v1 offset:256
  v_mfma_f32_16x16x32_bf16 v[20:23], v[168:171], v[144:147], v[20:23]
  v_mfma_f32_16x16x32_bf16 v[24:27], v[168:171], a[208:211], v[24:27]
  s_waitcnt lgkmcnt(3)
  buffer_load_dwordx4 v9, s[12:15], s63 offen offset:1024  lds
  v_mfma_f32_16x16x32_bf16 v[244:247], v[216:219], v[208:211], 0
  ds_read_b128 v[160:163], v2 offset:43264
  v_mfma_f32_16x16x32_bf16 v[28:31], v[168:171], a[232:235], v[28:31]
  ds_read_b64_tr_b16 v[168:169], v4 offset:24576
  v_readlane_b32 s74, v0, s40
  v_mfma_f32_16x16x32_bf16 v[16:19], v[172:175], v[124:127], v[16:19]
  s_mul_i32 s7, s78, 12288
  ds_read_b64_tr_b16 v[170:171], v4 offset:30720
  v_mfma_f32_16x16x32_bf16 v[20:23], v[172:175], v[148:151], v[20:23]
  ds_read_b32 v202, v1 offset:288
  ds_read_b32 v204, v1 offset:320
  v_mfma_f32_16x16x32_bf16 v[24:27], v[172:175], a[212:215], v[24:27]
  ds_read_b32 v206, v1 offset:352
  v_mfma_f32_16x16x32_bf16 v[28:31], v[172:175], a[236:239], v[28:31]
  ds_read_b128 v[164:167], v3 offset:43264
  v_mfma_f32_16x16x32_bf16 v[32:35], v[176:179], a[240:243], v[192:195]
  v_exp_f32 v184, v16
  v_mfma_f32_16x16x32_bf16 v[36:39], v[176:179], v[128:131], v[196:199]
  s_waitcnt lgkmcnt(9)
  s_waitcnt vmcnt(7)
  ds_read_b64_tr_b16 v[172:173], v5 offset:24576
  v_mfma_f32_16x16x32_bf16 v[244:247], v[220:223], v[212:215], v[244:247]
  v_exp_f32 v185, v17
  v_mfma_f32_16x16x32_bf16 v[40:43], v[176:179], a[192:195], v[88:91]
  s_add_u32 m0, s53, 0
  ds_read_b64_tr_b16 v[174:175], v5 offset:30720
  ds_read_b128 v[208:211], v250 offset:4096
  v_mfma_f32_16x16x32_bf16 v[44:47], v[176:179], a[216:219], v[92:95]
  s_waitcnt lgkmcnt(10)
  buffer_load_dwordx4 v[200:201], s[16:19], 0 idxen offen  lds
  v_mfma_f32_16x16x32_bf16 v[32:35], v[180:183], a[244:247], v[32:35]
  s_add_u32 m0, s53, 1024
  v_exp_f32 v186, v18
  v_mfma_f32_16x16x32_bf16 v[36:39], v[180:183], v[132:135], v[36:39]
  s_add_u32 s7, s7, s75
  ds_read_b64_tr_b16 v[176:177], v6 offset:24576
  v_cvt_pk_bf16_f32 v64, v184, v185
  v_mfma_f32_16x16x32_bf16 v[40:43], v[180:183], a[196:199], v[40:43]
  v_exp_f32 v187, v19
  v_mfma_f32_16x16x32_bf16 v[44:47], v[180:183], a[220:223], v[44:47]
  s_waitcnt lgkmcnt(7)
  buffer_load_dwordx4 v[202:203], s[16:19], 0 idxen offen  lds
  v_mfma_f32_16x16x32_bf16 v[32:35], v[152:155], a[248:251], v[32:35]
  v_exp_f32 v188, v20
  v_mfma_f32_16x16x32_bf16 v[36:39], v[152:155], v[136:139], v[36:39]
  s_waitcnt lgkmcnt(1)
  ds_read_b128 v[212:215], v251 offset:4096
  v_cvt_pk_bf16_f32 v65, v186, v187
  v_mfma_f32_16x16x32_bf16 v[240:243], v[224:227], v[208:211], v[240:243]
  v_exp_f32 v189, v21
  v_mfma_f32_16x16x32_bf16 v[40:43], v[152:155], a[200:203], v[40:43]
  s_add_u32 m0, s53, 2048
  v_exp_f32 v190, v22
  v_mfma_f32_16x16x32_bf16 v[44:47], v[152:155], a[224:227], v[44:47]
  buffer_load_dwordx4 v[204:205], s[16:19], 0 idxen offen  lds
  v_mfma_f32_16x16x32_bf16 v[32:35], v[156:159], a[252:255], v[32:35]
  s_add_u32 m0, s52, 0
  ds_read_b64_tr_b16 v[178:179], v6 offset:30720
  ds_read_b64_tr_b16 v[180:181], v7 offset:24576
  v_mfma_f32_16x16x32_bf16 v[36:39], v[156:159], v[140:143], v[36:39]
  s_mul_i32 s6, s74, 12288
  v_cvt_pk_bf16_f32 v68, v188, v189
  v_mfma_f32_16x16x32_bf16 v[40:43], v[156:159], a[204:207], v[40:43]
  ds_read_b128 v[208:211], v250 offset:6144
  v_mfma_f32_16x16x32_bf16 v[44:47], v[156:159], a[228:231], v[44:47]
  v_exp_f32 v191, v23
  v_mfma_f32_16x16x32_bf16 v[32:35], v[160:163], v[120:123], v[32:35]
  s_waitcnt lgkmcnt(3)
  buffer_load_dwordx4 v10, s[12:15], s63 offen offset:2048  lds
  v_mfma_f32_16x16x32_bf16 v[240:243], v[228:231], v[212:215], v[240:243]
  s_add_u32 m0, s53, 3072
  v_exp_f32 v184, v24
  v_mfma_f32_16x16x32_bf16 v[36:39], v[160:163], v[144:147], v[36:39]
  ds_read_b128 v[212:215], v251 offset:6144
  v_cvt_pk_bf16_f32 v69, v190, v191
  v_mfma_f32_16x16x32_bf16 v[40:43], v[160:163], a[208:211], v[40:43]
  v_exp_f32 v185, v25
  v_mfma_f32_16x16x32_bf16 v[44:47], v[160:163], a[232:235], v[44:47]
  buffer_load_dwordx4 v[206:207], s[16:19], 0 idxen offen  lds
  v_mfma_f32_16x16x32_bf16 v[32:35], v[164:167], v[124:127], v[32:35]
  v_exp_f32 v186, v26
  v_mfma_f32_16x16x32_bf16 v[36:39], v[164:167], v[148:151], v[36:39]
  s_add_u32 s6, s6, s75
  ds_read_b64_tr_b16 v[182:183], v7 offset:30720
  v_cvt_pk_bf16_f32 v72, v184, v185
  v_mfma_f32_16x16x32_bf16 v[40:43], v[164:167], a[212:215], v[40:43]
  s_waitcnt vmcnt(26)
  s_barrier
  v_exp_f32 v187, v27
  v_mfma_f32_16x16x32_bf16 v[44:47], v[164:167], a[236:239], v[44:47]
  v_exp_f32 v188, v28
  v_mfma_f32_16x16x32_bf16 a[0:3], v[168:171], v[48:51], a[0:3]
  s_waitcnt lgkmcnt(2)
  ds_read_b64_tr_b16 v[152:153], v4 offset:24704
  v_cvt_pk_bf16_f32 v73, v186, v187
  v_mfma_f32_16x16x32_bf16 v[244:247], v[224:227], v[208:211], v[244:247]
  v_exp_f32 v189, v29
  v_mfma_f32_16x16x32_bf16 a[48:51], v[168:171], v[52:55], a[48:51]
  ds_read_b64_tr_b16 v[154:155], v4 offset:30848
  ds_read_b64_tr_b16 v[156:157], v5 offset:24704
  v_mfma_f32_16x16x32_bf16 a[96:99], v[168:171], v[56:59], a[96:99]
  s_add_u32 s32, s32, 1
  v_exp_f32 v190, v30
  v_mfma_f32_16x16x32_bf16 a[144:147], v[168:171], v[60:63], a[144:147]
  ds_read_b64_tr_b16 v[158:159], v5 offset:30848
  ds_read_b64_tr_b16 v[160:161], v6 offset:24704
  v_mfma_f32_16x16x32_bf16 a[4:7], v[172:175], v[48:51], a[4:7]
  ds_read_b64_tr_b16 v[162:163], v6 offset:30848
  v_cvt_pk_bf16_f32 v76, v188, v189
  v_mfma_f32_16x16x32_bf16 a[52:55], v[172:175], v[52:55], a[52:55]
  s_add_u32 m0, s51, 36864
  v_exp_f32 v191, v31
  v_mfma_f32_16x16x32_bf16 a[100:103], v[172:175], v[56:59], a[100:103]
  buffer_load_dwordx4 v8, s[8:11], s6 offen offset:0  lds
  v_mfma_f32_16x16x32_bf16 a[148:151], v[172:175], v[60:63], a[148:151]
  s_waitcnt lgkmcnt(7)
  s_waitcnt vmcnt(7)
  v_cvt_pk_bf16_f32 v77, v190, v191
  v_mfma_f32_16x16x32_bf16 v[244:247], v[228:231], v[212:215], v[244:247]
  ds_read_b64_tr_b16 v[164:165], v7 offset:24704
  ds_read_b128 v[208:211], v250 offset:8192
  v_mfma_f32_16x16x32_bf16 a[8:11], v[176:179], v[48:51], a[8:11]
  s_add_u32 m0, s53, 4096
  v_exp_f32 v184, v32
  v_mfma_f32_16x16x32_bf16 a[56:59], v[176:179], v[52:55], a[56:59]
  buffer_load_dwordx4 v[200:201], s[16:19], s60 idxen offen  lds
  v_mfma_f32_16x16x32_bf16 a[104:107], v[176:179], v[56:59], a[104:107]
  v_exp_f32 v185, v33
  v_mfma_f32_16x16x32_bf16 a[152:155], v[176:179], v[60:63], a[152:155]
  s_waitcnt lgkmcnt(8)
  ds_read_b64_tr_b16 v[166:167], v7 offset:30848
  ds_read_b64_tr_b16 v[168:169], v4 offset:24832
  v_mfma_f32_16x16x32_bf16 a[12:15], v[180:183], v[48:51], a[12:15]
  s_add_u32 m0, s51, 36864
  v_exp_f32 v186, v34
  v_mfma_f32_16x16x32_bf16 a[60:63], v[180:183], v[52:55], a[60:63]
  buffer_load_dwordx4 v9, s[8:11], s6 offen offset:1024  lds
  v_mfma_f32_16x16x32_bf16 a[108:111], v[180:183], v[56:59], a[108:111]
  s_add_u32 m0, s53, 5120
  ds_read_b128 v[212:215], v251 offset:8192
  v_cvt_pk_bf16_f32 v66, v184, v185
  v_mfma_f32_16x16x32_bf16 a[156:159], v[180:183], v[60:63], a[156:159]
  s_waitcnt lgkmcnt(3)
  buffer_load_dwordx4 v[202:203], s[16:19], s60 idxen offen  lds
  v_mfma_f32_16x16x32_bf16 v[240:243], v[232:235], v[208:211], v[240:243]
  v_exp_f32 v187, v35
  v_mfma_f32_16x16x32_bf16 a[16:19], v[152:155], v[48:51], a[16:19]
  v_exp_f32 v188, v36
  v_mfma_f32_16x16x32_bf16 a[64:67], v[152:155], v[52:55], a[64:67]
  s_add_u32 m0, s53, 6144
  ds_read_b128 v[208:211], v250 offset:10240
  v_cvt_pk_bf16_f32 v67, v186, v187
  v_mfma_f32_16x16x32_bf16 a[112:115], v[152:155], v[56:59], a[112:115]
  buffer_load_dwordx4 v[204:205], s[16:19], s60 idxen offen  lds
  v_mfma_f32_16x16x32_bf16 a[160:163], v[152:155], v[60:63], a[160:163]
  v_exp_f32 v189, v37
  v_mfma_f32_16x16x32_bf16 a[20:23], v[156:159], v[48:51], a[20:23]
  s_add_u32 m0, s51, 36864
  v_exp_f32 v190, v38
  v_cvt_pk_bf16_f32 v70, v188, v189
  v_mfma_f32_16x16x32_bf16 a[68:71], v[156:159], v[52:55], a[68:71]
  v_exp_f32 v191, v39
  v_mfma_f32_16x16x32_bf16 a[116:119], v[156:159], v[56:59], a[116:119]
  s_waitcnt lgkmcnt(1)
  buffer_load_dwordx4 v10, s[8:11], s6 offen offset:2048  lds
  v_mfma_f32_16x16x32_bf16 v[240:243], v[236:239], v[212:215], v[240:243]
  s_add_u32 m0, s53, 7168
  v_exp_f32 v184, v40
  v_mfma_f32_16x16x32_bf16 a[164:167], v[156:159], v[60:63], a[164:167]
  ds_read_b64_tr_b16 v[170:171], v4 offset:30976
  v_cvt_pk_bf16_f32 v71, v190, v191
  v_mfma_f32_16x16x32_bf16 a[24:27], v[160:163], v[48:51], a[24:27]
  v_exp_f32 v185, v41
  v_mfma_f32_16x16x32_bf16 a[72:75], v[160:163], v[52:55], a[72:75]
  buffer_load_dwordx4 v[206:207], s[16:19], s60 idxen offen  lds
  v_mfma_f32_16x16x32_bf16 a[120:123], v[160:163], v[56:59], a[120:123]
  s_add_u32 m0, s52, 12288
  v_exp_f32 v186, v42
  v_mfma_f32_16x16x32_bf16 a[168:171], v[160:163], v[60:63], a[168:171]
  ds_read_b128 v[152:155], v2 offset:0
  v_cvt_pk_bf16_f32 v74, v184, v185
  v_mfma_f32_16x16x32_bf16 a[28:31], v[164:167], v[48:51], a[28:31]
  v_exp_f32 v187, v43
  v_mfma_f32_16x16x32_bf16 a[76:79], v[164:167], v[52:55], a[76:79]
  v_exp_f32 v188, v44
  v_mfma_f32_16x16x32_bf16 a[124:127], v[164:167], v[56:59], a[124:127]
  s_waitcnt lgkmcnt(2)
  ds_read_b128 v[212:215], v251 offset:10240
  v_cvt_pk_bf16_f32 v75, v186, v187
  v_mfma_f32_16x16x32_bf16 v[244:247], v[232:235], v[208:211], v[244:247]
  v_exp_f32 v189, v45
  v_mfma_f32_16x16x32_bf16 a[172:175], v[164:167], v[60:63], a[172:175]
  s_waitcnt lgkmcnt(2)
  v_exp_f32 v190, v46
  v_mfma_f32_16x16x32_bf16 a[32:35], v[168:171], v[48:51], a[32:35]
  ds_read_b64_tr_b16 v[172:173], v5 offset:24832
  v_cvt_pk_bf16_f32 v78, v188, v189
  v_mfma_f32_16x16x32_bf16 a[80:83], v[168:171], v[52:55], a[80:83]
  v_exp_f32 v191, v47
  v_mfma_f32_16x16x32_bf16 a[128:131], v[168:171], v[56:59], a[128:131]
  ds_read_b64_tr_b16 v[174:175], v5 offset:30976
  v_cvt_pk_bf16_f32 v79, v190, v191
  v_mfma_f32_16x16x32_bf16 a[176:179], v[168:171], v[60:63], a[176:179]
  ds_read_b128 v[156:159], v3 offset:0
  v_cndmask_b32 v248, v248, v240, s[92:93]
  v_mfma_f32_16x16x32_bf16 v[96:99], v[112:115], v[64:67], v[96:99]
  ds_read_b64_tr_b16 v[176:177], v6 offset:24832
  v_mfma_f32_16x16x32_bf16 v[100:103], v[112:115], v[68:71], v[100:103]
  s_waitcnt lgkmcnt(4)
  ds_read_b64_tr_b16 v[178:179], v6 offset:30976
  v_mfma_f32_16x16x32_bf16 v[244:247], v[236:239], v[212:215], v[244:247]
  buffer_load_dwordx4 v8, s[12:15], s7 offen offset:0  lds
  v_mfma_f32_16x16x32_bf16 v[104:107], v[112:115], v[72:75], v[104:107]
  ds_read_b64_tr_b16 v[180:181], v7 offset:24832
  ds_read_b128 v[160:163], v2 offset:128
  v_mfma_f32_16x16x32_bf16 v[108:111], v[112:115], v[76:79], v[108:111]
  s_waitcnt lgkmcnt(5)
  v_mfma_f32_16x16x32_bf16 a[36:39], v[172:175], v[48:51], a[36:39]
  s_add_u32 m0, s52, 12288
  ds_read_b64_tr_b16 v[182:183], v7 offset:30976
  v_mfma_f32_16x16x32_bf16 a[84:87], v[172:175], v[52:55], a[84:87]
  ds_read_b128 v[164:167], v3 offset:128
  v_mfma_f32_16x16x32_bf16 a[132:135], v[172:175], v[56:59], a[132:135]
  v_mfma_f32_16x16x32_bf16 a[180:183], v[172:175], v[60:63], a[180:183]
  s_waitcnt lgkmcnt(4)
  v_max3_f32 v14, v96, v100, v104
  v_cndmask_b32 v248, v248, v241, s[94:95]
  v_mfma_f32_16x16x32_bf16 a[40:43], v[176:179], v[48:51], a[40:43]
  v_mfma_f32_16x16x32_bf16 a[88:91], v[176:179], v[52:55], a[88:91]
  buffer_load_dwordx4 v9, s[12:15], s7 offen offset:1024  lds
  v_mfma_f32_16x16x32_bf16 a[136:139], v[176:179], v[56:59], a[136:139]
  s_cmp_ge_u32 s77, s36
  s_cselect_b64 s[66:67], -1, 0
  v_mfma_f32_16x16x32_bf16 a[184:187], v[176:179], v[60:63], a[184:187]
  s_waitcnt lgkmcnt(1)
  v_max_f32 v14, v14, v108
  v_mfma_f32_16x16x32_bf16 a[44:47], v[180:183], v[48:51], a[44:47]
  s_add_u32 m0, s52, 12288
  v_cmp_nge_f32 s[64:65], s50, v14
  v_mfma_f32_16x16x32_bf16 a[92:95], v[180:183], v[52:55], a[92:95]
  buffer_load_dwordx4 v10, s[12:15], s7 offen offset:2048  lds
  v_mfma_f32_16x16x32_bf16 a[140:143], v[180:183], v[56:59], a[140:143]
  v_add_u32 v1, 256, v1
  v_mfma_f32_16x16x32_bf16 a[188:191], v[180:183], v[60:63], a[188:191]
  v_cndmask_b32 v249, v249, v246, s[92:93]
  v_cndmask_b32 v249, v249, v247, s[94:95]
  s_or_b64 vcc, s[64:65], s[66:67]
  s_cbranch_vccnz P1K1s1_SLOW
P1K1s1_SLOWB:
  s_add_u32 s3, s33, s29
  s_and_b32 s3, s3, 1
  s_cmp_lg_u32 s3, 0
  s_cbranch_scc1 P1K1_NT
  s_cmp_lt_u32 s33, 1
  s_cbranch_scc1 P1K1_NT
  s_cmp_ge_u32 s96, 3
  s_cbranch_scc1 P1K1_NT
  s_mov_b32 m0, 160768
  s_nop 0
  buffer_load_dword v15, s[68:71], s97 offen  lds
  s_add_u32 s97, s97, 8192
  s_add_u32 s96, s96, 1
P1K1_NT:
  s_cmp_eq_u32 s33, 7
  s_cbranch_scc0 P1K1_NVE
  s_call_b64 s[4:5], VEARLY
P1K1_NVE:
  s_cmp_eq_u32 s33, 1
  s_cbranch_scc0 P1K1_NK0
  s_call_b64 s[72:73], KEND_0
P1K1_NK0:
  s_cmp_eq_u32 s33, 3
  s_cbranch_scc0 P1K1_NK1
  s_call_b64 s[72:73], KEND_1
P1K1_NK1:
  s_cmp_eq_u32 s33, 5
  s_cbranch_scc0 P1K1_NK2
  s_call_b64 s[72:73], KEND_2
P1K1_NK2:
  s_cmp_eq_u32 s33, 7
  s_cbranch_scc0 P1K1_NK3
  s_call_b64 s[72:73], KEND_3
P1K1_NK3:
  s_cmp_eq_u32 s33, s38
  s_cbranch_scc0 P1K1_NP
  ds_read_b64_tr_b16 v[168:169], v4 offset:36864
  ds_read_b64_tr_b16 v[170:171], v4 offset:43008
  ds_read_b64_tr_b16 v[172:173], v5 offset:36864
  ds_read_b64_tr_b16 v[174:175], v5 offset:43008
  ds_read_b64_tr_b16 v[176:177], v6 offset:36864
  ds_read_b64_tr_b16 v[178:179], v6 offset:43008
  ds_read_b64_tr_b16 v[180:181], v7 offset:36864
  ds_read_b64_tr_b16 v[182:183], v7 offset:43008
  s_waitcnt lgkmcnt(6)
  v_mfma_f32_16x16x32_bf16 a[0:3], v[168:171], v[64:67], a[0:3]
  v_mfma_f32_16x16x32_bf16 a[48:51], v[168:171], v[68:71], a[48:51]
  s_waitcnt lgkmcnt(4)
  ds_read_b64_tr_b16 v[168:169], v4 offset:36992
  ds_read_b64_tr_b16 v[170:171], v4 offset:43136
  v_mfma_f32_16x16x32_bf16 a[4:7], v[172:175], v[64:67], a[4:7]
  v_mfma_f32_16x16x32_bf16 a[52:55], v[172:175], v[68:71], a[52:55]
  s_waitcnt lgkmcnt(4)
  ds_read_b64_tr_b16 v[172:173], v5 offset:36992
  ds_read_b64_tr_b16 v[174:175], v5 offset:43136
  v_mfma_f32_16x16x32_bf16 a[8:11], v[176:179], v[64:67], a[8:11]
  v_mfma_f32_16x16x32_bf16 a[56:59], v[176:179], v[68:71], a[56:59]
  s_waitcnt lgkmcnt(4)
  ds_read_b64_tr_b16 v[176:177], v6 offset:36992
  ds_read_b64_tr_b16 v[178:179], v6 offset:43136
  v_mfma_f32_16x16x32_bf16 a[12:15], v[180:183], v[64:67], a[12:15]
  v_mfma_f32_16x16x32_bf16 a[60:63], v[180:183], v[68:71], a[60:63]
  s_waitcnt lgkmcnt(4)
  ds_read_b64_tr_b16 v[180:181], v7 offset:36992
  ds_read_b64_tr_b16 v[182:183], v7 offset:43136
  v_mfma_f32_16x16x32_bf16 a[16:19], v[168:171], v[64:67], a[16:19]
  v_mfma_f32_16x16x32_bf16 a[64:67], v[168:171], v[68:71], a[64:67]
  s_waitcnt lgkmcnt(4)
  ds_read_b64_tr_b16 v[168:169], v4 offset:37120
  ds_read_b64_tr_b16 v[170:171], v4 offset:43264
  v_mfma_f32_16x16x32_bf16 a[20:23], v[172:175], v[64:67], a[20:23]
  v_mfma_f32_16x16x32_bf16 a[68:71], v[172:175], v[68:71], a[68:71]
  s_waitcnt lgkmcnt(4)
  ds_read_b64_tr_b16 v[172:173], v5 offset:37120
  ds_read_b64_tr_b16 v[174:175], v5 offset:43264
  v_mfma_f32_16x16x32_bf16 a[24:27], v[176:179], v[64:67], a[24:27]
  v_mfma_f32_16x16x32_bf16 a[72:75], v[176:179], v[68:71], a[72:75]
  s_waitcnt lgkmcnt(4)
  ds_read_b64_tr_b16 v[176:177], v6 offset:37120
  ds_read_b64_tr_b16 v[178:179], v6 offset:43264
  v_mfma_f32_16x16x32_bf16 a[28:31], v[180:183], v[64:67], a[28:31]
  v_mfma_f32_16x16x32_bf16 a[76:79], v[180:183], v[68:71], a[76:79]
  s_waitcnt lgkmcnt(4)
  ds_read_b64_tr_b16 v[180:181], v7 offset:37120
  ds_read_b64_tr_b16 v[182:183], v7 offset:43264
  v_mfma_f32_16x16x32_bf16 a[32:35], v[168:171], v[64:67], a[32:35]
  v_mfma_f32_16x16x32_bf16 a[80:83], v[168:171], v[68:71], a[80:83]
  s_waitcnt lgkmcnt(4)
  v_mfma_f32_16x16x32_bf16 a[36:39], v[172:175], v[64:67], a[36:39]
  v_mfma_f32_16x16x32_bf16 a[84:87], v[172:175], v[68:71], a[84:87]
  s_waitcnt lgkmcnt(2)
  v_mfma_f32_16x16x32_bf16 a[40:43], v[176:179], v[64:67], a[40:43]
  v_mfma_f32_16x16x32_bf16 a[88:91], v[176:179], v[68:71], a[88:91]
  s_waitcnt lgkmcnt(0)
  v_mfma_f32_16x16x32_bf16 a[44:47], v[180:183], v[64:67], a[44:47]
  v_mfma_f32_16x16x32_bf16 a[92:95], v[180:183], v[68:71], a[92:95]
  s_call_b64 s[72:73], MASK_p2
  s_mov_b32 s34, 2
P1K1_NP:
  s_add_u32 s33, s33, 1
  s_cmp_eq_u32 s33, 8
  s_cbranch_scc1 SWITCH
  s_cmp_eq_u32 s34, 2
  s_cbranch_scc1 P2K0
  s_branch P1K0
.p2align 6
P1V0:
  s_waitcnt lgkmcnt(3)
  v_mfma_f32_16x16x32_bf16 v[16:19], v[152:155], a[240:243], v[80:83]
  ds_read_b32 v200, v1 offset:256
  ds_read_b32 v202, v1 offset:288
  v_mfma_f32_16x16x32_bf16 v[20:23], v[152:155], v[128:131], v[84:87]
  ds_read_b32 v204, v1 offset:320
  ds_read_b32 v206, v1 offset:352
  v_mfma_f32_16x16x32_bf16 v[24:27], v[152:155], a[192:195], v[88:91]
  s_mov_b32 s76, s77
  v_mfma_f32_16x16x32_bf16 v[28:31], v[152:155], a[216:219], v[92:95]
  s_waitcnt lgkmcnt(6)
  ds_read_b128 v[232:235], v244
  v_mfma_f32_16x16x32_bf16 v[16:19], v[156:159], a[244:247], v[16:19]
  s_waitcnt vmcnt(12)
  v_mfma_f32_16x16x32_bf16 v[20:23], v[156:159], v[132:135], v[20:23]
  s_add_u32 m0, s53, 8192
  ds_read_b128 v[168:171], v2 offset:256
  ds_read_b64_tr_b16 v[208:209], v240 offset:0
  v_mfma_f32_16x16x32_bf16 v[24:27], v[156:159], a[196:199], v[24:27]
  s_waitcnt lgkmcnt(6)
  buffer_load_dwordx4 v[200:201], s[16:19], s80 idxen offen  lds
  v_mfma_f32_16x16x32_bf16 v[28:31], v[156:159], a[220:223], v[28:31]
  ds_read_b64_tr_b16 v[210:211], v240 offset:512
  ds_read_b64_tr_b16 v[212:213], v241 offset:0
  v_mfma_f32_16x16x32_bf16 v[16:19], v[160:163], a[248:251], v[16:19]
  s_mov_b32 s77, s78
  v_mfma_f32_16x16x32_bf16 v[20:23], v[160:163], v[136:139], v[20:23]
  s_add_u32 m0, s53, 9216
  ds_read_b128 v[172:175], v3 offset:256
  v_add_u32 v244, s87, v244
  v_mfma_f32_16x16x32_bf16 v[24:27], v[160:163], a[200:203], v[24:27]
  s_mov_b32 s78, s79
  s_mov_b32 s79, s74
  ds_read_b64_tr_b16 v[214:215], v241 offset:512
  v_mfma_f32_16x16x32_bf16 v[28:31], v[160:163], a[224:227], v[28:31]
  ds_read_b128 v[176:179], v2 offset:6144
  v_mfma_f32_16x16x32_bf16 v[16:19], v[164:167], a[252:255], v[16:19]
  s_add_u32 s40, s32, 4
  s_waitcnt lgkmcnt(10)
  buffer_load_dwordx4 v[202:203], s[16:19], s80 idxen offen  lds
  v_mfma_f32_16x16x32_bf16 v[20:23], v[164:167], v[140:143], v[20:23]
  s_waitcnt lgkmcnt(4)
  v_mfma_f32_16x16x32_bf16 v[216:219], v[208:211], v[232:235], 0
  ds_read_b128 v[180:183], v3 offset:6144
  v_readlane_b32 s74, v0, s40
  v_mfma_f32_16x16x32_bf16 v[24:27], v[164:167], a[204:207], v[24:27]
  s_add_u32 m0, s53, 10240
  v_mfma_f32_16x16x32_bf16 v[28:31], v[164:167], a[228:231], v[28:31]
  ds_read_b128 v[152:155], v2 offset:6272
  ds_read_b64_tr_b16 v[208:209], v242 offset:0
  v_mfma_f32_16x16x32_bf16 v[16:19], v[168:171], v[120:123], v[16:19]
  buffer_load_dwordx4 v[204:205], s[16:19], s80 idxen offen  lds
  v_mfma_f32_16x16x32_bf16 v[20:23], v[168:171], v[144:147], v[20:23]
  s_mul_i32 s63, s78, 12288
  ds_read_b128 v[156:159], v3 offset:6272
  v_mfma_f32_16x16x32_bf16 v[24:27], v[168:171], a[208:211], v[24:27]
  ds_read_b64_tr_b16 v[210:211], v242 offset:512
  v_mfma_f32_16x16x32_bf16 v[28:31], v[168:171], a[232:235], v[28:31]
  s_waitcnt lgkmcnt(7)
  s_add_u32 m0, s53, 11264
  ds_read_b128 v[160:163], v2 offset:6400
  v_mfma_f32_16x16x32_bf16 v[16:19], v[172:175], v[124:127], v[16:19]
  s_waitcnt lgkmcnt(7)
  s_add_u32 s63, s63, s75
  ds_read_b64_tr_b16 v[168:169], v4 offset:36864
  v_mfma_f32_16x16x32_bf16 v[220:223], v[212:215], v[232:235], 0
  ds_read_b64_tr_b16 v[212:213], v243 offset:0
  ds_read_b64_tr_b16 v[214:215], v243 offset:512
  v_mfma_f32_16x16x32_bf16 v[20:23], v[172:175], v[148:151], v[20:23]
  s_mul_i32 s62, s74, 12288
  buffer_load_dwordx4 v[206:207], s[16:19], s80 idxen offen  lds
  v_mfma_f32_16x16x32_bf16 v[24:27], v[172:175], a[212:215], v[24:27]
  ds_read_b128 v[164:167], v3 offset:6400
  ds_read_b64_tr_b16 v[170:171], v4 offset:43008
  v_mfma_f32_16x16x32_bf16 v[28:31], v[172:175], a[236:239], v[28:31]
  s_waitcnt lgkmcnt(11)
  v_exp_f32 v184, v16
  v_mfma_f32_16x16x32_bf16 v[32:35], v[176:179], a[240:243], v[192:195]
  v_exp_f32 v185, v17
  v_mfma_f32_16x16x32_bf16 v[36:39], v[176:179], v[128:131], v[196:199]
  v_exp_f32 v186, v18
  v_mfma_f32_16x16x32_bf16 v[40:43], v[176:179], a[192:195], v[88:91]
  ds_read_b64_tr_b16 v[172:173], v5 offset:36864
  v_cvt_pk_bf16_f32 v48, v184, v185
  v_mfma_f32_16x16x32_bf16 v[44:47], v[176:179], a[216:219], v[92:95]
  s_waitcnt lgkmcnt(11)
  v_exp_f32 v187, v19
  v_mfma_f32_16x16x32_bf16 v[32:35], v[180:183], a[244:247], v[32:35]
  s_waitcnt lgkmcnt(7)
  ds_read_b32 v200, v1 offset:384
  ds_read_b128 v[236:239], v245
  v_mfma_f32_16x16x32_bf16 v[224:227], v[208:211], v[232:235], 0
  v_exp_f32 v188, v20
  v_mfma_f32_16x16x32_bf16 v[36:39], v[180:183], v[132:135], v[36:39]
  ds_read_b64_tr_b16 v[174:175], v5 offset:43008
  ds_read_b32 v202, v1 offset:416
  v_mfma_f32_16x16x32_bf16 v[40:43], v[180:183], a[196:199], v[40:43]
  ds_read_b32 v204, v1 offset:448
  v_cvt_pk_bf16_f32 v49, v186, v187
  v_mfma_f32_16x16x32_bf16 v[44:47], v[180:183], a[220:223], v[44:47]
  ds_read_b64_tr_b16 v[176:177], v6 offset:36864
  v_exp_f32 v189, v21
  v_mfma_f32_16x16x32_bf16 v[32:35], v[152:155], a[248:251], v[32:35]
  ds_read_b64_tr_b16 v[178:179], v6 offset:43008
  ds_read_b32 v206, v1 offset:480
  v_mfma_f32_16x16x32_bf16 v[36:39], v[152:155], v[136:139], v[36:39]
  v_exp_f32 v190, v22
  v_mfma_f32_16x16x32_bf16 v[40:43], v[152:155], a[200:203], v[40:43]
  s_add_u32 s62, s62, s75
  ds_read_b64_tr_b16 v[180:181], v7 offset:36864
  v_cvt_pk_bf16_f32 v52, v188, v189
  v_mfma_f32_16x16x32_bf16 v[44:47], v[152:155], a[224:227], v[44:47]
  s_waitcnt lgkmcnt(12)
  s_waitcnt vmcnt(9)
  ds_read_b64_tr_b16 v[182:183], v7 offset:43008
  v_mfma_f32_16x16x32_bf16 v[228:231], v[212:215], v[232:235], 0
  ds_read_b64_tr_b16 v[208:209], v240 offset:4096
  ds_read_b64_tr_b16 v[210:211], v240 offset:4608
  v_mfma_f32_16x16x32_bf16 v[32:35], v[156:159], a[252:255], v[32:35]
  v_exp_f32 v191, v23
  v_mfma_f32_16x16x32_bf16 v[36:39], v[156:159], v[140:143], v[36:39]
  s_add_u32 m0, s53, 0
  v_exp_f32 v184, v24
  v_mfma_f32_16x16x32_bf16 v[40:43], v[156:159], a[204:207], v[40:43]
  s_waitcnt lgkmcnt(11)
  buffer_load_dwordx4 v[200:201], s[16:19], s80 idxen offen  lds
  v_mfma_f32_16x16x32_bf16 v[44:47], v[156:159], a[228:231], v[44:47]
  ds_read_b64_tr_b16 v[152:153], v4 offset:36992
  v_cvt_pk_bf16_f32 v53, v190, v191
  v_mfma_f32_16x16x32_bf16 v[32:35], v[160:163], v[120:123], v[32:35]
  ds_read_b64_tr_b16 v[154:155], v4 offset:43136
  ds_read_b64_tr_b16 v[212:213], v241 offset:4096
  v_mfma_f32_16x16x32_bf16 v[36:39], v[160:163], v[144:147], v[36:39]
  s_add_u32 m0, s53, 1024
  v_exp_f32 v185, v25
  v_mfma_f32_16x16x32_bf16 v[40:43], v[160:163], a[208:211], v[40:43]
  v_exp_f32 v186, v26
  v_mfma_f32_16x16x32_bf16 v[44:47], v[160:163], a[232:235], v[44:47]
  s_waitcnt lgkmcnt(3)
  ds_read_b64_tr_b16 v[156:157], v5 offset:36992
  ds_read_b64_tr_b16 v[214:215], v241 offset:4608
  v_mfma_f32_16x16x32_bf16 v[216:219], v[208:211], v[236:239], v[216:219]
  buffer_load_dwordx4 v[202:203], s[16:19], s80 idxen offen  lds
  v_mfma_f32_16x16x32_bf16 v[32:35], v[164:167], v[124:127], v[32:35]
  s_add_u32 m0, s53, 2048
  v_cvt_pk_bf16_f32 v56, v184, v185
  v_add_u32 v245, s87, v245
  v_mfma_f32_16x16x32_bf16 v[36:39], v[164:167], v[148:151], v[36:39]
  v_exp_f32 v187, v27
  v_mfma_f32_16x16x32_bf16 v[40:43], v[164:167], a[212:215], v[40:43]
  s_waitcnt vmcnt(19)
  s_barrier
  ds_read_b64_tr_b16 v[158:159], v5 offset:43136
  v_mfma_f32_16x16x32_bf16 v[44:47], v[164:167], a[236:239], v[44:47]
  buffer_load_dwordx4 v[204:205], s[16:19], s80 idxen offen  lds
  v_mfma_f32_16x16x32_bf16 a[0:3], v[168:171], v[64:67], a[0:3]
  v_exp_f32 v188, v28
  v_mfma_f32_16x16x32_bf16 a[48:51], v[168:171], v[68:71], a[48:51]
  ds_read_b64_tr_b16 v[208:209], v242 offset:4096
  v_cvt_pk_bf16_f32 v57, v186, v187
  v_mfma_f32_16x16x32_bf16 a[96:99], v[168:171], v[72:75], a[96:99]
  s_waitcnt lgkmcnt(2)
  v_exp_f32 v189, v29
  v_mfma_f32_16x16x32_bf16 v[220:223], v[212:215], v[236:239], v[220:223]
  s_add_u32 m0, s53, 3072
  ds_read_b64_tr_b16 v[210:211], v242 offset:4608
  ds_read_b128 v[232:235], v246
  v_mfma_f32_16x16x32_bf16 a[144:147], v[168:171], v[76:79], a[144:147]
  buffer_load_dwordx4 v[206:207], s[16:19], s80 idxen offen  lds
  v_mfma_f32_16x16x32_bf16 a[4:7], v[172:175], v[64:67], a[4:7]
  ds_read_b64_tr_b16 v[160:161], v6 offset:36992
  ds_read_b64_tr_b16 v[212:213], v243 offset:4096
  v_mfma_f32_16x16x32_bf16 a[52:55], v[172:175], v[68:71], a[52:55]
  v_exp_f32 v190, v30
  v_mfma_f32_16x16x32_bf16 a[100:103], v[172:175], v[72:75], a[100:103]
  s_add_u32 m0, s51, 0
  ds_read_b64_tr_b16 v[162:163], v6 offset:43136
  ds_read_b64_tr_b16 v[164:165], v7 offset:36992
  v_mfma_f32_16x16x32_bf16 a[148:151], v[172:175], v[76:79], a[148:151]
  ds_read_b64_tr_b16 v[166:167], v7 offset:43136
  v_add_u32 v1, s84, v1
  v_mfma_f32_16x16x32_bf16 a[8:11], v[176:179], v[64:67], a[8:11]
  ds_read_b32 v200, v1 offset:0
  v_cvt_pk_bf16_f32 v60, v188, v189
  v_mfma_f32_16x16x32_bf16 a[56:59], v[176:179], v[68:71], a[56:59]
  ds_read_b64_tr_b16 v[168:169], v4 offset:37120
  v_exp_f32 v191, v31
  v_mfma_f32_16x16x32_bf16 a[104:107], v[176:179], v[72:75], a[104:107]
  s_waitcnt lgkmcnt(8)
  ds_read_b64_tr_b16 v[214:215], v243 offset:4608
  v_cvt_pk_bf16_f32 v61, v190, v191
  v_mfma_f32_16x16x32_bf16 v[224:227], v[208:211], v[236:239], v[224:227]
  v_exp_f32 v184, v32
  v_exp_f32 v185, v33
  v_mfma_f32_16x16x32_bf16 a[152:155], v[176:179], v[76:79], a[152:155]
  ds_read_b32 v202, v1 offset:32
  v_exp_f32 v186, v34
  v_mfma_f32_16x16x32_bf16 a[12:15], v[180:183], v[64:67], a[12:15]
  ds_read_b64_tr_b16 v[170:171], v4 offset:43264
  ds_read_b64_tr_b16 v[172:173], v5 offset:37120
  v_cvt_pk_bf16_f32 v50, v184, v185
  v_mfma_f32_16x16x32_bf16 a[60:63], v[180:183], v[68:71], a[60:63]
  v_exp_f32 v187, v35
  v_mfma_f32_16x16x32_bf16 a[108:111], v[180:183], v[72:75], a[108:111]
  ds_read_b32 v204, v1 offset:64
  ds_read_b32 v206, v1 offset:96
  v_mfma_f32_16x16x32_bf16 a[156:159], v[180:183], v[76:79], a[156:159]
  buffer_load_dwordx4 v8, s[8:11], s62 offen offset:0  lds
  v_mfma_f32_16x16x32_bf16 a[16:19], v[152:155], v[64:67], a[16:19]
  v_exp_f32 v188, v36
  v_mfma_f32_16x16x32_bf16 a[64:67], v[152:155], v[68:71], a[64:67]
  s_waitcnt lgkmcnt(5)
  s_waitcnt vmcnt(5)
  v_cvt_pk_bf16_f32 v51, v186, v187
  v_mfma_f32_16x16x32_bf16 v[228:231], v[212:215], v[236:239], v[228:231]
  ds_read_b64_tr_b16 v[208:209], v240 offset:8192
  ds_read_b64_tr_b16 v[210:211], v240 offset:8704
  v_mfma_f32_16x16x32_bf16 a[112:115], v[152:155], v[72:75], a[112:115]
  s_add_u32 m0, s53, 4096
  v_exp_f32 v189, v37
  v_mfma_f32_16x16x32_bf16 a[160:163], v[152:155], v[76:79], a[160:163]
  buffer_load_dwordx4 v[200:201], s[16:19], s81 idxen offen  lds
  v_mfma_f32_16x16x32_bf16 a[20:23], v[156:159], v[64:67], a[20:23]
  v_exp_f32 v190, v38
  v_mfma_f32_16x16x32_bf16 a[68:71], v[156:159], v[68:71], a[68:71]
  s_add_u32 s32, s32, 1
  ds_read_b64_tr_b16 v[212:213], v241 offset:8192
  v_cvt_pk_bf16_f32 v54, v188, v189
  v_mfma_f32_16x16x32_bf16 a[116:119], v[156:159], v[72:75], a[116:119]
  s_add_u32 m0, s51, 0
  ds_read_b64_tr_b16 v[214:215], v241 offset:8704
  v_add_u32 v246, s87, v246
  v_mfma_f32_16x16x32_bf16 a[164:167], v[156:159], v[76:79], a[164:167]
  v_exp_f32 v191, v39
  v_mfma_f32_16x16x32_bf16 a[24:27], v[160:163], v[64:67], a[24:27]
  buffer_load_dwordx4 v9, s[8:11], s62 offen offset:1024  lds
  v_mfma_f32_16x16x32_bf16 a[72:75], v[160:163], v[68:71], a[72:75]
  s_waitcnt lgkmcnt(2)
  v_exp_f32 v184, v40
  v_mfma_f32_16x16x32_bf16 v[216:219], v[208:211], v[232:235], v[216:219]
  s_add_u32 m0, s53, 5120
  ds_read_b64_tr_b16 v[208:209], v242 offset:8192
  v_cvt_pk_bf16_f32 v55, v190, v191
  v_mfma_f32_16x16x32_bf16 a[120:123], v[160:163], v[72:75], a[120:123]
  v_exp_f32 v185, v41
  v_mfma_f32_16x16x32_bf16 a[168:171], v[160:163], v[76:79], a[168:171]
  buffer_load_dwordx4 v[202:203], s[16:19], s81 idxen offen  lds
  v_mfma_f32_16x16x32_bf16 a[28:31], v[164:167], v[64:67], a[28:31]
  s_add_u32 m0, s53, 6144
  v_exp_f32 v186, v42
  v_mfma_f32_16x16x32_bf16 a[76:79], v[164:167], v[68:71], a[76:79]
  v_cvt_pk_bf16_f32 v58, v184, v185
  v_exp_f32 v187, v43
  v_mfma_f32_16x16x32_bf16 a[124:127], v[164:167], v[72:75], a[124:127]
  v_exp_f32 v188, v44
  v_mfma_f32_16x16x32_bf16 a[172:175], v[164:167], v[76:79], a[172:175]
  ds_read_b64_tr_b16 v[174:175], v5 offset:43264
  v_cvt_pk_bf16_f32 v59, v186, v187
  v_mfma_f32_16x16x32_bf16 a[32:35], v[168:171], v[64:67], a[32:35]
  s_waitcnt lgkmcnt(2)
  buffer_load_dwordx4 v[204:205], s[16:19], s81 idxen offen  lds
  v_mfma_f32_16x16x32_bf16 v[220:223], v[212:215], v[232:235], v[220:223]
  v_exp_f32 v189, v45
  v_mfma_f32_16x16x32_bf16 a[80:83], v[168:171], v[68:71], a[80:83]
  v_exp_f32 v190, v46
  v_cvt_pk_bf16_f32 v62, v188, v189
  v_exp_f32 v191, v47
  v_mfma_f32_16x16x32_bf16 a[128:131], v[168:171], v[72:75], a[128:131]
  s_add_u32 m0, s53, 7168
  ds_read_b64_tr_b16 v[210:211], v242 offset:8704
  v_cvt_pk_bf16_f32 v63, v190, v191
  v_mfma_f32_16x16x32_bf16 a[176:179], v[168:171], v[76:79], a[176:179]
  ds_read_b64_tr_b16 v[176:177], v6 offset:37120
  ds_read_b64_tr_b16 v[178:179], v6 offset:43264
  v_mfma_f32_16x16x32_bf16 v[96:99], v[112:115], v[48:51], v[96:99]
  buffer_load_dwordx4 v[206:207], s[16:19], s81 idxen offen  lds
  v_mfma_f32_16x16x32_bf16 v[100:103], v[112:115], v[52:55], v[100:103]
  ds_read_b128 v[236:239], v247
  v_mfma_f32_16x16x32_bf16 v[104:107], v[112:115], v[56:59], v[104:107]
  s_cmp_ge_u32 s77, s36
  s_cselect_b64 s[66:67], -1, 0
  ds_read_b64_tr_b16 v[180:181], v7 offset:37120
  v_mfma_f32_16x16x32_bf16 v[108:111], v[112:115], v[60:63], v[108:111]
  s_waitcnt lgkmcnt(5)
  s_add_u32 m0, s51, 0
  ds_read_b32 v200, v1 offset:128
  v_mfma_f32_16x16x32_bf16 a[36:39], v[172:175], v[64:67], a[36:39]
  s_waitcnt lgkmcnt(5)
  ds_read_b64_tr_b16 v[212:213], v243 offset:8192
  ds_read_b64_tr_b16 v[214:215], v243 offset:8704
  v_mfma_f32_16x16x32_bf16 v[224:227], v[208:211], v[232:235], v[224:227]
  ds_read_b32 v202, v1 offset:160
  v_add_u32 v247, s87, v247
  v_mfma_f32_16x16x32_bf16 a[84:87], v[172:175], v[68:71], a[84:87]
  ds_read_b32 v204, v1 offset:192
  ds_read_b32 v206, v1 offset:224
  v_mfma_f32_16x16x32_bf16 a[132:135], v[172:175], v[72:75], a[132:135]
  ds_read_b64_tr_b16 v[182:183], v7 offset:43264
  v_mfma_f32_16x16x32_bf16 a[180:183], v[172:175], v[76:79], a[180:183]
  s_waitcnt lgkmcnt(9)
  ds_read_b128 v[152:155], v2 offset:12288
  v_mfma_f32_16x16x32_bf16 a[40:43], v[176:179], v[64:67], a[40:43]
  v_mfma_f32_16x16x32_bf16 a[88:91], v[176:179], v[68:71], a[88:91]
  ds_read_b128 v[156:159], v3 offset:12288
  v_mfma_f32_16x16x32_bf16 a[136:139], v[176:179], v[72:75], a[136:139]
  buffer_load_dwordx4 v10, s[8:11], s62 offen offset:2048  lds
  v_mfma_f32_16x16x32_bf16 a[184:187], v[176:179], v[76:79], a[184:187]
  s_waitcnt lgkmcnt(6)
  s_waitcnt vmcnt(7)
  ds_read_b128 v[160:163], v2 offset:12416
  v_mfma_f32_16x16x32_bf16 v[228:231], v[212:215], v[232:235], v[228:231]
  s_waitcnt lgkmcnt(3)
  ds_read_b64_tr_b16 v[208:209], v240 offset:0
  v_max3_f32 v14, v96, v100, v104
  v_mfma_f32_16x16x32_bf16 a[44:47], v[180:183], v[64:67], a[44:47]
  ds_read_b64_tr_b16 v[210:211], v240 offset:512
  v_max_f32 v14, v14, v108
  v_mfma_f32_16x16x32_bf16 a[92:95], v[180:183], v[68:71], a[92:95]
  s_add_u32 m0, s53, 8192
  v_cmp_nge_f32 s[64:65], s50, v14
  v_mfma_f32_16x16x32_bf16 a[140:143], v[180:183], v[72:75], a[140:143]
  ds_read_b128 v[164:167], v3 offset:12416
  v_mfma_f32_16x16x32_bf16 a[188:191], v[180:183], v[76:79], a[188:191]
  s_waitcnt lgkmcnt(5)
  buffer_load_dwordx4 v[200:201], s[16:19], s81 idxen offen  lds
  s_or_b64 vcc, s[64:65], s[66:67]
  s_cbranch_vccnz P1V0s0_SLOW
P1V0s0_SLOWB:
  v_mfma_f32_16x16x32_bf16 v[16:19], v[152:155], a[240:243], v[80:83]
  s_add_u32 m0, s53, 9216
  ds_read_b128 v[168:171], v2 offset:12544
  ds_read_b64_tr_b16 v[212:213], v241 offset:0
  v_mfma_f32_16x16x32_bf16 v[20:23], v[152:155], v[128:131], v[84:87]
  s_mov_b32 s76, s77
  v_mfma_f32_16x16x32_bf16 v[24:27], v[152:155], a[192:195], v[88:91]
  ds_read_b128 v[172:175], v3 offset:12544
  ds_read_b64_tr_b16 v[214:215], v241 offset:512
  v_mfma_f32_16x16x32_bf16 v[28:31], v[152:155], a[216:219], v[92:95]
  s_waitcnt lgkmcnt(5)
  buffer_load_dwordx4 v[202:203], s[16:19], s81 idxen offen  lds
  v_mfma_f32_16x16x32_bf16 v[216:219], v[208:211], v[236:239], v[216:219]
  s_mov_b32 s77, s78
  ds_read_b128 v[176:179], v2 offset:18432
  v_mfma_f32_16x16x32_bf16 v[16:19], v[156:159], a[244:247], v[16:19]
  s_mov_b32 s78, s79
  v_mfma_f32_16x16x32_bf16 v[20:23], v[156:159], v[132:135], v[20:23]
  s_add_u32 m0, s52, 24576
  ds_read_b128 v[180:183], v3 offset:18432
  ds_read_b64_tr_b16 v[208:209], v242 offset:0
  v_mfma_f32_16x16x32_bf16 v[24:27], v[156:159], a[196:199], v[24:27]
  buffer_load_dwordx4 v8, s[12:15], s63 offen offset:0  lds
  v_mfma_f32_16x16x32_bf16 v[28:31], v[156:159], a[220:223], v[28:31]
  s_add_u32 m0, s53, 10240
  ds_read_b128 v[232:235], v244
  v_mfma_f32_16x16x32_bf16 v[16:19], v[160:163], a[248:251], v[16:19]
  s_mov_b32 s79, s74
  s_add_u32 s40, s32, 4
  v_cvt_pk_bf16_f32 v248, v216, v217
  v_mfma_f32_16x16x32_bf16 v[20:23], v[160:163], v[136:139], v[20:23]
  ds_read_b64_tr_b16 v[210:211], v242 offset:512
  v_mfma_f32_16x16x32_bf16 v[24:27], v[160:163], a[200:203], v[24:27]
  s_waitcnt lgkmcnt(5)
  buffer_load_dwordx4 v[204:205], s[16:19], s81 idxen offen  lds
  v_mfma_f32_16x16x32_bf16 v[220:223], v[212:215], v[236:239], v[220:223]
  ds_read_b128 v[152:155], v2 offset:18560
  v_cvt_pk_bf16_f32 v249, v218, v219
  v_mfma_f32_16x16x32_bf16 v[28:31], v[160:163], a[224:227], v[28:31]
  ds_read_b64_tr_b16 v[212:213], v243 offset:0
  v_mfma_f32_16x16x32_bf16 v[16:19], v[164:167], a[252:255], v[16:19]
  s_add_u32 m0, s53, 11264
  ds_read_b128 v[156:159], v3 offset:18560
  v_readlane_b32 s74, v0, s40
  v_mfma_f32_16x16x32_bf16 v[20:23], v[164:167], v[140:143], v[20:23]
  s_mul_i32 s7, s78, 12288
  buffer_load_dwordx4 v[206:207], s[16:19], s81 idxen offen  lds
  v_mfma_f32_16x16x32_bf16 v[24:27], v[164:167], a[204:207], v[24:27]
  ds_read_b128 v[160:163], v2 offset:18688
  v_cvt_pk_bf16_f32 v250, v220, v221
  v_mfma_f32_16x16x32_bf16 v[28:31], v[164:167], a[228:231], v[28:31]
  s_add_u32 s7, s7, s75
  ds_read_b32 v200, v1 offset:256
  v_mfma_f32_16x16x32_bf16 v[16:19], v[168:171], v[120:123], v[16:19]
  s_add_u32 m0, s52, 24576
  ds_read_b128 v[164:167], v3 offset:18688
  v_cvt_pk_bf16_f32 v251, v222, v223
  v_mfma_f32_16x16x32_bf16 v[20:23], v[168:171], v[144:147], v[20:23]
  buffer_store_dwordx4 v[248:251], v13, s[24:27], s90 offen offset:0 sc1
  v_mfma_f32_16x16x32_bf16 v[24:27], v[168:171], a[208:211], v[24:27]
  s_waitcnt lgkmcnt(6)
  ds_read_b32 v202, v1 offset:288
  v_mfma_f32_16x16x32_bf16 v[224:227], v[208:211], v[236:239], v[224:227]
  ds_read_b32 v204, v1 offset:320
  ds_read_b32 v206, v1 offset:352
  v_mfma_f32_16x16x32_bf16 v[28:31], v[168:171], a[232:235], v[28:31]
  ds_read_b64_tr_b16 v[214:215], v243 offset:512
  v_add_u32 v244, s88, v244
  v_mfma_f32_16x16x32_bf16 v[16:19], v[172:175], v[124:127], v[16:19]
  ds_read_b64_tr_b16 v[168:169], v4 offset:0
  ds_read_b64_tr_b16 v[170:171], v4 offset:6144
  v_mfma_f32_16x16x32_bf16 v[20:23], v[172:175], v[148:151], v[20:23]
  buffer_load_dwordx4 v9, s[12:15], s63 offen offset:1024  lds
  v_mfma_f32_16x16x32_bf16 v[24:27], v[172:175], a[212:215], v[24:27]
  v_cvt_pk_bf16_f32 v252, v224, v225
  v_cvt_pk_bf16_f32 v253, v226, v227
  v_mfma_f32_16x16x32_bf16 v[28:31], v[172:175], a[236:239], v[28:31]
  ds_read_b64_tr_b16 v[172:173], v5 offset:0
  ds_read_b64_tr_b16 v[174:175], v5 offset:6144
  v_mfma_f32_16x16x32_bf16 v[32:35], v[176:179], a[240:243], v[192:195]
  v_exp_f32 v184, v16
  v_mfma_f32_16x16x32_bf16 v[36:39], v[176:179], v[128:131], v[196:199]
  s_waitcnt lgkmcnt(4)
  s_waitcnt vmcnt(8)
  v_exp_f32 v185, v17
  v_mfma_f32_16x16x32_bf16 v[228:231], v[212:215], v[236:239], v[228:231]
  s_add_u32 m0, s53, 0
  v_exp_f32 v186, v18
  v_mfma_f32_16x16x32_bf16 v[40:43], v[176:179], a[192:195], v[88:91]
  ds_read_b64_tr_b16 v[208:209], v240 offset:4096
  ds_read_b64_tr_b16 v[210:211], v240 offset:4608
  v_mfma_f32_16x16x32_bf16 v[44:47], v[176:179], a[216:219], v[92:95]
  buffer_load_dwordx4 v[200:201], s[16:19], s81 idxen offen  lds
  v_mfma_f32_16x16x32_bf16 v[32:35], v[180:183], a[244:247], v[32:35]
  ds_read_b64_tr_b16 v[176:177], v6 offset:0
  ds_read_b64_tr_b16 v[178:179], v6 offset:6144
  v_cvt_pk_bf16_f32 v64, v184, v185
  v_mfma_f32_16x16x32_bf16 v[36:39], v[180:183], v[132:135], v[36:39]
  s_add_u32 m0, s53, 1024
  v_exp_f32 v187, v19
  v_mfma_f32_16x16x32_bf16 v[40:43], v[180:183], a[196:199], v[40:43]
  v_exp_f32 v188, v20
  v_mfma_f32_16x16x32_bf16 v[44:47], v[180:183], a[220:223], v[44:47]
  buffer_load_dwordx4 v[202:203], s[16:19], s81 idxen offen  lds
  v_cvt_pk_bf16_f32 v65, v186, v187
  v_mfma_f32_16x16x32_bf16 v[32:35], v[152:155], a[248:251], v[32:35]
  ds_read_b64_tr_b16 v[212:213], v241 offset:4096
  ds_read_b128 v[236:239], v245
  v_mfma_f32_16x16x32_bf16 v[36:39], v[152:155], v[136:139], v[36:39]
  s_waitcnt lgkmcnt(4)
  v_exp_f32 v189, v21
  v_mfma_f32_16x16x32_bf16 v[216:219], v[208:211], v[232:235], 0
  ds_read_b64_tr_b16 v[214:215], v241 offset:4608
  v_exp_f32 v190, v22
  v_mfma_f32_16x16x32_bf16 v[40:43], v[152:155], a[200:203], v[40:43]
  s_add_u32 m0, s53, 2048
  ds_read_b64_tr_b16 v[180:181], v7 offset:0
  ds_read_b64_tr_b16 v[208:209], v242 offset:4096
  v_mfma_f32_16x16x32_bf16 v[44:47], v[152:155], a[224:227], v[44:47]
  buffer_load_dwordx4 v[204:205], s[16:19], s81 idxen offen  lds
  v_mfma_f32_16x16x32_bf16 v[32:35], v[156:159], a[252:255], v[32:35]
  s_add_u32 m0, s52, 24576
  ds_read_b64_tr_b16 v[182:183], v7 offset:6144
  v_cvt_pk_bf16_f32 v68, v188, v189
  v_mfma_f32_16x16x32_bf16 v[36:39], v[156:159], v[140:143], v[36:39]
  ds_read_b64_tr_b16 v[210:211], v242 offset:4608
  v_cvt_pk_bf16_f32 v254, v228, v229
  v_mfma_f32_16x16x32_bf16 v[40:43], v[156:159], a[204:207], v[40:43]
  v_exp_f32 v191, v23
  v_mfma_f32_16x16x32_bf16 v[44:47], v[156:159], a[228:231], v[44:47]
  v_exp_f32 v184, v24
  v_mfma_f32_16x16x32_bf16 v[32:35], v[160:163], v[120:123], v[32:35]
  s_waitcnt lgkmcnt(4)
  ds_read_b64_tr_b16 v[152:153], v4 offset:128
  v_cvt_pk_bf16_f32 v69, v190, v191
  v_mfma_f32_16x16x32_bf16 v[220:223], v[212:215], v[232:235], 0
  buffer_load_dwordx4 v10, s[12:15], s63 offen offset:2048  lds
  v_mfma_f32_16x16x32_bf16 v[36:39], v[160:163], v[144:147], v[36:39]
  s_add_u32 m0, s53, 3072
  ds_read_b64_tr_b16 v[154:155], v4 offset:6272
  v_cvt_pk_bf16_f32 v255, v230, v231
  v_mfma_f32_16x16x32_bf16 v[40:43], v[160:163], a[208:211], v[40:43]
  v_exp_f32 v185, v25
  v_mfma_f32_16x16x32_bf16 v[44:47], v[160:163], a[232:235], v[44:47]
  ds_read_b64_tr_b16 v[156:157], v5 offset:128
  ds_read_b64_tr_b16 v[158:159], v5 offset:6272
  ds_read_b64_tr_b16 v[212:213], v243 offset:4096
  v_mfma_f32_16x16x32_bf16 v[32:35], v[164:167], v[124:127], v[32:35]
  s_mul_i32 s6, s74, 12288
  buffer_load_dwordx4 v[206:207], s[16:19], s81 idxen offen  lds
  v_mfma_f32_16x16x32_bf16 v[36:39], v[164:167], v[148:151], v[36:39]
  s_add_u32 s6, s6, s75
  v_exp_f32 v186, v26
  v_cvt_pk_bf16_f32 v72, v184, v185
  v_mfma_f32_16x16x32_bf16 v[40:43], v[164:167], a[212:215], v[40:43]
  s_waitcnt vmcnt(28)
  s_barrier
  ds_read_b32 v200, v1 offset:384
  v_mfma_f32_16x16x32_bf16 v[44:47], v[164:167], a[236:239], v[44:47]
  ds_read_b32 v202, v1 offset:416
  v_exp_f32 v187, v27
  v_mfma_f32_16x16x32_bf16 a[0:3], v[168:171], v[48:51], a[0:3]
  s_waitcnt lgkmcnt(7)
  v_exp_f32 v188, v28
  v_mfma_f32_16x16x32_bf16 v[224:227], v[208:211], v[232:235], 0
  ds_read_b64_tr_b16 v[214:215], v243 offset:4608
  ds_read_b32 v204, v1 offset:448
  v_mfma_f32_16x16x32_bf16 a[48:51], v[168:171], v[52:55], a[48:51]
  ds_read_b32 v206, v1 offset:480
  v_cvt_pk_bf16_f32 v73, v186, v187
  v_mfma_f32_16x16x32_bf16 a[96:99], v[168:171], v[56:59], a[96:99]
  buffer_store_dwordx4 v[252:255], v13, s[24:27], s90 offen offset:1024 sc1
  v_mfma_f32_16x16x32_bf16 a[144:147], v[168:171], v[60:63], a[144:147]
  ds_read_b64_tr_b16 v[160:161], v6 offset:128
  v_add_u32 v245, s88, v245
  v_mfma_f32_16x16x32_bf16 a[4:7], v[172:175], v[48:51], a[4:7]
  s_add_u32 m0, s51, 12288
  v_exp_f32 v189, v29
  v_mfma_f32_16x16x32_bf16 a[52:55], v[172:175], v[52:55], a[52:55]
  v_exp_f32 v190, v30
  v_mfma_f32_16x16x32_bf16 a[100:103], v[172:175], v[56:59], a[100:103]
  buffer_load_dwordx4 v8, s[8:11], s6 offen offset:0  lds
  v_mfma_f32_16x16x32_bf16 a[148:151], v[172:175], v[60:63], a[148:151]
  s_waitcnt lgkmcnt(3)
  s_waitcnt vmcnt(9)
  v_cvt_pk_bf16_f32 v76, v188, v189
  v_mfma_f32_16x16x32_bf16 v[228:231], v[212:215], v[232:235], 0
  ds_read_b64_tr_b16 v[208:209], v240 offset:8192
  v_exp_f32 v191, v31
  v_mfma_f32_16x16x32_bf16 a[8:11], v[176:179], v[48:51], a[8:11]
  s_add_u32 m0, s53, 4096
  ds_read_b64_tr_b16 v[210:211], v240 offset:8704
  ds_read_b64_tr_b16 v[212:213], v241 offset:8192
  v_mfma_f32_16x16x32_bf16 a[56:59], v[176:179], v[52:55], a[56:59]
  buffer_load_dwordx4 v[200:201], s[16:19], s81 idxen offen  lds
  v_mfma_f32_16x16x32_bf16 a[104:107], v[176:179], v[56:59], a[104:107]
  v_cvt_pk_bf16_f32 v77, v190, v191
  v_exp_f32 v184, v32
  v_mfma_f32_16x16x32_bf16 a[152:155], v[176:179], v[60:63], a[152:155]
  ds_read_b64_tr_b16 v[162:163], v6 offset:6272
  ds_read_b64_tr_b16 v[214:215], v241 offset:8704
  v_mfma_f32_16x16x32_bf16 a[12:15], v[180:183], v[48:51], a[12:15]
  s_add_u32 m0, s51, 12288
  v_exp_f32 v185, v33
  v_mfma_f32_16x16x32_bf16 a[60:63], v[180:183], v[52:55], a[60:63]
  s_add_u32 s32, s32, 1
  buffer_load_dwordx4 v9, s[8:11], s6 offen offset:1024  lds
  v_mfma_f32_16x16x32_bf16 a[108:111], v[180:183], v[56:59], a[108:111]
  s_add_u32 m0, s53, 5120
  v_exp_f32 v186, v34
  v_mfma_f32_16x16x32_bf16 a[156:159], v[180:183], v[60:63], a[156:159]
  s_waitcnt lgkmcnt(3)
  ds_read_b64_tr_b16 v[164:165], v7 offset:128
  v_cvt_pk_bf16_f32 v66, v184, v185
  v_mfma_f32_16x16x32_bf16 v[216:219], v[208:211], v[236:239], v[216:219]
  ds_read_b64_tr_b16 v[166:167], v7 offset:6272
  v_exp_f32 v187, v35
  v_mfma_f32_16x16x32_bf16 a[16:19], v[152:155], v[48:51], a[16:19]
  v_exp_f32 v188, v36
  v_mfma_f32_16x16x32_bf16 a[64:67], v[152:155], v[52:55], a[64:67]
  buffer_load_dwordx4 v[202:203], s[16:19], s81 idxen offen  lds
  v_mfma_f32_16x16x32_bf16 a[112:115], v[152:155], v[56:59], a[112:115]
  s_add_u32 m0, s53, 6144
  ds_read_b64_tr_b16 v[208:209], v242 offset:8192
  v_cvt_pk_bf16_f32 v67, v186, v187
  v_mfma_f32_16x16x32_bf16 a[160:163], v[152:155], v[60:63], a[160:163]
  buffer_load_dwordx4 v[204:205], s[16:19], s81 idxen offen  lds
  v_mfma_f32_16x16x32_bf16 a[20:23], v[156:159], v[48:51], a[20:23]
  v_exp_f32 v189, v37
  v_mfma_f32_16x16x32_bf16 a[68:71], v[156:159], v[52:55], a[68:71]
  s_add_u32 m0, s51, 12288
  v_exp_f32 v190, v38
  v_mfma_f32_16x16x32_bf16 a[116:119], v[156:159], v[56:59], a[116:119]
  s_waitcnt lgkmcnt(3)
  ds_read_b64_tr_b16 v[168:169], v4 offset:256
  ds_read_b64_tr_b16 v[210:211], v242 offset:8704
  v_mfma_f32_16x16x32_bf16 v[220:223], v[212:215], v[236:239], v[220:223]
  buffer_load_dwordx4 v10, s[8:11], s6 offen offset:2048  lds
  v_mfma_f32_16x16x32_bf16 a[164:167], v[156:159], v[60:63], a[164:167]
  v_cvt_pk_bf16_f32 v70, v188, v189
  v_exp_f32 v191, v39
  v_mfma_f32_16x16x32_bf16 a[24:27], v[160:163], v[48:51], a[24:27]
  ds_read_b64_tr_b16 v[212:213], v243 offset:8192
  v_exp_f32 v184, v40
  v_mfma_f32_16x16x32_bf16 a[72:75], v[160:163], v[52:55], a[72:75]
  s_add_u32 m0, s53, 7168
  ds_read_b64_tr_b16 v[214:215], v243 offset:8704
  v_cvt_pk_bf16_f32 v71, v190, v191
  v_mfma_f32_16x16x32_bf16 a[120:123], v[160:163], v[56:59], a[120:123]
  ds_read_b64_tr_b16 v[170:171], v4 offset:6400
  buffer_load_dwordx4 v[206:207], s[16:19], s81 idxen offen  lds
  v_mfma_f32_16x16x32_bf16 a[168:171], v[160:163], v[60:63], a[168:171]
  s_waitcnt lgkmcnt(6)
  v_exp_f32 v185, v41
  v_mfma_f32_16x16x32_bf16 a[28:31], v[164:167], v[48:51], a[28:31]
  v_exp_f32 v186, v42
  v_mfma_f32_16x16x32_bf16 a[76:79], v[164:167], v[52:55], a[76:79]
  v_cvt_pk_bf16_f32 v74, v184, v185
  v_exp_f32 v187, v43
  v_mfma_f32_16x16x32_bf16 a[124:127], v[164:167], v[56:59], a[124:127]
  s_waitcnt lgkmcnt(3)
  v_exp_f32 v188, v44
  v_mfma_f32_16x16x32_bf16 v[224:227], v[208:211], v[236:239], v[224:227]
  s_add_u32 m0, s52, 36864
  ds_read_b64_tr_b16 v[172:173], v5 offset:256
  v_cvt_pk_bf16_f32 v75, v186, v187
  v_mfma_f32_16x16x32_bf16 a[172:175], v[164:167], v[60:63], a[172:175]
  s_waitcnt lgkmcnt(1)
  v_exp_f32 v189, v45
  v_mfma_f32_16x16x32_bf16 a[32:35], v[168:171], v[48:51], a[32:35]
  v_exp_f32 v190, v46
  v_mfma_f32_16x16x32_bf16 a[80:83], v[168:171], v[52:55], a[80:83]
  v_cvt_pk_bf16_f32 v78, v188, v189
  v_exp_f32 v191, v47
  v_mfma_f32_16x16x32_bf16 a[128:131], v[168:171], v[56:59], a[128:131]
  ds_read_b64_tr_b16 v[174:175], v5 offset:6400
  v_cvt_pk_bf16_f32 v79, v190, v191
  v_mfma_f32_16x16x32_bf16 a[176:179], v[168:171], v[60:63], a[176:179]
  v_mfma_f32_16x16x32_bf16 v[96:99], v[112:115], v[64:67], v[96:99]
  ds_read_b64_tr_b16 v[176:177], v6 offset:256
  ds_read_b64_tr_b16 v[178:179], v6 offset:6400
  v_mfma_f32_16x16x32_bf16 v[100:103], v[112:115], v[68:71], v[100:103]
  buffer_load_dwordx4 v8, s[12:15], s7 offen offset:0  lds
  v_mfma_f32_16x16x32_bf16 v[228:231], v[212:215], v[236:239], v[228:231]
  ds_read_b64_tr_b16 v[180:181], v7 offset:256
  v_mfma_f32_16x16x32_bf16 v[104:107], v[112:115], v[72:75], v[104:107]
  s_add_u32 m0, s52, 36864
  ds_read_b128 v[152:155], v2 offset:24576
  v_mfma_f32_16x16x32_bf16 v[108:111], v[112:115], v[76:79], v[108:111]
  s_waitcnt lgkmcnt(4)
  ds_read_b64_tr_b16 v[182:183], v7 offset:6400
  v_mfma_f32_16x16x32_bf16 a[36:39], v[172:175], v[48:51], a[36:39]
  buffer_load_dwordx4 v9, s[12:15], s7 offen offset:1024  lds
  v_mfma_f32_16x16x32_bf16 a[84:87], v[172:175], v[52:55], a[84:87]
  v_mfma_f32_16x16x32_bf16 a[132:135], v[172:175], v[56:59], a[132:135]
  v_mfma_f32_16x16x32_bf16 a[180:183], v[172:175], v[60:63], a[180:183]
  s_waitcnt lgkmcnt(3)
  v_mfma_f32_16x16x32_bf16 a[40:43], v[176:179], v[48:51], a[40:43]
  ds_read_b128 v[156:159], v3 offset:24576
  v_max3_f32 v14, v96, v100, v104
  v_mfma_f32_16x16x32_bf16 a[88:91], v[176:179], v[52:55], a[88:91]
  v_mfma_f32_16x16x32_bf16 a[136:139], v[176:179], v[56:59], a[136:139]
  ds_read_b128 v[160:163], v2 offset:24704
  v_mfma_f32_16x16x32_bf16 a[184:187], v[176:179], v[60:63], a[184:187]
  s_waitcnt lgkmcnt(2)
  v_mfma_f32_16x16x32_bf16 a[44:47], v[180:183], v[48:51], a[44:47]
  s_add_u32 m0, s52, 36864
  v_max_f32 v14, v14, v108
  v_cmp_nge_f32 s[64:65], s50, v14
  v_mfma_f32_16x16x32_bf16 a[92:95], v[180:183], v[52:55], a[92:95]
  buffer_load_dwordx4 v10, s[12:15], s7 offen offset:2048  lds
  v_mfma_f32_16x16x32_bf16 a[140:143], v[180:183], v[56:59], a[140:143]
  s_cmp_ge_u32 s77, s36
  s_cselect_b64 s[66:67], -1, 0
  v_mfma_f32_16x16x32_bf16 a[188:191], v[180:183], v[60:63], a[188:191]
  ds_read_b128 v[164:167], v3 offset:24704
  s_or_b64 vcc, s[64:65], s[66:67]
  s_cbranch_vccnz P1V0s1_SLOW
P1V0s1_SLOWB:
  s_add_u32 s33, s33, 1
  s_branch P1V1
.p2align 6
P1V1:
  s_waitcnt lgkmcnt(3)
  v_mfma_f32_16x16x32_bf16 v[16:19], v[152:155], a[240:243], v[80:83]
  s_mov_b32 s76, s77
  v_add_u32 v1, s85, v1
  v_mfma_f32_16x16x32_bf16 v[20:23], v[152:155], v[128:131], v[84:87]
  s_mov_b32 s77, s78
  ds_read_b32 v200, v1 offset:0
  ds_read_b32 v202, v1 offset:32
  v_mfma_f32_16x16x32_bf16 v[24:27], v[152:155], a[192:195], v[88:91]
  ds_read_b32 v204, v1 offset:64
  ds_read_b32 v206, v1 offset:96
  v_mfma_f32_16x16x32_bf16 v[28:31], v[152:155], a[216:219], v[92:95]
  s_waitcnt lgkmcnt(6)
  v_mfma_f32_16x16x32_bf16 v[16:19], v[156:159], a[244:247], v[16:19]
  s_waitcnt vmcnt(11)
  s_mov_b32 s78, s79
  ds_read_b128 v[168:171], v2 offset:24832
  v_mfma_f32_16x16x32_bf16 v[20:23], v[156:159], v[132:135], v[20:23]
  ds_read_b64_tr_b16 v[208:209], v240 offset:0
  v_mfma_f32_16x16x32_bf16 v[24:27], v[156:159], a[196:199], v[24:27]
  s_add_u32 m0, s53, 8192
  ds_read_b128 v[232:235], v246
  v_mfma_f32_16x16x32_bf16 v[28:31], v[156:159], a[220:223], v[28:31]
  s_waitcnt lgkmcnt(8)
  ds_read_b64_tr_b16 v[210:211], v240 offset:512
  v_add_u32 v246, s88, v246
  v_mfma_f32_16x16x32_bf16 v[16:19], v[160:163], a[248:251], v[16:19]
  v_mfma_f32_16x16x32_bf16 v[20:23], v[160:163], v[136:139], v[20:23]
  ds_read_b128 v[172:175], v3 offset:24832
  ds_read_b64_tr_b16 v[212:213], v241 offset:0
  v_mfma_f32_16x16x32_bf16 v[24:27], v[160:163], a[200:203], v[24:27]
  s_mov_b32 s79, s74
  s_waitcnt lgkmcnt(9)
  buffer_load_dwordx4 v[200:201], s[16:19], s82 idxen offen  lds
  v_mfma_f32_16x16x32_bf16 v[28:31], v[160:163], a[224:227], v[28:31]
  ds_read_b128 v[176:179], v2 offset:30720
  ds_read_b64_tr_b16 v[214:215], v241 offset:512
  v_mfma_f32_16x16x32_bf16 v[16:19], v[164:167], a[252:255], v[16:19]
  s_add_u32 m0, s53, 9216
  v_mfma_f32_16x16x32_bf16 v[20:23], v[164:167], v[140:143], v[20:23]
  s_waitcnt lgkmcnt(4)
  s_add_u32 s40, s32, 4
  ds_read_b128 v[180:183], v3 offset:30720
  v_mfma_f32_16x16x32_bf16 v[216:219], v[208:211], v[232:235], v[216:219]
  buffer_load_dwordx4 v[202:203], s[16:19], s82 idxen offen  lds
  v_mfma_f32_16x16x32_bf16 v[24:27], v[164:167], a[204:207], v[24:27]
  ds_read_b128 v[152:155], v2 offset:30848
  ds_read_b64_tr_b16 v[208:209], v242 offset:0
  v_mfma_f32_16x16x32_bf16 v[28:31], v[164:167], a[228:231], v[28:31]
  v_mfma_f32_16x16x32_bf16 v[16:19], v[168:171], v[120:123], v[16:19]
  s_add_u32 m0, s53, 10240
  ds_read_b128 v[156:159], v3 offset:30848
  ds_read_b64_tr_b16 v[210:211], v242 offset:512
  v_mfma_f32_16x16x32_bf16 v[20:23], v[168:171], v[144:147], v[20:23]
  buffer_load_dwordx4 v[204:205], s[16:19], s82 idxen offen  lds
  v_mfma_f32_16x16x32_bf16 v[24:27], v[168:171], a[208:211], v[24:27]
  s_add_u32 m0, s53, 11264
  v_readlane_b32 s74, v0, s40
  v_mfma_f32_16x16x32_bf16 v[28:31], v[168:171], a[232:235], v[28:31]
  s_waitcnt lgkmcnt(8)
  ds_read_b64_tr_b16 v[168:169], v4 offset:12288
  ds_read_b128 v[236:239], v247
  v_mfma_f32_16x16x32_bf16 v[16:19], v[172:175], v[124:127], v[16:19]
  s_waitcnt lgkmcnt(7)
  v_add_u32 v247, s88, v247
  v_mfma_f32_16x16x32_bf16 v[220:223], v[212:215], v[232:235], v[220:223]
  s_mul_i32 s63, s78, 12288
  ds_read_b128 v[160:163], v2 offset:30976
  ds_read_b64_tr_b16 v[170:171], v4 offset:18432
  v_mfma_f32_16x16x32_bf16 v[20:23], v[172:175], v[148:151], v[20:23]
  buffer_load_dwordx4 v[206:207], s[16:19], s82 idxen offen  lds
  v_mfma_f32_16x16x32_bf16 v[24:27], v[172:175], a[212:215], v[24:27]
  ds_read_b64_tr_b16 v[212:213], v243 offset:0
  ds_read_b64_tr_b16 v[214:215], v243 offset:512
  v_mfma_f32_16x16x32_bf16 v[28:31], v[172:175], a[236:239], v[28:31]
  v_exp_f32 v184, v16
  v_mfma_f32_16x16x32_bf16 v[32:35], v[176:179], a[240:243], v[192:195]
  ds_read_b128 v[164:167], v3 offset:30976
  ds_read_b64_tr_b16 v[172:173], v5 offset:12288
  v_mfma_f32_16x16x32_bf16 v[36:39], v[176:179], v[128:131], v[196:199]
  s_add_u32 s63, s63, s75
  v_exp_f32 v185, v17
  v_mfma_f32_16x16x32_bf16 v[40:43], v[176:179], a[192:195], v[88:91]
  ds_read_b64_tr_b16 v[174:175], v5 offset:18432
  ds_read_b32 v200, v1 offset:128
  v_mfma_f32_16x16x32_bf16 v[44:47], v[176:179], a[216:219], v[92:95]
  s_waitcnt lgkmcnt(14)
  v_exp_f32 v186, v18
  v_mfma_f32_16x16x32_bf16 v[32:35], v[180:183], a[244:247], v[32:35]
  s_waitcnt lgkmcnt(10)
  v_cvt_pk_bf16_f32 v48, v184, v185
  v_exp_f32 v187, v19
  v_mfma_f32_16x16x32_bf16 v[224:227], v[208:211], v[232:235], v[224:227]
  s_mul_i32 s62, s74, 12288
  v_exp_f32 v188, v20
  v_mfma_f32_16x16x32_bf16 v[36:39], v[180:183], v[132:135], v[36:39]
  ds_read_b64_tr_b16 v[176:177], v6 offset:12288
  ds_read_b32 v202, v1 offset:160
  v_mfma_f32_16x16x32_bf16 v[40:43], v[180:183], a[196:199], v[40:43]
  s_add_u32 s62, s62, s75
  ds_read_b32 v204, v1 offset:192
  v_cvt_pk_bf16_f32 v49, v186, v187
  v_mfma_f32_16x16x32_bf16 v[44:47], v[180:183], a[220:223], v[44:47]
  ds_read_b64_tr_b16 v[178:179], v6 offset:18432
  ds_read_b32 v206, v1 offset:224
  v_mfma_f32_16x16x32_bf16 v[32:35], v[152:155], a[248:251], v[32:35]
  v_exp_f32 v189, v21
  v_mfma_f32_16x16x32_bf16 v[36:39], v[152:155], v[136:139], v[36:39]
  ds_read_b64_tr_b16 v[180:181], v7 offset:12288
  ds_read_b64_tr_b16 v[182:183], v7 offset:18432
  v_mfma_f32_16x16x32_bf16 v[40:43], v[152:155], a[200:203], v[40:43]
  v_exp_f32 v190, v22
  v_cvt_pk_bf16_f32 v52, v188, v189
  v_mfma_f32_16x16x32_bf16 v[44:47], v[152:155], a[224:227], v[44:47]
  s_waitcnt lgkmcnt(11)
  s_waitcnt vmcnt(7)
  ds_read_b64_tr_b16 v[152:153], v4 offset:12416
  v_mfma_f32_16x16x32_bf16 v[228:231], v[212:215], v[232:235], v[228:231]
  v_exp_f32 v191, v23
  v_mfma_f32_16x16x32_bf16 v[32:35], v[156:159], a[252:255], v[32:35]
  v_exp_f32 v184, v24
  v_cvt_pk_bf16_f32 v53, v190, v191
  v_mfma_f32_16x16x32_bf16 v[36:39], v[156:159], v[140:143], v[36:39]
  s_add_u32 m0, s53, 0
  ds_read_b64_tr_b16 v[208:209], v240 offset:4096
  ds_read_b64_tr_b16 v[210:211], v240 offset:4608
  v_mfma_f32_16x16x32_bf16 v[40:43], v[156:159], a[204:207], v[40:43]
  v_exp_f32 v185, v25
  v_mfma_f32_16x16x32_bf16 v[44:47], v[156:159], a[228:231], v[44:47]
  ds_read_b64_tr_b16 v[154:155], v4 offset:18560
  ds_read_b64_tr_b16 v[212:213], v241 offset:4096
  v_mfma_f32_16x16x32_bf16 v[32:35], v[160:163], v[120:123], v[32:35]
  s_waitcnt lgkmcnt(12)
  buffer_load_dwordx4 v[200:201], s[16:19], s82 idxen offen  lds
  v_mfma_f32_16x16x32_bf16 v[36:39], v[160:163], v[144:147], v[36:39]
  s_add_u32 m0, s53, 1024
  v_exp_f32 v186, v26
  v_mfma_f32_16x16x32_bf16 v[40:43], v[160:163], a[208:211], v[40:43]
  ds_read_b64_tr_b16 v[214:215], v241 offset:4608
  v_cvt_pk_bf16_f32 v56, v184, v185
  v_mfma_f32_16x16x32_bf16 v[44:47], v[160:163], a[232:235], v[44:47]
  s_waitcnt lgkmcnt(3)
  ds_read_b64_tr_b16 v[156:157], v5 offset:12416
  ds_read_b64_tr_b16 v[158:159], v5 offset:18560
  v_mfma_f32_16x16x32_bf16 v[216:219], v[208:211], v[236:239], v[216:219]
  buffer_load_dwordx4 v[202:203], s[16:19], s82 idxen offen  lds
  v_mfma_f32_16x16x32_bf16 v[32:35], v[164:167], v[124:127], v[32:35]
  s_add_u32 m0, s53, 2048
  v_exp_f32 v187, v27
  v_mfma_f32_16x16x32_bf16 v[36:39], v[164:167], v[148:151], v[36:39]
  ds_read_b64_tr_b16 v[208:209], v242 offset:4096
  ds_read_b128 v[232:235], v244
  v_mfma_f32_16x16x32_bf16 v[40:43], v[164:167], a[212:215], v[40:43]
  s_waitcnt vmcnt(18)
  s_barrier
  v_exp_f32 v188, v28
  v_mfma_f32_16x16x32_bf16 v[44:47], v[164:167], a[236:239], v[44:47]
  v_cvt_pk_bf16_f32 v57, v186, v187
  v_cvt_pk_bf16_f32 v248, v216, v217
  v_mfma_f32_16x16x32_bf16 a[0:3], v[168:171], v[64:67], a[0:3]
  v_exp_f32 v189, v29
  v_mfma_f32_16x16x32_bf16 a[48:51], v[168:171], v[68:71], a[48:51]
  buffer_load_dwordx4 v[204:205], s[16:19], s82 idxen offen  lds
  v_mfma_f32_16x16x32_bf16 a[96:99], v[168:171], v[72:75], a[96:99]
  s_waitcnt lgkmcnt(4)
  v_exp_f32 v190, v30
  v_cvt_pk_bf16_f32 v60, v188, v189
  v_mfma_f32_16x16x32_bf16 v[220:223], v[212:215], v[236:239], v[220:223]
  s_add_u32 m0, s53, 3072
  v_exp_f32 v191, v31
  v_mfma_f32_16x16x32_bf16 a[144:147], v[168:171], v[76:79], a[144:147]
  ds_read_b64_tr_b16 v[210:211], v242 offset:4608
  ds_read_b64_tr_b16 v[212:213], v243 offset:4096
  v_cvt_pk_bf16_f32 v249, v218, v219
  v_mfma_f32_16x16x32_bf16 a[4:7], v[172:175], v[64:67], a[4:7]
  buffer_load_dwordx4 v[206:207], s[16:19], s82 idxen offen  lds
  v_mfma_f32_16x16x32_bf16 a[52:55], v[172:175], v[68:71], a[52:55]
  s_add_u32 m0, s51, 24576
  ds_read_b64_tr_b16 v[160:161], v6 offset:12416
  v_cvt_pk_bf16_f32 v61, v190, v191
  v_mfma_f32_16x16x32_bf16 a[100:103], v[172:175], v[72:75], a[100:103]
  ds_read_b64_tr_b16 v[214:215], v243 offset:4608
  v_cvt_pk_bf16_f32 v250, v220, v221
  v_mfma_f32_16x16x32_bf16 a[148:151], v[172:175], v[76:79], a[148:151]
  v_exp_f32 v184, v32
  v_exp_f32 v185, v33
  v_cvt_pk_bf16_f32 v251, v222, v223
  v_mfma_f32_16x16x32_bf16 a[8:11], v[176:179], v[64:67], a[8:11]
  ds_read_b64_tr_b16 v[162:163], v6 offset:18560
  ds_read_b32 v200, v1 offset:256
  v_mfma_f32_16x16x32_bf16 a[56:59], v[176:179], v[68:71], a[56:59]
  ds_read_b64_tr_b16 v[164:165], v7 offset:12416
  v_exp_f32 v186, v34
  v_mfma_f32_16x16x32_bf16 a[104:107], v[176:179], v[72:75], a[104:107]
  s_waitcnt lgkmcnt(6)
  buffer_load_dwordx4 v8, s[8:11], s62 offen offset:0  lds
  v_mfma_f32_16x16x32_bf16 v[224:227], v[208:211], v[236:239], v[224:227]
  ds_read_b64_tr_b16 v[166:167], v7 offset:18560
  ds_read_b32 v202, v1 offset:288
  v_cvt_pk_bf16_f32 v50, v184, v185
  v_mfma_f32_16x16x32_bf16 a[152:155], v[176:179], v[76:79], a[152:155]
  ds_read_b32 v204, v1 offset:320
  v_exp_f32 v187, v35
  v_mfma_f32_16x16x32_bf16 a[12:15], v[180:183], v[64:67], a[12:15]
  ds_read_b32 v206, v1 offset:352
  v_exp_f32 v188, v36
  v_mfma_f32_16x16x32_bf16 a[60:63], v[180:183], v[68:71], a[60:63]
  v_cvt_pk_bf16_f32 v51, v186, v187
  v_add_u32 v244, s89, v244
  v_mfma_f32_16x16x32_bf16 a[108:111], v[180:183], v[72:75], a[108:111]
  buffer_store_dwordx4 v[248:251], v13, s[24:27], s91 offen offset:0 sc1
  v_mfma_f32_16x16x32_bf16 a[156:159], v[180:183], v[76:79], a[156:159]
  v_exp_f32 v189, v37
  v_mfma_f32_16x16x32_bf16 a[16:19], v[152:155], v[64:67], a[16:19]
  s_add_u32 s32, s32, 1
  v_exp_f32 v190, v38
  v_mfma_f32_16x16x32_bf16 a[64:67], v[152:155], v[68:71], a[64:67]
  s_waitcnt lgkmcnt(7)
  s_waitcnt vmcnt(6)
  v_cvt_pk_bf16_f32 v54, v188, v189
  v_mfma_f32_16x16x32_bf16 v[228:231], v[212:215], v[236:239], v[228:231]
  s_add_u32 m0, s53, 4096
  ds_read_b64_tr_b16 v[208:209], v240 offset:8192
  ds_read_b64_tr_b16 v[210:211], v240 offset:8704
  v_mfma_f32_16x16x32_bf16 a[112:115], v[152:155], v[72:75], a[112:115]
  s_waitcnt lgkmcnt(7)
  buffer_load_dwordx4 v[200:201], s[16:19], s82 idxen offen  lds
  v_mfma_f32_16x16x32_bf16 a[160:163], v[152:155], v[76:79], a[160:163]
  v_exp_f32 v191, v39
  v_mfma_f32_16x16x32_bf16 a[20:23], v[156:159], v[64:67], a[20:23]
  v_exp_f32 v184, v40
  v_mfma_f32_16x16x32_bf16 a[68:71], v[156:159], v[68:71], a[68:71]
  ds_read_b64_tr_b16 v[168:169], v4 offset:12544
  ds_read_b64_tr_b16 v[212:213], v241 offset:8192
  v_mfma_f32_16x16x32_bf16 a[116:119], v[156:159], v[72:75], a[116:119]
  s_add_u32 m0, s51, 24576
  ds_read_b64_tr_b16 v[214:215], v241 offset:8704
  v_cvt_pk_bf16_f32 v55, v190, v191
  v_mfma_f32_16x16x32_bf16 a[164:167], v[156:159], v[76:79], a[164:167]
  v_exp_f32 v185, v41
  v_mfma_f32_16x16x32_bf16 a[24:27], v[160:163], v[64:67], a[24:27]
  buffer_load_dwordx4 v9, s[8:11], s62 offen offset:1024  lds
  v_mfma_f32_16x16x32_bf16 a[72:75], v[160:163], v[68:71], a[72:75]
  s_waitcnt lgkmcnt(3)
  ds_read_b64_tr_b16 v[170:171], v4 offset:18688
  ds_read_b64_tr_b16 v[172:173], v5 offset:12544
  v_mfma_f32_16x16x32_bf16 v[216:219], v[208:211], v[232:235], 0
  v_exp_f32 v186, v42
  v_cvt_pk_bf16_f32 v58, v184, v185
  v_mfma_f32_16x16x32_bf16 a[120:123], v[160:163], v[72:75], a[120:123]
  v_exp_f32 v187, v43
  v_mfma_f32_16x16x32_bf16 a[168:171], v[160:163], v[76:79], a[168:171]
  v_exp_f32 v188, v44
  v_mfma_f32_16x16x32_bf16 a[28:31], v[164:167], v[64:67], a[28:31]
  s_add_u32 m0, s53, 5120
  ds_read_b64_tr_b16 v[174:175], v5 offset:18688
  v_cvt_pk_bf16_f32 v59, v186, v187
  v_mfma_f32_16x16x32_bf16 a[76:79], v[164:167], v[68:71], a[76:79]
  buffer_load_dwordx4 v[202:203], s[16:19], s82 idxen offen  lds
  v_mfma_f32_16x16x32_bf16 a[124:127], v[164:167], v[72:75], a[124:127]
  s_add_u32 m0, s53, 6144
  v_exp_f32 v189, v45
  v_mfma_f32_16x16x32_bf16 a[172:175], v[164:167], v[76:79], a[172:175]
  s_waitcnt lgkmcnt(2)
  v_exp_f32 v190, v46
  v_mfma_f32_16x16x32_bf16 a[32:35], v[168:171], v[64:67], a[32:35]
  ds_read_b64_tr_b16 v[208:209], v242 offset:8192
  v_cvt_pk_bf16_f32 v62, v188, v189
  v_mfma_f32_16x16x32_bf16 v[220:223], v[212:215], v[232:235], 0
  buffer_load_dwordx4 v[204:205], s[16:19], s82 idxen offen  lds
  v_mfma_f32_16x16x32_bf16 a[80:83], v[168:171], v[68:71], a[80:83]
  v_exp_f32 v191, v47
  v_mfma_f32_16x16x32_bf16 a[128:131], v[168:171], v[72:75], a[128:131]
  s_add_u32 m0, s53, 7168
  ds_read_b64_tr_b16 v[210:211], v242 offset:8704
  v_cvt_pk_bf16_f32 v63, v190, v191
  v_mfma_f32_16x16x32_bf16 a[176:179], v[168:171], v[76:79], a[176:179]
  ds_read_b64_tr_b16 v[176:177], v6 offset:12544
  ds_read_b64_tr_b16 v[178:179], v6 offset:18688
  v_mfma_f32_16x16x32_bf16 v[96:99], v[112:115], v[48:51], v[96:99]
  buffer_load_dwordx4 v[206:207], s[16:19], s82 idxen offen  lds
  v_mfma_f32_16x16x32_bf16 v[100:103], v[112:115], v[52:55], v[100:103]
  s_add_u32 m0, s51, 24576
  ds_read_b64_tr_b16 v[180:181], v7 offset:12544
  ds_read_b64_tr_b16 v[182:183], v7 offset:18688
  v_mfma_f32_16x16x32_bf16 v[104:107], v[112:115], v[56:59], v[104:107]
  v_cvt_pk_bf16_f32 v252, v224, v225
  v_cvt_pk_bf16_f32 v253, v226, v227
  v_mfma_f32_16x16x32_bf16 v[108:111], v[112:115], v[60:63], v[108:111]
  s_waitcnt lgkmcnt(6)
  ds_read_b128 v[152:155], v2 offset:36864
  ds_read_b64_tr_b16 v[212:213], v243 offset:8192
  v_mfma_f32_16x16x32_bf16 a[36:39], v[172:175], v[64:67], a[36:39]
  s_waitcnt lgkmcnt(6)
  v_cvt_pk_bf16_f32 v254, v228, v229
  v_cvt_pk_bf16_f32 v255, v230, v231
  v_mfma_f32_16x16x32_bf16 v[224:227], v[208:211], v[232:235], 0
  ds_read_b128 v[156:159], v3 offset:36864
  ds_read_b64_tr_b16 v[214:215], v243 offset:8704
  v_mfma_f32_16x16x32_bf16 a[84:87], v[172:175], v[68:71], a[84:87]
  buffer_store_dwordx4 v[252:255], v13, s[24:27], s91 offen offset:1024 sc1
  v_mfma_f32_16x16x32_bf16 a[132:135], v[172:175], v[72:75], a[132:135]
  s_cmp_ge_u32 s77, s36
  s_cselect_b64 s[66:67], -1, 0
  ds_read_b32 v200, v1 offset:384
  v_mfma_f32_16x16x32_bf16 a[180:183], v[172:175], v[76:79], a[180:183]
  s_waitcnt lgkmcnt(7)
  ds_read_b32 v202, v1 offset:416
  ds_read_b32 v204, v1 offset:448
  v_mfma_f32_16x16x32_bf16 a[40:43], v[176:179], v[64:67], a[40:43]
  ds_read_b32 v206, v1 offset:480
  v_max3_f32 v14, v96, v100, v104
  v_mfma_f32_16x16x32_bf16 a[88:91], v[176:179], v[68:71], a[88:91]
  ds_read_b128 v[160:163], v2 offset:36992
  v_mfma_f32_16x16x32_bf16 a[136:139], v[176:179], v[72:75], a[136:139]
  buffer_load_dwordx4 v10, s[8:11], s62 offen offset:2048  lds
  v_mfma_f32_16x16x32_bf16 a[184:187], v[176:179], v[76:79], a[184:187]
  s_waitcnt lgkmcnt(5)
  s_waitcnt vmcnt(9)
  v_max_f32 v14, v14, v108
  v_mfma_f32_16x16x32_bf16 v[228:231], v[212:215], v[232:235], 0
  ds_read_b128 v[236:239], v245
  v_cmp_nge_f32 s[64:65], s50, v14
  v_mfma_f32_16x16x32_bf16 a[44:47], v[180:183], v[64:67], a[44:47]
  ds_read_b64_tr_b16 v[208:209], v240 offset:0
  v_mfma_f32_16x16x32_bf16 a[92:95], v[180:183], v[68:71], a[92:95]
  ds_read_b64_tr_b16 v[210:211], v240 offset:512
  v_add_u32 v245, s89, v245
  v_mfma_f32_16x16x32_bf16 a[140:143], v[180:183], v[72:75], a[140:143]
  s_add_u32 m0, s53, 8192
  ds_read_b128 v[164:167], v3 offset:36992
  v_mfma_f32_16x16x32_bf16 a[188:191], v[180:183], v[76:79], a[188:191]
  s_waitcnt lgkmcnt(8)
  buffer_load_dwordx4 v[200:201], s[16:19], s82 idxen offen  lds
  s_or_b64 vcc, s[64:65], s[66:67]
  s_cbranch_vccnz P1V1s0_SLOW
P1V1s0_SLOWB:
  v_mfma_f32_16x16x32_bf16 v[16:19], v[152:155], a[240:243], v[80:83]
  ds_read_b128 v[168:171], v2 offset:37120
  ds_read_b64_tr_b16 v[212:213], v241 offset:0
  v_mfma_f32_16x16x32_bf16 v[20:23], v[152:155], v[128:131], v[84:87]
  s_mov_b32 s76, s77
  s_add_u32 m0, s53, 9216
  v_mfma_f32_16x16x32_bf16 v[24:27], v[152:155], a[192:195], v[88:91]
  ds_read_b128 v[232:235], v246
  v_mfma_f32_16x16x32_bf16 v[28:31], v[152:155], a[216:219], v[92:95]
  s_waitcnt lgkmcnt(4)
  ds_read_b64_tr_b16 v[214:215], v241 offset:512
  v_mfma_f32_16x16x32_bf16 v[216:219], v[208:211], v[236:239], v[216:219]
  buffer_load_dwordx4 v[202:203], s[16:19], s82 idxen offen  lds
  v_mfma_f32_16x16x32_bf16 v[16:19], v[156:159], a[244:247], v[16:19]
  ds_read_b128 v[172:175], v3 offset:37120
  ds_read_b64_tr_b16 v[208:209], v242 offset:0
  v_mfma_f32_16x16x32_bf16 v[20:23], v[156:159], v[132:135], v[20:23]
  s_mov_b32 s77, s78
  s_mov_b32 s78, s79
  s_add_u32 m0, s52, 0
  v_mfma_f32_16x16x32_bf16 v[24:27], v[156:159], a[196:199], v[24:27]
  s_mov_b32 s79, s74
  ds_read_b128 v[176:179], v2 offset:43008
  ds_read_b64_tr_b16 v[210:211], v242 offset:512
  v_mfma_f32_16x16x32_bf16 v[28:31], v[156:159], a[220:223], v[28:31]
  buffer_load_dwordx4 v8, s[12:15], s63 offen offset:0  lds
  v_mfma_f32_16x16x32_bf16 v[16:19], v[160:163], a[248:251], v[16:19]
  ds_read_b128 v[180:183], v3 offset:43008
  v_mfma_f32_16x16x32_bf16 v[20:23], v[160:163], v[136:139], v[20:23]
  v_mfma_f32_16x16x32_bf16 v[24:27], v[160:163], a[200:203], v[24:27]
  s_waitcnt lgkmcnt(5)
  s_add_u32 m0, s53, 10240
  ds_read_b128 v[152:155], v2 offset:43136
  v_mfma_f32_16x16x32_bf16 v[220:223], v[212:215], v[236:239], v[220:223]
  buffer_load_dwordx4 v[204:205], s[16:19], s82 idxen offen  lds
  v_mfma_f32_16x16x32_bf16 v[28:31], v[160:163], a[224:227], v[28:31]
  s_add_u32 s40, s32, 4
  ds_read_b128 v[156:159], v3 offset:43136
  v_mfma_f32_16x16x32_bf16 v[16:19], v[164:167], a[252:255], v[16:19]
  s_add_u32 m0, s53, 11264
  v_mfma_f32_16x16x32_bf16 v[20:23], v[164:167], v[140:143], v[20:23]
  ds_read_b128 v[160:163], v2 offset:43264
  v_mfma_f32_16x16x32_bf16 v[24:27], v[164:167], a[204:207], v[24:27]
  buffer_load_dwordx4 v[206:207], s[16:19], s82 idxen offen  lds
  v_mfma_f32_16x16x32_bf16 v[28:31], v[164:167], a[228:231], v[28:31]
  ds_read_b64_tr_b16 v[212:213], v243 offset:0
  v_add_u32 v1, s86, v1
  v_mfma_f32_16x16x32_bf16 v[16:19], v[168:171], v[120:123], v[16:19]
  v_mfma_f32_16x16x32_bf16 v[20:23], v[168:171], v[144:147], v[20:23]
  ds_read_b32 v200, v1 offset:0
  ds_read_b32 v202, v1 offset:32
  v_mfma_f32_16x16x32_bf16 v[24:27], v[168:171], a[208:211], v[24:27]
  s_waitcnt lgkmcnt(7)
  ds_read_b64_tr_b16 v[214:215], v243 offset:512
  v_add_u32 v246, s89, v246
  v_mfma_f32_16x16x32_bf16 v[224:227], v[208:211], v[236:239], v[224:227]
  ds_read_b32 v204, v1 offset:64
  v_mfma_f32_16x16x32_bf16 v[28:31], v[168:171], a[232:235], v[28:31]
  ds_read_b64_tr_b16 v[168:169], v4 offset:24576
  ds_read_b32 v206, v1 offset:96
  v_mfma_f32_16x16x32_bf16 v[16:19], v[172:175], v[124:127], v[16:19]
  ds_read_b64_tr_b16 v[170:171], v4 offset:30720
  v_mfma_f32_16x16x32_bf16 v[20:23], v[172:175], v[148:151], v[20:23]
  s_add_u32 m0, s52, 0
  ds_read_b128 v[164:167], v3 offset:43264
  v_readlane_b32 s74, v0, s40
  v_mfma_f32_16x16x32_bf16 v[24:27], v[172:175], a[212:215], v[24:27]
  buffer_load_dwordx4 v9, s[12:15], s63 offen offset:1024  lds
  v_mfma_f32_16x16x32_bf16 v[28:31], v[172:175], a[236:239], v[28:31]
  ds_read_b64_tr_b16 v[172:173], v5 offset:24576
  ds_read_b64_tr_b16 v[174:175], v5 offset:30720
  v_mfma_f32_16x16x32_bf16 v[32:35], v[176:179], a[240:243], v[192:195]
  s_mul_i32 s7, s78, 12288
  v_exp_f32 v184, v16
  v_mfma_f32_16x16x32_bf16 v[36:39], v[176:179], v[128:131], v[196:199]
  s_waitcnt lgkmcnt(7)
  s_waitcnt vmcnt(8)
  v_exp_f32 v185, v17
  v_mfma_f32_16x16x32_bf16 v[228:231], v[212:215], v[236:239], v[228:231]
  s_add_u32 m0, s53, 0
  v_exp_f32 v186, v18
  v_mfma_f32_16x16x32_bf16 v[40:43], v[176:179], a[192:195], v[88:91]
  s_add_u32 s7, s7, s75
  ds_read_b64_tr_b16 v[208:209], v240 offset:4096
  v_cvt_pk_bf16_f32 v64, v184, v185
  v_mfma_f32_16x16x32_bf16 v[44:47], v[176:179], a[216:219], v[92:95]
  ds_read_b64_tr_b16 v[176:177], v6 offset:24576
  ds_read_b64_tr_b16 v[210:211], v240 offset:4608
  v_mfma_f32_16x16x32_bf16 v[32:35], v[180:183], a[244:247], v[32:35]
  s_mul_i32 s6, s74, 12288
  v_exp_f32 v187, v19
  v_mfma_f32_16x16x32_bf16 v[36:39], v[180:183], v[132:135], v[36:39]
  buffer_load_dwordx4 v[200:201], s[16:19], s83 idxen offen  lds
  v_mfma_f32_16x16x32_bf16 v[40:43], v[180:183], a[196:199], v[40:43]
  ds_read_b128 v[236:239], v247
  v_add_u32 v247, s89, v247
  v_mfma_f32_16x16x32_bf16 v[44:47], v[180:183], a[220:223], v[44:47]
  v_exp_f32 v188, v20
  v_mfma_f32_16x16x32_bf16 v[32:35], v[152:155], a[248:251], v[32:35]
  s_add_u32 m0, s53, 1024
  ds_read_b64_tr_b16 v[212:213], v241 offset:4096
  v_cvt_pk_bf16_f32 v65, v186, v187
  v_mfma_f32_16x16x32_bf16 v[36:39], v[152:155], v[136:139], v[36:39]
  s_waitcnt lgkmcnt(2)
  buffer_load_dwordx4 v[202:203], s[16:19], s83 idxen offen  lds
  v_mfma_f32_16x16x32_bf16 v[216:219], v[208:211], v[232:235], v[216:219]
  v_exp_f32 v189, v21
  v_mfma_f32_16x16x32_bf16 v[40:43], v[152:155], a[200:203], v[40:43]
  s_add_u32 m0, s53, 2048
  ds_read_b64_tr_b16 v[178:179], v6 offset:30720
  ds_read_b64_tr_b16 v[214:215], v241 offset:4608
  v_mfma_f32_16x16x32_bf16 v[44:47], v[152:155], a[224:227], v[44:47]
  ds_read_b64_tr_b16 v[208:209], v242 offset:4096
  ds_read_b64_tr_b16 v[210:211], v242 offset:4608
  v_mfma_f32_16x16x32_bf16 v[32:35], v[156:159], a[252:255], v[32:35]
  buffer_load_dwordx4 v[204:205], s[16:19], s83 idxen offen  lds
  v_mfma_f32_16x16x32_bf16 v[36:39], v[156:159], v[140:143], v[36:39]
  v_exp_f32 v190, v22
  v_mfma_f32_16x16x32_bf16 v[40:43], v[156:159], a[204:207], v[40:43]
  s_add_u32 m0, s52, 0
  ds_read_b64_tr_b16 v[180:181], v7 offset:24576
  v_cvt_pk_bf16_f32 v68, v188, v189
  v_mfma_f32_16x16x32_bf16 v[44:47], v[156:159], a[228:231], v[44:47]
  v_exp_f32 v191, v23
  v_mfma_f32_16x16x32_bf16 v[32:35], v[160:163], v[120:123], v[32:35]
  s_waitcnt lgkmcnt(3)
  buffer_load_dwordx4 v10, s[12:15], s63 offen offset:2048  lds
  v_mfma_f32_16x16x32_bf16 v[220:223], v[212:215], v[232:235], v[220:223]
  v_exp_f32 v184, v24
  v_mfma_f32_16x16x32_bf16 v[36:39], v[160:163], v[144:147], v[36:39]
  s_add_u32 m0, s53, 3072
  ds_read_b64_tr_b16 v[212:213], v243 offset:4096
  v_cvt_pk_bf16_f32 v69, v190, v191
  v_mfma_f32_16x16x32_bf16 v[40:43], v[160:163], a[208:211], v[40:43]
  s_add_u32 s6, s6, s75
  v_exp_f32 v185, v25
  v_mfma_f32_16x16x32_bf16 v[44:47], v[160:163], a[232:235], v[44:47]
  v_exp_f32 v186, v26
  v_mfma_f32_16x16x32_bf16 v[32:35], v[164:167], v[124:127], v[32:35]
  buffer_load_dwordx4 v[206:207], s[16:19], s83 idxen offen  lds
  v_mfma_f32_16x16x32_bf16 v[36:39], v[164:167], v[148:151], v[36:39]
  ds_read_b64_tr_b16 v[214:215], v243 offset:4608
  v_cvt_pk_bf16_f32 v72, v184, v185
  v_mfma_f32_16x16x32_bf16 v[40:43], v[164:167], a[212:215], v[40:43]
  s_waitcnt vmcnt(28)
  s_barrier
  v_exp_f32 v187, v27
  v_mfma_f32_16x16x32_bf16 v[44:47], v[164:167], a[236:239], v[44:47]
  v_exp_f32 v188, v28
  v_mfma_f32_16x16x32_bf16 a[0:3], v[168:171], v[48:51], a[0:3]
  s_waitcnt lgkmcnt(3)
  ds_read_b32 v200, v1 offset:128
  ds_read_b32 v202, v1 offset:160
  ds_read_b32 v204, v1 offset:192
  v_cvt_pk_bf16_f32 v73, v186, v187
  v_mfma_f32_16x16x32_bf16 v[224:227], v[208:211], v[232:235], v[224:227]
  v_exp_f32 v189, v29
  v_mfma_f32_16x16x32_bf16 a[48:51], v[168:171], v[52:55], a[48:51]
  s_add_u32 s32, s32, 1
  ds_read_b64_tr_b16 v[182:183], v7 offset:30720
  ds_read_b64_tr_b16 v[152:153], v4 offset:24704
  v_mfma_f32_16x16x32_bf16 a[96:99], v[168:171], v[56:59], a[96:99]
  s_add_u32 m0, s51, 36864
  ds_read_b32 v206, v1 offset:224
  v_exp_f32 v190, v30
  v_mfma_f32_16x16x32_bf16 a[144:147], v[168:171], v[60:63], a[144:147]
  v_cvt_pk_bf16_f32 v76, v188, v189
  v_exp_f32 v191, v31
  v_mfma_f32_16x16x32_bf16 a[4:7], v[172:175], v[48:51], a[4:7]
  v_cvt_pk_bf16_f32 v77, v190, v191
  v_exp_f32 v184, v32
  v_mfma_f32_16x16x32_bf16 a[52:55], v[172:175], v[52:55], a[52:55]
  buffer_load_dwordx4 v8, s[8:11], s6 offen offset:0  lds
  v_mfma_f32_16x16x32_bf16 a[100:103], v[172:175], v[56:59], a[100:103]
  v_exp_f32 v185, v33
  v_mfma_f32_16x16x32_bf16 a[148:151], v[172:175], v[60:63], a[148:151]
  s_waitcnt lgkmcnt(6)
  s_waitcnt vmcnt(7)
  ds_read_b64_tr_b16 v[154:155], v4 offset:30848
  v_mfma_f32_16x16x32_bf16 v[228:231], v[212:215], v[232:235], v[228:231]
  s_add_u32 m0, s53, 4096
  ds_read_b64_tr_b16 v[208:209], v240 offset:8192
  v_mfma_f32_16x16x32_bf16 a[8:11], v[176:179], v[48:51], a[8:11]
  s_waitcnt lgkmcnt(7)
  buffer_load_dwordx4 v[200:201], s[16:19], s83 idxen offen  lds
  v_mfma_f32_16x16x32_bf16 a[56:59], v[176:179], v[52:55], a[56:59]
  s_add_u32 m0, s51, 36864
  ds_read_b64_tr_b16 v[210:211], v240 offset:8704
  ds_read_b64_tr_b16 v[212:213], v241 offset:8192
  v_mfma_f32_16x16x32_bf16 a[104:107], v[176:179], v[56:59], a[104:107]
  ds_read_b64_tr_b16 v[214:215], v241 offset:8704
  v_exp_f32 v186, v34
  v_mfma_f32_16x16x32_bf16 a[152:155], v[176:179], v[60:63], a[152:155]
  s_waitcnt lgkmcnt(7)
  v_cvt_pk_bf16_f32 v66, v184, v185
  v_exp_f32 v187, v35
  v_mfma_f32_16x16x32_bf16 a[12:15], v[180:183], v[48:51], a[12:15]
  buffer_load_dwordx4 v9, s[8:11], s6 offen offset:1024  lds
  v_mfma_f32_16x16x32_bf16 a[60:63], v[180:183], v[52:55], a[60:63]
  s_add_u32 m0, s53, 5120
  ds_read_b64_tr_b16 v[156:157], v5 offset:24704
  ds_read_b64_tr_b16 v[158:159], v5 offset:30848
  v_mfma_f32_16x16x32_bf16 a[108:111], v[180:183], v[56:59], a[108:111]
  v_exp_f32 v188, v36
  v_mfma_f32_16x16x32_bf16 a[156:159], v[180:183], v[60:63], a[156:159]
  s_waitcnt lgkmcnt(4)
  ds_read_b64_tr_b16 v[160:161], v6 offset:24704
  v_cvt_pk_bf16_f32 v67, v186, v187
  v_mfma_f32_16x16x32_bf16 v[216:219], v[208:211], v[236:239], v[216:219]
  buffer_load_dwordx4 v[202:203], s[16:19], s83 idxen offen  lds
  v_mfma_f32_16x16x32_bf16 a[16:19], v[152:155], v[48:51], a[16:19]
  s_add_u32 m0, s53, 6144
  ds_read_b64_tr_b16 v[162:163], v6 offset:30848
  ds_read_b64_tr_b16 v[208:209], v242 offset:8192
  v_mfma_f32_16x16x32_bf16 a[64:67], v[152:155], v[52:55], a[64:67]
  v_exp_f32 v189, v37
  v_mfma_f32_16x16x32_bf16 a[112:115], v[152:155], v[56:59], a[112:115]
  v_exp_f32 v190, v38
  v_mfma_f32_16x16x32_bf16 a[160:163], v[152:155], v[60:63], a[160:163]
  s_waitcnt lgkmcnt(3)
  buffer_load_dwordx4 v[204:205], s[16:19], s83 idxen offen  lds
  v_mfma_f32_16x16x32_bf16 a[20:23], v[156:159], v[48:51], a[20:23]
  ds_read_b64_tr_b16 v[164:165], v7 offset:24704
  ds_read_b64_tr_b16 v[166:167], v7 offset:30848
  v_cvt_pk_bf16_f32 v70, v188, v189
  v_mfma_f32_16x16x32_bf16 a[68:71], v[156:159], v[52:55], a[68:71]
  s_add_u32 m0, s51, 36864
  v_exp_f32 v191, v39
  v_mfma_f32_16x16x32_bf16 a[116:119], v[156:159], v[56:59], a[116:119]
  v_exp_f32 v184, v40
  v_mfma_f32_16x16x32_bf16 v[220:223], v[212:215], v[236:239], v[220:223]
  buffer_load_dwordx4 v10, s[8:11], s6 offen offset:2048  lds
  v_mfma_f32_16x16x32_bf16 a[164:167], v[156:159], v[60:63], a[164:167]
  s_waitcnt lgkmcnt(3)
  ds_read_b64_tr_b16 v[168:169], v4 offset:24832
  ds_read_b64_tr_b16 v[210:211], v242 offset:8704
  v_mfma_f32_16x16x32_bf16 a[24:27], v[160:163], v[48:51], a[24:27]
  ds_read_b64_tr_b16 v[170:171], v4 offset:30976
  v_cvt_pk_bf16_f32 v71, v190, v191
  v_mfma_f32_16x16x32_bf16 a[72:75], v[160:163], v[52:55], a[72:75]
  s_add_u32 m0, s53, 7168
  v_exp_f32 v185, v41
  v_mfma_f32_16x16x32_bf16 a[120:123], v[160:163], v[56:59], a[120:123]
  buffer_load_dwordx4 v[206:207], s[16:19], s83 idxen offen  lds
  v_mfma_f32_16x16x32_bf16 a[168:171], v[160:163], v[60:63], a[168:171]
  s_waitcnt lgkmcnt(3)
  v_exp_f32 v186, v42
  v_mfma_f32_16x16x32_bf16 a[28:31], v[164:167], v[48:51], a[28:31]
  v_cvt_pk_bf16_f32 v74, v184, v185
  v_exp_f32 v187, v43
  v_mfma_f32_16x16x32_bf16 a[76:79], v[164:167], v[52:55], a[76:79]
  v_exp_f32 v188, v44
  v_cvt_pk_bf16_f32 v75, v186, v187
  v_mfma_f32_16x16x32_bf16 a[124:127], v[164:167], v[56:59], a[124:127]
  s_waitcnt lgkmcnt(1)
  v_exp_f32 v189, v45
  v_mfma_f32_16x16x32_bf16 v[224:227], v[208:211], v[236:239], v[224:227]
  v_exp_f32 v190, v46
  v_mfma_f32_16x16x32_bf16 a[172:175], v[164:167], v[60:63], a[172:175]
  s_waitcnt lgkmcnt(0)
  ds_read_b64_tr_b16 v[212:213], v243 offset:8192
  ds_read_b64_tr_b16 v[214:215], v243 offset:8704
  v_mfma_f32_16x16x32_bf16 a[32:35], v[168:171], v[48:51], a[32:35]
  ds_read_b64_tr_b16 v[172:173], v5 offset:24832
  v_cvt_pk_bf16_f32 v78, v188, v189
  v_mfma_f32_16x16x32_bf16 a[80:83], v[168:171], v[52:55], a[80:83]
  v_exp_f32 v191, v47
  v_mfma_f32_16x16x32_bf16 a[128:131], v[168:171], v[56:59], a[128:131]
  s_add_u32 m0, s52, 12288
  ds_read_b64_tr_b16 v[174:175], v5 offset:30976
  v_cvt_pk_bf16_f32 v79, v190, v191
  v_mfma_f32_16x16x32_bf16 a[176:179], v[168:171], v[60:63], a[176:179]
  buffer_load_dwordx4 v8, s[12:15], s7 offen offset:0  lds
  v_mfma_f32_16x16x32_bf16 v[96:99], v[112:115], v[64:67], v[96:99]
  s_add_u32 m0, s52, 12288
  ds_read_b64_tr_b16 v[176:177], v6 offset:24832
  v_cvt_pk_bf16_f32 v248, v216, v217
  v_mfma_f32_16x16x32_bf16 v[100:103], v[112:115], v[68:71], v[100:103]
  s_waitcnt lgkmcnt(3)
  ds_read_b64_tr_b16 v[178:179], v6 offset:30976
  ds_read_b64_tr_b16 v[180:181], v7 offset:24832
  v_mfma_f32_16x16x32_bf16 v[228:231], v[212:215], v[236:239], v[228:231]
  s_cmp_ge_u32 s77, s36
  s_cselect_b64 s[66:67], -1, 0
  v_cvt_pk_bf16_f32 v249, v218, v219
  v_mfma_f32_16x16x32_bf16 v[104:107], v[112:115], v[72:75], v[104:107]
  ds_read_b64_tr_b16 v[182:183], v7 offset:30976
  ds_read_b128 v[152:155], v2 offset:0
  v_mfma_f32_16x16x32_bf16 v[108:111], v[112:115], v[76:79], v[108:111]
  s_waitcnt lgkmcnt(5)
  buffer_load_dwordx4 v9, s[12:15], s7 offen offset:1024  lds
  v_mfma_f32_16x16x32_bf16 a[36:39], v[172:175], v[48:51], a[36:39]
  s_add_u32 m0, s52, 12288
  v_mfma_f32_16x16x32_bf16 a[84:87], v[172:175], v[52:55], a[84:87]
  v_cvt_pk_bf16_f32 v250, v220, v221
  v_cvt_pk_bf16_f32 v251, v222, v223
  v_mfma_f32_16x16x32_bf16 a[132:135], v[172:175], v[56:59], a[132:135]
  ds_read_b128 v[156:159], v3 offset:0
  v_mfma_f32_16x16x32_bf16 a[180:183], v[172:175], v[60:63], a[180:183]
  s_waitcnt lgkmcnt(4)
  buffer_store_dwordx4 v[248:251], v13, s[24:27], s92 offen offset:0 sc1
  v_mfma_f32_16x16x32_bf16 a[40:43], v[176:179], v[48:51], a[40:43]
  v_max3_f32 v14, v96, v100, v104
  v_cvt_pk_bf16_f32 v252, v224, v225
  v_mfma_f32_16x16x32_bf16 a[88:91], v[176:179], v[52:55], a[88:91]
  ds_read_b128 v[160:163], v2 offset:128
  v_cvt_pk_bf16_f32 v253, v226, v227
  v_mfma_f32_16x16x32_bf16 a[136:139], v[176:179], v[56:59], a[136:139]
  v_max_f32 v14, v14, v108
  v_cmp_nge_f32 s[64:65], s50, v14
  v_mfma_f32_16x16x32_bf16 a[184:187], v[176:179], v[60:63], a[184:187]
  s_waitcnt lgkmcnt(3)
  buffer_load_dwordx4 v10, s[12:15], s7 offen offset:2048  lds
  v_mfma_f32_16x16x32_bf16 a[44:47], v[180:183], v[48:51], a[44:47]
  v_mfma_f32_16x16x32_bf16 a[92:95], v[180:183], v[52:55], a[92:95]
  v_cvt_pk_bf16_f32 v254, v228, v229
  v_cvt_pk_bf16_f32 v255, v230, v231
  v_mfma_f32_16x16x32_bf16 a[140:143], v[180:183], v[56:59], a[140:143]
  ds_read_b128 v[164:167], v3 offset:128
  v_mfma_f32_16x16x32_bf16 a[188:191], v[180:183], v[60:63], a[188:191]
  buffer_store_dwordx4 v[252:255], v13, s[24:27], s92 offen offset:1024 sc1
  s_or_b64 vcc, s[64:65], s[66:67]
  s_cbranch_vccnz P1V1s1_SLOW
P1V1s1_SLOWB:
  s_cmp_eq_u32 s33, 9
  s_cbranch_scc0 P1V1_NV1
  s_call_b64 s[72:73], VSET_1
P1V1_NV1:
  s_cmp_eq_u32 s33, 11
  s_cbranch_scc0 P1V1_NV2
  s_call_b64 s[72:73], VSET_2
P1V1_NV2:
  s_cmp_eq_u32 s33, 13
  s_cbranch_scc0 P1V1_NV3
  s_call_b64 s[72:73], VSET_3
P1V1_NV3:
  s_cmp_eq_u32 s33, s38
  s_cbranch_scc0 P1V1_NP
  ds_read_b64_tr_b16 v[168:169], v4 offset:36864
  ds_read_b64_tr_b16 v[170:171], v4 offset:43008
  ds_read_b64_tr_b16 v[172:173], v5 offset:36864
  ds_read_b64_tr_b16 v[174:175], v5 offset:43008
  ds_read_b64_tr_b16 v[176:177], v6 offset:36864
  ds_read_b64_tr_b16 v[178:179], v6 offset:43008
  ds_read_b64_tr_b16 v[180:181], v7 offset:36864
  ds_read_b64_tr_b16 v[182:183], v7 offset:43008
  s_waitcnt lgkmcnt(6)
  v_mfma_f32_16x16x32_bf16 a[0:3], v[168:171], v[64:67], a[0:3]
  v_mfma_f32_16x16x32_bf16 a[48:51], v[168:171], v[68:71], a[48:51]
  s_waitcnt lgkmcnt(4)
  ds_read_b64_tr_b16 v[168:169], v4 offset:36992
  ds_read_b64_tr_b16 v[170:171], v4 offset:43136
  v_mfma_f32_16x16x32_bf16 a[4:7], v[172:175], v[64:67], a[4:7]
  v_mfma_f32_16x16x32_bf16 a[52:55], v[172:175], v[68:71], a[52:55]
  s_waitcnt lgkmcnt(4)
  ds_read_b64_tr_b16 v[172:173], v5 offset:36992
  ds_read_b64_tr_b16 v[174:175], v5 offset:43136
  v_mfma_f32_16x16x32_bf16 a[8:11], v[176:179], v[64:67], a[8:11]
  v_mfma_f32_16x16x32_bf16 a[56:59], v[176:179], v[68:71], a[56:59]
  s_waitcnt lgkmcnt(4)
  ds_read_b64_tr_b16 v[176:177], v6 offset:36992
  ds_read_b64_tr_b16 v[178:179], v6 offset:43136
  v_mfma_f32_16x16x32_bf16 a[12:15], v[180:183], v[64:67], a[12:15]
  v_mfma_f32_16x16x32_bf16 a[60:63], v[180:183], v[68:71], a[60:63]
  s_waitcnt lgkmcnt(4)
  ds_read_b64_tr_b16 v[180:181], v7 offset:36992
  ds_read_b64_tr_b16 v[182:183], v7 offset:43136
  v_mfma_f32_16x16x32_bf16 a[16:19], v[168:171], v[64:67], a[16:19]
  v_mfma_f32_16x16x32_bf16 a[64:67], v[168:171], v[68:71], a[64:67]
  s_waitcnt lgkmcnt(4)
  ds_read_b64_tr_b16 v[168:169], v4 offset:37120
  ds_read_b64_tr_b16 v[170:171], v4 offset:43264
  v_mfma_f32_16x16x32_bf16 a[20:23], v[172:175], v[64:67], a[20:23]
  v_mfma_f32_16x16x32_bf16 a[68:71], v[172:175], v[68:71], a[68:71]
  s_waitcnt lgkmcnt(4)
  ds_read_b64_tr_b16 v[172:173], v5 offset:37120
  ds_read_b64_tr_b16 v[174:175], v5 offset:43264
  v_mfma_f32_16x16x32_bf16 a[24:27], v[176:179], v[64:67], a[24:27]
  v_mfma_f32_16x16x32_bf16 a[72:75], v[176:179], v[68:71], a[72:75]
  s_waitcnt lgkmcnt(4)
  ds_read_b64_tr_b16 v[176:177], v6 offset:37120
  ds_read_b64_tr_b16 v[178:179], v6 offset:43264
  v_mfma_f32_16x16x32_bf16 a[28:31], v[180:183], v[64:67], a[28:31]
  v_mfma_f32_16x16x32_bf16 a[76:79], v[180:183], v[68:71], a[76:79]
  s_waitcnt lgkmcnt(4)
  ds_read_b64_tr_b16 v[180:181], v7 offset:37120
  ds_read_b64_tr_b16 v[182:183], v7 offset:43264
  v_mfma_f32_16x16x32_bf16 a[32:35], v[168:171], v[64:67], a[32:35]
  v_mfma_f32_16x16x32_bf16 a[80:83], v[168:171], v[68:71], a[80:83]
  s_waitcnt lgkmcnt(4)
  v_mfma_f32_16x16x32_bf16 a[36:39], v[172:175], v[64:67], a[36:39]
  v_mfma_f32_16x16x32_bf16 a[84:87], v[172:175], v[68:71], a[84:87]
  s_waitcnt lgkmcnt(2)
  v_mfma_f32_16x16x32_bf16 a[40:43], v[176:179], v[64:67], a[40:43]
  v_mfma_f32_16x16x32_bf16 a[88:91], v[176:179], v[68:71], a[88:91]
  s_waitcnt lgkmcnt(0)
  v_mfma_f32_16x16x32_bf16 a[44:47], v[180:183], v[64:67], a[44:47]
  v_mfma_f32_16x16x32_bf16 a[92:95], v[180:183], v[68:71], a[92:95]
  s_call_b64 s[72:73], MASK_p2
  s_mov_b32 s34, 2
P1V1_NP:
  s_cmp_eq_u32 s33, 15
  s_cbranch_scc1 FINISH
  s_add_u32 s33, s33, 1
  s_cmp_eq_u32 s34, 2
  s_cbranch_scc1 P2V0
  s_branch P1V0
.p2align 6
P2K0:
  s_waitcnt lgkmcnt(2)
  v_mfma_f32_16x16x32_bf16 v[24:27], v[152:155], a[192:195], v[88:91]
  s_add_u32 m0, s53, 8192
  ds_read_b128 v[168:171], v2 offset:256
  ds_read_b128 v[172:175], v3 offset:256
  v_mfma_f32_16x16x32_bf16 v[28:31], v[152:155], a[216:219], v[92:95]
  s_mov_b32 s76, s77
  buffer_load_dwordx4 v[200:201], s[16:19], s61 idxen offen  lds
  v_mfma_f32_16x16x32_bf16 v[24:27], v[156:159], a[196:199], v[24:27]
  s_add_u32 m0, s53, 9216
  ds_read_b128 v[176:179], v2 offset:6144
  v_mfma_f32_16x16x32_bf16 v[28:31], v[156:159], a[220:223], v[28:31]
  s_waitcnt lgkmcnt(3)
  v_mfma_f32_16x16x32_bf16 v[24:27], v[160:163], a[200:203], v[24:27]
  s_waitcnt vmcnt(11)
  ds_read_b128 v[180:183], v3 offset:6144
  ds_read_b128 v[152:155], v2 offset:6272
  v_mfma_f32_16x16x32_bf16 v[28:31], v[160:163], a[224:227], v[28:31]
  s_mov_b32 s77, s78
  v_mfma_f32_16x16x32_bf16 v[24:27], v[164:167], a[204:207], v[24:27]
  s_mov_b32 s78, s79
  s_mov_b32 s79, s74
  ds_read_b128 v[208:211], v250 offset:0
  v_mfma_f32_16x16x32_bf16 v[28:31], v[164:167], a[228:231], v[28:31]
  s_waitcnt lgkmcnt(4)
  buffer_load_dwordx4 v[202:203], s[16:19], s61 idxen offen  lds
  v_mfma_f32_16x16x32_bf16 v[24:27], v[168:171], a[208:211], v[24:27]
  s_add_u32 s40, s32, 4
  ds_read_b128 v[212:215], v251 offset:0
  v_mfma_f32_16x16x32_bf16 v[28:31], v[168:171], a[232:235], v[28:31]
  s_add_u32 m0, s53, 10240
  ds_read_b64_tr_b16 v[168:169], v4 offset:36864
  v_mfma_f32_16x16x32_bf16 v[24:27], v[172:175], a[212:215], v[24:27]
  ds_read_b128 v[156:159], v3 offset:6272
  v_readlane_b32 s74, v0, s40
  v_mfma_f32_16x16x32_bf16 v[28:31], v[172:175], a[236:239], v[28:31]
  s_waitcnt lgkmcnt(5)
  buffer_load_dwordx4 v[204:205], s[16:19], s61 idxen offen  lds
  v_mfma_f32_16x16x32_bf16 v[40:43], v[176:179], a[192:195], v[192:195]
  s_mul_i32 s63, s78, 12288
  ds_read_b128 v[160:163], v2 offset:6400
  ds_read_b64_tr_b16 v[170:171], v4 offset:43008
  v_mfma_f32_16x16x32_bf16 v[44:47], v[176:179], a[216:219], v[196:199]
  s_waitcnt lgkmcnt(5)
  s_add_u32 s63, s63, s75
  ds_read_b64_tr_b16 v[172:173], v5 offset:36864
  v_mfma_f32_16x16x32_bf16 v[240:243], v[216:219], v[208:211], 0
  s_add_u32 m0, s53, 11264
  ds_read_b128 v[164:167], v3 offset:6400
  v_exp_f32 v184, v24
  v_mfma_f32_16x16x32_bf16 v[40:43], v[180:183], a[196:199], v[40:43]
  buffer_load_dwordx4 v[206:207], s[16:19], s61 idxen offen  lds
  v_exp_f32 v185, v25
  v_mfma_f32_16x16x32_bf16 v[44:47], v[180:183], a[220:223], v[44:47]
  ds_read_b64_tr_b16 v[174:175], v5 offset:43008
  ds_read_b128 v[208:211], v250 offset:2048
  v_mfma_f32_16x16x32_bf16 v[40:43], v[152:155], a[200:203], v[40:43]
  s_mul_i32 s62, s74, 12288
  v_exp_f32 v186, v26
  v_mfma_f32_16x16x32_bf16 v[44:47], v[152:155], a[224:227], v[44:47]
  s_waitcnt lgkmcnt(6)
  ds_read_b64_tr_b16 v[176:177], v6 offset:36864
  v_cvt_pk_bf16_f32 v56, v184, v185
  v_mfma_f32_16x16x32_bf16 v[40:43], v[156:159], a[204:207], v[40:43]
  ds_read_b64_tr_b16 v[178:179], v6 offset:43008
  ds_read_b64_tr_b16 v[180:181], v7 offset:36864
  v_mfma_f32_16x16x32_bf16 v[44:47], v[156:159], a[228:231], v[44:47]
  s_waitcnt lgkmcnt(5)
  ds_read_b64_tr_b16 v[182:183], v7 offset:43008
  v_exp_f32 v187, v27
  v_mfma_f32_16x16x32_bf16 v[40:43], v[160:163], a[208:211], v[40:43]
  ds_read_b64_tr_b16 v[152:153], v4 offset:36992
  ds_read_b64_tr_b16 v[154:155], v4 offset:43136
  v_exp_f32 v188, v28
  v_mfma_f32_16x16x32_bf16 v[240:243], v[220:223], v[212:215], v[240:243]
  s_add_u32 s62, s62, s75
  ds_read_b64_tr_b16 v[156:157], v5 offset:36992
  v_cvt_pk_bf16_f32 v57, v186, v187
  v_mfma_f32_16x16x32_bf16 v[44:47], v[160:163], a[232:235], v[44:47]
  s_add_u32 s32, s32, 1
  v_exp_f32 v189, v29
  v_mfma_f32_16x16x32_bf16 v[40:43], v[164:167], a[212:215], v[40:43]
  s_waitcnt vmcnt(11)
  s_barrier
  ds_read_b128 v[212:215], v251 offset:2048
  v_mfma_f32_16x16x32_bf16 v[44:47], v[164:167], a[236:239], v[44:47]
  v_exp_f32 v190, v30
  v_cvt_pk_bf16_f32 v60, v188, v189
  v_mfma_f32_16x16x32_bf16 a[96:99], v[168:171], v[72:75], a[96:99]
  s_add_u32 m0, s51, 0
  ds_read_b64_tr_b16 v[158:159], v5 offset:43136
  ds_read_b64_tr_b16 v[160:161], v6 offset:36992
  v_mfma_f32_16x16x32_bf16 a[144:147], v[168:171], v[76:79], a[144:147]
  s_waitcnt lgkmcnt(11)
  ds_read_b32 v200, v1 offset:128
  v_exp_f32 v191, v31
  v_mfma_f32_16x16x32_bf16 a[100:103], v[172:175], v[72:75], a[100:103]
  ds_read_b64_tr_b16 v[162:163], v6 offset:43136
  buffer_load_dwordx4 v8, s[8:11], s62 offen offset:0  lds
  v_mfma_f32_16x16x32_bf16 a[148:151], v[172:175], v[76:79], a[148:151]
  s_waitcnt lgkmcnt(8)
  ds_read_b64_tr_b16 v[164:165], v7 offset:36992
  ds_read_b64_tr_b16 v[166:167], v7 offset:43136
  v_mfma_f32_16x16x32_bf16 a[104:107], v[176:179], v[72:75], a[104:107]
  ds_read_b32 v202, v1 offset:160
  v_cvt_pk_bf16_f32 v61, v190, v191
  v_mfma_f32_16x16x32_bf16 v[244:247], v[216:219], v[208:211], 0
  v_exp_f32 v184, v40
  v_mfma_f32_16x16x32_bf16 a[152:155], v[176:179], v[76:79], a[152:155]
  s_max_u32 s40, s76, s77
  ds_read_b64_tr_b16 v[168:169], v4 offset:37120
  ds_read_b32 v204, v1 offset:192
  v_mfma_f32_16x16x32_bf16 a[108:111], v[180:183], v[72:75], a[108:111]
  v_exp_f32 v185, v41
  v_mfma_f32_16x16x32_bf16 a[156:159], v[180:183], v[76:79], a[156:159]
  s_waitcnt lgkmcnt(8)
  v_exp_f32 v186, v42
  v_mfma_f32_16x16x32_bf16 a[112:115], v[152:155], v[72:75], a[112:115]
  s_add_u32 m0, s51, 0
  ds_read_b64_tr_b16 v[170:171], v4 offset:43264
  ds_read_b64_tr_b16 v[172:173], v5 offset:37120
  ds_read_b32 v206, v1 offset:224
  v_cvt_pk_bf16_f32 v58, v184, v185
  v_exp_f32 v187, v43
  v_exp_f32 v188, v44
  v_mfma_f32_16x16x32_bf16 a[160:163], v[152:155], v[76:79], a[160:163]
  buffer_load_dwordx4 v9, s[8:11], s62 offen offset:1024  lds
  v_mfma_f32_16x16x32_bf16 a[116:119], v[156:159], v[72:75], a[116:119]
  ds_read_b64_tr_b16 v[174:175], v5 offset:43264
  ds_read_b64_tr_b16 v[176:177], v6 offset:37120
  ds_read_b64_tr_b16 v[178:179], v6 offset:43264
  v_mfma_f32_16x16x32_bf16 a[164:167], v[156:159], v[76:79], a[164:167]
  s_waitcnt vmcnt(9)
  v_cvt_pk_bf16_f32 v59, v186, v187
  v_mfma_f32_16x16x32_bf16 v[244:247], v[220:223], v[212:215], v[244:247]
  s_waitcnt lgkmcnt(9)
  ds_read_b64_tr_b16 v[180:181], v7 offset:37120
  ds_read_b128 v[208:211], v250 offset:4096
  v_exp_f32 v189, v45
  v_mfma_f32_16x16x32_bf16 a[120:123], v[160:163], v[72:75], a[120:123]
  s_add_u32 m0, s53, 0
  v_exp_f32 v190, v46
  v_mfma_f32_16x16x32_bf16 a[168:171], v[160:163], v[76:79], a[168:171]
  buffer_load_dwordx4 v[200:201], s[16:19], 0 idxen offen  lds
  v_mfma_f32_16x16x32_bf16 a[124:127], v[164:167], v[72:75], a[124:127]
  s_add_u32 m0, s53, 1024
  ds_read_b128 v[152:155], v2 offset:12288
  v_cvt_pk_bf16_f32 v62, v188, v189
  v_mfma_f32_16x16x32_bf16 a[172:175], v[164:167], v[76:79], a[172:175]
  s_waitcnt lgkmcnt(5)
  v_exp_f32 v191, v47
  v_mfma_f32_16x16x32_bf16 a[128:131], v[168:171], v[72:75], a[128:131]
  ds_read_b64_tr_b16 v[182:183], v7 offset:43264
  v_cvt_pk_bf16_f32 v63, v190, v191
  v_mfma_f32_16x16x32_bf16 a[176:179], v[168:171], v[76:79], a[176:179]
  s_cmp_ge_u32 s40, s37
  s_cselect_b64 s[66:67], -1, 0
  ds_read_b128 v[156:159], v3 offset:12288
  v_mfma_f32_16x16x32_bf16 v[104:107], v[112:115], v[56:59], v[104:107]
  buffer_load_dwordx4 v[202:203], s[16:19], 0 idxen offen  lds
  v_mfma_f32_16x16x32_bf16 v[108:111], v[112:115], v[60:63], v[108:111]
  s_waitcnt lgkmcnt(3)
  s_add_u32 m0, s51, 0
  ds_read_b128 v[212:215], v251 offset:4096
  v_mfma_f32_16x16x32_bf16 v[240:243], v[224:227], v[208:211], v[240:243]
  v_mfma_f32_16x16x32_bf16 a[132:135], v[172:175], v[72:75], a[132:135]
  ds_read_b128 v[160:163], v2 offset:12416
  v_mfma_f32_16x16x32_bf16 a[180:183], v[172:175], v[76:79], a[180:183]
  buffer_load_dwordx4 v10, s[8:11], s62 offen offset:2048  lds
  v_mfma_f32_16x16x32_bf16 a[136:139], v[176:179], v[72:75], a[136:139]
  ds_read_b128 v[208:211], v250 offset:6144
  v_max_f32 v14, v104, v108
  v_mfma_f32_16x16x32_bf16 a[184:187], v[176:179], v[76:79], a[184:187]
  s_waitcnt lgkmcnt(4)
  v_cmp_nge_f32 s[64:65], s50, v14
  v_mfma_f32_16x16x32_bf16 a[140:143], v[180:183], v[72:75], a[140:143]
  s_add_u32 m0, s53, 2048
  ds_read_b128 v[164:167], v3 offset:12416
  v_mfma_f32_16x16x32_bf16 a[188:191], v[180:183], v[76:79], a[188:191]
  buffer_load_dwordx4 v[204:205], s[16:19], 0 idxen offen  lds
  s_or_b64 vcc, s[64:65], s[66:67]
  s_cbranch_vccnz P2K0s0_SLOW
P2K0s0_SLOWB:
  v_mfma_f32_16x16x32_bf16 v[24:27], v[152:155], a[192:195], v[88:91]
  s_waitcnt lgkmcnt(3)
  s_mov_b32 s76, s77
  ds_read_b128 v[168:171], v2 offset:12544
  v_mfma_f32_16x16x32_bf16 v[240:243], v[228:231], v[212:215], v[240:243]
  s_add_u32 m0, s53, 3072
  ds_read_b128 v[212:215], v251 offset:6144
  v_mfma_f32_16x16x32_bf16 v[28:31], v[152:155], a[216:219], v[92:95]
  s_mov_b32 s77, s78
  ds_read_b128 v[172:175], v3 offset:12544
  v_mfma_f32_16x16x32_bf16 v[24:27], v[156:159], a[196:199], v[24:27]
  buffer_load_dwordx4 v[206:207], s[16:19], 0 idxen offen  lds
  v_mfma_f32_16x16x32_bf16 v[28:31], v[156:159], a[220:223], v[28:31]
  s_waitcnt lgkmcnt(3)
  s_mov_b32 s78, s79
  ds_read_b128 v[176:179], v2 offset:18432
  v_mfma_f32_16x16x32_bf16 v[24:27], v[160:163], a[200:203], v[24:27]
  s_mov_b32 s79, s74
  v_mfma_f32_16x16x32_bf16 v[28:31], v[160:163], a[224:227], v[28:31]
  s_add_u32 m0, s52, 24576
  ds_read_b128 v[180:183], v3 offset:18432
  v_mfma_f32_16x16x32_bf16 v[24:27], v[164:167], a[204:207], v[24:27]
  buffer_load_dwordx4 v8, s[12:15], s63 offen offset:0  lds
  v_mfma_f32_16x16x32_bf16 v[28:31], v[164:167], a[228:231], v[28:31]
  s_waitcnt lgkmcnt(2)
  s_add_u32 s40, s32, 4
  ds_read_b128 v[152:155], v2 offset:18560
  v_mfma_f32_16x16x32_bf16 v[24:27], v[168:171], a[208:211], v[24:27]
  s_add_u32 m0, s52, 24576
  v_mfma_f32_16x16x32_bf16 v[244:247], v[224:227], v[208:211], v[244:247]
  ds_read_b128 v[156:159], v3 offset:18560
  v_readlane_b32 s74, v0, s40
  v_mfma_f32_16x16x32_bf16 v[28:31], v[168:171], a[232:235], v[28:31]
  s_mul_i32 s7, s78, 12288
  buffer_load_dwordx4 v9, s[12:15], s63 offen offset:1024  lds
  v_mfma_f32_16x16x32_bf16 v[24:27], v[172:175], a[212:215], v[24:27]
  ds_read_b128 v[160:163], v2 offset:18688
  ds_read_b64_tr_b16 v[168:169], v4 offset:0
  v_mfma_f32_16x16x32_bf16 v[28:31], v[172:175], a[236:239], v[28:31]
  s_waitcnt lgkmcnt(4)
  s_add_u32 s7, s7, s75
  ds_read_b64_tr_b16 v[170:171], v4 offset:6144
  v_mfma_f32_16x16x32_bf16 v[40:43], v[176:179], a[192:195], v[192:195]
  s_add_u32 m0, s52, 24576
  ds_read_b64_tr_b16 v[172:173], v5 offset:0
  ds_read_b64_tr_b16 v[174:175], v5 offset:6144
  v_mfma_f32_16x16x32_bf16 v[44:47], v[176:179], a[216:219], v[196:199]
  s_mul_i32 s6, s74, 12288
  buffer_load_dwordx4 v10, s[12:15], s63 offen offset:2048  lds
  v_mfma_f32_16x16x32_bf16 v[40:43], v[180:183], a[196:199], v[40:43]
  s_add_u32 s6, s6, s75
  ds_read_b128 v[164:167], v3 offset:18688
  v_exp_f32 v184, v24
  v_mfma_f32_16x16x32_bf16 v[44:47], v[180:183], a[220:223], v[44:47]
  s_waitcnt vmcnt(10)
  v_exp_f32 v185, v25
  v_mfma_f32_16x16x32_bf16 v[244:247], v[228:231], v[212:215], v[244:247]
  s_waitcnt lgkmcnt(6)
  ds_read_b64_tr_b16 v[176:177], v6 offset:0
  ds_read_b64_tr_b16 v[178:179], v6 offset:6144
  ds_read_b64_tr_b16 v[180:181], v7 offset:0
  v_mfma_f32_16x16x32_bf16 v[40:43], v[152:155], a[200:203], v[40:43]
  s_add_u32 m0, s53, 4096
  v_exp_f32 v186, v26
  v_cvt_pk_bf16_f32 v72, v184, v185
  v_mfma_f32_16x16x32_bf16 v[44:47], v[152:155], a[224:227], v[44:47]
  ds_read_b64_tr_b16 v[182:183], v7 offset:6144
  ds_read_b128 v[208:211], v250 offset:8192
  buffer_load_dwordx4 v[200:201], s[16:19], s60 idxen offen  lds
  v_mfma_f32_16x16x32_bf16 v[40:43], v[156:159], a[204:207], v[40:43]
  v_exp_f32 v187, v27
  v_mfma_f32_16x16x32_bf16 v[44:47], v[156:159], a[228:231], v[44:47]
  s_waitcnt lgkmcnt(5)
  ds_read_b64_tr_b16 v[152:153], v4 offset:128
  ds_read_b64_tr_b16 v[154:155], v4 offset:6272
  v_mfma_f32_16x16x32_bf16 v[40:43], v[160:163], a[208:211], v[40:43]
  ds_read_b64_tr_b16 v[156:157], v5 offset:128
  v_exp_f32 v188, v28
  v_cvt_pk_bf16_f32 v73, v186, v187
  v_mfma_f32_16x16x32_bf16 v[44:47], v[160:163], a[232:235], v[44:47]
  s_add_u32 m0, s53, 5120
  v_exp_f32 v189, v29
  v_mfma_f32_16x16x32_bf16 v[40:43], v[164:167], a[212:215], v[40:43]
  s_waitcnt vmcnt(15)
  s_barrier
  ds_read_b128 v[212:215], v251 offset:8192
  buffer_load_dwordx4 v[202:203], s[16:19], s60 idxen offen  lds
  v_exp_f32 v190, v30
  v_mfma_f32_16x16x32_bf16 v[44:47], v[164:167], a[236:239], v[44:47]
  s_waitcnt lgkmcnt(4)
  v_cvt_pk_bf16_f32 v76, v188, v189
  v_exp_f32 v191, v31
  v_mfma_f32_16x16x32_bf16 v[240:243], v[232:235], v[208:211], v[240:243]
  ds_read_b64_tr_b16 v[158:159], v5 offset:6272
  v_cvt_pk_bf16_f32 v77, v190, v191
  v_mfma_f32_16x16x32_bf16 a[96:99], v[168:171], v[56:59], a[96:99]
  s_add_u32 m0, s53, 6144
  ds_read_b64_tr_b16 v[160:161], v6 offset:128
  ds_read_b64_tr_b16 v[162:163], v6 offset:6272
  v_mfma_f32_16x16x32_bf16 a[144:147], v[168:171], v[60:63], a[144:147]
  ds_read_b64_tr_b16 v[164:165], v7 offset:128
  buffer_load_dwordx4 v[204:205], s[16:19], s60 idxen offen  lds
  v_mfma_f32_16x16x32_bf16 a[100:103], v[172:175], v[56:59], a[100:103]
  v_exp_f32 v184, v40
  v_mfma_f32_16x16x32_bf16 a[148:151], v[172:175], v[60:63], a[148:151]
  v_exp_f32 v185, v41
  v_mfma_f32_16x16x32_bf16 a[104:107], v[176:179], v[56:59], a[104:107]
  s_add_u32 m0, s51, 12288
  ds_read_b64_tr_b16 v[166:167], v7 offset:6272
  ds_read_b64_tr_b16 v[168:169], v4 offset:256
  v_mfma_f32_16x16x32_bf16 a[152:155], v[176:179], v[60:63], a[152:155]
  v_exp_f32 v186, v42
  v_mfma_f32_16x16x32_bf16 a[108:111], v[180:183], v[56:59], a[108:111]
  s_waitcnt lgkmcnt(6)
  ds_read_b128 v[208:211], v250 offset:10240
  buffer_load_dwordx4 v8, s[8:11], s6 offen offset:0  lds
  v_mfma_f32_16x16x32_bf16 v[240:243], v[236:239], v[212:215], v[240:243]
  s_add_u32 m0, s53, 7168
  ds_read_b64_tr_b16 v[170:171], v4 offset:6400
  v_cvt_pk_bf16_f32 v74, v184, v185
  v_mfma_f32_16x16x32_bf16 a[156:159], v[180:183], v[60:63], a[156:159]
  v_exp_f32 v187, v43
  v_mfma_f32_16x16x32_bf16 a[112:115], v[152:155], v[56:59], a[112:115]
  ds_read_b64_tr_b16 v[172:173], v5 offset:256
  v_exp_f32 v188, v44
  v_mfma_f32_16x16x32_bf16 a[160:163], v[152:155], v[60:63], a[160:163]
  s_waitcnt lgkmcnt(8)
  ds_read_b64_tr_b16 v[174:175], v5 offset:6400
  ds_read_b64_tr_b16 v[176:177], v6 offset:256
  v_mfma_f32_16x16x32_bf16 a[116:119], v[156:159], v[56:59], a[116:119]
  buffer_load_dwordx4 v[206:207], s[16:19], s60 idxen offen  lds
  v_mfma_f32_16x16x32_bf16 a[164:167], v[156:159], v[60:63], a[164:167]
  s_waitcnt lgkmcnt(6)
  ds_read_b64_tr_b16 v[178:179], v6 offset:6400
  ds_read_b128 v[212:215], v251 offset:10240
  v_mfma_f32_16x16x32_bf16 a[120:123], v[160:163], v[56:59], a[120:123]
  s_add_u32 s32, s32, 1
  v_cvt_pk_bf16_f32 v75, v186, v187
  v_exp_f32 v189, v45
  v_mfma_f32_16x16x32_bf16 a[168:171], v[160:163], v[60:63], a[168:171]
  s_max_u32 s40, s76, s77
  v_exp_f32 v190, v46
  v_mfma_f32_16x16x32_bf16 a[124:127], v[164:167], v[56:59], a[124:127]
  s_waitcnt lgkmcnt(6)
  ds_read_b128 v[152:155], v2 offset:24576
  v_cvt_pk_bf16_f32 v78, v188, v189
  v_mfma_f32_16x16x32_bf16 v[244:247], v[232:235], v[208:211], v[244:247]
  s_add_u32 m0, s51, 12288
  ds_read_b64_tr_b16 v[180:181], v7 offset:256
  v_exp_f32 v191, v47
  v_mfma_f32_16x16x32_bf16 a[172:175], v[164:167], v[60:63], a[172:175]
  s_waitcnt lgkmcnt(5)
  buffer_load_dwordx4 v9, s[8:11], s6 offen offset:1024  lds
  v_mfma_f32_16x16x32_bf16 a[128:131], v[168:171], v[56:59], a[128:131]
  ds_read_b64_tr_b16 v[182:183], v7 offset:6400
  v_cvt_pk_bf16_f32 v79, v190, v191
  v_mfma_f32_16x16x32_bf16 a[176:179], v[168:171], v[60:63], a[176:179]
  ds_read_b128 v[156:159], v3 offset:24576
  v_cndmask_b32 v248, v248, v240, s[80:81]
  v_mfma_f32_16x16x32_bf16 v[104:107], v[112:115], v[72:75], v[104:107]
  s_add_u32 m0, s51, 12288
  ds_read_b128 v[160:163], v2 offset:24704
  v_mfma_f32_16x16x32_bf16 v[108:111], v[112:115], v[76:79], v[108:111]
  buffer_load_dwordx4 v10, s[8:11], s6 offen offset:2048  lds
  v_mfma_f32_16x16x32_bf16 a[132:135], v[172:175], v[56:59], a[132:135]
  s_cmp_ge_u32 s40, s37
  s_cselect_b64 s[66:67], -1, 0
  ds_read_b128 v[164:167], v3 offset:24704
  v_mfma_f32_16x16x32_bf16 a[180:183], v[172:175], v[60:63], a[180:183]
  s_waitcnt lgkmcnt(6)
  s_waitcnt vmcnt(10)
  v_mfma_f32_16x16x32_bf16 v[244:247], v[236:239], v[212:215], v[244:247]
  ds_read_b128 v[208:211], v250 offset:0
  v_mfma_f32_16x16x32_bf16 a[136:139], v[176:179], v[56:59], a[136:139]
  s_add_u32 m0, s53, 8192
  v_max_f32 v14, v104, v108
  v_cmp_nge_f32 s[64:65], s50, v14
  v_mfma_f32_16x16x32_bf16 a[184:187], v[176:179], v[60:63], a[184:187]
  s_waitcnt lgkmcnt(4)
  buffer_load_dwordx4 v[200:201], s[16:19], s61 idxen offen  lds
  v_mfma_f32_16x16x32_bf16 a[140:143], v[180:183], v[56:59], a[140:143]
  s_add_u32 m0, s52, 36864
  ds_read_b128 v[212:215], v251 offset:0
  v_mfma_f32_16x16x32_bf16 a[188:191], v[180:183], v[60:63], a[188:191]
  buffer_load_dwordx4 v8, s[12:15], s7 offen offset:0  lds
  s_or_b64 vcc, s[64:65], s[66:67]
  s_cbranch_vccnz P2K0s1_SLOW
P2K0s1_SLOWB:
  v_mfma_f32_16x16x32_bf16 v[24:27], v[152:155], a[192:195], v[88:91]
  ds_read_b128 v[168:171], v2 offset:24832
  v_cndmask_b32 v248, v248, v241, s[82:83]
  v_mfma_f32_16x16x32_bf16 v[28:31], v[152:155], a[216:219], v[92:95]
  s_waitcnt lgkmcnt(5)
  s_mov_b32 s76, s77
  v_cndmask_b32 v249, v249, v246, s[80:81]
  v_mfma_f32_16x16x32_bf16 v[24:27], v[156:159], a[196:199], v[24:27]
  s_add_u32 m0, s53, 9216
  ds_read_b128 v[172:175], v3 offset:24832
  v_mfma_f32_16x16x32_bf16 v[28:31], v[156:159], a[220:223], v[28:31]
  s_waitcnt lgkmcnt(3)
  buffer_load_dwordx4 v[202:203], s[16:19], s61 idxen offen  lds
  v_mfma_f32_16x16x32_bf16 v[240:243], v[216:219], v[208:211], 0
  ds_read_b128 v[176:179], v2 offset:30720
  v_mfma_f32_16x16x32_bf16 v[24:27], v[160:163], a[200:203], v[24:27]
  s_add_u32 m0, s53, 10240
  ds_read_b128 v[180:183], v3 offset:30720
  v_mfma_f32_16x16x32_bf16 v[28:31], v[160:163], a[224:227], v[28:31]
  s_mov_b32 s77, s78
  s_mov_b32 s78, s79
  ds_read_b128 v[208:211], v250 offset:2048
  v_mfma_f32_16x16x32_bf16 v[24:27], v[164:167], a[204:207], v[24:27]
  s_mov_b32 s79, s74
  buffer_load_dwordx4 v[204:205], s[16:19], s61 idxen offen  lds
  v_mfma_f32_16x16x32_bf16 v[28:31], v[164:167], a[228:231], v[28:31]
  s_waitcnt lgkmcnt(3)
  s_add_u32 m0, s52, 36864
  ds_read_b128 v[152:155], v2 offset:30848
  v_mfma_f32_16x16x32_bf16 v[24:27], v[168:171], a[208:211], v[24:27]
  s_add_u32 s40, s32, 4
  v_cndmask_b32 v249, v249, v247, s[82:83]
  v_mfma_f32_16x16x32_bf16 v[28:31], v[168:171], a[232:235], v[28:31]
  ds_read_b128 v[156:159], v3 offset:30848
  ds_read_b64_tr_b16 v[168:169], v4 offset:12288
  v_mfma_f32_16x16x32_bf16 v[24:27], v[172:175], a[212:215], v[24:27]
  buffer_load_dwordx4 v9, s[12:15], s7 offen offset:1024  lds
  v_mfma_f32_16x16x32_bf16 v[240:243], v[220:223], v[212:215], v[240:243]
  s_add_u32 m0, s53, 11264
  ds_read_b128 v[160:163], v2 offset:30976
  v_mfma_f32_16x16x32_bf16 v[28:31], v[172:175], a[236:239], v[28:31]
  s_waitcnt lgkmcnt(5)
  ds_read_b64_tr_b16 v[170:171], v4 offset:18432
  v_readlane_b32 s74, v0, s40
  v_mfma_f32_16x16x32_bf16 v[40:43], v[176:179], a[192:195], v[192:195]
  ds_read_b64_tr_b16 v[172:173], v5 offset:12288
  ds_read_b64_tr_b16 v[174:175], v5 offset:18432
  v_mfma_f32_16x16x32_bf16 v[44:47], v[176:179], a[216:219], v[196:199]
  s_mul_i32 s63, s78, 12288
  v_exp_f32 v184, v24
  v_exp_f32 v185, v25
  v_mfma_f32_16x16x32_bf16 v[40:43], v[180:183], a[196:199], v[40:43]
  s_add_u32 s63, s63, s75
  ds_read_b128 v[164:167], v3 offset:30976
  buffer_load_dwordx4 v[206:207], s[16:19], s61 idxen offen  lds
  v_mfma_f32_16x16x32_bf16 v[44:47], v[180:183], a[220:223], v[44:47]
  s_waitcnt lgkmcnt(6)
  v_exp_f32 v186, v26
  v_mfma_f32_16x16x32_bf16 v[40:43], v[152:155], a[200:203], v[40:43]
  s_add_u32 m0, s52, 36864
  ds_read_b128 v[212:215], v251 offset:2048
  v_cvt_pk_bf16_f32 v56, v184, v185
  v_exp_f32 v187, v27
  v_mfma_f32_16x16x32_bf16 v[44:47], v[152:155], a[224:227], v[44:47]
  s_mul_i32 s62, s74, 12288
  ds_read_b32 v200, v1 offset:256
  v_exp_f32 v188, v28
  v_mfma_f32_16x16x32_bf16 v[40:43], v[156:159], a[204:207], v[40:43]
  ds_read_b64_tr_b16 v[176:177], v6 offset:12288
  buffer_load_dwordx4 v10, s[12:15], s7 offen offset:2048  lds
  v_mfma_f32_16x16x32_bf16 v[244:247], v[216:219], v[208:211], 0
  ds_read_b32 v202, v1 offset:288
  v_cvt_pk_bf16_f32 v57, v186, v187
  v_exp_f32 v189, v29
  v_mfma_f32_16x16x32_bf16 v[44:47], v[156:159], a[228:231], v[44:47]
  s_waitcnt lgkmcnt(4)
  ds_read_b64_tr_b16 v[178:179], v6 offset:18432
  ds_read_b64_tr_b16 v[180:181], v7 offset:12288
  v_mfma_f32_16x16x32_bf16 v[40:43], v[160:163], a[208:211], v[40:43]
  s_add_u32 s62, s62, s75
  v_exp_f32 v190, v30
  v_mfma_f32_16x16x32_bf16 v[44:47], v[160:163], a[232:235], v[44:47]
  s_add_u32 s32, s32, 1
  ds_read_b32 v204, v1 offset:320
  ds_read_b32 v206, v1 offset:352
  v_mfma_f32_16x16x32_bf16 v[40:43], v[164:167], a[212:215], v[40:43]
  s_waitcnt vmcnt(14)
  s_barrier
  ds_read_b64_tr_b16 v[182:183], v7 offset:18432
  v_mfma_f32_16x16x32_bf16 v[44:47], v[164:167], a[236:239], v[44:47]
  ds_read_b64_tr_b16 v[152:153], v4 offset:12416
  v_cvt_pk_bf16_f32 v60, v188, v189
  v_mfma_f32_16x16x32_bf16 a[96:99], v[168:171], v[72:75], a[96:99]
  s_add_u32 m0, s51, 24576
  ds_read_b64_tr_b16 v[154:155], v4 offset:18560
  v_exp_f32 v191, v31
  v_mfma_f32_16x16x32_bf16 a[144:147], v[168:171], v[76:79], a[144:147]
  s_waitcnt lgkmcnt(10)
  s_waitcnt vmcnt(9)
  ds_read_b64_tr_b16 v[156:157], v5 offset:12416
  ds_read_b64_tr_b16 v[158:159], v5 offset:18560
  v_mfma_f32_16x16x32_bf16 v[244:247], v[220:223], v[212:215], v[244:247]
  ds_read_b64_tr_b16 v[160:161], v6 offset:12416
  buffer_load_dwordx4 v8, s[8:11], s62 offen offset:0  lds
  v_mfma_f32_16x16x32_bf16 a[100:103], v[172:175], v[72:75], a[100:103]
  s_add_u32 m0, s53, 0
  ds_read_b128 v[208:211], v250 offset:4096
  v_cvt_pk_bf16_f32 v61, v190, v191
  v_mfma_f32_16x16x32_bf16 a[148:151], v[172:175], v[76:79], a[148:151]
  s_waitcnt lgkmcnt(6)
  v_exp_f32 v184, v40
  v_mfma_f32_16x16x32_bf16 a[104:107], v[176:179], v[72:75], a[104:107]
  s_max_u32 s40, s76, s77
  ds_read_b64_tr_b16 v[162:163], v6 offset:18560
  ds_read_b128 v[212:215], v251 offset:4096
  v_mfma_f32_16x16x32_bf16 a[152:155], v[176:179], v[76:79], a[152:155]
  buffer_load_dwordx4 v[200:201], s[16:19], 0 idxen offen  lds
  v_mfma_f32_16x16x32_bf16 a[108:111], v[180:183], v[72:75], a[108:111]
  ds_read_b64_tr_b16 v[164:165], v7 offset:12416
  ds_read_b64_tr_b16 v[166:167], v7 offset:18560
  v_mfma_f32_16x16x32_bf16 a[156:159], v[180:183], v[76:79], a[156:159]
  s_waitcnt lgkmcnt(6)
  v_exp_f32 v185, v41
  v_mfma_f32_16x16x32_bf16 a[112:115], v[152:155], v[72:75], a[112:115]
  s_add_u32 m0, s53, 1024
  ds_read_b64_tr_b16 v[168:169], v4 offset:12544
  ds_read_b64_tr_b16 v[170:171], v4 offset:18688
  v_mfma_f32_16x16x32_bf16 a[160:163], v[152:155], v[76:79], a[160:163]
  s_waitcnt lgkmcnt(6)
  buffer_load_dwordx4 v[202:203], s[16:19], 0 idxen offen  lds
  v_mfma_f32_16x16x32_bf16 v[240:243], v[224:227], v[208:211], v[240:243]
  ds_read_b64_tr_b16 v[172:173], v5 offset:12544
  ds_read_b64_tr_b16 v[174:175], v5 offset:18688
  v_mfma_f32_16x16x32_bf16 a[116:119], v[156:159], v[72:75], a[116:119]
  s_add_u32 m0, s51, 24576
  v_exp_f32 v186, v42
  v_mfma_f32_16x16x32_bf16 a[164:167], v[156:159], v[76:79], a[164:167]
  s_waitcnt lgkmcnt(4)
  ds_read_b64_tr_b16 v[176:177], v6 offset:12544
  ds_read_b128 v[208:211], v250 offset:6144
  v_mfma_f32_16x16x32_bf16 a[120:123], v[160:163], v[72:75], a[120:123]
  buffer_load_dwordx4 v9, s[8:11], s62 offen offset:1024  lds
  v_mfma_f32_16x16x32_bf16 a[168:171], v[160:163], v[76:79], a[168:171]
  s_add_u32 m0, s53, 2048
  ds_read_b64_tr_b16 v[178:179], v6 offset:18688
  ds_read_b64_tr_b16 v[180:181], v7 offset:12544
  v_cvt_pk_bf16_f32 v58, v184, v185
  v_exp_f32 v187, v43
  v_exp_f32 v188, v44
  v_cvt_pk_bf16_f32 v59, v186, v187
  v_mfma_f32_16x16x32_bf16 a[124:127], v[164:167], v[72:75], a[124:127]
  v_exp_f32 v189, v45
  v_exp_f32 v190, v46
  v_mfma_f32_16x16x32_bf16 a[172:175], v[164:167], v[76:79], a[172:175]
  s_waitcnt lgkmcnt(4)
  ds_read_b64_tr_b16 v[182:183], v7 offset:18688
  v_cvt_pk_bf16_f32 v62, v188, v189
  v_mfma_f32_16x16x32_bf16 a[128:131], v[168:171], v[72:75], a[128:131]
  v_exp_f32 v191, v47
  v_mfma_f32_16x16x32_bf16 v[240:243], v[228:231], v[212:215], v[240:243]
  buffer_load_dwordx4 v[204:205], s[16:19], 0 idxen offen  lds
  v_cvt_pk_bf16_f32 v63, v190, v191
  v_mfma_f32_16x16x32_bf16 a[176:179], v[168:171], v[76:79], a[176:179]
  ds_read_b128 v[152:155], v2 offset:36864
  v_mfma_f32_16x16x32_bf16 v[104:107], v[112:115], v[56:59], v[104:107]
  s_add_u32 m0, s53, 3072
  v_mfma_f32_16x16x32_bf16 v[108:111], v[112:115], v[60:63], v[108:111]
  s_cmp_ge_u32 s40, s37
  s_cselect_b64 s[66:67], -1, 0
  ds_read_b128 v[156:159], v3 offset:36864
  v_mfma_f32_16x16x32_bf16 a[132:135], v[172:175], v[72:75], a[132:135]
  buffer_load_dwordx4 v[206:207], s[16:19], 0 idxen offen  lds
  v_mfma_f32_16x16x32_bf16 a[180:183], v[172:175], v[76:79], a[180:183]
  s_waitcnt lgkmcnt(2)
  s_add_u32 m0, s51, 24576
  ds_read_b128 v[160:163], v2 offset:36992
  v_mfma_f32_16x16x32_bf16 a[136:139], v[176:179], v[72:75], a[136:139]
  v_add_u32 v1, 256, v1
  v_mfma_f32_16x16x32_bf16 a[184:187], v[176:179], v[76:79], a[184:187]
  ds_read_b128 v[164:167], v3 offset:36992
  v_mfma_f32_16x16x32_bf16 a[140:143], v[180:183], v[72:75], a[140:143]
  v_max_f32 v14, v104, v108
  v_cmp_nge_f32 s[64:65], s50, v14
  v_mfma_f32_16x16x32_bf16 v[244:247], v[224:227], v[208:211], v[244:247]
  ds_read_b128 v[212:215], v251 offset:6144
  v_mfma_f32_16x16x32_bf16 a[188:191], v[180:183], v[76:79], a[188:191]
  s_waitcnt lgkmcnt(3)
  buffer_load_dwordx4 v10, s[8:11], s62 offen offset:2048  lds
  s_or_b64 vcc, s[64:65], s[66:67]
  s_cbranch_vccnz P2K0s2_SLOW
P2K0s2_SLOWB:
  v_mfma_f32_16x16x32_bf16 v[24:27], v[152:155], a[192:195], v[88:91]
  s_mov_b32 s76, s77
  s_mov_b32 s77, s78
  ds_read_b128 v[168:171], v2 offset:37120
  v_mfma_f32_16x16x32_bf16 v[28:31], v[152:155], a[216:219], v[92:95]
  s_mov_b32 s78, s79
  s_mov_b32 s79, s74
  ds_read_b128 v[172:175], v3 offset:37120
  v_mfma_f32_16x16x32_bf16 v[24:27], v[156:159], a[196:199], v[24:27]
  s_add_u32 m0, s52, 0
  ds_read_b128 v[176:179], v2 offset:43008
  v_mfma_f32_16x16x32_bf16 v[28:31], v[156:159], a[220:223], v[28:31]
  s_waitcnt lgkmcnt(4)
  buffer_load_dwordx4 v8, s[12:15], s63 offen offset:0  lds
  v_mfma_f32_16x16x32_bf16 v[24:27], v[160:163], a[200:203], v[24:27]
  s_add_u32 s40, s32, 4
  ds_read_b128 v[180:183], v3 offset:43008
  v_mfma_f32_16x16x32_bf16 v[28:31], v[160:163], a[224:227], v[28:31]
  s_waitcnt lgkmcnt(4)
  s_waitcnt vmcnt(9)
  ds_read_b128 v[152:155], v2 offset:43136
  v_mfma_f32_16x16x32_bf16 v[244:247], v[228:231], v[212:215], v[244:247]
  s_add_u32 m0, s53, 4096
  ds_read_b128 v[208:211], v250 offset:8192
  v_readlane_b32 s74, v0, s40
  v_mfma_f32_16x16x32_bf16 v[24:27], v[164:167], a[204:207], v[24:27]
  s_mul_i32 s7, s78, 12288
  buffer_load_dwordx4 v[200:201], s[16:19], s60 idxen offen  lds
  v_mfma_f32_16x16x32_bf16 v[28:31], v[164:167], a[228:231], v[28:31]
  s_waitcnt lgkmcnt(4)
  s_add_u32 m0, s52, 0
  ds_read_b128 v[156:159], v3 offset:43136
  v_mfma_f32_16x16x32_bf16 v[24:27], v[168:171], a[208:211], v[24:27]
  buffer_load_dwordx4 v9, s[12:15], s63 offen offset:1024  lds
  v_mfma_f32_16x16x32_bf16 v[28:31], v[168:171], a[232:235], v[28:31]
  s_add_u32 s7, s7, s75
  ds_read_b64_tr_b16 v[168:169], v4 offset:24576
  ds_read_b128 v[212:215], v251 offset:8192
  v_mfma_f32_16x16x32_bf16 v[24:27], v[172:175], a[212:215], v[24:27]
  s_add_u32 m0, s53, 5120
  v_mfma_f32_16x16x32_bf16 v[28:31], v[172:175], a[236:239], v[28:31]
  s_waitcnt lgkmcnt(5)
  ds_read_b128 v[160:163], v2 offset:43264
  ds_read_b64_tr_b16 v[170:171], v4 offset:30720
  v_mfma_f32_16x16x32_bf16 v[40:43], v[176:179], a[192:195], v[192:195]
  s_mul_i32 s6, s74, 12288
  buffer_load_dwordx4 v[202:203], s[16:19], s60 idxen offen  lds
  v_mfma_f32_16x16x32_bf16 v[44:47], v[176:179], a[216:219], v[196:199]
  s_waitcnt lgkmcnt(5)
  ds_read_b128 v[164:167], v3 offset:43264
  ds_read_b64_tr_b16 v[172:173], v5 offset:24576
  v_mfma_f32_16x16x32_bf16 v[240:243], v[232:235], v[208:211], v[240:243]
  s_add_u32 s6, s6, s75
  v_exp_f32 v184, v24
  v_mfma_f32_16x16x32_bf16 v[40:43], v[180:183], a[196:199], v[40:43]
  s_add_u32 m0, s53, 6144
  ds_read_b64_tr_b16 v[174:175], v5 offset:30720
  v_exp_f32 v185, v25
  v_mfma_f32_16x16x32_bf16 v[44:47], v[180:183], a[220:223], v[44:47]
  ds_read_b64_tr_b16 v[176:177], v6 offset:24576
  ds_read_b64_tr_b16 v[178:179], v6 offset:30720
  v_mfma_f32_16x16x32_bf16 v[40:43], v[152:155], a[200:203], v[40:43]
  s_add_u32 s32, s32, 1
  ds_read_b64_tr_b16 v[180:181], v7 offset:24576
  buffer_load_dwordx4 v[204:205], s[16:19], s60 idxen offen  lds
  v_mfma_f32_16x16x32_bf16 v[44:47], v[152:155], a[224:227], v[44:47]
  s_waitcnt lgkmcnt(10)
  v_exp_f32 v186, v26
  v_mfma_f32_16x16x32_bf16 v[40:43], v[156:159], a[204:207], v[40:43]
  s_add_u32 m0, s52, 0
  ds_read_b64_tr_b16 v[182:183], v7 offset:30720
  ds_read_b128 v[208:211], v250 offset:10240
  v_cvt_pk_bf16_f32 v72, v184, v185
  v_mfma_f32_16x16x32_bf16 v[44:47], v[156:159], a[228:231], v[44:47]
  s_waitcnt lgkmcnt(7)
  v_exp_f32 v187, v27
  v_mfma_f32_16x16x32_bf16 v[40:43], v[160:163], a[208:211], v[40:43]
  buffer_load_dwordx4 v10, s[12:15], s63 offen offset:2048  lds
  v_mfma_f32_16x16x32_bf16 v[240:243], v[236:239], v[212:215], v[240:243]
  ds_read_b64_tr_b16 v[152:153], v4 offset:24704
  ds_read_b128 v[212:215], v251 offset:10240
  v_mfma_f32_16x16x32_bf16 v[44:47], v[160:163], a[232:235], v[44:47]
  s_add_u32 m0, s53, 7168
  v_exp_f32 v188, v28
  v_mfma_f32_16x16x32_bf16 v[40:43], v[164:167], a[212:215], v[40:43]
  s_waitcnt vmcnt(13)
  s_barrier
  ds_read_b64_tr_b16 v[154:155], v4 offset:30848
  v_mfma_f32_16x16x32_bf16 v[44:47], v[164:167], a[236:239], v[44:47]
  buffer_load_dwordx4 v[206:207], s[16:19], s60 idxen offen  lds
  v_mfma_f32_16x16x32_bf16 a[96:99], v[168:171], v[56:59], a[96:99]
  ds_read_b64_tr_b16 v[156:157], v5 offset:24704
  v_cvt_pk_bf16_f32 v73, v186, v187
  v_mfma_f32_16x16x32_bf16 a[144:147], v[168:171], v[60:63], a[144:147]
  s_waitcnt lgkmcnt(9)
  ds_read_b64_tr_b16 v[158:159], v5 offset:30848
  v_exp_f32 v189, v29
  v_mfma_f32_16x16x32_bf16 a[100:103], v[172:175], v[56:59], a[100:103]
  s_add_u32 m0, s51, 36864
  v_exp_f32 v190, v30
  v_mfma_f32_16x16x32_bf16 a[148:151], v[172:175], v[60:63], a[148:151]
  s_waitcnt lgkmcnt(6)
  ds_read_b64_tr_b16 v[160:161], v6 offset:24704
  v_cvt_pk_bf16_f32 v76, v188, v189
  v_mfma_f32_16x16x32_bf16 a[104:107], v[176:179], v[56:59], a[104:107]
  s_waitcnt lgkmcnt(6)
  ds_read_b64_tr_b16 v[162:163], v6 offset:30848
  v_exp_f32 v191, v31
  v_mfma_f32_16x16x32_bf16 v[244:247], v[232:235], v[208:211], v[244:247]
  ds_read_b64_tr_b16 v[164:165], v7 offset:24704
  ds_read_b64_tr_b16 v[166:167], v7 offset:30848
  v_cvt_pk_bf16_f32 v77, v190, v191
  v_mfma_f32_16x16x32_bf16 a[152:155], v[176:179], v[60:63], a[152:155]
  ds_read_b64_tr_b16 v[168:169], v4 offset:24832
  v_exp_f32 v184, v40
  v_mfma_f32_16x16x32_bf16 a[108:111], v[180:183], v[56:59], a[108:111]
  s_max_u32 s40, s76, s77
  buffer_load_dwordx4 v8, s[8:11], s6 offen offset:0  lds
  v_mfma_f32_16x16x32_bf16 a[156:159], v[180:183], v[60:63], a[156:159]
  s_waitcnt lgkmcnt(5)
  v_exp_f32 v185, v41
  v_exp_f32 v186, v42
  v_cvt_pk_bf16_f32 v74, v184, v185
  v_mfma_f32_16x16x32_bf16 a[112:115], v[152:155], v[56:59], a[112:115]
  s_add_u32 m0, s51, 36864
  ds_read_b64_tr_b16 v[170:171], v4 offset:30976
  ds_read_b64_tr_b16 v[172:173], v5 offset:24832
  v_mfma_f32_16x16x32_bf16 a[160:163], v[152:155], v[60:63], a[160:163]
  ds_read_b64_tr_b16 v[174:175], v5 offset:30976
  v_exp_f32 v187, v43
  v_exp_f32 v188, v44
  v_mfma_f32_16x16x32_bf16 a[116:119], v[156:159], v[56:59], a[116:119]
  buffer_load_dwordx4 v9, s[8:11], s6 offen offset:1024  lds
  v_mfma_f32_16x16x32_bf16 a[164:167], v[156:159], v[60:63], a[164:167]
  ds_read_b64_tr_b16 v[176:177], v6 offset:24832
  v_cvt_pk_bf16_f32 v75, v186, v187
  v_mfma_f32_16x16x32_bf16 v[244:247], v[236:239], v[212:215], v[244:247]
  s_waitcnt lgkmcnt(5)
  ds_read_b64_tr_b16 v[178:179], v6 offset:30976
  ds_read_b64_tr_b16 v[180:181], v7 offset:24832
  v_mfma_f32_16x16x32_bf16 a[120:123], v[160:163], v[56:59], a[120:123]
  s_add_u32 m0, s51, 36864
  v_exp_f32 v189, v45
  v_mfma_f32_16x16x32_bf16 a[168:171], v[160:163], v[60:63], a[168:171]
  buffer_load_dwordx4 v10, s[8:11], s6 offen offset:2048  lds
  v_mfma_f32_16x16x32_bf16 a[124:127], v[164:167], v[56:59], a[124:127]
  s_add_u32 m0, s52, 12288
  v_exp_f32 v190, v46
  v_cvt_pk_bf16_f32 v78, v188, v189
  v_mfma_f32_16x16x32_bf16 a[172:175], v[164:167], v[60:63], a[172:175]
  s_waitcnt lgkmcnt(3)
  ds_read_b64_tr_b16 v[182:183], v7 offset:30976
  v_exp_f32 v191, v47
  v_mfma_f32_16x16x32_bf16 a[128:131], v[168:171], v[56:59], a[128:131]
  ds_read_b128 v[152:155], v2 offset:0
  v_cvt_pk_bf16_f32 v79, v190, v191
  v_mfma_f32_16x16x32_bf16 a[176:179], v[168:171], v[60:63], a[176:179]
  buffer_load_dwordx4 v8, s[12:15], s7 offen offset:0  lds
  v_mfma_f32_16x16x32_bf16 v[104:107], v[112:115], v[72:75], v[104:107]
  s_cmp_ge_u32 s40, s37
  s_cselect_b64 s[66:67], -1, 0
  v_cndmask_b32 v248, v248, v240, s[84:85]
  v_mfma_f32_16x16x32_bf16 v[108:111], v[112:115], v[76:79], v[108:111]
  v_cndmask_b32 v248, v248, v241, s[86:87]
  v_mfma_f32_16x16x32_bf16 a[132:135], v[172:175], v[56:59], a[132:135]
  s_add_u32 m0, s52, 12288
  ds_read_b128 v[156:159], v3 offset:0
  v_mfma_f32_16x16x32_bf16 a[180:183], v[172:175], v[60:63], a[180:183]
  s_waitcnt lgkmcnt(2)
  buffer_load_dwordx4 v9, s[12:15], s7 offen offset:1024  lds
  v_mfma_f32_16x16x32_bf16 a[136:139], v[176:179], v[56:59], a[136:139]
  ds_read_b128 v[160:163], v2 offset:128
  v_cndmask_b32 v249, v249, v246, s[84:85]
  v_mfma_f32_16x16x32_bf16 a[184:187], v[176:179], v[60:63], a[184:187]
  v_max_f32 v14, v104, v108
  v_cmp_nge_f32 s[64:65], s50, v14
  v_mfma_f32_16x16x32_bf16 a[140:143], v[180:183], v[56:59], a[140:143]
  s_add_u32 m0, s52, 12288
  ds_read_b128 v[164:167], v3 offset:128
  v_cndmask_b32 v249, v249, v247, s[86:87]
  v_mfma_f32_16x16x32_bf16 a[188:191], v[180:183], v[60:63], a[188:191]
  buffer_load_dwordx4 v10, s[12:15], s7 offen offset:2048  lds
  s_or_b64 vcc, s[64:65], s[66:67]
  s_cbranch_vccnz P2K0s3_SLOW
P2K0s3_SLOWB:
  s_add_u32 s3, s33, s29
  s_and_b32 s3, s3, 1
  s_cmp_lg_u32 s3, 0
  s_cbranch_scc1 P2K0_NT
  s_cmp_lt_u32 s33, 1
  s_cbranch_scc1 P2K0_NT
  s_cmp_ge_u32 s96, 3
  s_cbranch_scc1 P2K0_NT
  s_mov_b32 m0, 160768
  s_nop 0
  buffer_load_dword v15, s[68:71], s97 offen  lds
  s_add_u32 s97, s97, 8192
  s_add_u32 s96, s96, 1
P2K0_NT:
  s_add_u32 s33, s33, 1
  s_branch P2K1
.p2align 6
P2K1:
  s_waitcnt lgkmcnt(2)
  v_mfma_f32_16x16x32_bf16 v[24:27], v[152:155], a[192:195], v[88:91]
  s_add_u32 m0, s53, 8192
  ds_read_b128 v[168:171], v2 offset:256
  ds_read_b128 v[172:175], v3 offset:256
  v_mfma_f32_16x16x32_bf16 v[28:31], v[152:155], a[216:219], v[92:95]
  s_mov_b32 s76, s77
  buffer_load_dwordx4 v[200:201], s[16:19], s61 idxen offen  lds
  v_mfma_f32_16x16x32_bf16 v[24:27], v[156:159], a[196:199], v[24:27]
  s_add_u32 m0, s53, 9216
  ds_read_b128 v[176:179], v2 offset:6144
  v_mfma_f32_16x16x32_bf16 v[28:31], v[156:159], a[220:223], v[28:31]
  s_waitcnt lgkmcnt(3)
  v_mfma_f32_16x16x32_bf16 v[24:27], v[160:163], a[200:203], v[24:27]
  s_waitcnt vmcnt(15)
  ds_read_b128 v[180:183], v3 offset:6144
  ds_read_b128 v[152:155], v2 offset:6272
  v_mfma_f32_16x16x32_bf16 v[28:31], v[160:163], a[224:227], v[28:31]
  s_mov_b32 s77, s78
  v_mfma_f32_16x16x32_bf16 v[24:27], v[164:167], a[204:207], v[24:27]
  s_mov_b32 s78, s79
  s_mov_b32 s79, s74
  ds_read_b128 v[208:211], v250 offset:0
  v_mfma_f32_16x16x32_bf16 v[28:31], v[164:167], a[228:231], v[28:31]
  s_waitcnt lgkmcnt(4)
  buffer_load_dwordx4 v[202:203], s[16:19], s61 idxen offen  lds
  v_mfma_f32_16x16x32_bf16 v[24:27], v[168:171], a[208:211], v[24:27]
  s_add_u32 s40, s32, 4
  ds_read_b128 v[212:215], v251 offset:0
  v_mfma_f32_16x16x32_bf16 v[28:31], v[168:171], a[232:235], v[28:31]
  s_add_u32 m0, s53, 10240
  ds_read_b64_tr_b16 v[168:169], v4 offset:36864
  v_mfma_f32_16x16x32_bf16 v[24:27], v[172:175], a[212:215], v[24:27]
  ds_read_b128 v[156:159], v3 offset:6272
  v_readlane_b32 s74, v0, s40
  v_mfma_f32_16x16x32_bf16 v[28:31], v[172:175], a[236:239], v[28:31]
  s_waitcnt lgkmcnt(5)
  buffer_load_dwordx4 v[204:205], s[16:19], s61 idxen offen  lds
  v_mfma_f32_16x16x32_bf16 v[40:43], v[176:179], a[192:195], v[192:195]
  s_mul_i32 s63, s78, 12288
  ds_read_b128 v[160:163], v2 offset:6400
  ds_read_b64_tr_b16 v[170:171], v4 offset:43008
  v_mfma_f32_16x16x32_bf16 v[44:47], v[176:179], a[216:219], v[196:199]
  s_waitcnt lgkmcnt(5)
  s_add_u32 s63, s63, s75
  ds_read_b64_tr_b16 v[172:173], v5 offset:36864
  v_mfma_f32_16x16x32_bf16 v[240:243], v[216:219], v[208:211], 0
  s_add_u32 m0, s53, 11264
  ds_read_b128 v[164:167], v3 offset:6400
  v_exp_f32 v184, v24
  v_mfma_f32_16x16x32_bf16 v[40:43], v[180:183], a[196:199], v[40:43]
  buffer_load_dwordx4 v[206:207], s[16:19], s61 idxen offen  lds
  v_exp_f32 v185, v25
  v_mfma_f32_16x16x32_bf16 v[44:47], v[180:183], a[220:223], v[44:47]
  ds_read_b64_tr_b16 v[174:175], v5 offset:43008
  ds_read_b128 v[208:211], v250 offset:2048
  v_mfma_f32_16x16x32_bf16 v[40:43], v[152:155], a[200:203], v[40:43]
  s_mul_i32 s62, s74, 12288
  v_exp_f32 v186, v26
  v_mfma_f32_16x16x32_bf16 v[44:47], v[152:155], a[224:227], v[44:47]
  s_waitcnt lgkmcnt(6)
  ds_read_b64_tr_b16 v[176:177], v6 offset:36864
  v_cvt_pk_bf16_f32 v56, v184, v185
  v_mfma_f32_16x16x32_bf16 v[40:43], v[156:159], a[204:207], v[40:43]
  ds_read_b64_tr_b16 v[178:179], v6 offset:43008
  ds_read_b64_tr_b16 v[180:181], v7 offset:36864
  v_mfma_f32_16x16x32_bf16 v[44:47], v[156:159], a[228:231], v[44:47]
  s_waitcnt lgkmcnt(5)
  ds_read_b64_tr_b16 v[182:183], v7 offset:43008
  v_exp_f32 v187, v27
  v_mfma_f32_16x16x32_bf16 v[40:43], v[160:163], a[208:211], v[40:43]
  ds_read_b64_tr_b16 v[152:153], v4 offset:36992
  ds_read_b64_tr_b16 v[154:155], v4 offset:43136
  v_exp_f32 v188, v28
  v_mfma_f32_16x16x32_bf16 v[240:243], v[220:223], v[212:215], v[240:243]
  s_add_u32 s62, s62, s75
  ds_read_b64_tr_b16 v[156:157], v5 offset:36992
  v_cvt_pk_bf16_f32 v57, v186, v187
  v_mfma_f32_16x16x32_bf16 v[44:47], v[160:163], a[232:235], v[44:47]
  s_add_u32 s32, s32, 1
  v_exp_f32 v189, v29
  v_mfma_f32_16x16x32_bf16 v[40:43], v[164:167], a[212:215], v[40:43]
  s_waitcnt vmcnt(11)
  s_barrier
  ds_read_b128 v[212:215], v251 offset:2048
  v_mfma_f32_16x16x32_bf16 v[44:47], v[164:167], a[236:239], v[44:47]
  v_exp_f32 v190, v30
  v_cvt_pk_bf16_f32 v60, v188, v189
  v_mfma_f32_16x16x32_bf16 a[96:99], v[168:171], v[72:75], a[96:99]
  s_add_u32 m0, s51, 0
  ds_read_b64_tr_b16 v[158:159], v5 offset:43136
  ds_read_b64_tr_b16 v[160:161], v6 offset:36992
  v_mfma_f32_16x16x32_bf16 a[144:147], v[168:171], v[76:79], a[144:147]
  s_waitcnt lgkmcnt(11)
  ds_read_b32 v200, v1 offset:128
  v_exp_f32 v191, v31
  v_mfma_f32_16x16x32_bf16 a[100:103], v[172:175], v[72:75], a[100:103]
  ds_read_b64_tr_b16 v[162:163], v6 offset:43136
  buffer_load_dwordx4 v8, s[8:11], s62 offen offset:0  lds
  v_mfma_f32_16x16x32_bf16 a[148:151], v[172:175], v[76:79], a[148:151]
  s_waitcnt lgkmcnt(8)
  ds_read_b64_tr_b16 v[164:165], v7 offset:36992
  ds_read_b64_tr_b16 v[166:167], v7 offset:43136
  v_mfma_f32_16x16x32_bf16 a[104:107], v[176:179], v[72:75], a[104:107]
  ds_read_b32 v202, v1 offset:160
  v_cvt_pk_bf16_f32 v61, v190, v191
  v_mfma_f32_16x16x32_bf16 v[244:247], v[216:219], v[208:211], 0
  v_exp_f32 v184, v40
  v_mfma_f32_16x16x32_bf16 a[152:155], v[176:179], v[76:79], a[152:155]
  s_max_u32 s40, s76, s77
  ds_read_b64_tr_b16 v[168:169], v4 offset:37120
  ds_read_b32 v204, v1 offset:192
  v_mfma_f32_16x16x32_bf16 a[108:111], v[180:183], v[72:75], a[108:111]
  v_exp_f32 v185, v41
  v_mfma_f32_16x16x32_bf16 a[156:159], v[180:183], v[76:79], a[156:159]
  s_waitcnt lgkmcnt(8)
  v_exp_f32 v186, v42
  v_mfma_f32_16x16x32_bf16 a[112:115], v[152:155], v[72:75], a[112:115]
  s_add_u32 m0, s51, 0
  ds_read_b64_tr_b16 v[170:171], v4 offset:43264
  ds_read_b64_tr_b16 v[172:173], v5 offset:37120
  ds_read_b32 v206, v1 offset:224
  v_cvt_pk_bf16_f32 v58, v184, v185
  v_exp_f32 v187, v43
  v_exp_f32 v188, v44
  v_mfma_f32_16x16x32_bf16 a[160:163], v[152:155], v[76:79], a[160:163]
  buffer_load_dwordx4 v9, s[8:11], s62 offen offset:1024  lds
  v_mfma_f32_16x16x32_bf16 a[116:119], v[156:159], v[72:75], a[116:119]
  ds_read_b64_tr_b16 v[174:175], v5 offset:43264
  ds_read_b64_tr_b16 v[176:177], v6 offset:37120
  ds_read_b64_tr_b16 v[178:179], v6 offset:43264
  v_mfma_f32_16x16x32_bf16 a[164:167], v[156:159], v[76:79], a[164:167]
  s_waitcnt vmcnt(12)
  v_cvt_pk_bf16_f32 v59, v186, v187
  v_mfma_f32_16x16x32_bf16 v[244:247], v[220:223], v[212:215], v[244:247]
  s_waitcnt lgkmcnt(9)
  ds_read_b64_tr_b16 v[180:181], v7 offset:37120
  ds_read_b128 v[208:211], v250 offset:4096
  v_exp_f32 v189, v45
  v_mfma_f32_16x16x32_bf16 a[120:123], v[160:163], v[72:75], a[120:123]
  s_add_u32 m0, s53, 0
  v_exp_f32 v190, v46
  v_mfma_f32_16x16x32_bf16 a[168:171], v[160:163], v[76:79], a[168:171]
  buffer_load_dwordx4 v[200:201], s[16:19], 0 idxen offen  lds
  v_mfma_f32_16x16x32_bf16 a[124:127], v[164:167], v[72:75], a[124:127]
  s_add_u32 m0, s53, 1024
  ds_read_b128 v[152:155], v2 offset:12288
  v_cvt_pk_bf16_f32 v62, v188, v189
  v_mfma_f32_16x16x32_bf16 a[172:175], v[164:167], v[76:79], a[172:175]
  s_waitcnt lgkmcnt(5)
  v_exp_f32 v191, v47
  v_mfma_f32_16x16x32_bf16 a[128:131], v[168:171], v[72:75], a[128:131]
  ds_read_b64_tr_b16 v[182:183], v7 offset:43264
  v_cvt_pk_bf16_f32 v63, v190, v191
  v_mfma_f32_16x16x32_bf16 a[176:179], v[168:171], v[76:79], a[176:179]
  s_cmp_ge_u32 s40, s37
  s_cselect_b64 s[66:67], -1, 0
  ds_read_b128 v[156:159], v3 offset:12288
  v_mfma_f32_16x16x32_bf16 v[104:107], v[112:115], v[56:59], v[104:107]
  buffer_load_dwordx4 v[202:203], s[16:19], 0 idxen offen  lds
  v_mfma_f32_16x16x32_bf16 v[108:111], v[112:115], v[60:63], v[108:111]
  s_waitcnt lgkmcnt(3)
  s_add_u32 m0, s51, 0
  ds_read_b128 v[212:215], v251 offset:4096
  v_mfma_f32_16x16x32_bf16 v[240:243], v[224:227], v[208:211], v[240:243]
  v_mfma_f32_16x16x32_bf16 a[132:135], v[172:175], v[72:75], a[132:135]
  ds_read_b128 v[160:163], v2 offset:12416
  v_mfma_f32_16x16x32_bf16 a[180:183], v[172:175], v[76:79], a[180:183]
  buffer_load_dwordx4 v10, s[8:11], s62 offen offset:2048  lds
  v_mfma_f32_16x16x32_bf16 a[136:139], v[176:179], v[72:75], a[136:139]
  ds_read_b128 v[208:211], v250 offset:6144
  v_max_f32 v14, v104, v108
  v_mfma_f32_16x16x32_bf16 a[184:187], v[176:179], v[76:79], a[184:187]
  s_waitcnt lgkmcnt(4)
  v_cmp_nge_f32 s[64:65], s50, v14
  v_mfma_f32_16x16x32_bf16 a[140:143], v[180:183], v[72:75], a[140:143]
  s_add_u32 m0, s53, 2048
  ds_read_b128 v[164:167], v3 offset:12416
  v_mfma_f32_16x16x32_bf16 a[188:191], v[180:183], v[76:79], a[188:191]
  buffer_load_dwordx4 v[204:205], s[16:19], 0 idxen offen  lds
  s_or_b64 vcc, s[64:65], s[66:67]
  s_cbranch_vccnz P2K1s0_SLOW
P2K1s0_SLOWB:
  v_mfma_f32_16x16x32_bf16 v[24:27], v[152:155], a[192:195], v[88:91]
  s_waitcnt lgkmcnt(3)
  s_mov_b32 s76, s77
  ds_read_b128 v[168:171], v2 offset:12544
  v_mfma_f32_16x16x32_bf16 v[240:243], v[228:231], v[212:215], v[240:243]
  s_add_u32 m0, s53, 3072
  ds_read_b128 v[212:215], v251 offset:6144
  v_mfma_f32_16x16x32_bf16 v[28:31], v[152:155], a[216:219], v[92:95]
  s_mov_b32 s77, s78
  ds_read_b128 v[172:175], v3 offset:12544
  v_mfma_f32_16x16x32_bf16 v[24:27], v[156:159], a[196:199], v[24:27]
  buffer_load_dwordx4 v[206:207], s[16:19], 0 idxen offen  lds
  v_mfma_f32_16x16x32_bf16 v[28:31], v[156:159], a[220:223], v[28:31]
  s_waitcnt lgkmcnt(3)
  s_mov_b32 s78, s79
  ds_read_b128 v[176:179], v2 offset:18432
  v_mfma_f32_16x16x32_bf16 v[24:27], v[160:163], a[200:203], v[24:27]
  s_mov_b32 s79, s74
  v_mfma_f32_16x16x32_bf16 v[28:31], v[160:163], a[224:227], v[28:31]
  s_add_u32 m0, s52, 24576
  ds_read_b128 v[180:183], v3 offset:18432
  v_mfma_f32_16x16x32_bf16 v[24:27], v[164:167], a[204:207], v[24:27]
  buffer_load_dwordx4 v8, s[12:15], s63 offen offset:0  lds
  v_mfma_f32_16x16x32_bf16 v[28:31], v[164:167], a[228:231], v[28:31]
  s_waitcnt lgkmcnt(2)
  s_add_u32 s40, s32, 4
  ds_read_b128 v[152:155], v2 offset:18560
  v_mfma_f32_16x16x32_bf16 v[24:27], v[168:171], a[208:211], v[24:27]
  s_add_u32 m0, s52, 24576
  v_mfma_f32_16x16x32_bf16 v[244:247], v[224:227], v[208:211], v[244:247]
  ds_read_b128 v[156:159], v3 offset:18560
  v_readlane_b32 s74, v0, s40
  v_mfma_f32_16x16x32_bf16 v[28:31], v[168:171], a[232:235], v[28:31]
  s_mul_i32 s7, s78, 12288
  buffer_load_dwordx4 v9, s[12:15], s63 offen offset:1024  lds
  v_mfma_f32_16x16x32_bf16 v[24:27], v[172:175], a[212:215], v[24:27]
  ds_read_b128 v[160:163], v2 offset:18688
  ds_read_b64_tr_b16 v[168:169], v4 offset:0
  v_mfma_f32_16x16x32_bf16 v[28:31], v[172:175], a[236:239], v[28:31]
  s_waitcnt lgkmcnt(4)
  s_add_u32 s7, s7, s75
  ds_read_b64_tr_b16 v[170:171], v4 offset:6144
  v_mfma_f32_16x16x32_bf16 v[40:43], v[176:179], a[192:195], v[192:195]
  s_add_u32 m0, s52, 24576
  ds_read_b64_tr_b16 v[172:173], v5 offset:0
  ds_read_b64_tr_b16 v[174:175], v5 offset:6144
  v_mfma_f32_16x16x32_bf16 v[44:47], v[176:179], a[216:219], v[196:199]
  s_mul_i32 s6, s74, 12288
  buffer_load_dwordx4 v10, s[12:15], s63 offen offset:2048  lds
  v_mfma_f32_16x16x32_bf16 v[40:43], v[180:183], a[196:199], v[40:43]
  s_add_u32 s6, s6, s75
  ds_read_b128 v[164:167], v3 offset:18688
  v_exp_f32 v184, v24
  v_mfma_f32_16x16x32_bf16 v[44:47], v[180:183], a[220:223], v[44:47]
  s_waitcnt vmcnt(10)
  v_exp_f32 v185, v25
  v_mfma_f32_16x16x32_bf16 v[244:247], v[228:231], v[212:215], v[244:247]
  s_waitcnt lgkmcnt(6)
  ds_read_b64_tr_b16 v[176:177], v6 offset:0
  ds_read_b64_tr_b16 v[178:179], v6 offset:6144
  ds_read_b64_tr_b16 v[180:181], v7 offset:0
  v_mfma_f32_16x16x32_bf16 v[40:43], v[152:155], a[200:203], v[40:43]
  s_add_u32 m0, s53, 4096
  v_exp_f32 v186, v26
  v_cvt_pk_bf16_f32 v72, v184, v185
  v_mfma_f32_16x16x32_bf16 v[44:47], v[152:155], a[224:227], v[44:47]
  ds_read_b64_tr_b16 v[182:183], v7 offset:6144
  ds_read_b128 v[208:211], v250 offset:8192
  buffer_load_dwordx4 v[200:201], s[16:19], s60 idxen offen  lds
  v_mfma_f32_16x16x32_bf16 v[40:43], v[156:159], a[204:207], v[40:43]
  v_exp_f32 v187, v27
  v_mfma_f32_16x16x32_bf16 v[44:47], v[156:159], a[228:231], v[44:47]
  s_waitcnt lgkmcnt(5)
  ds_read_b64_tr_b16 v[152:153], v4 offset:128
  ds_read_b64_tr_b16 v[154:155], v4 offset:6272
  v_mfma_f32_16x16x32_bf16 v[40:43], v[160:163], a[208:211], v[40:43]
  ds_read_b64_tr_b16 v[156:157], v5 offset:128
  v_exp_f32 v188, v28
  v_cvt_pk_bf16_f32 v73, v186, v187
  v_mfma_f32_16x16x32_bf16 v[44:47], v[160:163], a[232:235], v[44:47]
  s_add_u32 m0, s53, 5120
  v_exp_f32 v189, v29
  v_mfma_f32_16x16x32_bf16 v[40:43], v[164:167], a[212:215], v[40:43]
  s_waitcnt vmcnt(15)
  s_barrier
  ds_read_b128 v[212:215], v251 offset:8192
  buffer_load_dwordx4 v[202:203], s[16:19], s60 idxen offen  lds
  v_exp_f32 v190, v30
  v_mfma_f32_16x16x32_bf16 v[44:47], v[164:167], a[236:239], v[44:47]
  s_waitcnt lgkmcnt(4)
  v_cvt_pk_bf16_f32 v76, v188, v189
  v_exp_f32 v191, v31
  v_mfma_f32_16x16x32_bf16 v[240:243], v[232:235], v[208:211], v[240:243]
  ds_read_b64_tr_b16 v[158:159], v5 offset:6272
  v_cvt_pk_bf16_f32 v77, v190, v191
  v_mfma_f32_16x16x32_bf16 a[96:99], v[168:171], v[56:59], a[96:99]
  s_add_u32 m0, s53, 6144
  ds_read_b64_tr_b16 v[160:161], v6 offset:128
  ds_read_b64_tr_b16 v[162:163], v6 offset:6272
  v_mfma_f32_16x16x32_bf16 a[144:147], v[168:171], v[60:63], a[144:147]
  ds_read_b64_tr_b16 v[164:165], v7 offset:128
  buffer_load_dwordx4 v[204:205], s[16:19], s60 idxen offen  lds
  v_mfma_f32_16x16x32_bf16 a[100:103], v[172:175], v[56:59], a[100:103]
  v_exp_f32 v184, v40
  v_mfma_f32_16x16x32_bf16 a[148:151], v[172:175], v[60:63], a[148:151]
  v_exp_f32 v185, v41
  v_mfma_f32_16x16x32_bf16 a[104:107], v[176:179], v[56:59], a[104:107]
  s_add_u32 m0, s51, 12288
  ds_read_b64_tr_b16 v[166:167], v7 offset:6272
  ds_read_b64_tr_b16 v[168:169], v4 offset:256
  v_mfma_f32_16x16x32_bf16 a[152:155], v[176:179], v[60:63], a[152:155]
  v_exp_f32 v186, v42
  v_mfma_f32_16x16x32_bf16 a[108:111], v[180:183], v[56:59], a[108:111]
  s_waitcnt lgkmcnt(6)
  ds_read_b128 v[208:211], v250 offset:10240
  buffer_load_dwordx4 v8, s[8:11], s6 offen offset:0  lds
  v_mfma_f32_16x16x32_bf16 v[240:243], v[236:239], v[212:215], v[240:243]
  s_add_u32 m0, s53, 7168
  ds_read_b64_tr_b16 v[170:171], v4 offset:6400
  v_cvt_pk_bf16_f32 v74, v184, v185
  v_mfma_f32_16x16x32_bf16 a[156:159], v[180:183], v[60:63], a[156:159]
  v_exp_f32 v187, v43
  v_mfma_f32_16x16x32_bf16 a[112:115], v[152:155], v[56:59], a[112:115]
  ds_read_b64_tr_b16 v[172:173], v5 offset:256
  v_exp_f32 v188, v44
  v_mfma_f32_16x16x32_bf16 a[160:163], v[152:155], v[60:63], a[160:163]
  s_waitcnt lgkmcnt(8)
  ds_read_b64_tr_b16 v[174:175], v5 offset:6400
  ds_read_b64_tr_b16 v[176:177], v6 offset:256
  v_mfma_f32_16x16x32_bf16 a[116:119], v[156:159], v[56:59], a[116:119]
  buffer_load_dwordx4 v[206:207], s[16:19], s60 idxen offen  lds
  v_mfma_f32_16x16x32_bf16 a[164:167], v[156:159], v[60:63], a[164:167]
  s_waitcnt lgkmcnt(6)
  ds_read_b64_tr_b16 v[178:179], v6 offset:6400
  ds_read_b128 v[212:215], v251 offset:10240
  v_mfma_f32_16x16x32_bf16 a[120:123], v[160:163], v[56:59], a[120:123]
  s_add_u32 s32, s32, 1
  v_cvt_pk_bf16_f32 v75, v186, v187
  v_exp_f32 v189, v45
  v_mfma_f32_16x16x32_bf16 a[168:171], v[160:163], v[60:63], a[168:171]
  s_max_u32 s40, s76, s77
  v_exp_f32 v190, v46
  v_mfma_f32_16x16x32_bf16 a[124:127], v[164:167], v[56:59], a[124:127]
  s_waitcnt lgkmcnt(6)
  ds_read_b128 v[152:155], v2 offset:24576
  v_cvt_pk_bf16_f32 v78, v188, v189
  v_mfma_f32_16x16x32_bf16 v[244:247], v[232:235], v[208:211], v[244:247]
  s_add_u32 m0, s51, 12288
  ds_read_b64_tr_b16 v[180:181], v7 offset:256
  v_exp_f32 v191, v47
  v_mfma_f32_16x16x32_bf16 a[172:175], v[164:167], v[60:63], a[172:175]
  s_waitcnt lgkmcnt(5)
  buffer_load_dwordx4 v9, s[8:11], s6 offen offset:1024  lds
  v_mfma_f32_16x16x32_bf16 a[128:131], v[168:171], v[56:59], a[128:131]
  ds_read_b64_tr_b16 v[182:183], v7 offset:6400
  v_cvt_pk_bf16_f32 v79, v190, v191
  v_mfma_f32_16x16x32_bf16 a[176:179], v[168:171], v[60:63], a[176:179]
  ds_read_b128 v[156:159], v3 offset:24576
  v_cndmask_b32 v248, v248, v240, s[88:89]
  v_mfma_f32_16x16x32_bf16 v[104:107], v[112:115], v[72:75], v[104:107]
  s_add_u32 m0, s51, 12288
  ds_read_b128 v[160:163], v2 offset:24704
  v_mfma_f32_16x16x32_bf16 v[108:111], v[112:115], v[76:79], v[108:111]
  buffer_load_dwordx4 v10, s[8:11], s6 offen offset:2048  lds
  v_mfma_f32_16x16x32_bf16 a[132:135], v[172:175], v[56:59], a[132:135]
  s_cmp_ge_u32 s40, s37
  s_cselect_b64 s[66:67], -1, 0
  ds_read_b128 v[164:167], v3 offset:24704
  v_mfma_f32_16x16x32_bf16 a[180:183], v[172:175], v[60:63], a[180:183]
  s_waitcnt lgkmcnt(6)
  s_waitcnt vmcnt(10)
  v_mfma_f32_16x16x32_bf16 v[244:247], v[236:239], v[212:215], v[244:247]
  ds_read_b128 v[208:211], v250 offset:0
  v_mfma_f32_16x16x32_bf16 a[136:139], v[176:179], v[56:59], a[136:139]
  s_add_u32 m0, s53, 8192
  v_max_f32 v14, v104, v108
  v_cmp_nge_f32 s[64:65], s50, v14
  v_mfma_f32_16x16x32_bf16 a[184:187], v[176:179], v[60:63], a[184:187]
  s_waitcnt lgkmcnt(4)
  buffer_load_dwordx4 v[200:201], s[16:19], s61 idxen offen  lds
  v_mfma_f32_16x16x32_bf16 a[140:143], v[180:183], v[56:59], a[140:143]
  s_add_u32 m0, s52, 36864
  ds_read_b128 v[212:215], v251 offset:0
  v_mfma_f32_16x16x32_bf16 a[188:191], v[180:183], v[60:63], a[188:191]
  buffer_load_dwordx4 v8, s[12:15], s7 offen offset:0  lds
  s_or_b64 vcc, s[64:65], s[66:67]
  s_cbranch_vccnz P2K1s1_SLOW
P2K1s1_SLOWB:
  v_mfma_f32_16x16x32_bf16 v[24:27], v[152:155], a[192:195], v[88:91]
  ds_read_b128 v[168:171], v2 offset:24832
  v_cndmask_b32 v248, v248, v241, s[90:91]
  v_mfma_f32_16x16x32_bf16 v[28:31], v[152:155], a[216:219], v[92:95]
  s_waitcnt lgkmcnt(5)
  s_mov_b32 s76, s77
  v_cndmask_b32 v249, v249, v246, s[88:89]
  v_mfma_f32_16x16x32_bf16 v[24:27], v[156:159], a[196:199], v[24:27]
  s_add_u32 m0, s53, 9216
  ds_read_b128 v[172:175], v3 offset:24832
  v_mfma_f32_16x16x32_bf16 v[28:31], v[156:159], a[220:223], v[28:31]
  s_waitcnt lgkmcnt(3)
  buffer_load_dwordx4 v[202:203], s[16:19], s61 idxen offen  lds
  v_mfma_f32_16x16x32_bf16 v[240:243], v[216:219], v[208:211], 0
  ds_read_b128 v[176:179], v2 offset:30720
  v_mfma_f32_16x16x32_bf16 v[24:27], v[160:163], a[200:203], v[24:27]
  s_add_u32 m0, s53, 10240
  ds_read_b128 v[180:183], v3 offset:30720
  v_mfma_f32_16x16x32_bf16 v[28:31], v[160:163], a[224:227], v[28:31]
  s_mov_b32 s77, s78
  s_mov_b32 s78, s79
  ds_read_b128 v[208:211], v250 offset:2048
  v_mfma_f32_16x16x32_bf16 v[24:27], v[164:167], a[204:207], v[24:27]
  s_mov_b32 s79, s74
  buffer_load_dwordx4 v[204:205], s[16:19], s61 idxen offen  lds
  v_mfma_f32_16x16x32_bf16 v[28:31], v[164:167], a[228:231], v[28:31]
  s_waitcnt lgkmcnt(3)
  s_add_u32 m0, s52, 36864
  ds_read_b128 v[152:155], v2 offset:30848
  v_mfma_f32_16x16x32_bf16 v[24:27], v[168:171], a[208:211], v[24:27]
  s_add_u32 s40, s32, 4
  v_cndmask_b32 v249, v249, v247, s[90:91]
  v_mfma_f32_16x16x32_bf16 v[28:31], v[168:171], a[232:235], v[28:31]
  ds_read_b128 v[156:159], v3 offset:30848
  ds_read_b64_tr_b16 v[168:169], v4 offset:12288
  v_mfma_f32_16x16x32_bf16 v[24:27], v[172:175], a[212:215], v[24:27]
  buffer_load_dwordx4 v9, s[12:15], s7 offen offset:1024  lds
  v_mfma_f32_16x16x32_bf16 v[240:243], v[220:223], v[212:215], v[240:243]
  s_add_u32 m0, s53, 11264
  ds_read_b128 v[160:163], v2 offset:30976
  v_mfma_f32_16x16x32_bf16 v[28:31], v[172:175], a[236:239], v[28:31]
  s_waitcnt lgkmcnt(5)
  ds_read_b64_tr_b16 v[170:171], v4 offset:18432
  v_readlane_b32 s74, v0, s40
  v_mfma_f32_16x16x32_bf16 v[40:43], v[176:179], a[192:195], v[192:195]
  ds_read_b64_tr_b16 v[172:173], v5 offset:12288
  ds_read_b64_tr_b16 v[174:175], v5 offset:18432
  v_mfma_f32_16x16x32_bf16 v[44:47], v[176:179], a[216:219], v[196:199]
  s_mul_i32 s63, s78, 12288
  v_exp_f32 v184, v24
  v_exp_f32 v185, v25
  v_mfma_f32_16x16x32_bf16 v[40:43], v[180:183], a[196:199], v[40:43]
  s_add_u32 s63, s63, s75
  ds_read_b128 v[164:167], v3 offset:30976
  buffer_load_dwordx4 v[206:207], s[16:19], s61 idxen offen  lds
  v_mfma_f32_16x16x32_bf16 v[44:47], v[180:183], a[220:223], v[44:47]
  s_waitcnt lgkmcnt(6)
  v_exp_f32 v186, v26
  v_mfma_f32_16x16x32_bf16 v[40:43], v[152:155], a[200:203], v[40:43]
  s_add_u32 m0, s52, 36864
  ds_read_b128 v[212:215], v251 offset:2048
  v_cvt_pk_bf16_f32 v56, v184, v185
  v_exp_f32 v187, v27
  v_mfma_f32_16x16x32_bf16 v[44:47], v[152:155], a[224:227], v[44:47]
  s_mul_i32 s62, s74, 12288
  ds_read_b32 v200, v1 offset:256
  v_exp_f32 v188, v28
  v_mfma_f32_16x16x32_bf16 v[40:43], v[156:159], a[204:207], v[40:43]
  ds_read_b64_tr_b16 v[176:177], v6 offset:12288
  buffer_load_dwordx4 v10, s[12:15], s7 offen offset:2048  lds
  v_mfma_f32_16x16x32_bf16 v[244:247], v[216:219], v[208:211], 0
  ds_read_b32 v202, v1 offset:288
  v_cvt_pk_bf16_f32 v57, v186, v187
  v_exp_f32 v189, v29
  v_mfma_f32_16x16x32_bf16 v[44:47], v[156:159], a[228:231], v[44:47]
  s_waitcnt lgkmcnt(4)
  ds_read_b64_tr_b16 v[178:179], v6 offset:18432
  ds_read_b64_tr_b16 v[180:181], v7 offset:12288
  v_mfma_f32_16x16x32_bf16 v[40:43], v[160:163], a[208:211], v[40:43]
  s_add_u32 s62, s62, s75
  v_exp_f32 v190, v30
  v_mfma_f32_16x16x32_bf16 v[44:47], v[160:163], a[232:235], v[44:47]
  s_add_u32 s32, s32, 1
  ds_read_b32 v204, v1 offset:320
  ds_read_b32 v206, v1 offset:352
  v_mfma_f32_16x16x32_bf16 v[40:43], v[164:167], a[212:215], v[40:43]
  s_waitcnt vmcnt(14)
  s_barrier
  ds_read_b64_tr_b16 v[182:183], v7 offset:18432
  v_mfma_f32_16x16x32_bf16 v[44:47], v[164:167], a[236:239], v[44:47]
  ds_read_b64_tr_b16 v[152:153], v4 offset:12416
  v_cvt_pk_bf16_f32 v60, v188, v189
  v_mfma_f32_16x16x32_bf16 a[96:99], v[168:171], v[72:75], a[96:99]
  s_add_u32 m0, s51, 24576
  ds_read_b64_tr_b16 v[154:155], v4 offset:18560
  v_exp_f32 v191, v31
  v_mfma_f32_16x16x32_bf16 a[144:147], v[168:171], v[76:79], a[144:147]
  s_waitcnt lgkmcnt(10)
  s_waitcnt vmcnt(9)
  ds_read_b64_tr_b16 v[156:157], v5 offset:12416
  ds_read_b64_tr_b16 v[158:159], v5 offset:18560
  v_mfma_f32_16x16x32_bf16 v[244:247], v[220:223], v[212:215], v[244:247]
  ds_read_b64_tr_b16 v[160:161], v6 offset:12416
  buffer_load_dwordx4 v8, s[8:11], s62 offen offset:0  lds
  v_mfma_f32_16x16x32_bf16 a[100:103], v[172:175], v[72:75], a[100:103]
  s_add_u32 m0, s53, 0
  ds_read_b128 v[208:211], v250 offset:4096
  v_cvt_pk_bf16_f32 v61, v190, v191
  v_mfma_f32_16x16x32_bf16 a[148:151], v[172:175], v[76:79], a[148:151]
  s_waitcnt lgkmcnt(6)
  v_exp_f32 v184, v40
  v_mfma_f32_16x16x32_bf16 a[104:107], v[176:179], v[72:75], a[104:107]
  s_max_u32 s40, s76, s77
  ds_read_b64_tr_b16 v[162:163], v6 offset:18560
  ds_read_b128 v[212:215], v251 offset:4096
  v_mfma_f32_16x16x32_bf16 a[152:155], v[176:179], v[76:79], a[152:155]
  buffer_load_dwordx4 v[200:201], s[16:19], 0 idxen offen  lds
  v_mfma_f32_16x16x32_bf16 a[108:111], v[180:183], v[72:75], a[108:111]
  ds_read_b64_tr_b16 v[164:165], v7 offset:12416
  ds_read_b64_tr_b16 v[166:167], v7 offset:18560
  v_mfma_f32_16x16x32_bf16 a[156:159], v[180:183], v[76:79], a[156:159]
  s_waitcnt lgkmcnt(6)
  v_exp_f32 v185, v41
  v_mfma_f32_16x16x32_bf16 a[112:115], v[152:155], v[72:75], a[112:115]
  s_add_u32 m0, s53, 1024
  ds_read_b64_tr_b16 v[168:169], v4 offset:12544
  ds_read_b64_tr_b16 v[170:171], v4 offset:18688
  v_mfma_f32_16x16x32_bf16 a[160:163], v[152:155], v[76:79], a[160:163]
  s_waitcnt lgkmcnt(6)
  buffer_load_dwordx4 v[202:203], s[16:19], 0 idxen offen  lds
  v_mfma_f32_16x16x32_bf16 v[240:243], v[224:227], v[208:211], v[240:243]
  ds_read_b64_tr_b16 v[172:173], v5 offset:12544
  ds_read_b64_tr_b16 v[174:175], v5 offset:18688
  v_mfma_f32_16x16x32_bf16 a[116:119], v[156:159], v[72:75], a[116:119]
  s_add_u32 m0, s51, 24576
  v_exp_f32 v186, v42
  v_mfma_f32_16x16x32_bf16 a[164:167], v[156:159], v[76:79], a[164:167]
  s_waitcnt lgkmcnt(4)
  ds_read_b64_tr_b16 v[176:177], v6 offset:12544
  ds_read_b128 v[208:211], v250 offset:6144
  v_mfma_f32_16x16x32_bf16 a[120:123], v[160:163], v[72:75], a[120:123]
  buffer_load_dwordx4 v9, s[8:11], s62 offen offset:1024  lds
  v_mfma_f32_16x16x32_bf16 a[168:171], v[160:163], v[76:79], a[168:171]
  s_add_u32 m0, s53, 2048
  ds_read_b64_tr_b16 v[178:179], v6 offset:18688
  ds_read_b64_tr_b16 v[180:181], v7 offset:12544
  v_cvt_pk_bf16_f32 v58, v184, v185
  v_exp_f32 v187, v43
  v_exp_f32 v188, v44
  v_cvt_pk_bf16_f32 v59, v186, v187
  v_mfma_f32_16x16x32_bf16 a[124:127], v[164:167], v[72:75], a[124:127]
  v_exp_f32 v189, v45
  v_exp_f32 v190, v46
  v_mfma_f32_16x16x32_bf16 a[172:175], v[164:167], v[76:79], a[172:175]
  s_waitcnt lgkmcnt(4)
  ds_read_b64_tr_b16 v[182:183], v7 offset:18688
  v_cvt_pk_bf16_f32 v62, v188, v189
  v_mfma_f32_16x16x32_bf16 a[128:131], v[168:171], v[72:75], a[128:131]
  v_exp_f32 v191, v47
  v_mfma_f32_16x16x32_bf16 v[240:243], v[228:231], v[212:215], v[240:243]
  buffer_load_dwordx4 v[204:205], s[16:19], 0 idxen offen  lds
  v_cvt_pk_bf16_f32 v63, v190, v191
  v_mfma_f32_16x16x32_bf16 a[176:179], v[168:171], v[76:79], a[176:179]
  ds_read_b128 v[152:155], v2 offset:36864
  v_mfma_f32_16x16x32_bf16 v[104:107], v[112:115], v[56:59], v[104:107]
  s_add_u32 m0, s53, 3072
  v_mfma_f32_16x16x32_bf16 v[108:111], v[112:115], v[60:63], v[108:111]
  s_cmp_ge_u32 s40, s37
  s_cselect_b64 s[66:67], -1, 0
  ds_read_b128 v[156:159], v3 offset:36864
  v_mfma_f32_16x16x32_bf16 a[132:135], v[172:175], v[72:75], a[132:135]
  buffer_load_dwordx4 v[206:207], s[16:19], 0 idxen offen  lds
  v_mfma_f32_16x16x32_bf16 a[180:183], v[172:175], v[76:79], a[180:183]
  s_waitcnt lgkmcnt(2)
  s_add_u32 m0, s51, 24576
  ds_read_b128 v[160:163], v2 offset:36992
  v_mfma_f32_16x16x32_bf16 a[136:139], v[176:179], v[72:75], a[136:139]
  v_add_u32 v1, 256, v1
  v_mfma_f32_16x16x32_bf16 a[184:187], v[176:179], v[76:79], a[184:187]
  ds_read_b128 v[164:167], v3 offset:36992
  v_mfma_f32_16x16x32_bf16 a[140:143], v[180:183], v[72:75], a[140:143]
  v_max_f32 v14, v104, v108
  v_cmp_nge_f32 s[64:65], s50, v14
  v_mfma_f32_16x16x32_bf16 v[244:247], v[224:227], v[208:211], v[244:247]
  ds_read_b128 v[212:215], v251 offset:6144
  v_mfma_f32_16x16x32_bf16 a[188:191], v[180:183], v[76:79], a[188:191]
  s_waitcnt lgkmcnt(3)
  buffer_load_dwordx4 v10, s[8:11], s62 offen offset:2048  lds
  s_or_b64 vcc, s[64:65], s[66:67]
  s_cbranch_vccnz P2K1s2_SLOW
P2K1s2_SLOWB:
  v_mfma_f32_16x16x32_bf16 v[24:27], v[152:155], a[192:195], v[88:91]
  s_mov_b32 s76, s77
  s_mov_b32 s77, s78
  ds_read_b128 v[168:171], v2 offset:37120
  v_mfma_f32_16x16x32_bf16 v[28:31], v[152:155], a[216:219], v[92:95]
  s_mov_b32 s78, s79
  s_mov_b32 s79, s74
  ds_read_b128 v[172:175], v3 offset:37120
  v_mfma_f32_16x16x32_bf16 v[24:27], v[156:159], a[196:199], v[24:27]
  s_add_u32 m0, s52, 0
  ds_read_b128 v[176:179], v2 offset:43008
  v_mfma_f32_16x16x32_bf16 v[28:31], v[156:159], a[220:223], v[28:31]
  s_waitcnt lgkmcnt(4)
  buffer_load_dwordx4 v8, s[12:15], s63 offen offset:0  lds
  v_mfma_f32_16x16x32_bf16 v[24:27], v[160:163], a[200:203], v[24:27]
  s_add_u32 s40, s32, 4
  ds_read_b128 v[180:183], v3 offset:43008
  v_mfma_f32_16x16x32_bf16 v[28:31], v[160:163], a[224:227], v[28:31]
  s_waitcnt lgkmcnt(4)
  s_waitcnt vmcnt(9)
  ds_read_b128 v[152:155], v2 offset:43136
  v_mfma_f32_16x16x32_bf16 v[244:247], v[228:231], v[212:215], v[244:247]
  s_add_u32 m0, s53, 4096
  ds_read_b128 v[208:211], v250 offset:8192
  v_readlane_b32 s74, v0, s40
  v_mfma_f32_16x16x32_bf16 v[24:27], v[164:167], a[204:207], v[24:27]
  s_mul_i32 s7, s78, 12288
  buffer_load_dwordx4 v[200:201], s[16:19], s60 idxen offen  lds
  v_mfma_f32_16x16x32_bf16 v[28:31], v[164:167], a[228:231], v[28:31]
  s_waitcnt lgkmcnt(4)
  s_add_u32 m0, s52, 0
  ds_read_b128 v[156:159], v3 offset:43136
  v_mfma_f32_16x16x32_bf16 v[24:27], v[168:171], a[208:211], v[24:27]
  buffer_load_dwordx4 v9, s[12:15], s63 offen offset:1024  lds
  v_mfma_f32_16x16x32_bf16 v[28:31], v[168:171], a[232:235], v[28:31]
  s_add_u32 s7, s7, s75
  ds_read_b64_tr_b16 v[168:169], v4 offset:24576
  ds_read_b128 v[212:215], v251 offset:8192
  v_mfma_f32_16x16x32_bf16 v[24:27], v[172:175], a[212:215], v[24:27]
  s_add_u32 m0, s53, 5120
  v_mfma_f32_16x16x32_bf16 v[28:31], v[172:175], a[236:239], v[28:31]
  s_waitcnt lgkmcnt(5)
  ds_read_b128 v[160:163], v2 offset:43264
  ds_read_b64_tr_b16 v[170:171], v4 offset:30720
  v_mfma_f32_16x16x32_bf16 v[40:43], v[176:179], a[192:195], v[192:195]
  s_mul_i32 s6, s74, 12288
  buffer_load_dwordx4 v[202:203], s[16:19], s60 idxen offen  lds
  v_mfma_f32_16x16x32_bf16 v[44:47], v[176:179], a[216:219], v[196:199]
  s_waitcnt lgkmcnt(5)
  ds_read_b128 v[164:167], v3 offset:43264
  ds_read_b64_tr_b16 v[172:173], v5 offset:24576
  v_mfma_f32_16x16x32_bf16 v[240:243], v[232:235], v[208:211], v[240:243]
  s_add_u32 s6, s6, s75
  v_exp_f32 v184, v24
  v_mfma_f32_16x16x32_bf16 v[40:43], v[180:183], a[196:199], v[40:43]
  s_add_u32 m0, s53, 6144
  ds_read_b64_tr_b16 v[174:175], v5 offset:30720
  v_exp_f32 v185, v25
  v_mfma_f32_16x16x32_bf16 v[44:47], v[180:183], a[220:223], v[44:47]
  ds_read_b64_tr_b16 v[176:177], v6 offset:24576
  ds_read_b64_tr_b16 v[178:179], v6 offset:30720
  v_mfma_f32_16x16x32_bf16 v[40:43], v[152:155], a[200:203], v[40:43]
  s_add_u32 s32, s32, 1
  ds_read_b64_tr_b16 v[180:181], v7 offset:24576
  buffer_load_dwordx4 v[204:205], s[16:19], s60 idxen offen  lds
  v_mfma_f32_16x16x32_bf16 v[44:47], v[152:155], a[224:227], v[44:47]
  s_waitcnt lgkmcnt(10)
  v_exp_f32 v186, v26
  v_mfma_f32_16x16x32_bf16 v[40:43], v[156:159], a[204:207], v[40:43]
  s_add_u32 m0, s52, 0
  ds_read_b64_tr_b16 v[182:183], v7 offset:30720
  ds_read_b128 v[208:211], v250 offset:10240
  v_cvt_pk_bf16_f32 v72, v184, v185
  v_mfma_f32_16x16x32_bf16 v[44:47], v[156:159], a[228:231], v[44:47]
  s_waitcnt lgkmcnt(7)
  v_exp_f32 v187, v27
  v_mfma_f32_16x16x32_bf16 v[40:43], v[160:163], a[208:211], v[40:43]
  buffer_load_dwordx4 v10, s[12:15], s63 offen offset:2048  lds
  v_mfma_f32_16x16x32_bf16 v[240:243], v[236:239], v[212:215], v[240:243]
  ds_read_b64_tr_b16 v[152:153], v4 offset:24704
  ds_read_b128 v[212:215], v251 offset:10240
  v_mfma_f32_16x16x32_bf16 v[44:47], v[160:163], a[232:235], v[44:47]
  s_add_u32 m0, s53, 7168
  v_exp_f32 v188, v28
  v_mfma_f32_16x16x32_bf16 v[40:43], v[164:167], a[212:215], v[40:43]
  s_waitcnt vmcnt(13)
  s_barrier
  ds_read_b64_tr_b16 v[154:155], v4 offset:30848
  v_mfma_f32_16x16x32_bf16 v[44:47], v[164:167], a[236:239], v[44:47]
  buffer_load_dwordx4 v[206:207], s[16:19], s60 idxen offen  lds
  v_mfma_f32_16x16x32_bf16 a[96:99], v[168:171], v[56:59], a[96:99]
  ds_read_b64_tr_b16 v[156:157], v5 offset:24704
  v_cvt_pk_bf16_f32 v73, v186, v187
  v_mfma_f32_16x16x32_bf16 a[144:147], v[168:171], v[60:63], a[144:147]
  s_waitcnt lgkmcnt(9)
  ds_read_b64_tr_b16 v[158:159], v5 offset:30848
  v_exp_f32 v189, v29
  v_mfma_f32_16x16x32_bf16 a[100:103], v[172:175], v[56:59], a[100:103]
  s_add_u32 m0, s51, 36864
  v_exp_f32 v190, v30
  v_mfma_f32_16x16x32_bf16 a[148:151], v[172:175], v[60:63], a[148:151]
  s_waitcnt lgkmcnt(6)
  ds_read_b64_tr_b16 v[160:161], v6 offset:24704
  v_cvt_pk_bf16_f32 v76, v188, v189
  v_mfma_f32_16x16x32_bf16 a[104:107], v[176:179], v[56:59], a[104:107]
  s_waitcnt lgkmcnt(6)
  ds_read_b64_tr_b16 v[162:163], v6 offset:30848
  v_exp_f32 v191, v31
  v_mfma_f32_16x16x32_bf16 v[244:247], v[232:235], v[208:211], v[244:247]
  ds_read_b64_tr_b16 v[164:165], v7 offset:24704
  ds_read_b64_tr_b16 v[166:167], v7 offset:30848
  v_cvt_pk_bf16_f32 v77, v190, v191
  v_mfma_f32_16x16x32_bf16 a[152:155], v[176:179], v[60:63], a[152:155]
  ds_read_b64_tr_b16 v[168:169], v4 offset:24832
  v_exp_f32 v184, v40
  v_mfma_f32_16x16x32_bf16 a[108:111], v[180:183], v[56:59], a[108:111]
  s_max_u32 s40, s76, s77
  buffer_load_dwordx4 v8, s[8:11], s6 offen offset:0  lds
  v_mfma_f32_16x16x32_bf16 a[156:159], v[180:183], v[60:63], a[156:159]
  s_waitcnt lgkmcnt(5)
  v_exp_f32 v185, v41
  v_exp_f32 v186, v42
  v_cvt_pk_bf16_f32 v74, v184, v185
  v_mfma_f32_16x16x32_bf16 a[112:115], v[152:155], v[56:59], a[112:115]
  s_add_u32 m0, s51, 36864
  ds_read_b64_tr_b16 v[170:171], v4 offset:30976
  ds_read_b64_tr_b16 v[172:173], v5 offset:24832
  v_mfma_f32_16x16x32_bf16 a[160:163], v[152:155], v[60:63], a[160:163]
  ds_read_b64_tr_b16 v[174:175], v5 offset:30976
  v_exp_f32 v187, v43
  v_exp_f32 v188, v44
  v_mfma_f32_16x16x32_bf16 a[116:119], v[156:159], v[56:59], a[116:119]
  buffer_load_dwordx4 v9, s[8:11], s6 offen offset:1024  lds
  v_mfma_f32_16x16x32_bf16 a[164:167], v[156:159], v[60:63], a[164:167]
  ds_read_b64_tr_b16 v[176:177], v6 offset:24832
  v_cvt_pk_bf16_f32 v75, v186, v187
  v_mfma_f32_16x16x32_bf16 v[244:247], v[236:239], v[212:215], v[244:247]
  s_waitcnt lgkmcnt(5)
  ds_read_b64_tr_b16 v[178:179], v6 offset:30976
  ds_read_b64_tr_b16 v[180:181], v7 offset:24832
  v_mfma_f32_16x16x32_bf16 a[120:123], v[160:163], v[56:59], a[120:123]
  s_add_u32 m0, s51, 36864
  v_exp_f32 v189, v45
  v_mfma_f32_16x16x32_bf16 a[168:171], v[160:163], v[60:63], a[168:171]
  buffer_load_dwordx4 v10, s[8:11], s6 offen offset:2048  lds
  v_mfma_f32_16x16x32_bf16 a[124:127], v[164:167], v[56:59], a[124:127]
  s_add_u32 m0, s52, 12288
  v_exp_f32 v190, v46
  v_cvt_pk_bf16_f32 v78, v188, v189
  v_mfma_f32_16x16x32_bf16 a[172:175], v[164:167], v[60:63], a[172:175]
  s_waitcnt lgkmcnt(3)
  ds_read_b64_tr_b16 v[182:183], v7 offset:30976
  v_exp_f32 v191, v47
  v_mfma_f32_16x16x32_bf16 a[128:131], v[168:171], v[56:59], a[128:131]
  ds_read_b128 v[152:155], v2 offset:0
  v_cvt_pk_bf16_f32 v79, v190, v191
  v_mfma_f32_16x16x32_bf16 a[176:179], v[168:171], v[60:63], a[176:179]
  buffer_load_dwordx4 v8, s[12:15], s7 offen offset:0  lds
  v_mfma_f32_16x16x32_bf16 v[104:107], v[112:115], v[72:75], v[104:107]
  s_cmp_ge_u32 s40, s37
  s_cselect_b64 s[66:67], -1, 0
  v_cndmask_b32 v248, v248, v240, s[92:93]
  v_mfma_f32_16x16x32_bf16 v[108:111], v[112:115], v[76:79], v[108:111]
  v_cndmask_b32 v248, v248, v241, s[94:95]
  v_mfma_f32_16x16x32_bf16 a[132:135], v[172:175], v[56:59], a[132:135]
  s_add_u32 m0, s52, 12288
  ds_read_b128 v[156:159], v3 offset:0
  v_mfma_f32_16x16x32_bf16 a[180:183], v[172:175], v[60:63], a[180:183]
  s_waitcnt lgkmcnt(2)
  buffer_load_dwordx4 v9, s[12:15], s7 offen offset:1024  lds
  v_mfma_f32_16x16x32_bf16 a[136:139], v[176:179], v[56:59], a[136:139]
  ds_read_b128 v[160:163], v2 offset:128
  v_cndmask_b32 v249, v249, v246, s[92:93]
  v_mfma_f32_16x16x32_bf16 a[184:187], v[176:179], v[60:63], a[184:187]
  v_max_f32 v14, v104, v108
  v_cmp_nge_f32 s[64:65], s50, v14
  v_mfma_f32_16x16x32_bf16 a[140:143], v[180:183], v[56:59], a[140:143]
  s_add_u32 m0, s52, 12288
  ds_read_b128 v[164:167], v3 offset:128
  v_cndmask_b32 v249, v249, v247, s[94:95]
  v_mfma_f32_16x16x32_bf16 a[188:191], v[180:183], v[60:63], a[188:191]
  buffer_load_dwordx4 v10, s[12:15], s7 offen offset:2048  lds
  s_or_b64 vcc, s[64:65], s[66:67]
  s_cbranch_vccnz P2K1s3_SLOW
P2K1s3_SLOWB:
  s_add_u32 s3, s33, s29
  s_and_b32 s3, s3, 1
  s_cmp_lg_u32 s3, 0
  s_cbranch_scc1 P2K1_NT
  s_cmp_lt_u32 s33, 1
  s_cbranch_scc1 P2K1_NT
  s_cmp_ge_u32 s96, 3
  s_cbranch_scc1 P2K1_NT
  s_mov_b32 m0, 160768
  s_nop 0
  buffer_load_dword v15, s[68:71], s97 offen  lds
  s_add_u32 s97, s97, 8192
  s_add_u32 s96, s96, 1
P2K1_NT:
  s_cmp_eq_u32 s33, 7
  s_cbranch_scc0 P2K1_NVE
  s_call_b64 s[4:5], VEARLY
P2K1_NVE:
  s_cmp_eq_u32 s33, 1
  s_cbranch_scc0 P2K1_NK0
  s_call_b64 s[72:73], KEND_0
P2K1_NK0:
  s_cmp_eq_u32 s33, 3
  s_cbranch_scc0 P2K1_NK1
  s_call_b64 s[72:73], KEND_1
P2K1_NK1:
  s_cmp_eq_u32 s33, 5
  s_cbranch_scc0 P2K1_NK2
  s_call_b64 s[72:73], KEND_2
P2K1_NK2:
  s_cmp_eq_u32 s33, 7
  s_cbranch_scc0 P2K1_NK3
  s_call_b64 s[72:73], KEND_3
P2K1_NK3:
  s_add_u32 s33, s33, 1
  s_cmp_eq_u32 s33, 8
  s_cbranch_scc1 SWITCH
  s_branch P2K0
.p2align 6
P2V0:
  s_waitcnt lgkmcnt(2)
  v_mfma_f32_16x16x32_bf16 v[24:27], v[152:155], a[192:195], v[88:91]
  ds_read_b128 v[168:171], v2 offset:256
  ds_read_b128 v[172:175], v3 offset:256
  ds_read_b32 v200, v1 offset:256
  ds_read_b32 v202, v1 offset:288
  v_mfma_f32_16x16x32_bf16 v[28:31], v[152:155], a[216:219], v[92:95]
  ds_read_b32 v204, v1 offset:320
  ds_read_b32 v206, v1 offset:352
  v_mfma_f32_16x16x32_bf16 v[24:27], v[156:159], a[196:199], v[24:27]
  ds_read_b128 v[232:235], v244
  v_mfma_f32_16x16x32_bf16 v[28:31], v[156:159], a[220:223], v[28:31]
  s_waitcnt lgkmcnt(7)
  v_add_u32 v244, s87, v244
  v_mfma_f32_16x16x32_bf16 v[24:27], v[160:163], a[200:203], v[24:27]
  s_waitcnt vmcnt(12)
  s_mov_b32 s76, s77
  ds_read_b128 v[176:179], v2 offset:6144
  v_mfma_f32_16x16x32_bf16 v[28:31], v[160:163], a[224:227], v[28:31]
  s_mov_b32 s77, s78
  s_mov_b32 s78, s79
  ds_read_b128 v[180:183], v3 offset:6144
  v_mfma_f32_16x16x32_bf16 v[24:27], v[164:167], a[204:207], v[24:27]
  s_mov_b32 s79, s74
  s_add_u32 s40, s32, 4
  ds_read_b64_tr_b16 v[208:209], v240 offset:0
  v_mfma_f32_16x16x32_bf16 v[28:31], v[164:167], a[228:231], v[28:31]
  s_waitcnt lgkmcnt(8)
  ds_read_b64_tr_b16 v[210:211], v240 offset:512
  v_mfma_f32_16x16x32_bf16 v[24:27], v[168:171], a[208:211], v[24:27]
  s_add_u32 m0, s53, 8192
  ds_read_b128 v[152:155], v2 offset:6272
  v_readlane_b32 s74, v0, s40
  v_mfma_f32_16x16x32_bf16 v[28:31], v[168:171], a[232:235], v[28:31]
  s_waitcnt lgkmcnt(9)
  buffer_load_dwordx4 v[200:201], s[16:19], s80 idxen offen  lds
  v_mfma_f32_16x16x32_bf16 v[24:27], v[172:175], a[212:215], v[24:27]
  s_add_u32 m0, s53, 9216
  ds_read_b128 v[156:159], v3 offset:6272
  ds_read_b64_tr_b16 v[212:213], v241 offset:0
  v_mfma_f32_16x16x32_bf16 v[28:31], v[172:175], a[236:239], v[28:31]
  s_waitcnt lgkmcnt(5)
  v_mfma_f32_16x16x32_bf16 v[40:43], v[176:179], a[192:195], v[192:195]
  ds_read_b128 v[160:163], v2 offset:6400
  ds_read_b64_tr_b16 v[214:215], v241 offset:512
  v_mfma_f32_16x16x32_bf16 v[44:47], v[176:179], a[216:219], v[196:199]
  s_waitcnt lgkmcnt(5)
  buffer_load_dwordx4 v[202:203], s[16:19], s80 idxen offen  lds
  v_mfma_f32_16x16x32_bf16 v[216:219], v[208:211], v[232:235], 0
  s_add_u32 m0, s53, 10240
  ds_read_b128 v[164:167], v3 offset:6400
  ds_read_b64_tr_b16 v[208:209], v242 offset:0
  v_exp_f32 v184, v24
  v_exp_f32 v185, v25
  v_mfma_f32_16x16x32_bf16 v[40:43], v[180:183], a[196:199], v[40:43]
  v_exp_f32 v186, v26
  v_mfma_f32_16x16x32_bf16 v[44:47], v[180:183], a[220:223], v[44:47]
  s_waitcnt lgkmcnt(5)
  ds_read_b64_tr_b16 v[168:169], v4 offset:36864
  ds_read_b64_tr_b16 v[170:171], v4 offset:43008
  v_mfma_f32_16x16x32_bf16 v[40:43], v[152:155], a[200:203], v[40:43]
  s_mul_i32 s63, s78, 12288
  ds_read_b64_tr_b16 v[172:173], v5 offset:36864
  buffer_load_dwordx4 v[204:205], s[16:19], s80 idxen offen  lds
  v_mfma_f32_16x16x32_bf16 v[44:47], v[152:155], a[224:227], v[44:47]
  s_add_u32 m0, s53, 11264
  ds_read_b64_tr_b16 v[174:175], v5 offset:43008
  v_cvt_pk_bf16_f32 v56, v184, v185
  v_mfma_f32_16x16x32_bf16 v[40:43], v[156:159], a[204:207], v[40:43]
  s_add_u32 s63, s63, s75
  ds_read_b64_tr_b16 v[176:177], v6 offset:36864
  ds_read_b64_tr_b16 v[178:179], v6 offset:43008
  v_mfma_f32_16x16x32_bf16 v[44:47], v[156:159], a[228:231], v[44:47]
  s_waitcnt lgkmcnt(7)
  ds_read_b64_tr_b16 v[180:181], v7 offset:36864
  v_exp_f32 v187, v27
  v_mfma_f32_16x16x32_bf16 v[40:43], v[160:163], a[208:211], v[40:43]
  ds_read_b64_tr_b16 v[210:211], v242 offset:512
  buffer_load_dwordx4 v[206:207], s[16:19], s80 idxen offen  lds
  v_mfma_f32_16x16x32_bf16 v[220:223], v[212:215], v[232:235], 0
  s_mul_i32 s62, s74, 12288
  ds_read_b64_tr_b16 v[182:183], v7 offset:43008
  ds_read_b64_tr_b16 v[152:153], v4 offset:36992
  v_mfma_f32_16x16x32_bf16 v[44:47], v[160:163], a[232:235], v[44:47]
  s_add_u32 s62, s62, s75
  v_exp_f32 v188, v28
  v_mfma_f32_16x16x32_bf16 v[40:43], v[164:167], a[212:215], v[40:43]
  s_waitcnt vmcnt(13)
  s_barrier
  ds_read_b64_tr_b16 v[154:155], v4 offset:43136
  ds_read_b64_tr_b16 v[156:157], v5 offset:36992
  ds_read_b64_tr_b16 v[158:159], v5 offset:43136
  v_mfma_f32_16x16x32_bf16 v[44:47], v[164:167], a[236:239], v[44:47]
  s_waitcnt lgkmcnt(9)
  v_cvt_pk_bf16_f32 v57, v186, v187
  v_exp_f32 v189, v29
  v_mfma_f32_16x16x32_bf16 a[96:99], v[168:171], v[72:75], a[96:99]
  s_add_u32 m0, s51, 0
  ds_read_b64_tr_b16 v[212:213], v243 offset:0
  v_exp_f32 v190, v30
  v_mfma_f32_16x16x32_bf16 a[144:147], v[168:171], v[76:79], a[144:147]
  ds_read_b64_tr_b16 v[160:161], v6 offset:36992
  v_cvt_pk_bf16_f32 v60, v188, v189
  v_exp_f32 v191, v31
  v_mfma_f32_16x16x32_bf16 a[100:103], v[172:175], v[72:75], a[100:103]
  ds_read_b64_tr_b16 v[162:163], v6 offset:43136
  ds_read_b32 v200, v1 offset:384
  v_mfma_f32_16x16x32_bf16 a[148:151], v[172:175], v[76:79], a[148:151]
  s_waitcnt lgkmcnt(8)
  ds_read_b64_tr_b16 v[164:165], v7 offset:36992
  buffer_load_dwordx4 v8, s[8:11], s62 offen offset:0  lds
  v_cvt_pk_bf16_f32 v61, v190, v191
  v_mfma_f32_16x16x32_bf16 a[104:107], v[176:179], v[72:75], a[104:107]
  ds_read_b64_tr_b16 v[214:215], v243 offset:512
  v_exp_f32 v184, v40
  v_exp_f32 v185, v41
  v_exp_f32 v186, v42
  v_mfma_f32_16x16x32_bf16 v[224:227], v[208:211], v[232:235], 0
  ds_read_b32 v202, v1 offset:416
  v_cvt_pk_bf16_f32 v58, v184, v185
  v_mfma_f32_16x16x32_bf16 a[152:155], v[176:179], v[76:79], a[152:155]
  s_add_u32 s32, s32, 1
  ds_read_b64_tr_b16 v[166:167], v7 offset:43136
  ds_read_b32 v204, v1 offset:448
  v_mfma_f32_16x16x32_bf16 a[108:111], v[180:183], v[72:75], a[108:111]
  s_add_u32 m0, s51, 0
  ds_read_b32 v206, v1 offset:480
  v_exp_f32 v187, v43
  v_mfma_f32_16x16x32_bf16 a[156:159], v[180:183], v[76:79], a[156:159]
  s_waitcnt lgkmcnt(10)
  ds_read_b64_tr_b16 v[168:169], v4 offset:37120
  ds_read_b64_tr_b16 v[170:171], v4 offset:43264
  v_mfma_f32_16x16x32_bf16 a[112:115], v[152:155], v[72:75], a[112:115]
  v_exp_f32 v188, v44
  v_cvt_pk_bf16_f32 v59, v186, v187
  v_exp_f32 v189, v45
  v_exp_f32 v190, v46
  v_mfma_f32_16x16x32_bf16 a[160:163], v[152:155], v[76:79], a[160:163]
  buffer_load_dwordx4 v9, s[8:11], s62 offen offset:1024  lds
  v_mfma_f32_16x16x32_bf16 a[116:119], v[156:159], v[72:75], a[116:119]
  ds_read_b64_tr_b16 v[172:173], v5 offset:37120
  ds_read_b64_tr_b16 v[174:175], v5 offset:43264
  v_mfma_f32_16x16x32_bf16 a[164:167], v[156:159], v[76:79], a[164:167]
  s_waitcnt lgkmcnt(8)
  s_waitcnt vmcnt(11)
  v_cvt_pk_bf16_f32 v62, v188, v189
  v_mfma_f32_16x16x32_bf16 v[228:231], v[212:215], v[232:235], 0
  ds_read_b64_tr_b16 v[208:209], v240 offset:4096
  ds_read_b64_tr_b16 v[210:211], v240 offset:4608
  v_mfma_f32_16x16x32_bf16 a[120:123], v[160:163], v[72:75], a[120:123]
  s_add_u32 m0, s53, 0
  v_exp_f32 v191, v47
  v_mfma_f32_16x16x32_bf16 a[168:171], v[160:163], v[76:79], a[168:171]
  s_waitcnt lgkmcnt(8)
  s_max_u32 s40, s76, s77
  ds_read_b64_tr_b16 v[176:177], v6 offset:37120
  ds_read_b128 v[236:239], v245
  v_mfma_f32_16x16x32_bf16 a[124:127], v[164:167], v[72:75], a[124:127]
  buffer_load_dwordx4 v[200:201], s[16:19], s80 idxen offen  lds
  v_mfma_f32_16x16x32_bf16 a[172:175], v[164:167], v[76:79], a[172:175]
  s_waitcnt lgkmcnt(4)
  ds_read_b64_tr_b16 v[178:179], v6 offset:43264
  ds_read_b64_tr_b16 v[180:181], v7 offset:37120
  v_mfma_f32_16x16x32_bf16 a[128:131], v[168:171], v[72:75], a[128:131]
  ds_read_b64_tr_b16 v[182:183], v7 offset:43264
  v_cvt_pk_bf16_f32 v63, v190, v191
  v_mfma_f32_16x16x32_bf16 a[176:179], v[168:171], v[76:79], a[176:179]
  s_add_u32 m0, s53, 1024
  ds_read_b128 v[152:155], v2 offset:12288
  v_mfma_f32_16x16x32_bf16 v[104:107], v[112:115], v[56:59], v[104:107]
  buffer_load_dwordx4 v[202:203], s[16:19], s80 idxen offen  lds
  v_mfma_f32_16x16x32_bf16 v[108:111], v[112:115], v[60:63], v[108:111]
  s_waitcnt lgkmcnt(4)
  ds_read_b128 v[156:159], v3 offset:12288
  ds_read_b64_tr_b16 v[212:213], v241 offset:4096
  v_mfma_f32_16x16x32_bf16 v[216:219], v[208:211], v[236:239], v[216:219]
  s_cmp_ge_u32 s40, s37
  s_cselect_b64 s[66:67], -1, 0
  v_add_u32 v245, s87, v245
  v_mfma_f32_16x16x32_bf16 a[132:135], v[172:175], v[72:75], a[132:135]
  s_add_u32 m0, s51, 0
  ds_read_b128 v[160:163], v2 offset:12416
  ds_read_b64_tr_b16 v[214:215], v241 offset:4608
  v_mfma_f32_16x16x32_bf16 a[180:183], v[172:175], v[76:79], a[180:183]
  s_waitcnt lgkmcnt(5)
  buffer_load_dwordx4 v10, s[8:11], s62 offen offset:2048  lds
  v_mfma_f32_16x16x32_bf16 a[136:139], v[176:179], v[72:75], a[136:139]
  ds_read_b64_tr_b16 v[208:209], v242 offset:4096
  ds_read_b128 v[232:235], v246
  v_mfma_f32_16x16x32_bf16 a[184:187], v[176:179], v[76:79], a[184:187]
  s_add_u32 m0, s53, 2048
  v_max_f32 v14, v104, v108
  v_cmp_nge_f32 s[64:65], s50, v14
  v_mfma_f32_16x16x32_bf16 a[140:143], v[180:183], v[72:75], a[140:143]
  ds_read_b128 v[164:167], v3 offset:12416
  ds_read_b64_tr_b16 v[210:211], v242 offset:4608
  v_mfma_f32_16x16x32_bf16 a[188:191], v[180:183], v[76:79], a[188:191]
  s_waitcnt lgkmcnt(7)
  buffer_load_dwordx4 v[204:205], s[16:19], s80 idxen offen  lds
  s_or_b64 vcc, s[64:65], s[66:67]
  s_cbranch_vccnz P2V0s0_SLOW
P2V0s0_SLOWB:
  v_mfma_f32_16x16x32_bf16 v[24:27], v[152:155], a[192:195], v[88:91]
  s_waitcnt lgkmcnt(4)
  ds_read_b128 v[168:171], v2 offset:12544
  v_mfma_f32_16x16x32_bf16 v[220:223], v[212:215], v[236:239], v[220:223]
  s_add_u32 m0, s53, 3072
  ds_read_b64_tr_b16 v[212:213], v243 offset:4096
  v_mfma_f32_16x16x32_bf16 v[28:31], v[152:155], a[216:219], v[92:95]
  s_mov_b32 s76, s77
  ds_read_b128 v[172:175], v3 offset:12544
  v_add_u32 v246, s87, v246
  v_mfma_f32_16x16x32_bf16 v[24:27], v[156:159], a[196:199], v[24:27]
  buffer_load_dwordx4 v[206:207], s[16:19], s80 idxen offen  lds
  v_mfma_f32_16x16x32_bf16 v[28:31], v[156:159], a[220:223], v[28:31]
  s_mov_b32 s77, s78
  ds_read_b128 v[176:179], v2 offset:18432
  v_mfma_f32_16x16x32_bf16 v[24:27], v[160:163], a[200:203], v[24:27]
  s_mov_b32 s78, s79
  s_add_u32 m0, s52, 24576
  ds_read_b128 v[180:183], v3 offset:18432
  v_mfma_f32_16x16x32_bf16 v[28:31], v[160:163], a[224:227], v[28:31]
  s_waitcnt lgkmcnt(6)
  s_mov_b32 s79, s74
  ds_read_b128 v[152:155], v2 offset:18560
  v_add_u32 v1, s84, v1
  v_mfma_f32_16x16x32_bf16 v[24:27], v[164:167], a[204:207], v[24:27]
  s_add_u32 s40, s32, 4
  buffer_load_dwordx4 v8, s[12:15], s63 offen offset:0  lds
  v_mfma_f32_16x16x32_bf16 v[28:31], v[164:167], a[228:231], v[28:31]
  s_waitcnt lgkmcnt(3)
  ds_read_b128 v[156:159], v3 offset:18560
  v_readlane_b32 s74, v0, s40
  v_mfma_f32_16x16x32_bf16 v[24:27], v[168:171], a[208:211], v[24:27]
  s_mul_i32 s7, s78, 12288
  ds_read_b32 v200, v1 offset:0
  v_mfma_f32_16x16x32_bf16 v[224:227], v[208:211], v[236:239], v[224:227]
  s_add_u32 m0, s52, 24576
  ds_read_b64_tr_b16 v[214:215], v243 offset:4608
  ds_read_b32 v202, v1 offset:32
  v_mfma_f32_16x16x32_bf16 v[28:31], v[168:171], a[232:235], v[28:31]
  buffer_load_dwordx4 v9, s[12:15], s63 offen offset:1024  lds
  v_mfma_f32_16x16x32_bf16 v[24:27], v[172:175], a[212:215], v[24:27]
  ds_read_b32 v204, v1 offset:64
  ds_read_b32 v206, v1 offset:96
  v_mfma_f32_16x16x32_bf16 v[28:31], v[172:175], a[236:239], v[28:31]
  s_waitcnt lgkmcnt(7)
  s_add_u32 s7, s7, s75
  ds_read_b64_tr_b16 v[168:169], v4 offset:0
  v_mfma_f32_16x16x32_bf16 v[40:43], v[176:179], a[192:195], v[192:195]
  s_add_u32 m0, s52, 24576
  ds_read_b128 v[160:163], v2 offset:18688
  ds_read_b64_tr_b16 v[170:171], v4 offset:6144
  v_mfma_f32_16x16x32_bf16 v[44:47], v[176:179], a[216:219], v[196:199]
  buffer_load_dwordx4 v10, s[12:15], s63 offen offset:2048  lds
  v_mfma_f32_16x16x32_bf16 v[40:43], v[180:183], a[196:199], v[40:43]
  ds_read_b128 v[164:167], v3 offset:18688
  v_exp_f32 v184, v24
  v_mfma_f32_16x16x32_bf16 v[44:47], v[180:183], a[220:223], v[44:47]
  s_waitcnt lgkmcnt(7)
  s_waitcnt vmcnt(10)
  ds_read_b64_tr_b16 v[172:173], v5 offset:0
  v_mfma_f32_16x16x32_bf16 v[228:231], v[212:215], v[236:239], v[228:231]
  ds_read_b64_tr_b16 v[208:209], v240 offset:8192
  ds_read_b64_tr_b16 v[210:211], v240 offset:8704
  v_mfma_f32_16x16x32_bf16 v[40:43], v[152:155], a[200:203], v[40:43]
  s_add_u32 m0, s53, 4096
  ds_read_b64_tr_b16 v[174:175], v5 offset:6144
  v_exp_f32 v185, v25
  v_mfma_f32_16x16x32_bf16 v[44:47], v[152:155], a[224:227], v[44:47]
  s_mul_i32 s6, s74, 12288
  buffer_load_dwordx4 v[200:201], s[16:19], s81 idxen offen  lds
  v_mfma_f32_16x16x32_bf16 v[40:43], v[156:159], a[204:207], v[40:43]
  s_add_u32 s6, s6, s75
  ds_read_b64_tr_b16 v[212:213], v241 offset:8192
  ds_read_b64_tr_b16 v[214:215], v241 offset:8704
  v_mfma_f32_16x16x32_bf16 v[44:47], v[156:159], a[228:231], v[44:47]
  s_waitcnt lgkmcnt(6)
  v_exp_f32 v186, v26
  v_cvt_pk_bf16_f32 v72, v184, v185
  v_exp_f32 v187, v27
  v_exp_f32 v188, v28
  v_mfma_f32_16x16x32_bf16 v[40:43], v[160:163], a[208:211], v[40:43]
  ds_read_b64_tr_b16 v[176:177], v6 offset:0
  ds_read_b64_tr_b16 v[178:179], v6 offset:6144
  v_cvt_pk_bf16_f32 v73, v186, v187
  v_mfma_f32_16x16x32_bf16 v[44:47], v[160:163], a[232:235], v[44:47]
  s_add_u32 m0, s53, 5120
  ds_read_b64_tr_b16 v[180:181], v7 offset:0
  v_exp_f32 v189, v29
  v_mfma_f32_16x16x32_bf16 v[40:43], v[164:167], a[212:215], v[40:43]
  s_waitcnt vmcnt(15)
  s_barrier
  ds_read_b64_tr_b16 v[182:183], v7 offset:6144
  v_exp_f32 v190, v30
  v_mfma_f32_16x16x32_bf16 v[44:47], v[164:167], a[236:239], v[44:47]
  s_waitcnt lgkmcnt(7)
  buffer_load_dwordx4 v[202:203], s[16:19], s81 idxen offen  lds
  v_cvt_pk_bf16_f32 v76, v188, v189
  v_mfma_f32_16x16x32_bf16 v[216:219], v[208:211], v[232:235], v[216:219]
  ds_read_b64_tr_b16 v[152:153], v4 offset:128
  ds_read_b64_tr_b16 v[154:155], v4 offset:6272
  ds_read_b64_tr_b16 v[156:157], v5 offset:128
  v_mfma_f32_16x16x32_bf16 a[96:99], v[168:171], v[56:59], a[96:99]
  v_exp_f32 v191, v31
  v_mfma_f32_16x16x32_bf16 a[144:147], v[168:171], v[60:63], a[144:147]
  s_waitcnt lgkmcnt(9)
  s_add_u32 m0, s53, 6144
  ds_read_b64_tr_b16 v[158:159], v5 offset:6272
  ds_read_b64_tr_b16 v[160:161], v6 offset:128
  v_mfma_f32_16x16x32_bf16 a[100:103], v[172:175], v[56:59], a[100:103]
  ds_read_b64_tr_b16 v[208:209], v242 offset:8192
  buffer_load_dwordx4 v[204:205], s[16:19], s81 idxen offen  lds
  v_mfma_f32_16x16x32_bf16 a[148:151], v[172:175], v[60:63], a[148:151]
  s_waitcnt lgkmcnt(6)
  ds_read_b64_tr_b16 v[162:163], v6 offset:6272
  ds_read_b64_tr_b16 v[210:211], v242 offset:8704
  v_mfma_f32_16x16x32_bf16 a[104:107], v[176:179], v[56:59], a[104:107]
  s_add_u32 m0, s51, 12288
  ds_read_b64_tr_b16 v[164:165], v7 offset:128
  v_cvt_pk_bf16_f32 v77, v190, v191
  v_exp_f32 v184, v40
  v_mfma_f32_16x16x32_bf16 a[152:155], v[176:179], v[60:63], a[152:155]
  v_exp_f32 v185, v41
  v_mfma_f32_16x16x32_bf16 a[108:111], v[180:183], v[56:59], a[108:111]
  ds_read_b64_tr_b16 v[166:167], v7 offset:6272
  ds_read_b64_tr_b16 v[168:169], v4 offset:256
  v_mfma_f32_16x16x32_bf16 v[220:223], v[212:215], v[232:235], v[220:223]
  s_add_u32 s32, s32, 1
  ds_read_b64_tr_b16 v[170:171], v4 offset:6400
  buffer_load_dwordx4 v8, s[8:11], s6 offen offset:0  lds
  v_exp_f32 v186, v42
  v_mfma_f32_16x16x32_bf16 a[156:159], v[180:183], v[60:63], a[156:159]
  s_waitcnt lgkmcnt(8)
  ds_read_b64_tr_b16 v[172:173], v5 offset:256
  ds_read_b64_tr_b16 v[174:175], v5 offset:6400
  v_mfma_f32_16x16x32_bf16 a[112:115], v[152:155], v[56:59], a[112:115]
  s_add_u32 m0, s53, 7168
  ds_read_b64_tr_b16 v[212:213], v243 offset:8192
  v_cvt_pk_bf16_f32 v74, v184, v185
  v_mfma_f32_16x16x32_bf16 a[160:163], v[152:155], v[60:63], a[160:163]
  v_exp_f32 v187, v43
  v_mfma_f32_16x16x32_bf16 a[116:119], v[156:159], v[56:59], a[116:119]
  s_max_u32 s40, s76, s77
  ds_read_b64_tr_b16 v[176:177], v6 offset:256
  ds_read_b128 v[152:155], v2 offset:24576
  buffer_load_dwordx4 v[206:207], s[16:19], s81 idxen offen  lds
  v_mfma_f32_16x16x32_bf16 a[164:167], v[156:159], v[60:63], a[164:167]
  s_waitcnt lgkmcnt(7)
  v_exp_f32 v188, v44
  v_mfma_f32_16x16x32_bf16 a[120:123], v[160:163], v[56:59], a[120:123]
  ds_read_b32 v200, v1 offset:128
  v_cvt_pk_bf16_f32 v75, v186, v187
  v_exp_f32 v189, v45
  v_mfma_f32_16x16x32_bf16 a[168:171], v[160:163], v[60:63], a[168:171]
  ds_read_b64_tr_b16 v[214:215], v243 offset:8704
  ds_read_b32 v202, v1 offset:160
  v_mfma_f32_16x16x32_bf16 a[124:127], v[164:167], v[56:59], a[124:127]
  ds_read_b64_tr_b16 v[178:179], v6 offset:6400
  v_exp_f32 v190, v46
  v_mfma_f32_16x16x32_bf16 v[224:227], v[208:211], v[232:235], v[224:227]
  ds_read_b64_tr_b16 v[180:181], v7 offset:256
  ds_read_b32 v204, v1 offset:192
  v_mfma_f32_16x16x32_bf16 a[172:175], v[164:167], v[60:63], a[172:175]
  s_waitcnt lgkmcnt(9)
  v_cvt_pk_bf16_f32 v78, v188, v189
  v_exp_f32 v191, v47
  v_mfma_f32_16x16x32_bf16 a[128:131], v[168:171], v[56:59], a[128:131]
  s_add_u32 m0, s51, 12288
  ds_read_b64_tr_b16 v[182:183], v7 offset:6400
  ds_read_b128 v[156:159], v3 offset:24576
  v_cvt_pk_bf16_f32 v79, v190, v191
  v_mfma_f32_16x16x32_bf16 a[176:179], v[168:171], v[60:63], a[176:179]
  buffer_load_dwordx4 v9, s[8:11], s6 offen offset:1024  lds
  v_mfma_f32_16x16x32_bf16 v[104:107], v[112:115], v[72:75], v[104:107]
  s_add_u32 m0, s51, 12288
  ds_read_b32 v206, v1 offset:224
  ds_read_b128 v[236:239], v247
  v_mfma_f32_16x16x32_bf16 v[108:111], v[112:115], v[76:79], v[108:111]
  v_add_u32 v247, s87, v247
  v_mfma_f32_16x16x32_bf16 a[132:135], v[172:175], v[56:59], a[132:135]
  s_cmp_ge_u32 s40, s37
  s_cselect_b64 s[66:67], -1, 0
  ds_read_b128 v[160:163], v2 offset:24704
  v_mfma_f32_16x16x32_bf16 a[180:183], v[172:175], v[60:63], a[180:183]
  s_waitcnt lgkmcnt(9)
  s_waitcnt vmcnt(9)
  buffer_load_dwordx4 v10, s[8:11], s6 offen offset:2048  lds
  v_mfma_f32_16x16x32_bf16 v[228:231], v[212:215], v[232:235], v[228:231]
  s_waitcnt lgkmcnt(4)
  ds_read_b64_tr_b16 v[208:209], v240 offset:0
  ds_read_b64_tr_b16 v[210:211], v240 offset:512
  v_mfma_f32_16x16x32_bf16 a[136:139], v[176:179], v[56:59], a[136:139]
  s_add_u32 m0, s53, 8192
  ds_read_b64_tr_b16 v[212:213], v241 offset:0
  v_max_f32 v14, v104, v108
  v_mfma_f32_16x16x32_bf16 a[184:187], v[176:179], v[60:63], a[184:187]
  ds_read_b128 v[164:167], v3 offset:24704
  v_cmp_nge_f32 s[64:65], s50, v14
  v_mfma_f32_16x16x32_bf16 a[140:143], v[180:183], v[56:59], a[140:143]
  buffer_load_dwordx4 v[200:201], s[16:19], s81 idxen offen  lds
  v_mfma_f32_16x16x32_bf16 a[188:191], v[180:183], v[60:63], a[188:191]
  ds_read_b128 v[232:235], v244
  v_add_u32 v244, s88, v244
  s_or_b64 vcc, s[64:65], s[66:67]
  s_cbranch_vccnz P2V0s1_SLOW
P2V0s1_SLOWB:
  v_mfma_f32_16x16x32_bf16 v[24:27], v[152:155], a[192:195], v[88:91]
  s_add_u32 m0, s52, 36864
  ds_read_b128 v[168:171], v2 offset:24832
  v_mfma_f32_16x16x32_bf16 v[28:31], v[152:155], a[216:219], v[92:95]
  s_waitcnt lgkmcnt(9)
  ds_read_b128 v[172:175], v3 offset:24832
  v_mfma_f32_16x16x32_bf16 v[24:27], v[156:159], a[196:199], v[24:27]
  s_mov_b32 s76, s77
  buffer_load_dwordx4 v8, s[12:15], s7 offen offset:0  lds
  v_mfma_f32_16x16x32_bf16 v[28:31], v[156:159], a[220:223], v[28:31]
  s_waitcnt lgkmcnt(5)
  s_mov_b32 s77, s78
  ds_read_b128 v[176:179], v2 offset:30720
  v_mfma_f32_16x16x32_bf16 v[216:219], v[208:211], v[236:239], v[216:219]
  s_mov_b32 s78, s79
  s_add_u32 m0, s53, 9216
  v_mfma_f32_16x16x32_bf16 v[24:27], v[160:163], a[200:203], v[24:27]
  s_mov_b32 s79, s74
  ds_read_b128 v[180:183], v3 offset:30720
  ds_read_b64_tr_b16 v[214:215], v241 offset:512
  v_mfma_f32_16x16x32_bf16 v[28:31], v[160:163], a[224:227], v[28:31]
  s_waitcnt lgkmcnt(6)
  buffer_load_dwordx4 v[202:203], s[16:19], s81 idxen offen  lds
  v_mfma_f32_16x16x32_bf16 v[24:27], v[164:167], a[204:207], v[24:27]
  s_add_u32 m0, s53, 10240
  ds_read_b128 v[152:155], v2 offset:30848
  ds_read_b64_tr_b16 v[208:209], v242 offset:0
  v_mfma_f32_16x16x32_bf16 v[28:31], v[164:167], a[228:231], v[28:31]
  s_waitcnt lgkmcnt(5)
  buffer_load_dwordx4 v[204:205], s[16:19], s81 idxen offen  lds
  v_mfma_f32_16x16x32_bf16 v[24:27], v[168:171], a[208:211], v[24:27]
  s_add_u32 s40, s32, 4
  ds_read_b128 v[156:159], v3 offset:30848
  ds_read_b64_tr_b16 v[210:211], v242 offset:512
  v_mfma_f32_16x16x32_bf16 v[28:31], v[168:171], a[232:235], v[28:31]
  s_add_u32 m0, s52, 36864
  v_readlane_b32 s74, v0, s40
  v_cvt_pk_bf16_f32 v248, v216, v217
  v_mfma_f32_16x16x32_bf16 v[24:27], v[172:175], a[212:215], v[24:27]
  s_waitcnt lgkmcnt(4)
  ds_read_b128 v[160:163], v2 offset:30976
  ds_read_b64_tr_b16 v[168:169], v4 offset:12288
  v_mfma_f32_16x16x32_bf16 v[220:223], v[212:215], v[236:239], v[220:223]
  buffer_load_dwordx4 v9, s[12:15], s7 offen offset:1024  lds
  v_mfma_f32_16x16x32_bf16 v[28:31], v[172:175], a[236:239], v[28:31]
  ds_read_b64_tr_b16 v[212:213], v243 offset:0
  v_cvt_pk_bf16_f32 v249, v218, v219
  v_mfma_f32_16x16x32_bf16 v[40:43], v[176:179], a[192:195], v[192:195]
  s_add_u32 m0, s53, 11264
  ds_read_b64_tr_b16 v[170:171], v4 offset:18432
  ds_read_b64_tr_b16 v[172:173], v5 offset:12288
  v_mfma_f32_16x16x32_bf16 v[44:47], v[176:179], a[216:219], v[196:199]
  v_exp_f32 v184, v24
  v_mfma_f32_16x16x32_bf16 v[40:43], v[180:183], a[196:199], v[40:43]
  s_mul_i32 s63, s78, 12288
  ds_read_b128 v[164:167], v3 offset:30976
  ds_read_b64_tr_b16 v[174:175], v5 offset:18432
  buffer_load_dwordx4 v[206:207], s[16:19], s81 idxen offen  lds
  v_mfma_f32_16x16x32_bf16 v[44:47], v[180:183], a[220:223], v[44:47]
  s_waitcnt lgkmcnt(8)
  v_exp_f32 v185, v25
  v_mfma_f32_16x16x32_bf16 v[40:43], v[152:155], a[200:203], v[40:43]
  s_add_u32 s63, s63, s75
  ds_read_b64_tr_b16 v[176:177], v6 offset:12288
  ds_read_b64_tr_b16 v[214:215], v243 offset:512
  ds_read_b32 v200, v1 offset:256
  v_mfma_f32_16x16x32_bf16 v[44:47], v[152:155], a[224:227], v[44:47]
  s_add_u32 m0, s52, 36864
  v_exp_f32 v186, v26
  v_mfma_f32_16x16x32_bf16 v[40:43], v[156:159], a[204:207], v[40:43]
  s_waitcnt lgkmcnt(10)
  ds_read_b64_tr_b16 v[178:179], v6 offset:18432
  ds_read_b64_tr_b16 v[180:181], v7 offset:12288
  ds_read_b32 v202, v1 offset:288
  buffer_load_dwordx4 v10, s[12:15], s7 offen offset:2048  lds
  v_cvt_pk_bf16_f32 v56, v184, v185
  v_mfma_f32_16x16x32_bf16 v[224:227], v[208:211], v[236:239], v[224:227]
  s_mul_i32 s62, s74, 12288
  v_exp_f32 v187, v27
  v_mfma_f32_16x16x32_bf16 v[44:47], v[156:159], a[228:231], v[44:47]
  s_waitcnt lgkmcnt(7)
  ds_read_b32 v204, v1 offset:320
  v_exp_f32 v188, v28
  v_cvt_pk_bf16_f32 v250, v220, v221
  v_mfma_f32_16x16x32_bf16 v[40:43], v[160:163], a[208:211], v[40:43]
  v_cvt_pk_bf16_f32 v57, v186, v187
  v_cvt_pk_bf16_f32 v251, v222, v223
  v_mfma_f32_16x16x32_bf16 v[44:47], v[160:163], a[232:235], v[44:47]
  s_add_u32 s62, s62, s75
  ds_read_b64_tr_b16 v[182:183], v7 offset:18432
  ds_read_b64_tr_b16 v[152:153], v4 offset:12416
  v_exp_f32 v189, v29
  v_mfma_f32_16x16x32_bf16 v[40:43], v[164:167], a[212:215], v[40:43]
  s_waitcnt vmcnt(14)
  s_barrier
  ds_read_b32 v206, v1 offset:352
  buffer_store_dwordx4 v[248:251], v13, s[24:27], s90 offen offset:0 sc1
  v_mfma_f32_16x16x32_bf16 v[44:47], v[164:167], a[236:239], v[44:47]
  ds_read_b64_tr_b16 v[154:155], v4 offset:18560
  v_exp_f32 v190, v30
  v_mfma_f32_16x16x32_bf16 a[96:99], v[168:171], v[72:75], a[96:99]
  s_add_u32 m0, s51, 24576
  ds_read_b64_tr_b16 v[156:157], v5 offset:12416
  ds_read_b64_tr_b16 v[158:159], v5 offset:18560
  v_mfma_f32_16x16x32_bf16 a[144:147], v[168:171], v[76:79], a[144:147]
  s_waitcnt lgkmcnt(11)
  s_waitcnt vmcnt(10)
  v_cvt_pk_bf16_f32 v60, v188, v189
  v_mfma_f32_16x16x32_bf16 v[228:231], v[212:215], v[236:239], v[228:231]
  ds_read_b64_tr_b16 v[160:161], v6 offset:12416
  ds_read_b64_tr_b16 v[162:163], v6 offset:18560
  ds_read_b64_tr_b16 v[208:209], v240 offset:4096
  buffer_load_dwordx4 v8, s[8:11], s62 offen offset:0  lds
  v_mfma_f32_16x16x32_bf16 a[100:103], v[172:175], v[72:75], a[100:103]
  s_add_u32 m0, s53, 0
  v_exp_f32 v191, v31
  v_mfma_f32_16x16x32_bf16 a[148:151], v[172:175], v[76:79], a[148:151]
  s_waitcnt lgkmcnt(8)
  ds_read_b64_tr_b16 v[164:165], v7 offset:12416
  ds_read_b64_tr_b16 v[166:167], v7 offset:18560
  ds_read_b64_tr_b16 v[210:211], v240 offset:4608
  v_cvt_pk_bf16_f32 v61, v190, v191
  v_mfma_f32_16x16x32_bf16 a[104:107], v[176:179], v[72:75], a[104:107]
  v_exp_f32 v184, v40
  v_mfma_f32_16x16x32_bf16 a[152:155], v[176:179], v[76:79], a[152:155]
  buffer_load_dwordx4 v[200:201], s[16:19], s81 idxen offen  lds
  v_exp_f32 v185, v41
  v_exp_f32 v186, v42
  v_cvt_pk_bf16_f32 v252, v224, v225
  v_mfma_f32_16x16x32_bf16 a[108:111], v[180:183], v[72:75], a[108:111]
  ds_read_b64_tr_b16 v[168:169], v4 offset:12544
  v_cvt_pk_bf16_f32 v58, v184, v185
  v_mfma_f32_16x16x32_bf16 a[156:159], v[180:183], v[76:79], a[156:159]
  s_waitcnt lgkmcnt(7)
  ds_read_b64_tr_b16 v[170:171], v4 offset:18688
  ds_read_b64_tr_b16 v[172:173], v5 offset:12544
  v_mfma_f32_16x16x32_bf16 a[112:115], v[152:155], v[72:75], a[112:115]
  s_add_u32 m0, s53, 1024
  ds_read_b64_tr_b16 v[174:175], v5 offset:18688
  v_exp_f32 v187, v43
  v_mfma_f32_16x16x32_bf16 a[160:163], v[152:155], v[76:79], a[160:163]
  s_waitcnt lgkmcnt(4)
  buffer_load_dwordx4 v[202:203], s[16:19], s81 idxen offen  lds
  v_mfma_f32_16x16x32_bf16 v[216:219], v[208:211], v[232:235], 0
  s_add_u32 m0, s51, 24576
  ds_read_b64_tr_b16 v[212:213], v241 offset:4096
  ds_read_b64_tr_b16 v[214:215], v241 offset:4608
  v_exp_f32 v188, v44
  v_mfma_f32_16x16x32_bf16 a[116:119], v[156:159], v[72:75], a[116:119]
  s_add_u32 s32, s32, 1
  buffer_load_dwordx4 v9, s[8:11], s62 offen offset:1024  lds
  v_cvt_pk_bf16_f32 v59, v186, v187
  v_mfma_f32_16x16x32_bf16 a[164:167], v[156:159], v[76:79], a[164:167]
  ds_read_b128 v[152:155], v2 offset:36864
  v_exp_f32 v189, v45
  v_mfma_f32_16x16x32_bf16 a[120:123], v[160:163], v[72:75], a[120:123]
  v_exp_f32 v190, v46
  v_mfma_f32_16x16x32_bf16 a[168:171], v[160:163], v[76:79], a[168:171]
  s_add_u32 m0, s53, 2048
  ds_read_b64_tr_b16 v[176:177], v6 offset:12544
  ds_read_b64_tr_b16 v[178:179], v6 offset:18688
  ds_read_b64_tr_b16 v[180:181], v7 offset:12544
  v_cvt_pk_bf16_f32 v62, v188, v189
  v_mfma_f32_16x16x32_bf16 a[124:127], v[164:167], v[72:75], a[124:127]
  buffer_load_dwordx4 v[204:205], s[16:19], s81 idxen offen  lds
  v_mfma_f32_16x16x32_bf16 a[172:175], v[164:167], v[76:79], a[172:175]
  s_waitcnt lgkmcnt(6)
  ds_read_b64_tr_b16 v[182:183], v7 offset:18688
  ds_read_b128 v[236:239], v245
  v_mfma_f32_16x16x32_bf16 a[128:131], v[168:171], v[72:75], a[128:131]
  s_waitcnt lgkmcnt(6)
  v_exp_f32 v191, v47
  v_mfma_f32_16x16x32_bf16 v[220:223], v[212:215], v[232:235], 0
  s_add_u32 m0, s53, 3072
  ds_read_b64_tr_b16 v[208:209], v242 offset:4096
  v_cvt_pk_bf16_f32 v63, v190, v191
  v_mfma_f32_16x16x32_bf16 a[176:179], v[168:171], v[76:79], a[176:179]
  s_max_u32 s40, s76, s77
  buffer_load_dwordx4 v[206:207], s[16:19], s81 idxen offen  lds
  v_mfma_f32_16x16x32_bf16 v[104:107], v[112:115], v[56:59], v[104:107]
  ds_read_b128 v[156:159], v3 offset:36864
  ds_read_b64_tr_b16 v[210:211], v242 offset:4608
  v_mfma_f32_16x16x32_bf16 v[108:111], v[112:115], v[60:63], v[108:111]
  s_add_u32 m0, s51, 24576
  v_cvt_pk_bf16_f32 v253, v226, v227
  v_cvt_pk_bf16_f32 v254, v228, v229
  v_mfma_f32_16x16x32_bf16 a[132:135], v[172:175], v[72:75], a[132:135]
  ds_read_b128 v[160:163], v2 offset:36992
  v_cvt_pk_bf16_f32 v255, v230, v231
  v_mfma_f32_16x16x32_bf16 a[180:183], v[172:175], v[76:79], a[180:183]
  s_waitcnt lgkmcnt(5)
  buffer_load_dwordx4 v10, s[8:11], s62 offen offset:2048  lds
  v_mfma_f32_16x16x32_bf16 a[136:139], v[176:179], v[72:75], a[136:139]
  ds_read_b128 v[164:167], v3 offset:36992
  ds_read_b64_tr_b16 v[212:213], v243 offset:4096
  v_mfma_f32_16x16x32_bf16 a[184:187], v[176:179], v[76:79], a[184:187]
  s_cmp_ge_u32 s40, s37
  s_cselect_b64 s[66:67], -1, 0
  v_max_f32 v14, v104, v108
  v_mfma_f32_16x16x32_bf16 a[140:143], v[180:183], v[72:75], a[140:143]
  s_waitcnt lgkmcnt(3)
  ds_read_b64_tr_b16 v[214:215], v243 offset:4608
  v_cmp_nge_f32 s[64:65], s50, v14
  v_mfma_f32_16x16x32_bf16 v[224:227], v[208:211], v[232:235], 0
  ds_read_b32 v200, v1 offset:384
  ds_read_b32 v202, v1 offset:416
  v_mfma_f32_16x16x32_bf16 a[188:191], v[180:183], v[76:79], a[188:191]
  buffer_store_dwordx4 v[252:255], v13, s[24:27], s90 offen offset:1024 sc1
  s_or_b64 vcc, s[64:65], s[66:67]
  s_cbranch_vccnz P2V0s2_SLOW
P2V0s2_SLOWB:
  v_mfma_f32_16x16x32_bf16 v[24:27], v[152:155], a[192:195], v[88:91]
  s_add_u32 m0, s52, 0
  ds_read_b128 v[168:171], v2 offset:37120
  ds_read_b32 v204, v1 offset:448
  v_mfma_f32_16x16x32_bf16 v[28:31], v[152:155], a[216:219], v[92:95]
  s_mov_b32 s76, s77
  s_mov_b32 s77, s78
  v_mfma_f32_16x16x32_bf16 v[24:27], v[156:159], a[196:199], v[24:27]
  s_mov_b32 s78, s79
  ds_read_b128 v[172:175], v3 offset:37120
  ds_read_b32 v206, v1 offset:480
  v_mfma_f32_16x16x32_bf16 v[28:31], v[156:159], a[220:223], v[28:31]
  s_waitcnt lgkmcnt(8)
  buffer_load_dwordx4 v8, s[12:15], s63 offen offset:0  lds
  v_mfma_f32_16x16x32_bf16 v[24:27], v[160:163], a[200:203], v[24:27]
  s_mov_b32 s79, s74
  ds_read_b128 v[176:179], v2 offset:43008
  v_mfma_f32_16x16x32_bf16 v[28:31], v[160:163], a[224:227], v[28:31]
  s_waitcnt lgkmcnt(7)
  s_waitcnt vmcnt(11)
  v_add_u32 v245, s88, v245
  v_mfma_f32_16x16x32_bf16 v[228:231], v[212:215], v[232:235], 0
  s_add_u32 m0, s53, 4096
  ds_read_b128 v[180:183], v3 offset:43008
  ds_read_b64_tr_b16 v[208:209], v240 offset:8192
  v_mfma_f32_16x16x32_bf16 v[24:27], v[164:167], a[204:207], v[24:27]
  s_add_u32 s40, s32, 4
  s_waitcnt lgkmcnt(8)
  buffer_load_dwordx4 v[200:201], s[16:19], s81 idxen offen  lds
  v_mfma_f32_16x16x32_bf16 v[28:31], v[164:167], a[228:231], v[28:31]
  s_waitcnt lgkmcnt(4)
  ds_read_b128 v[152:155], v2 offset:43136
  ds_read_b64_tr_b16 v[210:211], v240 offset:8704
  v_mfma_f32_16x16x32_bf16 v[24:27], v[168:171], a[208:211], v[24:27]
  s_add_u32 m0, s52, 0
  v_readlane_b32 s74, v0, s40
  v_mfma_f32_16x16x32_bf16 v[28:31], v[168:171], a[232:235], v[28:31]
  s_mul_i32 s7, s78, 12288
  ds_read_b128 v[156:159], v3 offset:43136
  ds_read_b64_tr_b16 v[212:213], v241 offset:8192
  v_mfma_f32_16x16x32_bf16 v[24:27], v[172:175], a[212:215], v[24:27]
  buffer_load_dwordx4 v9, s[12:15], s63 offen offset:1024  lds
  v_mfma_f32_16x16x32_bf16 v[28:31], v[172:175], a[236:239], v[28:31]
  s_waitcnt lgkmcnt(5)
  s_add_u32 m0, s53, 5120
  ds_read_b128 v[160:163], v2 offset:43264
  v_mfma_f32_16x16x32_bf16 v[40:43], v[176:179], a[192:195], v[192:195]
  s_add_u32 s7, s7, s75
  buffer_load_dwordx4 v[202:203], s[16:19], s81 idxen offen  lds
  v_mfma_f32_16x16x32_bf16 v[44:47], v[176:179], a[216:219], v[196:199]
  s_waitcnt lgkmcnt(3)
  ds_read_b128 v[164:167], v3 offset:43264
  ds_read_b64_tr_b16 v[168:169], v4 offset:24576
  v_mfma_f32_16x16x32_bf16 v[216:219], v[208:211], v[236:239], v[216:219]
  s_add_u32 m0, s53, 6144
  v_exp_f32 v184, v24
  v_mfma_f32_16x16x32_bf16 v[40:43], v[180:183], a[196:199], v[40:43]
  s_mul_i32 s6, s74, 12288
  ds_read_b64_tr_b16 v[170:171], v4 offset:30720
  ds_read_b64_tr_b16 v[214:215], v241 offset:8704
  ds_read_b64_tr_b16 v[208:209], v242 offset:8192
  v_mfma_f32_16x16x32_bf16 v[44:47], v[180:183], a[220:223], v[44:47]
  buffer_load_dwordx4 v[204:205], s[16:19], s81 idxen offen  lds
  v_mfma_f32_16x16x32_bf16 v[40:43], v[152:155], a[200:203], v[40:43]
  s_add_u32 m0, s52, 0
  v_exp_f32 v185, v25
  v_mfma_f32_16x16x32_bf16 v[44:47], v[152:155], a[224:227], v[44:47]
  s_waitcnt lgkmcnt(7)
  s_add_u32 s6, s6, s75
  ds_read_b64_tr_b16 v[172:173], v5 offset:24576
  ds_read_b64_tr_b16 v[174:175], v5 offset:30720
  ds_read_b64_tr_b16 v[176:177], v6 offset:24576
  v_mfma_f32_16x16x32_bf16 v[40:43], v[156:159], a[204:207], v[40:43]
  v_exp_f32 v186, v26
  v_mfma_f32_16x16x32_bf16 v[44:47], v[156:159], a[228:231], v[44:47]
  s_waitcnt lgkmcnt(7)
  ds_read_b64_tr_b16 v[178:179], v6 offset:30720
  buffer_load_dwordx4 v10, s[12:15], s63 offen offset:2048  lds
  v_cvt_pk_bf16_f32 v72, v184, v185
  v_mfma_f32_16x16x32_bf16 v[40:43], v[160:163], a[208:211], v[40:43]
  s_waitcnt lgkmcnt(5)
  ds_read_b64_tr_b16 v[180:181], v7 offset:24576
  v_exp_f32 v187, v27
  v_mfma_f32_16x16x32_bf16 v[220:223], v[212:215], v[236:239], v[220:223]
  ds_read_b64_tr_b16 v[182:183], v7 offset:30720
  ds_read_b64_tr_b16 v[210:211], v242 offset:8704
  v_mfma_f32_16x16x32_bf16 v[44:47], v[160:163], a[232:235], v[44:47]
  s_add_u32 m0, s53, 7168
  ds_read_b64_tr_b16 v[152:153], v4 offset:24704
  v_exp_f32 v188, v28
  v_mfma_f32_16x16x32_bf16 v[40:43], v[164:167], a[212:215], v[40:43]
  s_waitcnt vmcnt(15)
  s_barrier
  ds_read_b64_tr_b16 v[154:155], v4 offset:30848
  v_mfma_f32_16x16x32_bf16 v[44:47], v[164:167], a[236:239], v[44:47]
  ds_read_b64_tr_b16 v[156:157], v5 offset:24704
  ds_read_b64_tr_b16 v[158:159], v5 offset:30848
  buffer_load_dwordx4 v[206:207], s[16:19], s81 idxen offen  lds
  v_mfma_f32_16x16x32_bf16 a[96:99], v[168:171], v[56:59], a[96:99]
  ds_read_b64_tr_b16 v[160:161], v6 offset:24704
  v_cvt_pk_bf16_f32 v73, v186, v187
  v_mfma_f32_16x16x32_bf16 a[144:147], v[168:171], v[60:63], a[144:147]
  s_waitcnt lgkmcnt(10)
  s_add_u32 m0, s51, 36864
  v_exp_f32 v189, v29
  v_mfma_f32_16x16x32_bf16 a[100:103], v[172:175], v[56:59], a[100:103]
  ds_read_b64_tr_b16 v[162:163], v6 offset:30848
  ds_read_b64_tr_b16 v[212:213], v243 offset:8192
  v_exp_f32 v190, v30
  v_mfma_f32_16x16x32_bf16 a[148:151], v[172:175], v[60:63], a[148:151]
  s_waitcnt lgkmcnt(8)
  buffer_load_dwordx4 v8, s[8:11], s6 offen offset:0  lds
  v_cvt_pk_bf16_f32 v76, v188, v189
  v_mfma_f32_16x16x32_bf16 a[104:107], v[176:179], v[56:59], a[104:107]
  s_waitcnt lgkmcnt(7)
  ds_read_b64_tr_b16 v[164:165], v7 offset:24704
  ds_read_b64_tr_b16 v[214:215], v243 offset:8704
  v_mfma_f32_16x16x32_bf16 v[224:227], v[208:211], v[236:239], v[224:227]
  s_add_u32 s32, s32, 1
  v_exp_f32 v191, v31
  v_mfma_f32_16x16x32_bf16 a[152:155], v[176:179], v[60:63], a[152:155]
  s_add_u32 m0, s51, 36864
  ds_read_b64_tr_b16 v[166:167], v7 offset:30848
  ds_read_b64_tr_b16 v[168:169], v4 offset:24832
  v_mfma_f32_16x16x32_bf16 a[108:111], v[180:183], v[56:59], a[108:111]
  buffer_load_dwordx4 v9, s[8:11], s6 offen offset:1024  lds
  v_mfma_f32_16x16x32_bf16 a[156:159], v[180:183], v[60:63], a[156:159]
  s_waitcnt lgkmcnt(7)
  ds_read_b64_tr_b16 v[170:171], v4 offset:30976
  v_cvt_pk_bf16_f32 v77, v190, v191
  v_exp_f32 v184, v40
  v_exp_f32 v185, v41
  v_mfma_f32_16x16x32_bf16 a[112:115], v[152:155], v[56:59], a[112:115]
  ds_read_b64_tr_b16 v[172:173], v5 offset:24832
  v_exp_f32 v186, v42
  v_cvt_pk_bf16_f32 v74, v184, v185
  v_exp_f32 v187, v43
  v_mfma_f32_16x16x32_bf16 a[160:163], v[152:155], v[60:63], a[160:163]
  v_exp_f32 v188, v44
  v_mfma_f32_16x16x32_bf16 a[116:119], v[156:159], v[56:59], a[116:119]
  s_add_u32 m0, s51, 36864
  ds_read_b64_tr_b16 v[174:175], v5 offset:30976
  v_cvt_pk_bf16_f32 v75, v186, v187
  v_mfma_f32_16x16x32_bf16 a[164:167], v[156:159], v[60:63], a[164:167]
  s_waitcnt lgkmcnt(5)
  buffer_load_dwordx4 v10, s[8:11], s6 offen offset:2048  lds
  v_mfma_f32_16x16x32_bf16 v[228:231], v[212:215], v[236:239], v[228:231]
  ds_read_b64_tr_b16 v[176:177], v6 offset:24832
  ds_read_b64_tr_b16 v[178:179], v6 offset:30976
  v_mfma_f32_16x16x32_bf16 a[120:123], v[160:163], v[56:59], a[120:123]
  s_max_u32 s40, s76, s77
  v_exp_f32 v189, v45
  v_mfma_f32_16x16x32_bf16 a[168:171], v[160:163], v[60:63], a[168:171]
  s_waitcnt lgkmcnt(6)
  v_exp_f32 v190, v46
  v_mfma_f32_16x16x32_bf16 a[124:127], v[164:167], v[56:59], a[124:127]
  ds_read_b64_tr_b16 v[180:181], v7 offset:24832
  ds_read_b64_tr_b16 v[182:183], v7 offset:30976
  v_mfma_f32_16x16x32_bf16 a[172:175], v[164:167], v[60:63], a[172:175]
  s_waitcnt lgkmcnt(4)
  v_cvt_pk_bf16_f32 v78, v188, v189
  v_exp_f32 v191, v47
  v_mfma_f32_16x16x32_bf16 a[128:131], v[168:171], v[56:59], a[128:131]
  s_add_u32 m0, s52, 12288
  ds_read_b128 v[152:155], v2 offset:0
  v_cvt_pk_bf16_f32 v79, v190, v191
  v_mfma_f32_16x16x32_bf16 a[176:179], v[168:171], v[60:63], a[176:179]
  buffer_load_dwordx4 v8, s[12:15], s7 offen offset:0  lds
  v_mfma_f32_16x16x32_bf16 v[104:107], v[112:115], v[72:75], v[104:107]
  ds_read_b128 v[156:159], v3 offset:0
  v_mfma_f32_16x16x32_bf16 v[108:111], v[112:115], v[76:79], v[108:111]
  s_cmp_ge_u32 s40, s37
  s_cselect_b64 s[66:67], -1, 0
  v_mfma_f32_16x16x32_bf16 a[132:135], v[172:175], v[56:59], a[132:135]
  s_add_u32 m0, s52, 12288
  v_mfma_f32_16x16x32_bf16 a[180:183], v[172:175], v[60:63], a[180:183]
  s_waitcnt lgkmcnt(2)
  buffer_load_dwordx4 v9, s[12:15], s7 offen offset:1024  lds
  v_mfma_f32_16x16x32_bf16 a[136:139], v[176:179], v[56:59], a[136:139]
  s_add_u32 m0, s52, 12288
  ds_read_b128 v[160:163], v2 offset:128
  v_mfma_f32_16x16x32_bf16 a[184:187], v[176:179], v[60:63], a[184:187]
  v_max_f32 v14, v104, v108
  v_mfma_f32_16x16x32_bf16 a[140:143], v[180:183], v[56:59], a[140:143]
  ds_read_b128 v[164:167], v3 offset:128
  v_cmp_nge_f32 s[64:65], s50, v14
  v_mfma_f32_16x16x32_bf16 a[188:191], v[180:183], v[60:63], a[188:191]
  buffer_load_dwordx4 v10, s[12:15], s7 offen offset:2048  lds
  s_or_b64 vcc, s[64:65], s[66:67]
  s_cbranch_vccnz P2V0s3_SLOW
P2V0s3_SLOWB:
  s_add_u32 s33, s33, 1
  s_branch P2V1
.p2align 6
P2V1:
  s_waitcnt lgkmcnt(2)
  v_mfma_f32_16x16x32_bf16 v[24:27], v[152:155], a[192:195], v[88:91]
  ds_read_b128 v[168:171], v2 offset:256
  ds_read_b128 v[172:175], v3 offset:256
  ds_read_b128 v[176:179], v2 offset:6144
  v_add_u32 v1, s85, v1
  v_mfma_f32_16x16x32_bf16 v[28:31], v[152:155], a[216:219], v[92:95]
  s_mov_b32 s76, s77
  ds_read_b32 v200, v1 offset:0
  ds_read_b32 v202, v1 offset:32
  v_mfma_f32_16x16x32_bf16 v[24:27], v[156:159], a[196:199], v[24:27]
  s_mov_b32 s77, s78
  ds_read_b32 v204, v1 offset:64
  ds_read_b32 v206, v1 offset:96
  v_mfma_f32_16x16x32_bf16 v[28:31], v[156:159], a[220:223], v[28:31]
  s_waitcnt lgkmcnt(7)
  s_mov_b32 s78, s79
  s_mov_b32 s79, s74
  v_mfma_f32_16x16x32_bf16 v[24:27], v[160:163], a[200:203], v[24:27]
  s_waitcnt vmcnt(15)
  s_add_u32 s40, s32, 4
  ds_read_b128 v[232:235], v246
  v_mfma_f32_16x16x32_bf16 v[28:31], v[160:163], a[224:227], v[28:31]
  ds_read_b128 v[180:183], v3 offset:6144
  v_readlane_b32 s74, v0, s40
  v_mfma_f32_16x16x32_bf16 v[24:27], v[164:167], a[204:207], v[24:27]
  s_add_u32 m0, s53, 8192
  ds_read_b64_tr_b16 v[208:209], v240 offset:0
  ds_read_b64_tr_b16 v[210:211], v240 offset:512
  v_mfma_f32_16x16x32_bf16 v[28:31], v[164:167], a[228:231], v[28:31]
  s_waitcnt lgkmcnt(7)
  buffer_load_dwordx4 v[200:201], s[16:19], s82 idxen offen  lds
  v_mfma_f32_16x16x32_bf16 v[24:27], v[168:171], a[208:211], v[24:27]
  s_add_u32 m0, s53, 9216
  ds_read_b128 v[152:155], v2 offset:6272
  ds_read_b64_tr_b16 v[212:213], v241 offset:0
  v_mfma_f32_16x16x32_bf16 v[28:31], v[168:171], a[232:235], v[28:31]
  v_add_u32 v246, s88, v246
  v_mfma_f32_16x16x32_bf16 v[24:27], v[172:175], a[212:215], v[24:27]
  ds_read_b128 v[156:159], v3 offset:6272
  ds_read_b64_tr_b16 v[214:215], v241 offset:512
  v_mfma_f32_16x16x32_bf16 v[28:31], v[172:175], a[236:239], v[28:31]
  s_mul_i32 s63, s78, 12288
  s_add_u32 s63, s63, s75
  v_mfma_f32_16x16x32_bf16 v[40:43], v[176:179], a[192:195], v[192:195]
  ds_read_b128 v[160:163], v2 offset:6400
  ds_read_b64_tr_b16 v[168:169], v4 offset:36864
  v_mfma_f32_16x16x32_bf16 v[44:47], v[176:179], a[216:219], v[196:199]
  s_waitcnt lgkmcnt(6)
  s_waitcnt lgkmcnt(12)
  buffer_load_dwordx4 v[202:203], s[16:19], s82 idxen offen  lds
  v_mfma_f32_16x16x32_bf16 v[216:219], v[208:211], v[232:235], v[216:219]
  s_add_u32 m0, s53, 10240
  ds_read_b128 v[164:167], v3 offset:6400
  ds_read_b64_tr_b16 v[170:171], v4 offset:43008
  v_mfma_f32_16x16x32_bf16 v[40:43], v[180:183], a[196:199], v[40:43]
  s_mul_i32 s62, s74, 12288
  v_exp_f32 v184, v24
  v_mfma_f32_16x16x32_bf16 v[44:47], v[180:183], a[220:223], v[44:47]
  s_waitcnt lgkmcnt(5)
  ds_read_b64_tr_b16 v[172:173], v5 offset:36864
  ds_read_b64_tr_b16 v[174:175], v5 offset:43008
  ds_read_b64_tr_b16 v[176:177], v6 offset:36864
  v_exp_f32 v185, v25
  v_mfma_f32_16x16x32_bf16 v[40:43], v[152:155], a[200:203], v[40:43]
  s_add_u32 s62, s62, s75
  v_exp_f32 v186, v26
  v_mfma_f32_16x16x32_bf16 v[44:47], v[152:155], a[224:227], v[44:47]
  ds_read_b64_tr_b16 v[178:179], v6 offset:43008
  ds_read_b64_tr_b16 v[180:181], v7 offset:36864
  ds_read_b64_tr_b16 v[208:209], v242 offset:0
  v_cvt_pk_bf16_f32 v56, v184, v185
  v_mfma_f32_16x16x32_bf16 v[40:43], v[156:159], a[204:207], v[40:43]
  buffer_load_dwordx4 v[204:205], s[16:19], s82 idxen offen  lds
  v_mfma_f32_16x16x32_bf16 v[44:47], v[156:159], a[228:231], v[44:47]
  s_waitcnt lgkmcnt(7)
  ds_read_b64_tr_b16 v[182:183], v7 offset:43008
  ds_read_b64_tr_b16 v[152:153], v4 offset:36992
  v_exp_f32 v187, v27
  v_exp_f32 v188, v28
  v_mfma_f32_16x16x32_bf16 v[40:43], v[160:163], a[208:211], v[40:43]
  ds_read_b64_tr_b16 v[154:155], v4 offset:43136
  v_cvt_pk_bf16_f32 v57, v186, v187
  v_mfma_f32_16x16x32_bf16 v[220:223], v[212:215], v[232:235], v[220:223]
  s_add_u32 m0, s53, 11264
  ds_read_b64_tr_b16 v[156:157], v5 offset:36992
  ds_read_b64_tr_b16 v[158:159], v5 offset:43136
  v_mfma_f32_16x16x32_bf16 v[44:47], v[160:163], a[232:235], v[44:47]
  ds_read_b64_tr_b16 v[210:211], v242 offset:512
  v_exp_f32 v189, v29
  v_exp_f32 v190, v30
  v_mfma_f32_16x16x32_bf16 v[40:43], v[164:167], a[212:215], v[40:43]
  s_waitcnt vmcnt(10)
  s_barrier
  ds_read_b64_tr_b16 v[160:161], v6 offset:36992
  ds_read_b64_tr_b16 v[162:163], v6 offset:43136
  v_mfma_f32_16x16x32_bf16 v[44:47], v[164:167], a[236:239], v[44:47]
  s_waitcnt lgkmcnt(12)
  ds_read_b64_tr_b16 v[212:213], v243 offset:0
  v_cvt_pk_bf16_f32 v60, v188, v189
  v_mfma_f32_16x16x32_bf16 a[96:99], v[168:171], v[72:75], a[96:99]
  ds_read_b128 v[236:239], v247
  buffer_load_dwordx4 v[206:207], s[16:19], s82 idxen offen  lds
  v_mfma_f32_16x16x32_bf16 a[144:147], v[168:171], v[76:79], a[144:147]
  s_add_u32 m0, s51, 0
  v_exp_f32 v191, v31
  v_mfma_f32_16x16x32_bf16 a[100:103], v[172:175], v[72:75], a[100:103]
  ds_read_b64_tr_b16 v[164:165], v7 offset:36992
  ds_read_b32 v200, v1 offset:128
  v_mfma_f32_16x16x32_bf16 a[148:151], v[172:175], v[76:79], a[148:151]
  s_waitcnt lgkmcnt(11)
  ds_read_b32 v202, v1 offset:160
  v_cvt_pk_bf16_f32 v61, v190, v191
  v_mfma_f32_16x16x32_bf16 a[104:107], v[176:179], v[72:75], a[104:107]
  s_waitcnt lgkmcnt(7)
  v_exp_f32 v184, v40
  v_mfma_f32_16x16x32_bf16 v[224:227], v[208:211], v[232:235], v[224:227]
  ds_read_b64_tr_b16 v[166:167], v7 offset:43136
  ds_read_b64_tr_b16 v[168:169], v4 offset:37120
  ds_read_b64_tr_b16 v[214:215], v243 offset:512
  v_mfma_f32_16x16x32_bf16 a[152:155], v[176:179], v[76:79], a[152:155]
  buffer_load_dwordx4 v8, s[8:11], s62 offen offset:0  lds
  v_mfma_f32_16x16x32_bf16 a[108:111], v[180:183], v[72:75], a[108:111]
  ds_read_b32 v204, v1 offset:192
  ds_read_b32 v206, v1 offset:224
  v_exp_f32 v185, v41
  v_mfma_f32_16x16x32_bf16 a[156:159], v[180:183], v[76:79], a[156:159]
  ds_read_b64_tr_b16 v[170:171], v4 offset:43264
  v_exp_f32 v186, v42
  v_mfma_f32_16x16x32_bf16 a[112:115], v[152:155], v[72:75], a[112:115]
  s_add_u32 s32, s32, 1
  ds_read_b64_tr_b16 v[172:173], v5 offset:37120
  v_cvt_pk_bf16_f32 v58, v184, v185
  v_mfma_f32_16x16x32_bf16 a[160:163], v[152:155], v[76:79], a[160:163]
  v_exp_f32 v187, v43
  v_exp_f32 v188, v44
  v_mfma_f32_16x16x32_bf16 a[116:119], v[156:159], v[72:75], a[116:119]
  s_add_u32 m0, s51, 0
  ds_read_b64_tr_b16 v[174:175], v5 offset:43264
  v_cvt_pk_bf16_f32 v59, v186, v187
  v_mfma_f32_16x16x32_bf16 a[164:167], v[156:159], v[76:79], a[164:167]
  s_waitcnt lgkmcnt(5)
  s_waitcnt vmcnt(11)
  buffer_load_dwordx4 v9, s[8:11], s62 offen offset:1024  lds
  v_mfma_f32_16x16x32_bf16 v[228:231], v[212:215], v[232:235], v[228:231]
  ds_read_b64_tr_b16 v[176:177], v6 offset:37120
  ds_read_b64_tr_b16 v[178:179], v6 offset:43264
  v_mfma_f32_16x16x32_bf16 a[120:123], v[160:163], v[72:75], a[120:123]
  v_exp_f32 v189, v45
  v_mfma_f32_16x16x32_bf16 a[168:171], v[160:163], v[76:79], a[168:171]
  s_add_u32 m0, s53, 0
  ds_read_b64_tr_b16 v[208:209], v240 offset:4096
  ds_read_b64_tr_b16 v[210:211], v240 offset:4608
  v_mfma_f32_16x16x32_bf16 a[124:127], v[164:167], v[72:75], a[124:127]
  s_max_u32 s40, s76, s77
  buffer_load_dwordx4 v[200:201], s[16:19], s82 idxen offen  lds
  v_exp_f32 v190, v46
  v_cvt_pk_bf16_f32 v62, v188, v189
  v_mfma_f32_16x16x32_bf16 a[172:175], v[164:167], v[76:79], a[172:175]
  s_waitcnt lgkmcnt(4)
  ds_read_b64_tr_b16 v[180:181], v7 offset:37120
  v_exp_f32 v191, v47
  v_mfma_f32_16x16x32_bf16 a[128:131], v[168:171], v[72:75], a[128:131]
  ds_read_b64_tr_b16 v[182:183], v7 offset:43264
  v_cvt_pk_bf16_f32 v63, v190, v191
  v_mfma_f32_16x16x32_bf16 a[176:179], v[168:171], v[76:79], a[176:179]
  s_add_u32 m0, s53, 1024
  ds_read_b128 v[152:155], v2 offset:12288
  v_mfma_f32_16x16x32_bf16 v[104:107], v[112:115], v[56:59], v[104:107]
  buffer_load_dwordx4 v[202:203], s[16:19], s82 idxen offen  lds
  v_mfma_f32_16x16x32_bf16 v[108:111], v[112:115], v[60:63], v[108:111]
  s_waitcnt lgkmcnt(3)
  ds_read_b128 v[156:159], v3 offset:12288
  ds_read_b64_tr_b16 v[212:213], v241 offset:4096
  v_mfma_f32_16x16x32_bf16 v[216:219], v[208:211], v[236:239], v[216:219]
  s_cmp_ge_u32 s40, s37
  s_cselect_b64 s[66:67], -1, 0
  v_add_u32 v247, s88, v247
  v_mfma_f32_16x16x32_bf16 a[132:135], v[172:175], v[72:75], a[132:135]
  s_add_u32 m0, s51, 0
  ds_read_b128 v[160:163], v2 offset:12416
  ds_read_b64_tr_b16 v[214:215], v241 offset:4608
  v_mfma_f32_16x16x32_bf16 a[180:183], v[172:175], v[76:79], a[180:183]
  buffer_load_dwordx4 v10, s[8:11], s62 offen offset:2048  lds
  v_mfma_f32_16x16x32_bf16 a[136:139], v[176:179], v[72:75], a[136:139]
  ds_read_b128 v[164:167], v3 offset:12416
  ds_read_b64_tr_b16 v[208:209], v242 offset:4096
  v_mfma_f32_16x16x32_bf16 a[184:187], v[176:179], v[76:79], a[184:187]
  s_waitcnt lgkmcnt(7)
  v_max_f32 v14, v104, v108
  v_cmp_nge_f32 s[64:65], s50, v14
  v_mfma_f32_16x16x32_bf16 a[140:143], v[180:183], v[72:75], a[140:143]
  s_add_u32 m0, s53, 2048
  ds_read_b64_tr_b16 v[210:211], v242 offset:4608
  ds_read_b128 v[232:235], v244
  v_mfma_f32_16x16x32_bf16 a[188:191], v[180:183], v[76:79], a[188:191]
  s_waitcnt lgkmcnt(7)
  buffer_load_dwordx4 v[204:205], s[16:19], s82 idxen offen  lds
  s_or_b64 vcc, s[64:65], s[66:67]
  s_cbranch_vccnz P2V1s0_SLOW
P2V1s0_SLOWB:
  v_mfma_f32_16x16x32_bf16 v[24:27], v[152:155], a[192:195], v[88:91]
  s_waitcnt lgkmcnt(4)
  ds_read_b128 v[168:171], v2 offset:12544
  v_cvt_pk_bf16_f32 v248, v216, v217
  v_mfma_f32_16x16x32_bf16 v[220:223], v[212:215], v[236:239], v[220:223]
  s_add_u32 m0, s53, 3072
  v_add_u32 v244, s89, v244
  v_cvt_pk_bf16_f32 v249, v218, v219
  v_mfma_f32_16x16x32_bf16 v[28:31], v[152:155], a[216:219], v[92:95]
  s_mov_b32 s76, s77
  ds_read_b128 v[172:175], v3 offset:12544
  ds_read_b64_tr_b16 v[212:213], v243 offset:4096
  v_mfma_f32_16x16x32_bf16 v[24:27], v[156:159], a[196:199], v[24:27]
  s_mov_b32 s77, s78
  buffer_load_dwordx4 v[206:207], s[16:19], s82 idxen offen  lds
  v_mfma_f32_16x16x32_bf16 v[28:31], v[156:159], a[220:223], v[28:31]
  ds_read_b128 v[176:179], v2 offset:18432
  ds_read_b64_tr_b16 v[214:215], v243 offset:4608
  v_mfma_f32_16x16x32_bf16 v[24:27], v[160:163], a[200:203], v[24:27]
  s_mov_b32 s78, s79
  v_cvt_pk_bf16_f32 v250, v220, v221
  v_cvt_pk_bf16_f32 v251, v222, v223
  v_mfma_f32_16x16x32_bf16 v[28:31], v[160:163], a[224:227], v[28:31]
  s_waitcnt lgkmcnt(8)
  s_add_u32 m0, s52, 24576
  ds_read_b128 v[180:183], v3 offset:18432
  ds_read_b32 v200, v1 offset:256
  v_mfma_f32_16x16x32_bf16 v[24:27], v[164:167], a[204:207], v[24:27]
  buffer_load_dwordx4 v8, s[12:15], s63 offen offset:0  lds
  v_mfma_f32_16x16x32_bf16 v[28:31], v[164:167], a[228:231], v[28:31]
  s_waitcnt lgkmcnt(5)
  ds_read_b128 v[152:155], v2 offset:18560
  ds_read_b32 v202, v1 offset:288
  v_mfma_f32_16x16x32_bf16 v[24:27], v[168:171], a[208:211], v[24:27]
  buffer_store_dwordx4 v[248:251], v13, s[24:27], s91 offen offset:0 sc1
  v_mfma_f32_16x16x32_bf16 v[224:227], v[208:211], v[236:239], v[224:227]
  s_add_u32 m0, s52, 24576
  ds_read_b128 v[156:159], v3 offset:18560
  ds_read_b32 v204, v1 offset:320
  v_mfma_f32_16x16x32_bf16 v[28:31], v[168:171], a[232:235], v[28:31]
  s_mov_b32 s79, s74
  buffer_load_dwordx4 v9, s[12:15], s63 offen offset:1024  lds
  v_mfma_f32_16x16x32_bf16 v[24:27], v[172:175], a[212:215], v[24:27]
  s_add_u32 s40, s32, 4
  ds_read_b64_tr_b16 v[168:169], v4 offset:0
  ds_read_b64_tr_b16 v[170:171], v4 offset:6144
  v_mfma_f32_16x16x32_bf16 v[28:31], v[172:175], a[236:239], v[28:31]
  s_waitcnt lgkmcnt(7)
  ds_read_b32 v206, v1 offset:352
  v_readlane_b32 s74, v0, s40
  v_mfma_f32_16x16x32_bf16 v[40:43], v[176:179], a[192:195], v[192:195]
  s_add_u32 m0, s52, 24576
  ds_read_b128 v[160:163], v2 offset:18688
  v_cvt_pk_bf16_f32 v252, v224, v225
  v_mfma_f32_16x16x32_bf16 v[44:47], v[176:179], a[216:219], v[196:199]
  s_mul_i32 s7, s78, 12288
  ds_read_b64_tr_b16 v[172:173], v5 offset:0
  buffer_load_dwordx4 v10, s[12:15], s63 offen offset:2048  lds
  v_mfma_f32_16x16x32_bf16 v[40:43], v[180:183], a[196:199], v[40:43]
  s_add_u32 s7, s7, s75
  ds_read_b128 v[164:167], v3 offset:18688
  v_exp_f32 v184, v24
  v_mfma_f32_16x16x32_bf16 v[44:47], v[180:183], a[220:223], v[44:47]
  s_waitcnt vmcnt(11)
  ds_read_b64_tr_b16 v[174:175], v5 offset:6144
  v_mfma_f32_16x16x32_bf16 v[228:231], v[212:215], v[236:239], v[228:231]
  s_waitcnt lgkmcnt(8)
  ds_read_b64_tr_b16 v[176:177], v6 offset:0
  ds_read_b64_tr_b16 v[208:209], v240 offset:8192
  v_mfma_f32_16x16x32_bf16 v[40:43], v[152:155], a[200:203], v[40:43]
  s_mul_i32 s6, s74, 12288
  ds_read_b64_tr_b16 v[210:211], v240 offset:8704
  v_exp_f32 v185, v25
  v_mfma_f32_16x16x32_bf16 v[44:47], v[152:155], a[224:227], v[44:47]
  s_add_u32 s6, s6, s75
  ds_read_b64_tr_b16 v[178:179], v6 offset:6144
  v_exp_f32 v186, v26
  v_mfma_f32_16x16x32_bf16 v[40:43], v[156:159], a[204:207], v[40:43]
  s_add_u32 m0, s53, 4096
  ds_read_b64_tr_b16 v[180:181], v7 offset:0
  ds_read_b64_tr_b16 v[212:213], v241 offset:8192
  v_mfma_f32_16x16x32_bf16 v[44:47], v[156:159], a[228:231], v[44:47]
  s_waitcnt lgkmcnt(7)
  ds_read_b64_tr_b16 v[182:183], v7 offset:6144
  buffer_load_dwordx4 v[200:201], s[16:19], s82 idxen offen  lds
  v_cvt_pk_bf16_f32 v72, v184, v185
  v_exp_f32 v187, v27
  v_mfma_f32_16x16x32_bf16 v[40:43], v[160:163], a[208:211], v[40:43]
  s_add_u32 s32, s32, 1
  ds_read_b64_tr_b16 v[152:153], v4 offset:128
  v_exp_f32 v188, v28
  v_mfma_f32_16x16x32_bf16 v[44:47], v[160:163], a[232:235], v[44:47]
  s_add_u32 m0, s53, 5120
  ds_read_b64_tr_b16 v[154:155], v4 offset:6272
  ds_read_b64_tr_b16 v[156:157], v5 offset:128
  v_mfma_f32_16x16x32_bf16 v[40:43], v[164:167], a[212:215], v[40:43]
  s_waitcnt vmcnt(16)
  s_barrier
  v_cvt_pk_bf16_f32 v73, v186, v187
  v_exp_f32 v189, v29
  v_mfma_f32_16x16x32_bf16 v[44:47], v[164:167], a[236:239], v[44:47]
  s_waitcnt lgkmcnt(7)
  ds_read_b64_tr_b16 v[158:159], v5 offset:6272
  buffer_load_dwordx4 v[202:203], s[16:19], s82 idxen offen  lds
  v_exp_f32 v190, v30
  v_mfma_f32_16x16x32_bf16 v[216:219], v[208:211], v[232:235], 0
  ds_read_b64_tr_b16 v[160:161], v6 offset:128
  ds_read_b64_tr_b16 v[214:215], v241 offset:8704
  v_mfma_f32_16x16x32_bf16 a[96:99], v[168:171], v[56:59], a[96:99]
  v_cvt_pk_bf16_f32 v76, v188, v189
  v_cvt_pk_bf16_f32 v253, v226, v227
  v_mfma_f32_16x16x32_bf16 a[144:147], v[168:171], v[60:63], a[144:147]
  ds_read_b64_tr_b16 v[162:163], v6 offset:6272
  ds_read_b64_tr_b16 v[164:165], v7 offset:128
  ds_read_b64_tr_b16 v[208:209], v242 offset:8192
  v_mfma_f32_16x16x32_bf16 a[100:103], v[172:175], v[56:59], a[100:103]
  s_add_u32 m0, s53, 6144
  v_exp_f32 v191, v31
  v_mfma_f32_16x16x32_bf16 a[148:151], v[172:175], v[60:63], a[148:151]
  s_waitcnt lgkmcnt(9)
  buffer_load_dwordx4 v[204:205], s[16:19], s82 idxen offen  lds
  v_mfma_f32_16x16x32_bf16 a[104:107], v[176:179], v[56:59], a[104:107]
  s_add_u32 m0, s51, 12288
  ds_read_b128 v[236:239], v245
  v_cvt_pk_bf16_f32 v77, v190, v191
  v_exp_f32 v184, v40
  v_mfma_f32_16x16x32_bf16 a[152:155], v[176:179], v[60:63], a[152:155]
  ds_read_b64_tr_b16 v[166:167], v7 offset:6272
  v_exp_f32 v185, v41
  v_exp_f32 v186, v42
  v_mfma_f32_16x16x32_bf16 a[108:111], v[180:183], v[56:59], a[108:111]
  s_waitcnt lgkmcnt(5)
  ds_read_b64_tr_b16 v[168:169], v4 offset:256
  ds_read_b64_tr_b16 v[210:211], v242 offset:8704
  v_mfma_f32_16x16x32_bf16 v[220:223], v[212:215], v[232:235], 0
  ds_read_b64_tr_b16 v[170:171], v4 offset:6400
  buffer_load_dwordx4 v8, s[8:11], s6 offen offset:0  lds
  v_mfma_f32_16x16x32_bf16 a[156:159], v[180:183], v[60:63], a[156:159]
  ds_read_b64_tr_b16 v[172:173], v5 offset:256
  v_cvt_pk_bf16_f32 v74, v184, v185
  v_exp_f32 v187, v43
  v_mfma_f32_16x16x32_bf16 a[112:115], v[152:155], v[56:59], a[112:115]
  v_exp_f32 v188, v44
  v_mfma_f32_16x16x32_bf16 a[160:163], v[152:155], v[60:63], a[160:163]
  s_add_u32 m0, s53, 7168
  ds_read_b64_tr_b16 v[174:175], v5 offset:6400
  ds_read_b64_tr_b16 v[176:177], v6 offset:256
  v_mfma_f32_16x16x32_bf16 a[116:119], v[156:159], v[56:59], a[116:119]
  ds_read_b64_tr_b16 v[178:179], v6 offset:6400
  buffer_load_dwordx4 v[206:207], s[16:19], s82 idxen offen  lds
  v_mfma_f32_16x16x32_bf16 a[164:167], v[156:159], v[60:63], a[164:167]
  s_waitcnt lgkmcnt(7)
  ds_read_b128 v[152:155], v2 offset:24576
  v_cvt_pk_bf16_f32 v75, v186, v187
  v_mfma_f32_16x16x32_bf16 a[120:123], v[160:163], v[56:59], a[120:123]
  s_add_u32 m0, s51, 12288
  ds_read_b64_tr_b16 v[180:181], v7 offset:256
  v_exp_f32 v189, v45
  v_mfma_f32_16x16x32_bf16 a[168:171], v[160:163], v[60:63], a[168:171]
  ds_read_b32 v200, v1 offset:384
  v_exp_f32 v190, v46
  v_mfma_f32_16x16x32_bf16 a[124:127], v[164:167], v[56:59], a[124:127]
  s_waitcnt lgkmcnt(8)
  ds_read_b64_tr_b16 v[212:213], v243 offset:8192
  buffer_load_dwordx4 v9, s[8:11], s6 offen offset:1024  lds
  v_cvt_pk_bf16_f32 v78, v188, v189
  v_mfma_f32_16x16x32_bf16 v[224:227], v[208:211], v[232:235], 0
  s_max_u32 s40, s76, s77
  v_exp_f32 v191, v47
  v_mfma_f32_16x16x32_bf16 a[172:175], v[164:167], v[60:63], a[172:175]
  s_waitcnt lgkmcnt(6)
  ds_read_b64_tr_b16 v[182:183], v7 offset:6400
  ds_read_b64_tr_b16 v[214:215], v243 offset:8704
  v_mfma_f32_16x16x32_bf16 a[128:131], v[168:171], v[56:59], a[128:131]
  s_add_u32 m0, s51, 12288
  ds_read_b32 v202, v1 offset:416
  v_cvt_pk_bf16_f32 v79, v190, v191
  v_mfma_f32_16x16x32_bf16 a[176:179], v[168:171], v[60:63], a[176:179]
  ds_read_b32 v204, v1 offset:448
  ds_read_b32 v206, v1 offset:480
  v_mfma_f32_16x16x32_bf16 v[104:107], v[112:115], v[72:75], v[104:107]
  buffer_load_dwordx4 v10, s[8:11], s6 offen offset:2048  lds
  v_mfma_f32_16x16x32_bf16 v[108:111], v[112:115], v[76:79], v[108:111]
  ds_read_b128 v[156:159], v3 offset:24576
  v_cvt_pk_bf16_f32 v254, v228, v229
  v_mfma_f32_16x16x32_bf16 a[132:135], v[172:175], v[56:59], a[132:135]
  v_cvt_pk_bf16_f32 v255, v230, v231
  v_mfma_f32_16x16x32_bf16 a[180:183], v[172:175], v[60:63], a[180:183]
  s_waitcnt lgkmcnt(4)
  s_waitcnt vmcnt(11)
  ds_read_b128 v[160:163], v2 offset:24704
  v_mfma_f32_16x16x32_bf16 v[228:231], v[212:215], v[232:235], 0
  buffer_store_dwordx4 v[252:255], v13, s[24:27], s91 offen offset:1024 sc1
  v_mfma_f32_16x16x32_bf16 a[136:139], v[176:179], v[56:59], a[136:139]
  ds_read_b64_tr_b16 v[208:209], v240 offset:0
  v_max_f32 v14, v104, v108
  v_mfma_f32_16x16x32_bf16 a[184:187], v[176:179], v[60:63], a[184:187]
  s_add_u32 m0, s53, 8192
  ds_read_b64_tr_b16 v[210:211], v240 offset:512
  v_cmp_nge_f32 s[64:65], s50, v14
  v_mfma_f32_16x16x32_bf16 a[140:143], v[180:183], v[56:59], a[140:143]
  s_cmp_ge_u32 s40, s37
  s_cselect_b64 s[66:67], -1, 0
  ds_read_b128 v[164:167], v3 offset:24704
  v_mfma_f32_16x16x32_bf16 a[188:191], v[180:183], v[60:63], a[188:191]
  buffer_load_dwordx4 v[200:201], s[16:19], s82 idxen offen  lds
  s_or_b64 vcc, s[64:65], s[66:67]
  s_cbranch_vccnz P2V1s1_SLOW
P2V1s1_SLOWB:
  v_mfma_f32_16x16x32_bf16 v[24:27], v[152:155], a[192:195], v[88:91]
  s_add_u32 m0, s52, 36864
  ds_read_b128 v[168:171], v2 offset:24832
  ds_read_b64_tr_b16 v[212:213], v241 offset:0
  v_mfma_f32_16x16x32_bf16 v[28:31], v[152:155], a[216:219], v[92:95]
  s_waitcnt lgkmcnt(6)
  s_mov_b32 s76, s77
  v_mfma_f32_16x16x32_bf16 v[24:27], v[156:159], a[196:199], v[24:27]
  s_mov_b32 s77, s78
  ds_read_b128 v[172:175], v3 offset:24832
  ds_read_b64_tr_b16 v[214:215], v241 offset:512
  v_mfma_f32_16x16x32_bf16 v[28:31], v[156:159], a[220:223], v[28:31]
  s_waitcnt lgkmcnt(5)
  buffer_load_dwordx4 v8, s[12:15], s7 offen offset:0  lds
  v_mfma_f32_16x16x32_bf16 v[216:219], v[208:211], v[236:239], v[216:219]
  ds_read_b128 v[176:179], v2 offset:30720
  ds_read_b64_tr_b16 v[208:209], v242 offset:0
  v_mfma_f32_16x16x32_bf16 v[24:27], v[160:163], a[200:203], v[24:27]
  s_mov_b32 s78, s79
  s_mov_b32 s79, s74
  s_add_u32 m0, s53, 9216
  v_mfma_f32_16x16x32_bf16 v[28:31], v[160:163], a[224:227], v[28:31]
  s_waitcnt lgkmcnt(6)
  ds_read_b128 v[180:183], v3 offset:30720
  ds_read_b64_tr_b16 v[210:211], v242 offset:512
  v_mfma_f32_16x16x32_bf16 v[24:27], v[164:167], a[204:207], v[24:27]
  buffer_load_dwordx4 v[202:203], s[16:19], s82 idxen offen  lds
  v_mfma_f32_16x16x32_bf16 v[28:31], v[164:167], a[228:231], v[28:31]
  s_waitcnt lgkmcnt(5)
  s_add_u32 s40, s32, 4
  ds_read_b128 v[152:155], v2 offset:30848
  v_mfma_f32_16x16x32_bf16 v[24:27], v[168:171], a[208:211], v[24:27]
  s_add_u32 m0, s53, 10240
  v_readlane_b32 s74, v0, s40
  v_add_u32 v245, s89, v245
  v_mfma_f32_16x16x32_bf16 v[28:31], v[168:171], a[232:235], v[28:31]
  s_mul_i32 s63, s78, 12288
  ds_read_b128 v[156:159], v3 offset:30848
  ds_read_b64_tr_b16 v[168:169], v4 offset:12288
  v_mfma_f32_16x16x32_bf16 v[24:27], v[172:175], a[212:215], v[24:27]
  s_waitcnt lgkmcnt(7)
  buffer_load_dwordx4 v[204:205], s[16:19], s82 idxen offen  lds
  v_mfma_f32_16x16x32_bf16 v[220:223], v[212:215], v[236:239], v[220:223]
  s_add_u32 m0, s52, 36864
  ds_read_b128 v[160:163], v2 offset:30976
  ds_read_b64_tr_b16 v[170:171], v4 offset:18432
  v_mfma_f32_16x16x32_bf16 v[28:31], v[172:175], a[236:239], v[28:31]
  s_waitcnt lgkmcnt(6)
  buffer_load_dwordx4 v9, s[12:15], s7 offen offset:1024  lds
  v_mfma_f32_16x16x32_bf16 v[40:43], v[176:179], a[192:195], v[192:195]
  s_add_u32 m0, s53, 11264
  ds_read_b128 v[164:167], v3 offset:30976
  ds_read_b64_tr_b16 v[172:173], v5 offset:12288
  v_mfma_f32_16x16x32_bf16 v[44:47], v[176:179], a[216:219], v[196:199]
  v_exp_f32 v184, v24
  v_exp_f32 v185, v25
  v_mfma_f32_16x16x32_bf16 v[40:43], v[180:183], a[196:199], v[40:43]
  s_add_u32 s63, s63, s75
  ds_read_b128 v[232:235], v246
  buffer_load_dwordx4 v[206:207], s[16:19], s82 idxen offen  lds
  v_mfma_f32_16x16x32_bf16 v[44:47], v[180:183], a[220:223], v[44:47]
  s_waitcnt lgkmcnt(6)
  ds_read_b64_tr_b16 v[174:175], v5 offset:18432
  v_add_u32 v1, s86, v1
  v_mfma_f32_16x16x32_bf16 v[40:43], v[152:155], a[200:203], v[40:43]
  ds_read_b64_tr_b16 v[176:177], v6 offset:12288
  ds_read_b64_tr_b16 v[212:213], v243 offset:0
  v_mfma_f32_16x16x32_bf16 v[44:47], v[152:155], a[224:227], v[44:47]
  s_add_u32 m0, s52, 36864
  ds_read_b64_tr_b16 v[178:179], v6 offset:18432
  v_exp_f32 v186, v26
  v_mfma_f32_16x16x32_bf16 v[40:43], v[156:159], a[204:207], v[40:43]
  ds_read_b64_tr_b16 v[180:181], v7 offset:12288
  ds_read_b64_tr_b16 v[214:215], v243 offset:512
  buffer_load_dwordx4 v10, s[12:15], s7 offen offset:2048  lds
  v_mfma_f32_16x16x32_bf16 v[224:227], v[208:211], v[236:239], v[224:227]
  ds_read_b64_tr_b16 v[182:183], v7 offset:18432
  v_cvt_pk_bf16_f32 v56, v184, v185
  v_mfma_f32_16x16x32_bf16 v[44:47], v[156:159], a[228:231], v[44:47]
  s_waitcnt lgkmcnt(9)
  ds_read_b64_tr_b16 v[152:153], v4 offset:12416
  ds_read_b32 v200, v1 offset:0
  v_mfma_f32_16x16x32_bf16 v[40:43], v[160:163], a[208:211], v[40:43]
  s_mul_i32 s62, s74, 12288
  ds_read_b32 v202, v1 offset:32
  v_exp_f32 v187, v27
  v_mfma_f32_16x16x32_bf16 v[44:47], v[160:163], a[232:235], v[44:47]
  s_add_u32 s62, s62, s75
  ds_read_b32 v204, v1 offset:64
  ds_read_b32 v206, v1 offset:96
  v_mfma_f32_16x16x32_bf16 v[40:43], v[164:167], a[212:215], v[40:43]
  s_waitcnt vmcnt(15)
  s_barrier
  ds_read_b64_tr_b16 v[154:155], v4 offset:18560
  v_exp_f32 v188, v28
  v_mfma_f32_16x16x32_bf16 v[44:47], v[164:167], a[236:239], v[44:47]
  ds_read_b64_tr_b16 v[156:157], v5 offset:12416
  v_cvt_pk_bf16_f32 v57, v186, v187
  v_mfma_f32_16x16x32_bf16 a[96:99], v[168:171], v[72:75], a[96:99]
  s_add_u32 m0, s51, 24576
  ds_read_b64_tr_b16 v[158:159], v5 offset:18560
  ds_read_b64_tr_b16 v[160:161], v6 offset:12416
  v_add_u32 v246, s89, v246
  v_mfma_f32_16x16x32_bf16 a[144:147], v[168:171], v[76:79], a[144:147]
  s_waitcnt lgkmcnt(10)
  s_waitcnt vmcnt(10)
  buffer_load_dwordx4 v8, s[8:11], s62 offen offset:0  lds
  v_exp_f32 v189, v29
  v_exp_f32 v190, v30
  v_mfma_f32_16x16x32_bf16 v[228:231], v[212:215], v[236:239], v[228:231]
  ds_read_b64_tr_b16 v[162:163], v6 offset:18560
  v_cvt_pk_bf16_f32 v60, v188, v189
  v_mfma_f32_16x16x32_bf16 a[100:103], v[172:175], v[72:75], a[100:103]
  s_add_u32 s32, s32, 1
  ds_read_b64_tr_b16 v[208:209], v240 offset:4096
  ds_read_b64_tr_b16 v[210:211], v240 offset:4608
  v_mfma_f32_16x16x32_bf16 a[148:151], v[172:175], v[76:79], a[148:151]
  v_exp_f32 v191, v31
  v_mfma_f32_16x16x32_bf16 a[104:107], v[176:179], v[72:75], a[104:107]
  s_add_u32 m0, s53, 0
  ds_read_b64_tr_b16 v[164:165], v7 offset:12416
  v_cvt_pk_bf16_f32 v61, v190, v191
  v_mfma_f32_16x16x32_bf16 a[152:155], v[176:179], v[76:79], a[152:155]
  ds_read_b64_tr_b16 v[166:167], v7 offset:18560
  s_waitcnt lgkmcnt(12)
  buffer_load_dwordx4 v[200:201], s[16:19], s83 idxen offen  lds
  v_mfma_f32_16x16x32_bf16 a[108:111], v[180:183], v[72:75], a[108:111]
  s_add_u32 m0, s53, 1024
  ds_read_b64_tr_b16 v[212:213], v241 offset:4096
  v_exp_f32 v184, v40
  v_mfma_f32_16x16x32_bf16 a[156:159], v[180:183], v[76:79], a[156:159]
  s_waitcnt lgkmcnt(7)
  ds_read_b64_tr_b16 v[168:169], v4 offset:12544
  v_exp_f32 v185, v41
  v_exp_f32 v186, v42
  v_mfma_f32_16x16x32_bf16 a[112:115], v[152:155], v[72:75], a[112:115]
  ds_read_b64_tr_b16 v[170:171], v4 offset:18688
  ds_read_b64_tr_b16 v[172:173], v5 offset:12544
  v_mfma_f32_16x16x32_bf16 a[160:163], v[152:155], v[76:79], a[160:163]
  s_waitcnt lgkmcnt(6)
  buffer_load_dwordx4 v[202:203], s[16:19], s83 idxen offen  lds
  v_cvt_pk_bf16_f32 v58, v184, v185
  v_mfma_f32_16x16x32_bf16 v[216:219], v[208:211], v[232:235], v[216:219]
  s_add_u32 m0, s51, 24576
  ds_read_b64_tr_b16 v[174:175], v5 offset:18688
  ds_read_b64_tr_b16 v[214:215], v241 offset:4608
  v_mfma_f32_16x16x32_bf16 a[116:119], v[156:159], v[72:75], a[116:119]
  v_exp_f32 v187, v43
  v_mfma_f32_16x16x32_bf16 a[164:167], v[156:159], v[76:79], a[164:167]
  ds_read_b64_tr_b16 v[176:177], v6 offset:12544
  ds_read_b128 v[152:155], v2 offset:36864
  v_mfma_f32_16x16x32_bf16 a[120:123], v[160:163], v[72:75], a[120:123]
  buffer_load_dwordx4 v9, s[8:11], s62 offen offset:1024  lds
  v_mfma_f32_16x16x32_bf16 a[168:171], v[160:163], v[76:79], a[168:171]
  s_waitcnt lgkmcnt(8)
  v_exp_f32 v188, v44
  v_mfma_f32_16x16x32_bf16 a[124:127], v[164:167], v[72:75], a[124:127]
  s_add_u32 m0, s53, 2048
  ds_read_b64_tr_b16 v[178:179], v6 offset:18688
  ds_read_b128 v[156:159], v3 offset:36864
  v_cvt_pk_bf16_f32 v59, v186, v187
  v_exp_f32 v189, v45
  v_exp_f32 v190, v46
  v_cvt_pk_bf16_f32 v62, v188, v189
  v_mfma_f32_16x16x32_bf16 a[172:175], v[164:167], v[76:79], a[172:175]
  s_waitcnt lgkmcnt(5)
  v_exp_f32 v191, v47
  v_mfma_f32_16x16x32_bf16 a[128:131], v[168:171], v[72:75], a[128:131]
  s_waitcnt lgkmcnt(4)
  ds_read_b64_tr_b16 v[180:181], v7 offset:12544
  ds_read_b64_tr_b16 v[182:183], v7 offset:18688
  v_mfma_f32_16x16x32_bf16 v[220:223], v[212:215], v[232:235], v[220:223]
  s_max_u32 s40, s76, s77
  buffer_load_dwordx4 v[204:205], s[16:19], s83 idxen offen  lds
  v_cvt_pk_bf16_f32 v63, v190, v191
  v_mfma_f32_16x16x32_bf16 a[176:179], v[168:171], v[76:79], a[176:179]
  s_add_u32 m0, s53, 3072
  ds_read_b64_tr_b16 v[208:209], v242 offset:4096
  ds_read_b64_tr_b16 v[210:211], v242 offset:4608
  v_mfma_f32_16x16x32_bf16 v[104:107], v[112:115], v[56:59], v[104:107]
  s_cmp_ge_u32 s40, s37
  s_cselect_b64 s[66:67], -1, 0
  ds_read_b64_tr_b16 v[212:213], v243 offset:4096
  v_mfma_f32_16x16x32_bf16 v[108:111], v[112:115], v[60:63], v[108:111]
  ds_read_b128 v[160:163], v2 offset:36992
  v_mfma_f32_16x16x32_bf16 a[132:135], v[172:175], v[72:75], a[132:135]
  buffer_load_dwordx4 v[206:207], s[16:19], s83 idxen offen  lds
  v_mfma_f32_16x16x32_bf16 a[180:183], v[172:175], v[76:79], a[180:183]
  s_waitcnt lgkmcnt(4)
  ds_read_b128 v[236:239], v247
  v_mfma_f32_16x16x32_bf16 a[136:139], v[176:179], v[72:75], a[136:139]
  ds_read_b32 v200, v1 offset:128
  v_mfma_f32_16x16x32_bf16 a[184:187], v[176:179], v[76:79], a[184:187]
  ds_read_b64_tr_b16 v[214:215], v243 offset:4608
  ds_read_b32 v202, v1 offset:160
  v_mfma_f32_16x16x32_bf16 a[140:143], v[180:183], v[72:75], a[140:143]
  s_waitcnt lgkmcnt(6)
  v_max_f32 v14, v104, v108
  v_cmp_nge_f32 s[64:65], s50, v14
  v_mfma_f32_16x16x32_bf16 v[224:227], v[208:211], v[232:235], v[224:227]
  s_add_u32 m0, s51, 24576
  ds_read_b128 v[164:167], v3 offset:36992
  ds_read_b32 v204, v1 offset:192
  v_mfma_f32_16x16x32_bf16 a[188:191], v[180:183], v[76:79], a[188:191]
  buffer_load_dwordx4 v10, s[8:11], s62 offen offset:2048  lds
  s_or_b64 vcc, s[64:65], s[66:67]
  s_cbranch_vccnz P2V1s2_SLOW
P2V1s2_SLOWB:
  v_mfma_f32_16x16x32_bf16 v[24:27], v[152:155], a[192:195], v[88:91]
  s_add_u32 m0, s52, 0
  ds_read_b128 v[168:171], v2 offset:37120
  ds_read_b32 v206, v1 offset:224
  v_mfma_f32_16x16x32_bf16 v[28:31], v[152:155], a[216:219], v[92:95]
  s_mov_b32 s76, s77
  s_mov_b32 s77, s78
  v_mfma_f32_16x16x32_bf16 v[24:27], v[156:159], a[196:199], v[24:27]
  s_mov_b32 s78, s79
  ds_read_b128 v[172:175], v3 offset:37120
  v_add_u32 v247, s89, v247
  v_mfma_f32_16x16x32_bf16 v[28:31], v[156:159], a[220:223], v[28:31]
  s_waitcnt lgkmcnt(4)
  buffer_load_dwordx4 v8, s[12:15], s63 offen offset:0  lds
  v_mfma_f32_16x16x32_bf16 v[24:27], v[160:163], a[200:203], v[24:27]
  s_mov_b32 s79, s74
  ds_read_b128 v[176:179], v2 offset:43008
  ds_read_b128 v[180:183], v3 offset:43008
  v_mfma_f32_16x16x32_bf16 v[28:31], v[160:163], a[224:227], v[28:31]
  s_waitcnt vmcnt(9)
  s_add_u32 s40, s32, 4
  v_mfma_f32_16x16x32_bf16 v[228:231], v[212:215], v[232:235], v[228:231]
  s_add_u32 m0, s53, 4096
  ds_read_b64_tr_b16 v[208:209], v240 offset:8192
  ds_read_b64_tr_b16 v[210:211], v240 offset:8704
  v_mfma_f32_16x16x32_bf16 v[24:27], v[164:167], a[204:207], v[24:27]
  buffer_load_dwordx4 v[200:201], s[16:19], s83 idxen offen  lds
  v_mfma_f32_16x16x32_bf16 v[28:31], v[164:167], a[228:231], v[28:31]
  s_waitcnt lgkmcnt(4)
  ds_read_b128 v[152:155], v2 offset:43136
  ds_read_b64_tr_b16 v[212:213], v241 offset:8192
  v_mfma_f32_16x16x32_bf16 v[24:27], v[168:171], a[208:211], v[24:27]
  s_add_u32 m0, s52, 0
  v_readlane_b32 s74, v0, s40
  v_mfma_f32_16x16x32_bf16 v[28:31], v[168:171], a[232:235], v[28:31]
  s_mul_i32 s7, s78, 12288
  ds_read_b128 v[156:159], v3 offset:43136
  ds_read_b64_tr_b16 v[168:169], v4 offset:24576
  v_mfma_f32_16x16x32_bf16 v[24:27], v[172:175], a[212:215], v[24:27]
  buffer_load_dwordx4 v9, s[12:15], s63 offen offset:1024  lds
  v_mfma_f32_16x16x32_bf16 v[28:31], v[172:175], a[236:239], v[28:31]
  s_waitcnt lgkmcnt(6)
  ds_read_b128 v[160:163], v2 offset:43264
  ds_read_b64_tr_b16 v[170:171], v4 offset:30720
  v_mfma_f32_16x16x32_bf16 v[40:43], v[176:179], a[192:195], v[192:195]
  s_add_u32 s7, s7, s75
  s_add_u32 m0, s53, 5120
  v_mfma_f32_16x16x32_bf16 v[44:47], v[176:179], a[216:219], v[196:199]
  s_waitcnt lgkmcnt(6)
  ds_read_b128 v[164:167], v3 offset:43264
  ds_read_b64_tr_b16 v[172:173], v5 offset:24576
  v_mfma_f32_16x16x32_bf16 v[216:219], v[208:211], v[236:239], v[216:219]
  buffer_load_dwordx4 v[202:203], s[16:19], s83 idxen offen  lds
  v_mfma_f32_16x16x32_bf16 v[40:43], v[180:183], a[196:199], v[40:43]
  s_add_u32 m0, s53, 6144
  ds_read_b64_tr_b16 v[174:175], v5 offset:30720
  ds_read_b64_tr_b16 v[214:215], v241 offset:8704
  v_mfma_f32_16x16x32_bf16 v[44:47], v[180:183], a[220:223], v[44:47]
  s_waitcnt lgkmcnt(7)
  ds_read_b64_tr_b16 v[176:177], v6 offset:24576
  v_exp_f32 v184, v24
  v_mfma_f32_16x16x32_bf16 v[40:43], v[152:155], a[200:203], v[40:43]
  ds_read_b64_tr_b16 v[178:179], v6 offset:30720
  ds_read_b64_tr_b16 v[180:181], v7 offset:24576
  v_mfma_f32_16x16x32_bf16 v[44:47], v[152:155], a[224:227], v[44:47]
  s_mul_i32 s6, s74, 12288
  buffer_load_dwordx4 v[204:205], s[16:19], s83 idxen offen  lds
  v_mfma_f32_16x16x32_bf16 v[40:43], v[156:159], a[204:207], v[40:43]
  s_add_u32 m0, s52, 0
  v_exp_f32 v185, v25
  v_mfma_f32_16x16x32_bf16 v[44:47], v[156:159], a[228:231], v[44:47]
  s_waitcnt lgkmcnt(6)
  ds_read_b64_tr_b16 v[208:209], v242 offset:8192
  v_exp_f32 v186, v26
  v_mfma_f32_16x16x32_bf16 v[40:43], v[160:163], a[208:211], v[40:43]
  s_waitcnt lgkmcnt(4)
  ds_read_b64_tr_b16 v[182:183], v7 offset:30720
  ds_read_b64_tr_b16 v[210:211], v242 offset:8704
  v_cvt_pk_bf16_f32 v72, v184, v185
  v_exp_f32 v187, v27
  v_mfma_f32_16x16x32_bf16 v[220:223], v[212:215], v[236:239], v[220:223]
  s_add_u32 s6, s6, s75
  ds_read_b64_tr_b16 v[152:153], v4 offset:24704
  buffer_load_dwordx4 v10, s[12:15], s63 offen offset:2048  lds
  v_mfma_f32_16x16x32_bf16 v[44:47], v[160:163], a[232:235], v[44:47]
  s_add_u32 m0, s53, 7168
  ds_read_b64_tr_b16 v[154:155], v4 offset:30848
  ds_read_b64_tr_b16 v[156:157], v5 offset:24704
  v_mfma_f32_16x16x32_bf16 v[40:43], v[164:167], a[212:215], v[40:43]
  s_waitcnt vmcnt(13)
  s_barrier
  ds_read_b64_tr_b16 v[212:213], v243 offset:8192
  v_mfma_f32_16x16x32_bf16 v[44:47], v[164:167], a[236:239], v[44:47]
  ds_read_b64_tr_b16 v[158:159], v5 offset:30848
  ds_read_b64_tr_b16 v[160:161], v6 offset:24704
  v_exp_f32 v188, v28
  v_mfma_f32_16x16x32_bf16 a[96:99], v[168:171], v[56:59], a[96:99]
  s_add_u32 s32, s32, 1
  buffer_load_dwordx4 v[206:207], s[16:19], s83 idxen offen  lds
  v_cvt_pk_bf16_f32 v73, v186, v187
  v_mfma_f32_16x16x32_bf16 a[144:147], v[168:171], v[60:63], a[144:147]
  ds_read_b64_tr_b16 v[162:163], v6 offset:30848
  v_exp_f32 v189, v29
  v_exp_f32 v190, v30
  v_cvt_pk_bf16_f32 v76, v188, v189
  v_mfma_f32_16x16x32_bf16 a[100:103], v[172:175], v[56:59], a[100:103]
  s_add_u32 m0, s51, 36864
  ds_read_b64_tr_b16 v[164:165], v7 offset:24704
  v_cvt_pk_bf16_f32 v248, v216, v217
  v_mfma_f32_16x16x32_bf16 a[148:151], v[172:175], v[60:63], a[148:151]
  s_waitcnt lgkmcnt(9)
  v_exp_f32 v191, v31
  v_mfma_f32_16x16x32_bf16 a[104:107], v[176:179], v[56:59], a[104:107]
  s_waitcnt lgkmcnt(8)
  ds_read_b64_tr_b16 v[166:167], v7 offset:30848
  ds_read_b64_tr_b16 v[214:215], v243 offset:8704
  v_mfma_f32_16x16x32_bf16 v[224:227], v[208:211], v[236:239], v[224:227]
  buffer_load_dwordx4 v8, s[8:11], s6 offen offset:0  lds
  v_mfma_f32_16x16x32_bf16 a[152:155], v[176:179], v[60:63], a[152:155]
  s_add_u32 m0, s51, 36864
  v_cvt_pk_bf16_f32 v77, v190, v191
  v_exp_f32 v184, v40
  v_mfma_f32_16x16x32_bf16 a[108:111], v[180:183], v[56:59], a[108:111]
  ds_read_b64_tr_b16 v[168:169], v4 offset:24832
  v_exp_f32 v185, v41
  v_mfma_f32_16x16x32_bf16 a[156:159], v[180:183], v[60:63], a[156:159]
  s_waitcnt lgkmcnt(6)
  ds_read_b64_tr_b16 v[170:171], v4 offset:30976
  ds_read_b64_tr_b16 v[172:173], v5 offset:24832
  v_mfma_f32_16x16x32_bf16 a[112:115], v[152:155], v[56:59], a[112:115]
  buffer_load_dwordx4 v9, s[8:11], s6 offen offset:1024  lds
  v_mfma_f32_16x16x32_bf16 a[160:163], v[152:155], v[60:63], a[160:163]
  ds_read_b64_tr_b16 v[174:175], v5 offset:30976
  ds_read_b64_tr_b16 v[176:177], v6 offset:24832
  v_mfma_f32_16x16x32_bf16 a[116:119], v[156:159], v[56:59], a[116:119]
  s_add_u32 m0, s51, 36864
  ds_read_b64_tr_b16 v[178:179], v6 offset:30976
  v_exp_f32 v186, v42
  v_mfma_f32_16x16x32_bf16 a[164:167], v[156:159], v[60:63], a[164:167]
  s_waitcnt lgkmcnt(6)
  ds_read_b64_tr_b16 v[180:181], v7 offset:24832
  v_cvt_pk_bf16_f32 v74, v184, v185
  v_exp_f32 v187, v43
  v_mfma_f32_16x16x32_bf16 v[228:231], v[212:215], v[236:239], v[228:231]
  buffer_load_dwordx4 v10, s[8:11], s6 offen offset:2048  lds
  v_mfma_f32_16x16x32_bf16 a[120:123], v[160:163], v[56:59], a[120:123]
  s_add_u32 m0, s52, 12288
  v_exp_f32 v188, v44
  v_mfma_f32_16x16x32_bf16 a[168:171], v[160:163], v[60:63], a[168:171]
  ds_read_b64_tr_b16 v[182:183], v7 offset:30976
  ds_read_b128 v[152:155], v2 offset:0
  v_cvt_pk_bf16_f32 v75, v186, v187
  v_mfma_f32_16x16x32_bf16 a[124:127], v[164:167], v[56:59], a[124:127]
  v_exp_f32 v189, v45
  v_exp_f32 v190, v46
  v_cvt_pk_bf16_f32 v78, v188, v189
  v_mfma_f32_16x16x32_bf16 a[172:175], v[164:167], v[60:63], a[172:175]
  s_waitcnt lgkmcnt(5)
  buffer_load_dwordx4 v8, s[12:15], s7 offen offset:0  lds
  v_exp_f32 v191, v47
  v_mfma_f32_16x16x32_bf16 a[128:131], v[168:171], v[56:59], a[128:131]
  s_add_u32 m0, s52, 12288
  ds_read_b128 v[156:159], v3 offset:0
  v_cvt_pk_bf16_f32 v79, v190, v191
  v_mfma_f32_16x16x32_bf16 a[176:179], v[168:171], v[60:63], a[176:179]
  v_cvt_pk_bf16_f32 v249, v218, v219
  v_cvt_pk_bf16_f32 v250, v220, v221
  v_mfma_f32_16x16x32_bf16 v[104:107], v[112:115], v[72:75], v[104:107]
  s_max_u32 s40, s76, s77
  ds_read_b128 v[160:163], v2 offset:128
  v_cvt_pk_bf16_f32 v251, v222, v223
  v_mfma_f32_16x16x32_bf16 v[108:111], v[112:115], v[76:79], v[108:111]
  buffer_store_dwordx4 v[248:251], v13, s[24:27], s92 offen offset:0 sc1
  v_mfma_f32_16x16x32_bf16 a[132:135], v[172:175], v[56:59], a[132:135]
  v_cvt_pk_bf16_f32 v252, v224, v225
  v_cvt_pk_bf16_f32 v253, v226, v227
  v_mfma_f32_16x16x32_bf16 a[180:183], v[172:175], v[60:63], a[180:183]
  s_waitcnt lgkmcnt(3)
  buffer_load_dwordx4 v9, s[12:15], s7 offen offset:1024  lds
  v_mfma_f32_16x16x32_bf16 a[136:139], v[176:179], v[56:59], a[136:139]
  v_cvt_pk_bf16_f32 v254, v228, v229
  v_cvt_pk_bf16_f32 v255, v230, v231
  v_mfma_f32_16x16x32_bf16 a[184:187], v[176:179], v[60:63], a[184:187]
  s_cmp_ge_u32 s40, s37
  s_cselect_b64 s[66:67], -1, 0
  v_max_f32 v14, v104, v108
  v_mfma_f32_16x16x32_bf16 a[140:143], v[180:183], v[56:59], a[140:143]
  s_add_u32 m0, s52, 12288
  ds_read_b128 v[164:167], v3 offset:128
  v_cmp_nge_f32 s[64:65], s50, v14
  v_mfma_f32_16x16x32_bf16 a[188:191], v[180:183], v[60:63], a[188:191]
  buffer_store_dwordx4 v[252:255], v13, s[24:27], s92 offen offset:1024 sc1
  buffer_load_dwordx4 v10, s[12:15], s7 offen offset:2048  lds
  s_or_b64 vcc, s[64:65], s[66:67]
  s_cbranch_vccnz P2V1s3_SLOW
P2V1s3_SLOWB:
  s_cmp_eq_u32 s33, 9
  s_cbranch_scc0 P2V1_NV1
  s_call_b64 s[72:73], VSET_1
P2V1_NV1:
  s_cmp_eq_u32 s33, 11
  s_cbranch_scc0 P2V1_NV2
  s_call_b64 s[72:73], VSET_2
P2V1_NV2:
  s_cmp_eq_u32 s33, 13
  s_cbranch_scc0 P2V1_NV3
  s_call_b64 s[72:73], VSET_3
P2V1_NV3:
  s_cmp_eq_u32 s33, 15
  s_cbranch_scc1 FINISH
  s_add_u32 s33, s33, 1
  s_branch P2V0
SWITCH:
  v_lshrrev_b32 v184, 4, v13
  v_lshrrev_b32 v185, 4, v184
  v_bfe_u32 v186, v184, 2, 2
  v_lshlrev_b32 v240, 10, v185
  v_lshl_add_u32 v240, v186, 7, v240
  v_and_b32 v186, 2, v186
  v_bfe_u32 v187, v184, 1, 1
  v_xor_b32 v186, v186, v187
  v_and_b32 v187, 1, v185
  v_lshlrev_b32 v187, 2, v187
  v_xor_b32 v186, v186, v187
  v_lshl_add_u32 v240, v186, 4, v240
  v_and_b32 v186, 1, v184
  v_lshl_add_u32 v240, v186, 3, v240
  v_add_u32 v240, s53, v240
  v_xor_b32 v241, 32, v240
  v_xor_b32 v242, 64, v240
  v_xor_b32 v243, 96, v240
  v_and_b32 v186, 15, v184
  v_sub_u32 v187, v186, v185
  s_lshl_b32 s3, s28, 10
  s_add_u32 s3, s3, 155648
  v_lshlrev_b32 v188, 4, v186
  v_add_u32 v188, s3, v188
  v_mov_b32 v189, 159744
  v_cmp_eq_u32 vcc, 0, v187
  s_nop 1
  v_cndmask_b32 v244, v189, v188, vcc
  v_cmp_eq_u32 vcc, 4, v187
  s_nop 1
  v_cndmask_b32 v245, v189, v188, vcc
  v_cmp_eq_u32 vcc, 8, v187
  s_nop 1
  v_cndmask_b32 v246, v189, v188, vcc
  v_cmp_eq_u32 vcc, 12, v187
  s_nop 1
  v_cndmask_b32 v247, v189, v188, vcc
  s_call_b64 s[72:73], VSET_0
  s_waitcnt vmcnt(0) lgkmcnt(0)
  s_cmp_eq_u32 s34, 2
  s_cbranch_scc1 P2V0
  s_branch P1V0
VEARLY:
  v_lshrrev_b32 v184, 7, v13
  v_lshlrev_b32 v184, 2, v184
  s_lshl_b32 s3, s28, 11
  s_add_u32 s3, s3, 147456
  v_add_u32 v1, s3, v184
  s_mov_b32 s16, s68
  s_and_b32 s17, s69, 0xffff
  s_or_b32 s17, s17, 0x01800000
  s_mov_b32 s18, 2048
  s_mov_b32 s19, 0x20000
  ds_read_b32 v200, v1 offset:0
  ds_read_b32 v202, v1 offset:32
  ds_read_b32 v204, v1 offset:64
  ds_read_b32 v206, v1 offset:96
  s_waitcnt lgkmcnt(0)
  s_add_u32 m0, s53, 0
  s_nop 0
  buffer_load_dwordx4 v[200:201], s[16:19], 0 idxen offen lds
  s_add_u32 m0, s53, 1024
  s_nop 0
  buffer_load_dwordx4 v[202:203], s[16:19], 0 idxen offen lds
  s_add_u32 m0, s53, 2048
  s_nop 0
  buffer_load_dwordx4 v[204:205], s[16:19], 0 idxen offen lds
  s_add_u32 m0, s53, 3072
  s_nop 0
  buffer_load_dwordx4 v[206:207], s[16:19], 0 idxen offen lds
  ds_read_b32 v200, v1 offset:128
  ds_read_b32 v202, v1 offset:160
  ds_read_b32 v204, v1 offset:192
  ds_read_b32 v206, v1 offset:224
  s_waitcnt lgkmcnt(0)
  s_add_u32 m0, s53, 4096
  s_nop 0
  buffer_load_dwordx4 v[200:201], s[16:19], 0 idxen offen lds
  s_add_u32 m0, s53, 5120
  s_nop 0
  buffer_load_dwordx4 v[202:203], s[16:19], 0 idxen offen lds
  s_add_u32 m0, s53, 6144
  s_nop 0
  buffer_load_dwordx4 v[204:205], s[16:19], 0 idxen offen lds
  s_add_u32 m0, s53, 7168
  s_nop 0
  buffer_load_dwordx4 v[206:207], s[16:19], 0 idxen offen lds
  s_setpc_b64 s[4:5]
FINISH:
  s_add_u32 s3, s58, 4096
  s_add_u32 s4, s58, 8192
  s_add_u32 s5, s59, 4096
  s_add_u32 s6, s59, 8192
  buffer_load_dwordx4 v[16:19], v13, s[24:27], s58 offen offset:0
  buffer_load_dwordx4 v[20:23], v13, s[24:27], s58 offen offset:1024
  buffer_load_dwordx4 v[24:27], v13, s[24:27], s3 offen offset:2048
  buffer_load_dwordx4 v[28:31], v13, s[24:27], s3 offen offset:3072
  buffer_load_dwordx4 v[32:35], v13, s[24:27], s59 offen offset:0
  buffer_load_dwordx4 v[36:39], v13, s[24:27], s59 offen offset:1024
  buffer_load_dwordx4 v[40:43], v13, s[24:27], s5 offen offset:2048
  buffer_load_dwordx4 v[44:47], v13, s[24:27], s5 offen offset:3072
  buffer_load_dwordx4 v[48:51], v13, s[24:27], s58 offen offset:2048
  buffer_load_dwordx4 v[52:55], v13, s[24:27], s58 offen offset:3072
  buffer_load_dwordx4 v[56:59], v13, s[24:27], s4 offen offset:0
  buffer_load_dwordx4 v[60:63], v13, s[24:27], s4 offen offset:1024
  buffer_load_dwordx4 v[64:67], v13, s[24:27], s59 offen offset:2048
  buffer_load_dwordx4 v[68:71], v13, s[24:27], s59 offen offset:3072
  buffer_load_dwordx4 v[80:83], v13, s[24:27], s6 offen offset:0
  buffer_load_dwordx4 v[84:87], v13, s[24:27], s6 offen offset:1024
  buffer_load_dwordx4 v[88:91], v13, s[24:27], s3 offen offset:0
  buffer_load_dwordx4 v[92:95], v13, s[24:27], s3 offen offset:1024
  buffer_load_dwordx4 v[120:123], v13, s[24:27], s4 offen offset:2048
  buffer_load_dwordx4 v[124:127], v13, s[24:27], s4 offen offset:3072
  buffer_load_dwordx4 v[128:131], v13, s[24:27], s5 offen offset:0
  buffer_load_dwordx4 v[132:135], v13, s[24:27], s5 offen offset:1024
  buffer_load_dwordx4 v[136:139], v13, s[24:27], s6 offen offset:2048
  buffer_load_dwordx4 v[140:143], v13, s[24:27], s6 offen offset:3072
  ds_read_b64_tr_b16 v[168:169], v4 offset:36864
  ds_read_b64_tr_b16 v[170:171], v4 offset:43008
  ds_read_b64_tr_b16 v[172:173], v5 offset:36864
  ds_read_b64_tr_b16 v[174:175], v5 offset:43008
  ds_read_b64_tr_b16 v[176:177], v6 offset:36864
  ds_read_b64_tr_b16 v[178:179], v6 offset:43008
  ds_read_b64_tr_b16 v[180:181], v7 offset:36864
  ds_read_b64_tr_b16 v[182:183], v7 offset:43008
  s_waitcnt lgkmcnt(6)
  v_mfma_f32_16x16x32_bf16 a[96:99], v[168:171], v[72:75], a[96:99]
  v_mfma_f32_16x16x32_bf16 a[144:147], v[168:171], v[76:79], a[144:147]
  s_waitcnt lgkmcnt(4)
  ds_read_b64_tr_b16 v[168:169], v4 offset:36992
  ds_read_b64_tr_b16 v[170:171], v4 offset:43136
  v_mfma_f32_16x16x32_bf16 a[100:103], v[172:175], v[72:75], a[100:103]
  v_mfma_f32_16x16x32_bf16 a[148:151], v[172:175], v[76:79], a[148:151]
  s_waitcnt lgkmcnt(4)
  ds_read_b64_tr_b16 v[172:173], v5 offset:36992
  ds_read_b64_tr_b16 v[174:175], v5 offset:43136
  v_mfma_f32_16x16x32_bf16 a[104:107], v[176:179], v[72:75], a[104:107]
  v_mfma_f32_16x16x32_bf16 a[152:155], v[176:179], v[76:79], a[152:155]
  s_waitcnt lgkmcnt(4)
  ds_read_b64_tr_b16 v[176:177], v6 offset:36992
  ds_read_b64_tr_b16 v[178:179], v6 offset:43136
  v_mfma_f32_16x16x32_bf16 a[108:111], v[180:183], v[72:75], a[108:111]
  v_mfma_f32_16x16x32_bf16 a[156:159], v[180:183], v[76:79], a[156:159]
  s_waitcnt lgkmcnt(4)
  ds_read_b64_tr_b16 v[180:181], v7 offset:36992
  ds_read_b64_tr_b16 v[182:183], v7 offset:43136
  v_mfma_f32_16x16x32_bf16 a[112:115], v[168:171], v[72:75], a[112:115]
  v_mfma_f32_16x16x32_bf16 a[160:163], v[168:171], v[76:79], a[160:163]
  s_waitcnt lgkmcnt(4)
  ds_read_b64_tr_b16 v[168:169], v4 offset:37120
  ds_read_b64_tr_b16 v[170:171], v4 offset:43264
  v_mfma_f32_16x16x32_bf16 a[116:119], v[172:175], v[72:75], a[116:119]
  v_mfma_f32_16x16x32_bf16 a[164:167], v[172:175], v[76:79], a[164:167]
  s_waitcnt lgkmcnt(4)
  ds_read_b64_tr_b16 v[172:173], v5 offset:37120
  ds_read_b64_tr_b16 v[174:175], v5 offset:43264
  v_mfma_f32_16x16x32_bf16 a[120:123], v[176:179], v[72:75], a[120:123]
  v_mfma_f32_16x16x32_bf16 a[168:171], v[176:179], v[76:79], a[168:171]
  s_waitcnt lgkmcnt(4)
  ds_read_b64_tr_b16 v[176:177], v6 offset:37120
  ds_read_b64_tr_b16 v[178:179], v6 offset:43264
  v_mfma_f32_16x16x32_bf16 a[124:127], v[180:183], v[72:75], a[124:127]
  v_mfma_f32_16x16x32_bf16 a[172:175], v[180:183], v[76:79], a[172:175]
  s_waitcnt lgkmcnt(4)
  ds_read_b64_tr_b16 v[180:181], v7 offset:37120
  ds_read_b64_tr_b16 v[182:183], v7 offset:43264
  v_mfma_f32_16x16x32_bf16 a[128:131], v[168:171], v[72:75], a[128:131]
  v_mfma_f32_16x16x32_bf16 a[176:179], v[168:171], v[76:79], a[176:179]
  s_waitcnt lgkmcnt(4)
  v_mfma_f32_16x16x32_bf16 a[132:135], v[172:175], v[72:75], a[132:135]
  v_mfma_f32_16x16x32_bf16 a[180:183], v[172:175], v[76:79], a[180:183]
  s_waitcnt lgkmcnt(2)
  v_mfma_f32_16x16x32_bf16 a[136:139], v[176:179], v[72:75], a[136:139]
  v_mfma_f32_16x16x32_bf16 a[184:187], v[176:179], v[76:79], a[184:187]
  s_waitcnt lgkmcnt(0)
  v_mfma_f32_16x16x32_bf16 a[140:143], v[180:183], v[72:75], a[140:143]
  v_mfma_f32_16x16x32_bf16 a[188:191], v[180:183], v[76:79], a[188:191]
  s_nop 7
  v_lshrrev_b32 v200, 4, v13
  v_and_b32 v201, 15, v200
  v_lshrrev_b32 v202, 4, v200
  v_lshrrev_b32 v203, 1, v202
  v_and_b32 v204, 7, v201
  v_xor_b32 v203, v203, v204
  v_lshlrev_b32 v203, 4, v203
  v_lshl_add_u32 v216, v201, 7, v203
  v_and_b32 v203, 1, v202
  v_lshl_add_u32 v216, v203, 3, v216
  v_add_u32 v216, s53, v216
  v_xor_b32 v217, 32, v216
  v_xor_b32 v218, 64, v216
  v_xor_b32 v219, 96, v216
  v_lshrrev_b32 v203, 3, v200
  v_and_b32 v204, 7, v200
  v_xor_b32 v205, v204, v203
  v_lshlrev_b32 v205, 4, v205
  v_lshl_add_u32 v220, v203, 7, v205
  v_add_u32 v220, s53, v220
  v_mul_u32_u24 v221, 384, v203
  v_lshl_add_u32 v221, v204, 4, v221
  v_rcp_f32 v224, v96
  v_rcp_f32 v225, v100
  v_rcp_f32 v226, v104
  v_rcp_f32 v227, v108
  s_nop 0
  v_mul_f32 v224, s56, v224
  v_mul_f32 v225, s56, v225
  v_mul_f32 v226, s56, v226
  v_mul_f32 v227, s56, v227
  s_waitcnt vmcnt(22)
  v_accvgpr_read_b32 v200, a0
  v_accvgpr_read_b32 v201, a1
  v_lshlrev_b32 v202, 16, v16
  v_and_b32 v203, s55, v16
  v_fma_f32 v200, v200, v224, v202
  v_fma_f32 v201, v201, v224, v203
  v_cvt_pk_bf16_f32 v204, v200, v201
  v_accvgpr_read_b32 v200, a2
  v_accvgpr_read_b32 v201, a3
  v_lshlrev_b32 v202, 16, v17
  v_and_b32 v203, s55, v17
  v_fma_f32 v200, v200, v224, v202
  v_fma_f32 v201, v201, v224, v203
  v_cvt_pk_bf16_f32 v205, v200, v201
  ds_write_b64 v216, v[204:205] offset:0
  v_accvgpr_read_b32 v200, a4
  v_accvgpr_read_b32 v201, a5
  v_lshlrev_b32 v202, 16, v18
  v_and_b32 v203, s55, v18
  v_fma_f32 v200, v200, v224, v202
  v_fma_f32 v201, v201, v224, v203
  v_cvt_pk_bf16_f32 v206, v200, v201
  v_accvgpr_read_b32 v200, a6
  v_accvgpr_read_b32 v201, a7
  v_lshlrev_b32 v202, 16, v19
  v_and_b32 v203, s55, v19
  v_fma_f32 v200, v200, v224, v202
  v_fma_f32 v201, v201, v224, v203
  v_cvt_pk_bf16_f32 v207, v200, v201
  ds_write_b64 v217, v[206:207] offset:0
  v_accvgpr_read_b32 v200, a8
  v_accvgpr_read_b32 v201, a9
  v_lshlrev_b32 v202, 16, v20
  v_and_b32 v203, s55, v20
  v_fma_f32 v200, v200, v224, v202
  v_fma_f32 v201, v201, v224, v203
  v_cvt_pk_bf16_f32 v204, v200, v201
  v_accvgpr_read_b32 v200, a10
  v_accvgpr_read_b32 v201, a11
  v_lshlrev_b32 v202, 16, v21
  v_and_b32 v203, s55, v21
  v_fma_f32 v200, v200, v224, v202
  v_fma_f32 v201, v201, v224, v203
  v_cvt_pk_bf16_f32 v205, v200, v201
  ds_write_b64 v218, v[204:205] offset:0
  v_accvgpr_read_b32 v200, a12
  v_accvgpr_read_b32 v201, a13
  v_lshlrev_b32 v202, 16, v22
  v_and_b32 v203, s55, v22
  v_fma_f32 v200, v200, v224, v202
  v_fma_f32 v201, v201, v224, v203
  v_cvt_pk_bf16_f32 v206, v200, v201
  v_accvgpr_read_b32 v200, a14
  v_accvgpr_read_b32 v201, a15
  v_lshlrev_b32 v202, 16, v23
  v_and_b32 v203, s55, v23
  v_fma_f32 v200, v200, v224, v202
  v_fma_f32 v201, v201, v224, v203
  v_cvt_pk_bf16_f32 v207, v200, v201
  ds_write_b64 v219, v[206:207] offset:0
  s_waitcnt vmcnt(20)
  v_accvgpr_read_b32 v200, a48
  v_accvgpr_read_b32 v201, a49
  v_lshlrev_b32 v202, 16, v24
  v_and_b32 v203, s55, v24
  v_fma_f32 v200, v200, v225, v202
  v_fma_f32 v201, v201, v225, v203
  v_cvt_pk_bf16_f32 v204, v200, v201
  v_accvgpr_read_b32 v200, a50
  v_accvgpr_read_b32 v201, a51
  v_lshlrev_b32 v202, 16, v25
  v_and_b32 v203, s55, v25
  v_fma_f32 v200, v200, v225, v202
  v_fma_f32 v201, v201, v225, v203
  v_cvt_pk_bf16_f32 v205, v200, v201
  ds_write_b64 v216, v[204:205] offset:2048
  v_accvgpr_read_b32 v200, a52
  v_accvgpr_read_b32 v201, a53
  v_lshlrev_b32 v202, 16, v26
  v_and_b32 v203, s55, v26
  v_fma_f32 v200, v200, v225, v202
  v_fma_f32 v201, v201, v225, v203
  v_cvt_pk_bf16_f32 v206, v200, v201
  v_accvgpr_read_b32 v200, a54
  v_accvgpr_read_b32 v201, a55
  v_lshlrev_b32 v202, 16, v27
  v_and_b32 v203, s55, v27
  v_fma_f32 v200, v200, v225, v202
  v_fma_f32 v201, v201, v225, v203
  v_cvt_pk_bf16_f32 v207, v200, v201
  ds_write_b64 v217, v[206:207] offset:2048
  s_waitcnt lgkmcnt(2)
  ds_read_b128 v[208:211], v220 offset:0
  ds_read_b128 v[212:215], v220 offset:1024
  s_add_u32 s6, s58, 0
  s_add_u32 s7, s6, 3072
  v_accvgpr_read_b32 v200, a56
  v_accvgpr_read_b32 v201, a57
  v_lshlrev_b32 v202, 16, v28
  v_and_b32 v203, s55, v28
  v_fma_f32 v200, v200, v225, v202
  v_fma_f32 v201, v201, v225, v203
  v_cvt_pk_bf16_f32 v204, v200, v201
  v_accvgpr_read_b32 v200, a58
  v_accvgpr_read_b32 v201, a59
  v_lshlrev_b32 v202, 16, v29
  v_and_b32 v203, s55, v29
  v_fma_f32 v200, v200, v225, v202
  v_fma_f32 v201, v201, v225, v203
  v_cvt_pk_bf16_f32 v205, v200, v201
  ds_write_b64 v218, v[204:205] offset:2048
  v_accvgpr_read_b32 v200, a60
  v_accvgpr_read_b32 v201, a61
  v_lshlrev_b32 v202, 16, v30
  v_and_b32 v203, s55, v30
  v_fma_f32 v200, v200, v225, v202
  v_fma_f32 v201, v201, v225, v203
  v_cvt_pk_bf16_f32 v206, v200, v201
  v_accvgpr_read_b32 v200, a62
  v_accvgpr_read_b32 v201, a63
  v_lshlrev_b32 v202, 16, v31
  v_and_b32 v203, s55, v31
  v_fma_f32 v200, v200, v225, v202
  v_fma_f32 v201, v201, v225, v203
  v_cvt_pk_bf16_f32 v207, v200, v201
  ds_write_b64 v219, v[206:207] offset:2048
  s_waitcnt lgkmcnt(2)
  buffer_store_dwordx4 v[208:211], v221, s[20:23], s6 offen sc1
  buffer_store_dwordx4 v[212:215], v221, s[20:23], s7 offen sc1
  s_waitcnt vmcnt(20)
  v_accvgpr_read_b32 v200, a96
  v_accvgpr_read_b32 v201, a97
  v_lshlrev_b32 v202, 16, v32
  v_and_b32 v203, s55, v32
  v_fma_f32 v200, v200, v226, v202
  v_fma_f32 v201, v201, v226, v203
  v_cvt_pk_bf16_f32 v204, v200, v201
  v_accvgpr_read_b32 v200, a98
  v_accvgpr_read_b32 v201, a99
  v_lshlrev_b32 v202, 16, v33
  v_and_b32 v203, s55, v33
  v_fma_f32 v200, v200, v226, v202
  v_fma_f32 v201, v201, v226, v203
  v_cvt_pk_bf16_f32 v205, v200, v201
  ds_write_b64 v216, v[204:205] offset:4096
  v_accvgpr_read_b32 v200, a100
  v_accvgpr_read_b32 v201, a101
  v_lshlrev_b32 v202, 16, v34
  v_and_b32 v203, s55, v34
  v_fma_f32 v200, v200, v226, v202
  v_fma_f32 v201, v201, v226, v203
  v_cvt_pk_bf16_f32 v206, v200, v201
  v_accvgpr_read_b32 v200, a102
  v_accvgpr_read_b32 v201, a103
  v_lshlrev_b32 v202, 16, v35
  v_and_b32 v203, s55, v35
  v_fma_f32 v200, v200, v226, v202
  v_fma_f32 v201, v201, v226, v203
  v_cvt_pk_bf16_f32 v207, v200, v201
  ds_write_b64 v217, v[206:207] offset:4096
  s_waitcnt lgkmcnt(2)
  ds_read_b128 v[208:211], v220 offset:2048
  ds_read_b128 v[212:215], v220 offset:3072
  s_add_u32 s6, s58, 6144
  s_add_u32 s7, s6, 3072
  v_accvgpr_read_b32 v200, a104
  v_accvgpr_read_b32 v201, a105
  v_lshlrev_b32 v202, 16, v36
  v_and_b32 v203, s55, v36
  v_fma_f32 v200, v200, v226, v202
  v_fma_f32 v201, v201, v226, v203
  v_cvt_pk_bf16_f32 v204, v200, v201
  v_accvgpr_read_b32 v200, a106
  v_accvgpr_read_b32 v201, a107
  v_lshlrev_b32 v202, 16, v37
  v_and_b32 v203, s55, v37
  v_fma_f32 v200, v200, v226, v202
  v_fma_f32 v201, v201, v226, v203
  v_cvt_pk_bf16_f32 v205, v200, v201
  ds_write_b64 v218, v[204:205] offset:4096
  v_accvgpr_read_b32 v200, a108
  v_accvgpr_read_b32 v201, a109
  v_lshlrev_b32 v202, 16, v38
  v_and_b32 v203, s55, v38
  v_fma_f32 v200, v200, v226, v202
  v_fma_f32 v201, v201, v226, v203
  v_cvt_pk_bf16_f32 v206, v200, v201
  v_accvgpr_read_b32 v200, a110
  v_accvgpr_read_b32 v201, a111
  v_lshlrev_b32 v202, 16, v39
  v_and_b32 v203, s55, v39
  v_fma_f32 v200, v200, v226, v202
  v_fma_f32 v201, v201, v226, v203
  v_cvt_pk_bf16_f32 v207, v200, v201
  ds_write_b64 v219, v[206:207] offset:4096
  s_waitcnt lgkmcnt(2)
  buffer_store_dwordx4 v[208:211], v221, s[20:23], s6 offen sc1
  buffer_store_dwordx4 v[212:215], v221, s[20:23], s7 offen sc1
  s_waitcnt vmcnt(20)
  v_accvgpr_read_b32 v200, a144
  v_accvgpr_read_b32 v201, a145
  v_lshlrev_b32 v202, 16, v40
  v_and_b32 v203, s55, v40
  v_fma_f32 v200, v200, v227, v202
  v_fma_f32 v201, v201, v227, v203
  v_cvt_pk_bf16_f32 v204, v200, v201
  v_accvgpr_read_b32 v200, a146
  v_accvgpr_read_b32 v201, a147
  v_lshlrev_b32 v202, 16, v41
  v_and_b32 v203, s55, v41
  v_fma_f32 v200, v200, v227, v202
  v_fma_f32 v201, v201, v227, v203
  v_cvt_pk_bf16_f32 v205, v200, v201
  ds_write_b64 v216, v[204:205] offset:0
  v_accvgpr_read_b32 v200, a148
  v_accvgpr_read_b32 v201, a149
  v_lshlrev_b32 v202, 16, v42
  v_and_b32 v203, s55, v42
  v_fma_f32 v200, v200, v227, v202
  v_fma_f32 v201, v201, v227, v203
  v_cvt_pk_bf16_f32 v206, v200, v201
  v_accvgpr_read_b32 v200, a150
  v_accvgpr_read_b32 v201, a151
  v_lshlrev_b32 v202, 16, v43
  v_and_b32 v203, s55, v43
  v_fma_f32 v200, v200, v227, v202
  v_fma_f32 v201, v201, v227, v203
  v_cvt_pk_bf16_f32 v207, v200, v201
  ds_write_b64 v217, v[206:207] offset:0
  s_waitcnt lgkmcnt(2)
  ds_read_b128 v[208:211], v220 offset:4096
  ds_read_b128 v[212:215], v220 offset:5120
  s_add_u32 s6, s59, 0
  s_add_u32 s7, s6, 3072
  v_accvgpr_read_b32 v200, a152
  v_accvgpr_read_b32 v201, a153
  v_lshlrev_b32 v202, 16, v44
  v_and_b32 v203, s55, v44
  v_fma_f32 v200, v200, v227, v202
  v_fma_f32 v201, v201, v227, v203
  v_cvt_pk_bf16_f32 v204, v200, v201
  v_accvgpr_read_b32 v200, a154
  v_accvgpr_read_b32 v201, a155
  v_lshlrev_b32 v202, 16, v45
  v_and_b32 v203, s55, v45
  v_fma_f32 v200, v200, v227, v202
  v_fma_f32 v201, v201, v227, v203
  v_cvt_pk_bf16_f32 v205, v200, v201
  ds_write_b64 v218, v[204:205] offset:0
  v_accvgpr_read_b32 v200, a156
  v_accvgpr_read_b32 v201, a157
  v_lshlrev_b32 v202, 16, v46
  v_and_b32 v203, s55, v46
  v_fma_f32 v200, v200, v227, v202
  v_fma_f32 v201, v201, v227, v203
  v_cvt_pk_bf16_f32 v206, v200, v201
  v_accvgpr_read_b32 v200, a158
  v_accvgpr_read_b32 v201, a159
  v_lshlrev_b32 v202, 16, v47
  v_and_b32 v203, s55, v47
  v_fma_f32 v200, v200, v227, v202
  v_fma_f32 v201, v201, v227, v203
  v_cvt_pk_bf16_f32 v207, v200, v201
  ds_write_b64 v219, v[206:207] offset:0
  s_waitcnt lgkmcnt(2)
  buffer_store_dwordx4 v[208:211], v221, s[20:23], s6 offen sc1
  buffer_store_dwordx4 v[212:215], v221, s[20:23], s7 offen sc1
  s_waitcnt vmcnt(20)
  v_accvgpr_read_b32 v200, a16
  v_accvgpr_read_b32 v201, a17
  v_lshlrev_b32 v202, 16, v48
  v_and_b32 v203, s55, v48
  v_fma_f32 v200, v200, v224, v202
  v_fma_f32 v201, v201, v224, v203
  v_cvt_pk_bf16_f32 v204, v200, v201
  v_accvgpr_read_b32 v200, a18
  v_accvgpr_read_b32 v201, a19
  v_lshlrev_b32 v202, 16, v49
  v_and_b32 v203, s55, v49
  v_fma_f32 v200, v200, v224, v202
  v_fma_f32 v201, v201, v224, v203
  v_cvt_pk_bf16_f32 v205, v200, v201
  ds_write_b64 v216, v[204:205] offset:2048
  v_accvgpr_read_b32 v200, a20
  v_accvgpr_read_b32 v201, a21
  v_lshlrev_b32 v202, 16, v50
  v_and_b32 v203, s55, v50
  v_fma_f32 v200, v200, v224, v202
  v_fma_f32 v201, v201, v224, v203
  v_cvt_pk_bf16_f32 v206, v200, v201
  v_accvgpr_read_b32 v200, a22
  v_accvgpr_read_b32 v201, a23
  v_lshlrev_b32 v202, 16, v51
  v_and_b32 v203, s55, v51
  v_fma_f32 v200, v200, v224, v202
  v_fma_f32 v201, v201, v224, v203
  v_cvt_pk_bf16_f32 v207, v200, v201
  ds_write_b64 v217, v[206:207] offset:2048
  s_waitcnt lgkmcnt(2)
  ds_read_b128 v[208:211], v220 offset:0
  ds_read_b128 v[212:215], v220 offset:1024
  s_add_u32 s6, s59, 6144
  s_add_u32 s7, s6, 3072
  v_accvgpr_read_b32 v200, a24
  v_accvgpr_read_b32 v201, a25
  v_lshlrev_b32 v202, 16, v52
  v_and_b32 v203, s55, v52
  v_fma_f32 v200, v200, v224, v202
  v_fma_f32 v201, v201, v224, v203
  v_cvt_pk_bf16_f32 v204, v200, v201
  v_accvgpr_read_b32 v200, a26
  v_accvgpr_read_b32 v201, a27
  v_lshlrev_b32 v202, 16, v53
  v_and_b32 v203, s55, v53
  v_fma_f32 v200, v200, v224, v202
  v_fma_f32 v201, v201, v224, v203
  v_cvt_pk_bf16_f32 v205, v200, v201
  ds_write_b64 v218, v[204:205] offset:2048
  v_accvgpr_read_b32 v200, a28
  v_accvgpr_read_b32 v201, a29
  v_lshlrev_b32 v202, 16, v54
  v_and_b32 v203, s55, v54
  v_fma_f32 v200, v200, v224, v202
  v_fma_f32 v201, v201, v224, v203
  v_cvt_pk_bf16_f32 v206, v200, v201
  v_accvgpr_read_b32 v200, a30
  v_accvgpr_read_b32 v201, a31
  v_lshlrev_b32 v202, 16, v55
  v_and_b32 v203, s55, v55
  v_fma_f32 v200, v200, v224, v202
  v_fma_f32 v201, v201, v224, v203
  v_cvt_pk_bf16_f32 v207, v200, v201
  ds_write_b64 v219, v[206:207] offset:2048
  s_waitcnt lgkmcnt(2)
  buffer_store_dwordx4 v[208:211], v221, s[20:23], s6 offen sc1
  buffer_store_dwordx4 v[212:215], v221, s[20:23], s7 offen sc1
  s_waitcnt vmcnt(20)
  v_accvgpr_read_b32 v200, a64
  v_accvgpr_read_b32 v201, a65
  v_lshlrev_b32 v202, 16, v56
  v_and_b32 v203, s55, v56
  v_fma_f32 v200, v200, v225, v202
  v_fma_f32 v201, v201, v225, v203
  v_cvt_pk_bf16_f32 v204, v200, v201
  v_accvgpr_read_b32 v200, a66
  v_accvgpr_read_b32 v201, a67
  v_lshlrev_b32 v202, 16, v57
  v_and_b32 v203, s55, v57
  v_fma_f32 v200, v200, v225, v202
  v_fma_f32 v201, v201, v225, v203
  v_cvt_pk_bf16_f32 v205, v200, v201
  ds_write_b64 v216, v[204:205] offset:4096
  v_accvgpr_read_b32 v200, a68
  v_accvgpr_read_b32 v201, a69
  v_lshlrev_b32 v202, 16, v58
  v_and_b32 v203, s55, v58
  v_fma_f32 v200, v200, v225, v202
  v_fma_f32 v201, v201, v225, v203
  v_cvt_pk_bf16_f32 v206, v200, v201
  v_accvgpr_read_b32 v200, a70
  v_accvgpr_read_b32 v201, a71
  v_lshlrev_b32 v202, 16, v59
  v_and_b32 v203, s55, v59
  v_fma_f32 v200, v200, v225, v202
  v_fma_f32 v201, v201, v225, v203
  v_cvt_pk_bf16_f32 v207, v200, v201
  ds_write_b64 v217, v[206:207] offset:4096
  s_waitcnt lgkmcnt(2)
  ds_read_b128 v[208:211], v220 offset:2048
  ds_read_b128 v[212:215], v220 offset:3072
  s_add_u32 s6, s58, 128
  s_add_u32 s7, s6, 3072
  v_accvgpr_read_b32 v200, a72
  v_accvgpr_read_b32 v201, a73
  v_lshlrev_b32 v202, 16, v60
  v_and_b32 v203, s55, v60
  v_fma_f32 v200, v200, v225, v202
  v_fma_f32 v201, v201, v225, v203
  v_cvt_pk_bf16_f32 v204, v200, v201
  v_accvgpr_read_b32 v200, a74
  v_accvgpr_read_b32 v201, a75
  v_lshlrev_b32 v202, 16, v61
  v_and_b32 v203, s55, v61
  v_fma_f32 v200, v200, v225, v202
  v_fma_f32 v201, v201, v225, v203
  v_cvt_pk_bf16_f32 v205, v200, v201
  ds_write_b64 v218, v[204:205] offset:4096
  v_accvgpr_read_b32 v200, a76
  v_accvgpr_read_b32 v201, a77
  v_lshlrev_b32 v202, 16, v62
  v_and_b32 v203, s55, v62
  v_fma_f32 v200, v200, v225, v202
  v_fma_f32 v201, v201, v225, v203
  v_cvt_pk_bf16_f32 v206, v200, v201
  v_accvgpr_read_b32 v200, a78
  v_accvgpr_read_b32 v201, a79
  v_lshlrev_b32 v202, 16, v63
  v_and_b32 v203, s55, v63
  v_fma_f32 v200, v200, v225, v202
  v_fma_f32 v201, v201, v225, v203
  v_cvt_pk_bf16_f32 v207, v200, v201
  ds_write_b64 v219, v[206:207] offset:4096
  s_waitcnt lgkmcnt(2)
  buffer_store_dwordx4 v[208:211], v221, s[20:23], s6 offen sc1
  buffer_store_dwordx4 v[212:215], v221, s[20:23], s7 offen sc1
  s_waitcnt vmcnt(20)
  v_accvgpr_read_b32 v200, a112
  v_accvgpr_read_b32 v201, a113
  v_lshlrev_b32 v202, 16, v64
  v_and_b32 v203, s55, v64
  v_fma_f32 v200, v200, v226, v202
  v_fma_f32 v201, v201, v226, v203
  v_cvt_pk_bf16_f32 v204, v200, v201
  v_accvgpr_read_b32 v200, a114
  v_accvgpr_read_b32 v201, a115
  v_lshlrev_b32 v202, 16, v65
  v_and_b32 v203, s55, v65
  v_fma_f32 v200, v200, v226, v202
  v_fma_f32 v201, v201, v226, v203
  v_cvt_pk_bf16_f32 v205, v200, v201
  ds_write_b64 v216, v[204:205] offset:0
  v_accvgpr_read_b32 v200, a116
  v_accvgpr_read_b32 v201, a117
  v_lshlrev_b32 v202, 16, v66
  v_and_b32 v203, s55, v66
  v_fma_f32 v200, v200, v226, v202
  v_fma_f32 v201, v201, v226, v203
  v_cvt_pk_bf16_f32 v206, v200, v201
  v_accvgpr_read_b32 v200, a118
  v_accvgpr_read_b32 v201, a119
  v_lshlrev_b32 v202, 16, v67
  v_and_b32 v203, s55, v67
  v_fma_f32 v200, v200, v226, v202
  v_fma_f32 v201, v201, v226, v203
  v_cvt_pk_bf16_f32 v207, v200, v201
  ds_write_b64 v217, v[206:207] offset:0
  s_waitcnt lgkmcnt(2)
  ds_read_b128 v[208:211], v220 offset:4096
  ds_read_b128 v[212:215], v220 offset:5120
  s_add_u32 s6, s58, 6272
  s_add_u32 s7, s6, 3072
  v_accvgpr_read_b32 v200, a120
  v_accvgpr_read_b32 v201, a121
  v_lshlrev_b32 v202, 16, v68
  v_and_b32 v203, s55, v68
  v_fma_f32 v200, v200, v226, v202
  v_fma_f32 v201, v201, v226, v203
  v_cvt_pk_bf16_f32 v204, v200, v201
  v_accvgpr_read_b32 v200, a122
  v_accvgpr_read_b32 v201, a123
  v_lshlrev_b32 v202, 16, v69
  v_and_b32 v203, s55, v69
  v_fma_f32 v200, v200, v226, v202
  v_fma_f32 v201, v201, v226, v203
  v_cvt_pk_bf16_f32 v205, v200, v201
  ds_write_b64 v218, v[204:205] offset:0
  v_accvgpr_read_b32 v200, a124
  v_accvgpr_read_b32 v201, a125
  v_lshlrev_b32 v202, 16, v70
  v_and_b32 v203, s55, v70
  v_fma_f32 v200, v200, v226, v202
  v_fma_f32 v201, v201, v226, v203
  v_cvt_pk_bf16_f32 v206, v200, v201
  v_accvgpr_read_b32 v200, a126
  v_accvgpr_read_b32 v201, a127
  v_lshlrev_b32 v202, 16, v71
  v_and_b32 v203, s55, v71
  v_fma_f32 v200, v200, v226, v202
  v_fma_f32 v201, v201, v226, v203
  v_cvt_pk_bf16_f32 v207, v200, v201
  ds_write_b64 v219, v[206:207] offset:0
  s_waitcnt lgkmcnt(2)
  buffer_store_dwordx4 v[208:211], v221, s[20:23], s6 offen sc1
  buffer_store_dwordx4 v[212:215], v221, s[20:23], s7 offen sc1
  s_waitcnt vmcnt(20)
  v_accvgpr_read_b32 v200, a160
  v_accvgpr_read_b32 v201, a161
  v_lshlrev_b32 v202, 16, v80
  v_and_b32 v203, s55, v80
  v_fma_f32 v200, v200, v227, v202
  v_fma_f32 v201, v201, v227, v203
  v_cvt_pk_bf16_f32 v204, v200, v201
  v_accvgpr_read_b32 v200, a162
  v_accvgpr_read_b32 v201, a163
  v_lshlrev_b32 v202, 16, v81
  v_and_b32 v203, s55, v81
  v_fma_f32 v200, v200, v227, v202
  v_fma_f32 v201, v201, v227, v203
  v_cvt_pk_bf16_f32 v205, v200, v201
  ds_write_b64 v216, v[204:205] offset:2048
  v_accvgpr_read_b32 v200, a164
  v_accvgpr_read_b32 v201, a165
  v_lshlrev_b32 v202, 16, v82
  v_and_b32 v203, s55, v82
  v_fma_f32 v200, v200, v227, v202
  v_fma_f32 v201, v201, v227, v203
  v_cvt_pk_bf16_f32 v206, v200, v201
  v_accvgpr_read_b32 v200, a166
  v_accvgpr_read_b32 v201, a167
  v_lshlrev_b32 v202, 16, v83
  v_and_b32 v203, s55, v83
  v_fma_f32 v200, v200, v227, v202
  v_fma_f32 v201, v201, v227, v203
  v_cvt_pk_bf16_f32 v207, v200, v201
  ds_write_b64 v217, v[206:207] offset:2048
  s_waitcnt lgkmcnt(2)
  ds_read_b128 v[208:211], v220 offset:0
  ds_read_b128 v[212:215], v220 offset:1024
  s_add_u32 s6, s59, 128
  s_add_u32 s7, s6, 3072
  v_accvgpr_read_b32 v200, a168
  v_accvgpr_read_b32 v201, a169
  v_lshlrev_b32 v202, 16, v84
  v_and_b32 v203, s55, v84
  v_fma_f32 v200, v200, v227, v202
  v_fma_f32 v201, v201, v227, v203
  v_cvt_pk_bf16_f32 v204, v200, v201
  v_accvgpr_read_b32 v200, a170
  v_accvgpr_read_b32 v201, a171
  v_lshlrev_b32 v202, 16, v85
  v_and_b32 v203, s55, v85
  v_fma_f32 v200, v200, v227, v202
  v_fma_f32 v201, v201, v227, v203
  v_cvt_pk_bf16_f32 v205, v200, v201
  ds_write_b64 v218, v[204:205] offset:2048
  v_accvgpr_read_b32 v200, a172
  v_accvgpr_read_b32 v201, a173
  v_lshlrev_b32 v202, 16, v86
  v_and_b32 v203, s55, v86
  v_fma_f32 v200, v200, v227, v202
  v_fma_f32 v201, v201, v227, v203
  v_cvt_pk_bf16_f32 v206, v200, v201
  v_accvgpr_read_b32 v200, a174
  v_accvgpr_read_b32 v201, a175
  v_lshlrev_b32 v202, 16, v87
  v_and_b32 v203, s55, v87
  v_fma_f32 v200, v200, v227, v202
  v_fma_f32 v201, v201, v227, v203
  v_cvt_pk_bf16_f32 v207, v200, v201
  ds_write_b64 v219, v[206:207] offset:2048
  s_waitcnt lgkmcnt(2)
  buffer_store_dwordx4 v[208:211], v221, s[20:23], s6 offen sc1
  buffer_store_dwordx4 v[212:215], v221, s[20:23], s7 offen sc1
  s_waitcnt vmcnt(20)
  v_accvgpr_read_b32 v200, a32
  v_accvgpr_read_b32 v201, a33
  v_lshlrev_b32 v202, 16, v88
  v_and_b32 v203, s55, v88
  v_fma_f32 v200, v200, v224, v202
  v_fma_f32 v201, v201, v224, v203
  v_cvt_pk_bf16_f32 v204, v200, v201
  v_accvgpr_read_b32 v200, a34
  v_accvgpr_read_b32 v201, a35
  v_lshlrev_b32 v202, 16, v89
  v_and_b32 v203, s55, v89
  v_fma_f32 v200, v200, v224, v202
  v_fma_f32 v201, v201, v224, v203
  v_cvt_pk_bf16_f32 v205, v200, v201
  ds_write_b64 v216, v[204:205] offset:4096
  v_accvgpr_read_b32 v200, a36
  v_accvgpr_read_b32 v201, a37
  v_lshlrev_b32 v202, 16, v90
  v_and_b32 v203, s55, v90
  v_fma_f32 v200, v200, v224, v202
  v_fma_f32 v201, v201, v224, v203
  v_cvt_pk_bf16_f32 v206, v200, v201
  v_accvgpr_read_b32 v200, a38
  v_accvgpr_read_b32 v201, a39
  v_lshlrev_b32 v202, 16, v91
  v_and_b32 v203, s55, v91
  v_fma_f32 v200, v200, v224, v202
  v_fma_f32 v201, v201, v224, v203
  v_cvt_pk_bf16_f32 v207, v200, v201
  ds_write_b64 v217, v[206:207] offset:4096
  s_waitcnt lgkmcnt(2)
  ds_read_b128 v[208:211], v220 offset:2048
  ds_read_b128 v[212:215], v220 offset:3072
  s_add_u32 s6, s59, 6272
  s_add_u32 s7, s6, 3072
  v_accvgpr_read_b32 v200, a40
  v_accvgpr_read_b32 v201, a41
  v_lshlrev_b32 v202, 16, v92
  v_and_b32 v203, s55, v92
  v_fma_f32 v200, v200, v224, v202
  v_fma_f32 v201, v201, v224, v203
  v_cvt_pk_bf16_f32 v204, v200, v201
  v_accvgpr_read_b32 v200, a42
  v_accvgpr_read_b32 v201, a43
  v_lshlrev_b32 v202, 16, v93
  v_and_b32 v203, s55, v93
  v_fma_f32 v200, v200, v224, v202
  v_fma_f32 v201, v201, v224, v203
  v_cvt_pk_bf16_f32 v205, v200, v201
  ds_write_b64 v218, v[204:205] offset:4096
  v_accvgpr_read_b32 v200, a44
  v_accvgpr_read_b32 v201, a45
  v_lshlrev_b32 v202, 16, v94
  v_and_b32 v203, s55, v94
  v_fma_f32 v200, v200, v224, v202
  v_fma_f32 v201, v201, v224, v203
  v_cvt_pk_bf16_f32 v206, v200, v201
  v_accvgpr_read_b32 v200, a46
  v_accvgpr_read_b32 v201, a47
  v_lshlrev_b32 v202, 16, v95
  v_and_b32 v203, s55, v95
  v_fma_f32 v200, v200, v224, v202
  v_fma_f32 v201, v201, v224, v203
  v_cvt_pk_bf16_f32 v207, v200, v201
  ds_write_b64 v219, v[206:207] offset:4096
  s_waitcnt lgkmcnt(2)
  buffer_store_dwordx4 v[208:211], v221, s[20:23], s6 offen sc1
  buffer_store_dwordx4 v[212:215], v221, s[20:23], s7 offen sc1
  s_waitcnt vmcnt(20)
  v_accvgpr_read_b32 v200, a80
  v_accvgpr_read_b32 v201, a81
  v_lshlrev_b32 v202, 16, v120
  v_and_b32 v203, s55, v120
  v_fma_f32 v200, v200, v225, v202
  v_fma_f32 v201, v201, v225, v203
  v_cvt_pk_bf16_f32 v204, v200, v201
  v_accvgpr_read_b32 v200, a82
  v_accvgpr_read_b32 v201, a83
  v_lshlrev_b32 v202, 16, v121
  v_and_b32 v203, s55, v121
  v_fma_f32 v200, v200, v225, v202
  v_fma_f32 v201, v201, v225, v203
  v_cvt_pk_bf16_f32 v205, v200, v201
  ds_write_b64 v216, v[204:205] offset:0
  v_accvgpr_read_b32 v200, a84
  v_accvgpr_read_b32 v201, a85
  v_lshlrev_b32 v202, 16, v122
  v_and_b32 v203, s55, v122
  v_fma_f32 v200, v200, v225, v202
  v_fma_f32 v201, v201, v225, v203
  v_cvt_pk_bf16_f32 v206, v200, v201
  v_accvgpr_read_b32 v200, a86
  v_accvgpr_read_b32 v201, a87
  v_lshlrev_b32 v202, 16, v123
  v_and_b32 v203, s55, v123
  v_fma_f32 v200, v200, v225, v202
  v_fma_f32 v201, v201, v225, v203
  v_cvt_pk_bf16_f32 v207, v200, v201
  ds_write_b64 v217, v[206:207] offset:0
  s_waitcnt lgkmcnt(2)
  ds_read_b128 v[208:211], v220 offset:4096
  ds_read_b128 v[212:215], v220 offset:5120
  s_add_u32 s6, s58, 256
  s_add_u32 s7, s6, 3072
  v_accvgpr_read_b32 v200, a88
  v_accvgpr_read_b32 v201, a89
  v_lshlrev_b32 v202, 16, v124
  v_and_b32 v203, s55, v124
  v_fma_f32 v200, v200, v225, v202
  v_fma_f32 v201, v201, v225, v203
  v_cvt_pk_bf16_f32 v204, v200, v201
  v_accvgpr_read_b32 v200, a90
  v_accvgpr_read_b32 v201, a91
  v_lshlrev_b32 v202, 16, v125
  v_and_b32 v203, s55, v125
  v_fma_f32 v200, v200, v225, v202
  v_fma_f32 v201, v201, v225, v203
  v_cvt_pk_bf16_f32 v205, v200, v201
  ds_write_b64 v218, v[204:205] offset:0
  v_accvgpr_read_b32 v200, a92
  v_accvgpr_read_b32 v201, a93
  v_lshlrev_b32 v202, 16, v126
  v_and_b32 v203, s55, v126
  v_fma_f32 v200, v200, v225, v202
  v_fma_f32 v201, v201, v225, v203
  v_cvt_pk_bf16_f32 v206, v200, v201
  v_accvgpr_read_b32 v200, a94
  v_accvgpr_read_b32 v201, a95
  v_lshlrev_b32 v202, 16, v127
  v_and_b32 v203, s55, v127
  v_fma_f32 v200, v200, v225, v202
  v_fma_f32 v201, v201, v225, v203
  v_cvt_pk_bf16_f32 v207, v200, v201
  ds_write_b64 v219, v[206:207] offset:0
  s_waitcnt lgkmcnt(2)
  buffer_store_dwordx4 v[208:211], v221, s[20:23], s6 offen sc1
  buffer_store_dwordx4 v[212:215], v221, s[20:23], s7 offen sc1
  s_waitcnt vmcnt(20)
  v_accvgpr_read_b32 v200, a128
  v_accvgpr_read_b32 v201, a129
  v_lshlrev_b32 v202, 16, v128
  v_and_b32 v203, s55, v128
  v_fma_f32 v200, v200, v226, v202
  v_fma_f32 v201, v201, v226, v203
  v_cvt_pk_bf16_f32 v204, v200, v201
  v_accvgpr_read_b32 v200, a130
  v_accvgpr_read_b32 v201, a131
  v_lshlrev_b32 v202, 16, v129
  v_and_b32 v203, s55, v129
  v_fma_f32 v200, v200, v226, v202
  v_fma_f32 v201, v201, v226, v203
  v_cvt_pk_bf16_f32 v205, v200, v201
  ds_write_b64 v216, v[204:205] offset:2048
  v_accvgpr_read_b32 v200, a132
  v_accvgpr_read_b32 v201, a133
  v_lshlrev_b32 v202, 16, v130
  v_and_b32 v203, s55, v130
  v_fma_f32 v200, v200, v226, v202
  v_fma_f32 v201, v201, v226, v203
  v_cvt_pk_bf16_f32 v206, v200, v201
  v_accvgpr_read_b32 v200, a134
  v_accvgpr_read_b32 v201, a135
  v_lshlrev_b32 v202, 16, v131
  v_and_b32 v203, s55, v131
  v_fma_f32 v200, v200, v226, v202
  v_fma_f32 v201, v201, v226, v203
  v_cvt_pk_bf16_f32 v207, v200, v201
  ds_write_b64 v217, v[206:207] offset:2048
  s_waitcnt lgkmcnt(2)
  ds_read_b128 v[208:211], v220 offset:0
  ds_read_b128 v[212:215], v220 offset:1024
  s_add_u32 s6, s58, 6400
  s_add_u32 s7, s6, 3072
  v_accvgpr_read_b32 v200, a136
  v_accvgpr_read_b32 v201, a137
  v_lshlrev_b32 v202, 16, v132
  v_and_b32 v203, s55, v132
  v_fma_f32 v200, v200, v226, v202
  v_fma_f32 v201, v201, v226, v203
  v_cvt_pk_bf16_f32 v204, v200, v201
  v_accvgpr_read_b32 v200, a138
  v_accvgpr_read_b32 v201, a139
  v_lshlrev_b32 v202, 16, v133
  v_and_b32 v203, s55, v133
  v_fma_f32 v200, v200, v226, v202
  v_fma_f32 v201, v201, v226, v203
  v_cvt_pk_bf16_f32 v205, v200, v201
  ds_write_b64 v218, v[204:205] offset:2048
  v_accvgpr_read_b32 v200, a140
  v_accvgpr_read_b32 v201, a141
  v_lshlrev_b32 v202, 16, v134
  v_and_b32 v203, s55, v134
  v_fma_f32 v200, v200, v226, v202
  v_fma_f32 v201, v201, v226, v203
  v_cvt_pk_bf16_f32 v206, v200, v201
  v_accvgpr_read_b32 v200, a142
  v_accvgpr_read_b32 v201, a143
  v_lshlrev_b32 v202, 16, v135
  v_and_b32 v203, s55, v135
  v_fma_f32 v200, v200, v226, v202
  v_fma_f32 v201, v201, v226, v203
  v_cvt_pk_bf16_f32 v207, v200, v201
  ds_write_b64 v219, v[206:207] offset:2048
  s_waitcnt lgkmcnt(2)
  buffer_store_dwordx4 v[208:211], v221, s[20:23], s6 offen sc1
  buffer_store_dwordx4 v[212:215], v221, s[20:23], s7 offen sc1
  s_waitcnt vmcnt(20)
  v_accvgpr_read_b32 v200, a176
  v_accvgpr_read_b32 v201, a177
  v_lshlrev_b32 v202, 16, v136
  v_and_b32 v203, s55, v136
  v_fma_f32 v200, v200, v227, v202
  v_fma_f32 v201, v201, v227, v203
  v_cvt_pk_bf16_f32 v204, v200, v201
  v_accvgpr_read_b32 v200, a178
  v_accvgpr_read_b32 v201, a179
  v_lshlrev_b32 v202, 16, v137
  v_and_b32 v203, s55, v137
  v_fma_f32 v200, v200, v227, v202
  v_fma_f32 v201, v201, v227, v203
  v_cvt_pk_bf16_f32 v205, v200, v201
  ds_write_b64 v216, v[204:205] offset:4096
  v_accvgpr_read_b32 v200, a180
  v_accvgpr_read_b32 v201, a181
  v_lshlrev_b32 v202, 16, v138
  v_and_b32 v203, s55, v138
  v_fma_f32 v200, v200, v227, v202
  v_fma_f32 v201, v201, v227, v203
  v_cvt_pk_bf16_f32 v206, v200, v201
  v_accvgpr_read_b32 v200, a182
  v_accvgpr_read_b32 v201, a183
  v_lshlrev_b32 v202, 16, v139
  v_and_b32 v203, s55, v139
  v_fma_f32 v200, v200, v227, v202
  v_fma_f32 v201, v201, v227, v203
  v_cvt_pk_bf16_f32 v207, v200, v201
  ds_write_b64 v217, v[206:207] offset:4096
  s_waitcnt lgkmcnt(2)
  ds_read_b128 v[208:211], v220 offset:2048
  ds_read_b128 v[212:215], v220 offset:3072
  s_add_u32 s6, s59, 256
  s_add_u32 s7, s6, 3072
  v_accvgpr_read_b32 v200, a184
  v_accvgpr_read_b32 v201, a185
  v_lshlrev_b32 v202, 16, v140
  v_and_b32 v203, s55, v140
  v_fma_f32 v200, v200, v227, v202
  v_fma_f32 v201, v201, v227, v203
  v_cvt_pk_bf16_f32 v204, v200, v201
  v_accvgpr_read_b32 v200, a186
  v_accvgpr_read_b32 v201, a187
  v_lshlrev_b32 v202, 16, v141
  v_and_b32 v203, s55, v141
  v_fma_f32 v200, v200, v227, v202
  v_fma_f32 v201, v201, v227, v203
  v_cvt_pk_bf16_f32 v205, v200, v201
  ds_write_b64 v218, v[204:205] offset:4096
  v_accvgpr_read_b32 v200, a188
  v_accvgpr_read_b32 v201, a189
  v_lshlrev_b32 v202, 16, v142
  v_and_b32 v203, s55, v142
  v_fma_f32 v200, v200, v227, v202
  v_fma_f32 v201, v201, v227, v203
  v_cvt_pk_bf16_f32 v206, v200, v201
  v_accvgpr_read_b32 v200, a190
  v_accvgpr_read_b32 v201, a191
  v_lshlrev_b32 v202, 16, v143
  v_and_b32 v203, s55, v143
  v_fma_f32 v200, v200, v227, v202
  v_fma_f32 v201, v201, v227, v203
  v_cvt_pk_bf16_f32 v207, v200, v201
  ds_write_b64 v219, v[206:207] offset:4096
  s_waitcnt lgkmcnt(2)
  buffer_store_dwordx4 v[208:211], v221, s[20:23], s6 offen sc1
  buffer_store_dwordx4 v[212:215], v221, s[20:23], s7 offen sc1
  s_waitcnt lgkmcnt(0)
  ds_read_b128 v[208:211], v220 offset:4096
  ds_read_b128 v[212:215], v220 offset:5120
  s_add_u32 s6, s59, 6400
  s_add_u32 s7, s6, 3072
  s_waitcnt lgkmcnt(0)
  buffer_store_dwordx4 v[208:211], v221, s[20:23], s6 offen sc1
  buffer_store_dwordx4 v[212:215], v221, s[20:23], s7 offen sc1
AT_END:
  s_endpgm
MASK_p1:
  s_sub_i32 s40, s77, s36
  s_sub_i32 s40, s40, s28
  s_lshl_b32 s40, s40, 5
  v_subrev_u32 v191, s40, v11
  v_cmp_le_i32 s[42:43], 0, v191
  v_cmp_le_i32 s[44:45], 1, v191
  v_cmp_le_i32 s[46:47], 2, v191
  v_cmp_le_i32 s[48:49], 3, v191
  v_cndmask_b32 v80, v12, v116, s[42:43]
  v_cndmask_b32 v81, v12, v116, s[44:45]
  v_cndmask_b32 v82, v12, v116, s[46:47]
  v_cndmask_b32 v83, v12, v116, s[48:49]
  v_cmp_le_i32 s[42:43], -16, v191
  v_cmp_le_i32 s[44:45], -15, v191
  v_cmp_le_i32 s[46:47], -14, v191
  v_cmp_le_i32 s[48:49], -13, v191
  v_cndmask_b32 v84, v12, v117, s[42:43]
  v_cndmask_b32 v85, v12, v117, s[44:45]
  v_cndmask_b32 v86, v12, v117, s[46:47]
  v_cndmask_b32 v87, v12, v117, s[48:49]
  v_cmp_le_i32 s[42:43], 16, v191
  v_cmp_le_i32 s[44:45], 17, v191
  v_cmp_le_i32 s[46:47], 18, v191
  v_cmp_le_i32 s[48:49], 19, v191
  v_cndmask_b32 v192, v12, v116, s[42:43]
  v_cndmask_b32 v193, v12, v116, s[44:45]
  v_cndmask_b32 v194, v12, v116, s[46:47]
  v_cndmask_b32 v195, v12, v116, s[48:49]
  v_cmp_le_i32 s[42:43], 0, v191
  v_cmp_le_i32 s[44:45], 1, v191
  v_cmp_le_i32 s[46:47], 2, v191
  v_cmp_le_i32 s[48:49], 3, v191
  v_cndmask_b32 v196, v12, v117, s[42:43]
  v_cndmask_b32 v197, v12, v117, s[44:45]
  v_cndmask_b32 v198, v12, v117, s[46:47]
  v_cndmask_b32 v199, v12, v117, s[48:49]
  s_nop 0
  s_setpc_b64 s[72:73]
RARE_p1_0:
  s_nop 7
  s_nop 7
  v_max3_f32 v188, v16, v17, v18
  v_max3_f32 v188, v188, v19, v32
  v_max3_f32 v188, v188, v33, v34
  v_max_f32 v188, v188, v35
  v_mov_b32 v190, v188
  s_nop 1
  v_permlane16_swap_b32 v188, v190
  s_nop 1
  v_max_f32 v188, v188, v190
  v_mov_b32 v190, v188
  s_nop 1
  v_permlane32_swap_b32 v188, v190
  s_nop 1
  v_max_f32 v188, v188, v190
  v_ceil_f32 v188, v188
  v_frexp_exp_i32_f32 v190, v96
  v_add_u32 v190, -12, v190
  v_cvt_f32_i32 v190, v190
  v_max3_f32 v188, v188, v190, 0
  v_cvt_i32_f32 v190, v188
  v_sub_u32 v190, 0, v190
  v_ldexp_f32 v189, 1.0, v190
  v_sub_f32 v16, v16, v188
  v_sub_f32 v17, v17, v188
  v_sub_f32 v18, v18, v188
  v_sub_f32 v19, v19, v188
  v_sub_f32 v32, v32, v188
  v_sub_f32 v33, v33, v188
  v_sub_f32 v34, v34, v188
  v_sub_f32 v35, v35, v188
  v_sub_f32 v80, v80, v188
  v_sub_f32 v81, v81, v188
  v_sub_f32 v82, v82, v188
  v_sub_f32 v83, v83, v188
  v_sub_f32 v192, v192, v188
  v_sub_f32 v193, v193, v188
  v_sub_f32 v194, v194, v188
  v_sub_f32 v195, v195, v188
  v_sub_f32 v116, v116, v188
  v_accvgpr_read_b32 v190, a0
  s_nop 0
  v_mul_f32 v190, v190, v189
  s_nop 0
  v_accvgpr_write_b32 a0, v190
  v_accvgpr_read_b32 v190, a1
  s_nop 0
  v_mul_f32 v190, v190, v189
  s_nop 0
  v_accvgpr_write_b32 a1, v190
  v_accvgpr_read_b32 v190, a2
  s_nop 0
  v_mul_f32 v190, v190, v189
  s_nop 0
  v_accvgpr_write_b32 a2, v190
  v_accvgpr_read_b32 v190, a3
  s_nop 0
  v_mul_f32 v190, v190, v189
  s_nop 0
  v_accvgpr_write_b32 a3, v190
  v_accvgpr_read_b32 v190, a4
  s_nop 0
  v_mul_f32 v190, v190, v189
  s_nop 0
  v_accvgpr_write_b32 a4, v190
  v_accvgpr_read_b32 v190, a5
  s_nop 0
  v_mul_f32 v190, v190, v189
  s_nop 0
  v_accvgpr_write_b32 a5, v190
  v_accvgpr_read_b32 v190, a6
  s_nop 0
  v_mul_f32 v190, v190, v189
  s_nop 0
  v_accvgpr_write_b32 a6, v190
  v_accvgpr_read_b32 v190, a7
  s_nop 0
  v_mul_f32 v190, v190, v189
  s_nop 0
  v_accvgpr_write_b32 a7, v190
  v_accvgpr_read_b32 v190, a8
  s_nop 0
  v_mul_f32 v190, v190, v189
  s_nop 0
  v_accvgpr_write_b32 a8, v190
  v_accvgpr_read_b32 v190, a9
  s_nop 0
  v_mul_f32 v190, v190, v189
  s_nop 0
  v_accvgpr_write_b32 a9, v190
  v_accvgpr_read_b32 v190, a10
  s_nop 0
  v_mul_f32 v190, v190, v189
  s_nop 0
  v_accvgpr_write_b32 a10, v190
  v_accvgpr_read_b32 v190, a11
  s_nop 0
  v_mul_f32 v190, v190, v189
  s_nop 0
  v_accvgpr_write_b32 a11, v190
  v_accvgpr_read_b32 v190, a12
  s_nop 0
  v_mul_f32 v190, v190, v189
  s_nop 0
  v_accvgpr_write_b32 a12, v190
  v_accvgpr_read_b32 v190, a13
  s_nop 0
  v_mul_f32 v190, v190, v189
  s_nop 0
  v_accvgpr_write_b32 a13, v190
  v_accvgpr_read_b32 v190, a14
  s_nop 0
  v_mul_f32 v190, v190, v189
  s_nop 0
  v_accvgpr_write_b32 a14, v190
  v_accvgpr_read_b32 v190, a15
  s_nop 0
  v_mul_f32 v190, v190, v189
  s_nop 0
  v_accvgpr_write_b32 a15, v190
  v_accvgpr_read_b32 v190, a16
  s_nop 0
  v_mul_f32 v190, v190, v189
  s_nop 0
  v_accvgpr_write_b32 a16, v190
  v_accvgpr_read_b32 v190, a17
  s_nop 0
  v_mul_f32 v190, v190, v189
  s_nop 0
  v_accvgpr_write_b32 a17, v190
  v_accvgpr_read_b32 v190, a18
  s_nop 0
  v_mul_f32 v190, v190, v189
  s_nop 0
  v_accvgpr_write_b32 a18, v190
  v_accvgpr_read_b32 v190, a19
  s_nop 0
  v_mul_f32 v190, v190, v189
  s_nop 0
  v_accvgpr_write_b32 a19, v190
  v_accvgpr_read_b32 v190, a20
  s_nop 0
  v_mul_f32 v190, v190, v189
  s_nop 0
  v_accvgpr_write_b32 a20, v190
  v_accvgpr_read_b32 v190, a21
  s_nop 0
  v_mul_f32 v190, v190, v189
  s_nop 0
  v_accvgpr_write_b32 a21, v190
  v_accvgpr_read_b32 v190, a22
  s_nop 0
  v_mul_f32 v190, v190, v189
  s_nop 0
  v_accvgpr_write_b32 a22, v190
  v_accvgpr_read_b32 v190, a23
  s_nop 0
  v_mul_f32 v190, v190, v189
  s_nop 0
  v_accvgpr_write_b32 a23, v190
  v_accvgpr_read_b32 v190, a24
  s_nop 0
  v_mul_f32 v190, v190, v189
  s_nop 0
  v_accvgpr_write_b32 a24, v190
  v_accvgpr_read_b32 v190, a25
  s_nop 0
  v_mul_f32 v190, v190, v189
  s_nop 0
  v_accvgpr_write_b32 a25, v190
  v_accvgpr_read_b32 v190, a26
  s_nop 0
  v_mul_f32 v190, v190, v189
  s_nop 0
  v_accvgpr_write_b32 a26, v190
  v_accvgpr_read_b32 v190, a27
  s_nop 0
  v_mul_f32 v190, v190, v189
  s_nop 0
  v_accvgpr_write_b32 a27, v190
  v_accvgpr_read_b32 v190, a28
  s_nop 0
  v_mul_f32 v190, v190, v189
  s_nop 0
  v_accvgpr_write_b32 a28, v190
  v_accvgpr_read_b32 v190, a29
  s_nop 0
  v_mul_f32 v190, v190, v189
  s_nop 0
  v_accvgpr_write_b32 a29, v190
  v_accvgpr_read_b32 v190, a30
  s_nop 0
  v_mul_f32 v190, v190, v189
  s_nop 0
  v_accvgpr_write_b32 a30, v190
  v_accvgpr_read_b32 v190, a31
  s_nop 0
  v_mul_f32 v190, v190, v189
  s_nop 0
  v_accvgpr_write_b32 a31, v190
  v_accvgpr_read_b32 v190, a32
  s_nop 0
  v_mul_f32 v190, v190, v189
  s_nop 0
  v_accvgpr_write_b32 a32, v190
  v_accvgpr_read_b32 v190, a33
  s_nop 0
  v_mul_f32 v190, v190, v189
  s_nop 0
  v_accvgpr_write_b32 a33, v190
  v_accvgpr_read_b32 v190, a34
  s_nop 0
  v_mul_f32 v190, v190, v189
  s_nop 0
  v_accvgpr_write_b32 a34, v190
  v_accvgpr_read_b32 v190, a35
  s_nop 0
  v_mul_f32 v190, v190, v189
  s_nop 0
  v_accvgpr_write_b32 a35, v190
  v_accvgpr_read_b32 v190, a36
  s_nop 0
  v_mul_f32 v190, v190, v189
  s_nop 0
  v_accvgpr_write_b32 a36, v190
  v_accvgpr_read_b32 v190, a37
  s_nop 0
  v_mul_f32 v190, v190, v189
  s_nop 0
  v_accvgpr_write_b32 a37, v190
  v_accvgpr_read_b32 v190, a38
  s_nop 0
  v_mul_f32 v190, v190, v189
  s_nop 0
  v_accvgpr_write_b32 a38, v190
  v_accvgpr_read_b32 v190, a39
  s_nop 0
  v_mul_f32 v190, v190, v189
  s_nop 0
  v_accvgpr_write_b32 a39, v190
  v_accvgpr_read_b32 v190, a40
  s_nop 0
  v_mul_f32 v190, v190, v189
  s_nop 0
  v_accvgpr_write_b32 a40, v190
  v_accvgpr_read_b32 v190, a41
  s_nop 0
  v_mul_f32 v190, v190, v189
  s_nop 0
  v_accvgpr_write_b32 a41, v190
  v_accvgpr_read_b32 v190, a42
  s_nop 0
  v_mul_f32 v190, v190, v189
  s_nop 0
  v_accvgpr_write_b32 a42, v190
  v_accvgpr_read_b32 v190, a43
  s_nop 0
  v_mul_f32 v190, v190, v189
  s_nop 0
  v_accvgpr_write_b32 a43, v190
  v_accvgpr_read_b32 v190, a44
  s_nop 0
  v_mul_f32 v190, v190, v189
  s_nop 0
  v_accvgpr_write_b32 a44, v190
  v_accvgpr_read_b32 v190, a45
  s_nop 0
  v_mul_f32 v190, v190, v189
  s_nop 0
  v_accvgpr_write_b32 a45, v190
  v_accvgpr_read_b32 v190, a46
  s_nop 0
  v_mul_f32 v190, v190, v189
  s_nop 0
  v_accvgpr_write_b32 a46, v190
  v_accvgpr_read_b32 v190, a47
  s_nop 0
  v_mul_f32 v190, v190, v189
  s_nop 0
  v_accvgpr_write_b32 a47, v190
  v_exp_f32 v184, v16
  v_exp_f32 v185, v17
  s_nop 0
  v_cvt_pk_bf16_f32 v48, v184, v185
  v_exp_f32 v184, v18
  v_exp_f32 v185, v19
  s_nop 0
  v_cvt_pk_bf16_f32 v49, v184, v185
  v_exp_f32 v184, v32
  v_exp_f32 v185, v33
  s_nop 0
  v_cvt_pk_bf16_f32 v50, v184, v185
  v_exp_f32 v184, v34
  v_exp_f32 v185, v35
  s_nop 0
  v_cvt_pk_bf16_f32 v51, v184, v185
  s_nop 1
  v_mfma_f32_16x16x32_bf16 v[184:187], v[112:115], v[48:51], 0
  s_nop 7
  s_nop 1
  v_mov_b32 v191, 0x203
  v_cmp_class_f32 vcc, v96, v191
  v_mov_b32 v191, 0x42800000
  v_cmp_ge_f32 s[42:43], v188, v191
  v_mul_f32 v190, v96, v189
  s_nop 3
  s_or_b64 vcc, vcc, s[42:43]
  s_nop 1
  v_cndmask_b32 v190, v190, v184, vcc
  v_mov_b32 v96, v190
  v_mov_b32 v97, v190
  v_mov_b32 v98, v190
  v_mov_b32 v99, v190
  v_max3_f32 v188, v20, v21, v22
  v_max3_f32 v188, v188, v23, v36
  v_max3_f32 v188, v188, v37, v38
  v_max_f32 v188, v188, v39
  v_mov_b32 v190, v188
  s_nop 1
  v_permlane16_swap_b32 v188, v190
  s_nop 1
  v_max_f32 v188, v188, v190
  v_mov_b32 v190, v188
  s_nop 1
  v_permlane32_swap_b32 v188, v190
  s_nop 1
  v_max_f32 v188, v188, v190
  v_ceil_f32 v188, v188
  v_frexp_exp_i32_f32 v190, v100
  v_add_u32 v190, -12, v190
  v_cvt_f32_i32 v190, v190
  v_max3_f32 v188, v188, v190, 0
  v_cvt_i32_f32 v190, v188
  v_sub_u32 v190, 0, v190
  v_ldexp_f32 v189, 1.0, v190
  v_sub_f32 v20, v20, v188
  v_sub_f32 v21, v21, v188
  v_sub_f32 v22, v22, v188
  v_sub_f32 v23, v23, v188
  v_sub_f32 v36, v36, v188
  v_sub_f32 v37, v37, v188
  v_sub_f32 v38, v38, v188
  v_sub_f32 v39, v39, v188
  v_sub_f32 v84, v84, v188
  v_sub_f32 v85, v85, v188
  v_sub_f32 v86, v86, v188
  v_sub_f32 v87, v87, v188
  v_sub_f32 v196, v196, v188
  v_sub_f32 v197, v197, v188
  v_sub_f32 v198, v198, v188
  v_sub_f32 v199, v199, v188
  v_sub_f32 v117, v117, v188
  v_accvgpr_read_b32 v190, a48
  s_nop 0
  v_mul_f32 v190, v190, v189
  s_nop 0
  v_accvgpr_write_b32 a48, v190
  v_accvgpr_read_b32 v190, a49
  s_nop 0
  v_mul_f32 v190, v190, v189
  s_nop 0
  v_accvgpr_write_b32 a49, v190
  v_accvgpr_read_b32 v190, a50
  s_nop 0
  v_mul_f32 v190, v190, v189
  s_nop 0
  v_accvgpr_write_b32 a50, v190
  v_accvgpr_read_b32 v190, a51
  s_nop 0
  v_mul_f32 v190, v190, v189
  s_nop 0
  v_accvgpr_write_b32 a51, v190
  v_accvgpr_read_b32 v190, a52
  s_nop 0
  v_mul_f32 v190, v190, v189
  s_nop 0
  v_accvgpr_write_b32 a52, v190
  v_accvgpr_read_b32 v190, a53
  s_nop 0
  v_mul_f32 v190, v190, v189
  s_nop 0
  v_accvgpr_write_b32 a53, v190
  v_accvgpr_read_b32 v190, a54
  s_nop 0
  v_mul_f32 v190, v190, v189
  s_nop 0
  v_accvgpr_write_b32 a54, v190
  v_accvgpr_read_b32 v190, a55
  s_nop 0
  v_mul_f32 v190, v190, v189
  s_nop 0
  v_accvgpr_write_b32 a55, v190
  v_accvgpr_read_b32 v190, a56
  s_nop 0
  v_mul_f32 v190, v190, v189
  s_nop 0
  v_accvgpr_write_b32 a56, v190
  v_accvgpr_read_b32 v190, a57
  s_nop 0
  v_mul_f32 v190, v190, v189
  s_nop 0
  v_accvgpr_write_b32 a57, v190
  v_accvgpr_read_b32 v190, a58
  s_nop 0
  v_mul_f32 v190, v190, v189
  s_nop 0
  v_accvgpr_write_b32 a58, v190
  v_accvgpr_read_b32 v190, a59
  s_nop 0
  v_mul_f32 v190, v190, v189
  s_nop 0
  v_accvgpr_write_b32 a59, v190
  v_accvgpr_read_b32 v190, a60
  s_nop 0
  v_mul_f32 v190, v190, v189
  s_nop 0
  v_accvgpr_write_b32 a60, v190
  v_accvgpr_read_b32 v190, a61
  s_nop 0
  v_mul_f32 v190, v190, v189
  s_nop 0
  v_accvgpr_write_b32 a61, v190
  v_accvgpr_read_b32 v190, a62
  s_nop 0
  v_mul_f32 v190, v190, v189
  s_nop 0
  v_accvgpr_write_b32 a62, v190
  v_accvgpr_read_b32 v190, a63
  s_nop 0
  v_mul_f32 v190, v190, v189
  s_nop 0
  v_accvgpr_write_b32 a63, v190
  v_accvgpr_read_b32 v190, a64
  s_nop 0
  v_mul_f32 v190, v190, v189
  s_nop 0
  v_accvgpr_write_b32 a64, v190
  v_accvgpr_read_b32 v190, a65
  s_nop 0
  v_mul_f32 v190, v190, v189
  s_nop 0
  v_accvgpr_write_b32 a65, v190
  v_accvgpr_read_b32 v190, a66
  s_nop 0
  v_mul_f32 v190, v190, v189
  s_nop 0
  v_accvgpr_write_b32 a66, v190
  v_accvgpr_read_b32 v190, a67
  s_nop 0
  v_mul_f32 v190, v190, v189
  s_nop 0
  v_accvgpr_write_b32 a67, v190
  v_accvgpr_read_b32 v190, a68
  s_nop 0
  v_mul_f32 v190, v190, v189
  s_nop 0
  v_accvgpr_write_b32 a68, v190
  v_accvgpr_read_b32 v190, a69
  s_nop 0
  v_mul_f32 v190, v190, v189
  s_nop 0
  v_accvgpr_write_b32 a69, v190
  v_accvgpr_read_b32 v190, a70
  s_nop 0
  v_mul_f32 v190, v190, v189
  s_nop 0
  v_accvgpr_write_b32 a70, v190
  v_accvgpr_read_b32 v190, a71
  s_nop 0
  v_mul_f32 v190, v190, v189
  s_nop 0
  v_accvgpr_write_b32 a71, v190
  v_accvgpr_read_b32 v190, a72
  s_nop 0
  v_mul_f32 v190, v190, v189
  s_nop 0
  v_accvgpr_write_b32 a72, v190
  v_accvgpr_read_b32 v190, a73
  s_nop 0
  v_mul_f32 v190, v190, v189
  s_nop 0
  v_accvgpr_write_b32 a73, v190
  v_accvgpr_read_b32 v190, a74
  s_nop 0
  v_mul_f32 v190, v190, v189
  s_nop 0
  v_accvgpr_write_b32 a74, v190
  v_accvgpr_read_b32 v190, a75
  s_nop 0
  v_mul_f32 v190, v190, v189
  s_nop 0
  v_accvgpr_write_b32 a75, v190
  v_accvgpr_read_b32 v190, a76
  s_nop 0
  v_mul_f32 v190, v190, v189
  s_nop 0
  v_accvgpr_write_b32 a76, v190
  v_accvgpr_read_b32 v190, a77
  s_nop 0
  v_mul_f32 v190, v190, v189
  s_nop 0
  v_accvgpr_write_b32 a77, v190
  v_accvgpr_read_b32 v190, a78
  s_nop 0
  v_mul_f32 v190, v190, v189
  s_nop 0
  v_accvgpr_write_b32 a78, v190
  v_accvgpr_read_b32 v190, a79
  s_nop 0
  v_mul_f32 v190, v190, v189
  s_nop 0
  v_accvgpr_write_b32 a79, v190
  v_accvgpr_read_b32 v190, a80
  s_nop 0
  v_mul_f32 v190, v190, v189
  s_nop 0
  v_accvgpr_write_b32 a80, v190
  v_accvgpr_read_b32 v190, a81
  s_nop 0
  v_mul_f32 v190, v190, v189
  s_nop 0
  v_accvgpr_write_b32 a81, v190
  v_accvgpr_read_b32 v190, a82
  s_nop 0
  v_mul_f32 v190, v190, v189
  s_nop 0
  v_accvgpr_write_b32 a82, v190
  v_accvgpr_read_b32 v190, a83
  s_nop 0
  v_mul_f32 v190, v190, v189
  s_nop 0
  v_accvgpr_write_b32 a83, v190
  v_accvgpr_read_b32 v190, a84
  s_nop 0
  v_mul_f32 v190, v190, v189
  s_nop 0
  v_accvgpr_write_b32 a84, v190
  v_accvgpr_read_b32 v190, a85
  s_nop 0
  v_mul_f32 v190, v190, v189
  s_nop 0
  v_accvgpr_write_b32 a85, v190
  v_accvgpr_read_b32 v190, a86
  s_nop 0
  v_mul_f32 v190, v190, v189
  s_nop 0
  v_accvgpr_write_b32 a86, v190
  v_accvgpr_read_b32 v190, a87
  s_nop 0
  v_mul_f32 v190, v190, v189
  s_nop 0
  v_accvgpr_write_b32 a87, v190
  v_accvgpr_read_b32 v190, a88
  s_nop 0
  v_mul_f32 v190, v190, v189
  s_nop 0
  v_accvgpr_write_b32 a88, v190
  v_accvgpr_read_b32 v190, a89
  s_nop 0
  v_mul_f32 v190, v190, v189
  s_nop 0
  v_accvgpr_write_b32 a89, v190
  v_accvgpr_read_b32 v190, a90
  s_nop 0
  v_mul_f32 v190, v190, v189
  s_nop 0
  v_accvgpr_write_b32 a90, v190
  v_accvgpr_read_b32 v190, a91
  s_nop 0
  v_mul_f32 v190, v190, v189
  s_nop 0
  v_accvgpr_write_b32 a91, v190
  v_accvgpr_read_b32 v190, a92
  s_nop 0
  v_mul_f32 v190, v190, v189
  s_nop 0
  v_accvgpr_write_b32 a92, v190
  v_accvgpr_read_b32 v190, a93
  s_nop 0
  v_mul_f32 v190, v190, v189
  s_nop 0
  v_accvgpr_write_b32 a93, v190
  v_accvgpr_read_b32 v190, a94
  s_nop 0
  v_mul_f32 v190, v190, v189
  s_nop 0
  v_accvgpr_write_b32 a94, v190
  v_accvgpr_read_b32 v190, a95
  s_nop 0
  v_mul_f32 v190, v190, v189
  s_nop 0
  v_accvgpr_write_b32 a95, v190
  v_exp_f32 v184, v20
  v_exp_f32 v185, v21
  s_nop 0
  v_cvt_pk_bf16_f32 v52, v184, v185
  v_exp_f32 v184, v22
  v_exp_f32 v185, v23
  s_nop 0
  v_cvt_pk_bf16_f32 v53, v184, v185
  v_exp_f32 v184, v36
  v_exp_f32 v185, v37
  s_nop 0
  v_cvt_pk_bf16_f32 v54, v184, v185
  v_exp_f32 v184, v38
  v_exp_f32 v185, v39
  s_nop 0
  v_cvt_pk_bf16_f32 v55, v184, v185
  s_nop 1
  v_mfma_f32_16x16x32_bf16 v[184:187], v[112:115], v[52:55], 0
  s_nop 7
  s_nop 1
  v_mov_b32 v191, 0x203
  v_cmp_class_f32 vcc, v100, v191
  v_mov_b32 v191, 0x42800000
  v_cmp_ge_f32 s[42:43], v188, v191
  v_mul_f32 v190, v100, v189
  s_nop 3
  s_or_b64 vcc, vcc, s[42:43]
  s_nop 1
  v_cndmask_b32 v190, v190, v184, vcc
  v_mov_b32 v100, v190
  v_mov_b32 v101, v190
  v_mov_b32 v102, v190
  v_mov_b32 v103, v190
  v_max3_f32 v188, v24, v25, v26
  v_max3_f32 v188, v188, v27, v40
  v_max3_f32 v188, v188, v41, v42
  v_max_f32 v188, v188, v43
  v_mov_b32 v190, v188
  s_nop 1
  v_permlane16_swap_b32 v188, v190
  s_nop 1
  v_max_f32 v188, v188, v190
  v_mov_b32 v190, v188
  s_nop 1
  v_permlane32_swap_b32 v188, v190
  s_nop 1
  v_max_f32 v188, v188, v190
  v_ceil_f32 v188, v188
  v_frexp_exp_i32_f32 v190, v104
  v_add_u32 v190, -12, v190
  v_cvt_f32_i32 v190, v190
  v_max3_f32 v188, v188, v190, 0
  v_cvt_i32_f32 v190, v188
  v_sub_u32 v190, 0, v190
  v_ldexp_f32 v189, 1.0, v190
  v_sub_f32 v24, v24, v188
  v_sub_f32 v25, v25, v188
  v_sub_f32 v26, v26, v188
  v_sub_f32 v27, v27, v188
  v_sub_f32 v40, v40, v188
  v_sub_f32 v41, v41, v188
  v_sub_f32 v42, v42, v188
  v_sub_f32 v43, v43, v188
  v_sub_f32 v88, v88, v188
  v_sub_f32 v89, v89, v188
  v_sub_f32 v90, v90, v188
  v_sub_f32 v91, v91, v188
  v_sub_f32 v118, v118, v188
  v_accvgpr_read_b32 v190, a96
  s_nop 0
  v_mul_f32 v190, v190, v189
  s_nop 0
  v_accvgpr_write_b32 a96, v190
  v_accvgpr_read_b32 v190, a97
  s_nop 0
  v_mul_f32 v190, v190, v189
  s_nop 0
  v_accvgpr_write_b32 a97, v190
  v_accvgpr_read_b32 v190, a98
  s_nop 0
  v_mul_f32 v190, v190, v189
  s_nop 0
  v_accvgpr_write_b32 a98, v190
  v_accvgpr_read_b32 v190, a99
  s_nop 0
  v_mul_f32 v190, v190, v189
  s_nop 0
  v_accvgpr_write_b32 a99, v190
  v_accvgpr_read_b32 v190, a100
  s_nop 0
  v_mul_f32 v190, v190, v189
  s_nop 0
  v_accvgpr_write_b32 a100, v190
  v_accvgpr_read_b32 v190, a101
  s_nop 0
  v_mul_f32 v190, v190, v189
  s_nop 0
  v_accvgpr_write_b32 a101, v190
  v_accvgpr_read_b32 v190, a102
  s_nop 0
  v_mul_f32 v190, v190, v189
  s_nop 0
  v_accvgpr_write_b32 a102, v190
  v_accvgpr_read_b32 v190, a103
  s_nop 0
  v_mul_f32 v190, v190, v189
  s_nop 0
  v_accvgpr_write_b32 a103, v190
  v_accvgpr_read_b32 v190, a104
  s_nop 0
  v_mul_f32 v190, v190, v189
  s_nop 0
  v_accvgpr_write_b32 a104, v190
  v_accvgpr_read_b32 v190, a105
  s_nop 0
  v_mul_f32 v190, v190, v189
  s_nop 0
  v_accvgpr_write_b32 a105, v190
  v_accvgpr_read_b32 v190, a106
  s_nop 0
  v_mul_f32 v190, v190, v189
  s_nop 0
  v_accvgpr_write_b32 a106, v190
  v_accvgpr_read_b32 v190, a107
  s_nop 0
  v_mul_f32 v190, v190, v189
  s_nop 0
  v_accvgpr_write_b32 a107, v190
  v_accvgpr_read_b32 v190, a108
  s_nop 0
  v_mul_f32 v190, v190, v189
  s_nop 0
  v_accvgpr_write_b32 a108, v190
  v_accvgpr_read_b32 v190, a109
  s_nop 0
  v_mul_f32 v190, v190, v189
  s_nop 0
  v_accvgpr_write_b32 a109, v190
  v_accvgpr_read_b32 v190, a110
  s_nop 0
  v_mul_f32 v190, v190, v189
  s_nop 0
  v_accvgpr_write_b32 a110, v190
  v_accvgpr_read_b32 v190, a111
  s_nop 0
  v_mul_f32 v190, v190, v189
  s_nop 0
  v_accvgpr_write_b32 a111, v190
  v_accvgpr_read_b32 v190, a112
  s_nop 0
  v_mul_f32 v190, v190, v189
  s_nop 0
  v_accvgpr_write_b32 a112, v190
  v_accvgpr_read_b32 v190, a113
  s_nop 0
  v_mul_f32 v190, v190, v189
  s_nop 0
  v_accvgpr_write_b32 a113, v190
  v_accvgpr_read_b32 v190, a114
  s_nop 0
  v_mul_f32 v190, v190, v189
  s_nop 0
  v_accvgpr_write_b32 a114, v190
  v_accvgpr_read_b32 v190, a115
  s_nop 0
  v_mul_f32 v190, v190, v189
  s_nop 0
  v_accvgpr_write_b32 a115, v190
  v_accvgpr_read_b32 v190, a116
  s_nop 0
  v_mul_f32 v190, v190, v189
  s_nop 0
  v_accvgpr_write_b32 a116, v190
  v_accvgpr_read_b32 v190, a117
  s_nop 0
  v_mul_f32 v190, v190, v189
  s_nop 0
  v_accvgpr_write_b32 a117, v190
  v_accvgpr_read_b32 v190, a118
  s_nop 0
  v_mul_f32 v190, v190, v189
  s_nop 0
  v_accvgpr_write_b32 a118, v190
  v_accvgpr_read_b32 v190, a119
  s_nop 0
  v_mul_f32 v190, v190, v189
  s_nop 0
  v_accvgpr_write_b32 a119, v190
  v_accvgpr_read_b32 v190, a120
  s_nop 0
  v_mul_f32 v190, v190, v189
  s_nop 0
  v_accvgpr_write_b32 a120, v190
  v_accvgpr_read_b32 v190, a121
  s_nop 0
  v_mul_f32 v190, v190, v189
  s_nop 0
  v_accvgpr_write_b32 a121, v190
  v_accvgpr_read_b32 v190, a122
  s_nop 0
  v_mul_f32 v190, v190, v189
  s_nop 0
  v_accvgpr_write_b32 a122, v190
  v_accvgpr_read_b32 v190, a123
  s_nop 0
  v_mul_f32 v190, v190, v189
  s_nop 0
  v_accvgpr_write_b32 a123, v190
  v_accvgpr_read_b32 v190, a124
  s_nop 0
  v_mul_f32 v190, v190, v189
  s_nop 0
  v_accvgpr_write_b32 a124, v190
  v_accvgpr_read_b32 v190, a125
  s_nop 0
  v_mul_f32 v190, v190, v189
  s_nop 0
  v_accvgpr_write_b32 a125, v190
  v_accvgpr_read_b32 v190, a126
  s_nop 0
  v_mul_f32 v190, v190, v189
  s_nop 0
  v_accvgpr_write_b32 a126, v190
  v_accvgpr_read_b32 v190, a127
  s_nop 0
  v_mul_f32 v190, v190, v189
  s_nop 0
  v_accvgpr_write_b32 a127, v190
  v_accvgpr_read_b32 v190, a128
  s_nop 0
  v_mul_f32 v190, v190, v189
  s_nop 0
  v_accvgpr_write_b32 a128, v190
  v_accvgpr_read_b32 v190, a129
  s_nop 0
  v_mul_f32 v190, v190, v189
  s_nop 0
  v_accvgpr_write_b32 a129, v190
  v_accvgpr_read_b32 v190, a130
  s_nop 0
  v_mul_f32 v190, v190, v189
  s_nop 0
  v_accvgpr_write_b32 a130, v190
  v_accvgpr_read_b32 v190, a131
  s_nop 0
  v_mul_f32 v190, v190, v189
  s_nop 0
  v_accvgpr_write_b32 a131, v190
  v_accvgpr_read_b32 v190, a132
  s_nop 0
  v_mul_f32 v190, v190, v189
  s_nop 0
  v_accvgpr_write_b32 a132, v190
  v_accvgpr_read_b32 v190, a133
  s_nop 0
  v_mul_f32 v190, v190, v189
  s_nop 0
  v_accvgpr_write_b32 a133, v190
  v_accvgpr_read_b32 v190, a134
  s_nop 0
  v_mul_f32 v190, v190, v189
  s_nop 0
  v_accvgpr_write_b32 a134, v190
  v_accvgpr_read_b32 v190, a135
  s_nop 0
  v_mul_f32 v190, v190, v189
  s_nop 0
  v_accvgpr_write_b32 a135, v190
  v_accvgpr_read_b32 v190, a136
  s_nop 0
  v_mul_f32 v190, v190, v189
  s_nop 0
  v_accvgpr_write_b32 a136, v190
  v_accvgpr_read_b32 v190, a137
  s_nop 0
  v_mul_f32 v190, v190, v189
  s_nop 0
  v_accvgpr_write_b32 a137, v190
  v_accvgpr_read_b32 v190, a138
  s_nop 0
  v_mul_f32 v190, v190, v189
  s_nop 0
  v_accvgpr_write_b32 a138, v190
  v_accvgpr_read_b32 v190, a139
  s_nop 0
  v_mul_f32 v190, v190, v189
  s_nop 0
  v_accvgpr_write_b32 a139, v190
  v_accvgpr_read_b32 v190, a140
  s_nop 0
  v_mul_f32 v190, v190, v189
  s_nop 0
  v_accvgpr_write_b32 a140, v190
  v_accvgpr_read_b32 v190, a141
  s_nop 0
  v_mul_f32 v190, v190, v189
  s_nop 0
  v_accvgpr_write_b32 a141, v190
  v_accvgpr_read_b32 v190, a142
  s_nop 0
  v_mul_f32 v190, v190, v189
  s_nop 0
  v_accvgpr_write_b32 a142, v190
  v_accvgpr_read_b32 v190, a143
  s_nop 0
  v_mul_f32 v190, v190, v189
  s_nop 0
  v_accvgpr_write_b32 a143, v190
  v_exp_f32 v184, v24
  v_exp_f32 v185, v25
  s_nop 0
  v_cvt_pk_bf16_f32 v56, v184, v185
  v_exp_f32 v184, v26
  v_exp_f32 v185, v27
  s_nop 0
  v_cvt_pk_bf16_f32 v57, v184, v185
  v_exp_f32 v184, v40
  v_exp_f32 v185, v41
  s_nop 0
  v_cvt_pk_bf16_f32 v58, v184, v185
  v_exp_f32 v184, v42
  v_exp_f32 v185, v43
  s_nop 0
  v_cvt_pk_bf16_f32 v59, v184, v185
  s_nop 1
  v_mfma_f32_16x16x32_bf16 v[184:187], v[112:115], v[56:59], 0
  s_nop 7
  s_nop 1
  v_mov_b32 v191, 0x203
  v_cmp_class_f32 vcc, v104, v191
  v_mov_b32 v191, 0x42800000
  v_cmp_ge_f32 s[42:43], v188, v191
  v_mul_f32 v190, v104, v189
  s_nop 3
  s_or_b64 vcc, vcc, s[42:43]
  s_nop 1
  v_cndmask_b32 v190, v190, v184, vcc
  v_mov_b32 v104, v190
  v_mov_b32 v105, v190
  v_mov_b32 v106, v190
  v_mov_b32 v107, v190
  v_max3_f32 v188, v28, v29, v30
  v_max3_f32 v188, v188, v31, v44
  v_max3_f32 v188, v188, v45, v46
  v_max_f32 v188, v188, v47
  v_mov_b32 v190, v188
  s_nop 1
  v_permlane16_swap_b32 v188, v190
  s_nop 1
  v_max_f32 v188, v188, v190
  v_mov_b32 v190, v188
  s_nop 1
  v_permlane32_swap_b32 v188, v190
  s_nop 1
  v_max_f32 v188, v188, v190
  v_ceil_f32 v188, v188
  v_frexp_exp_i32_f32 v190, v108
  v_add_u32 v190, -12, v190
  v_cvt_f32_i32 v190, v190
  v_max3_f32 v188, v188, v190, 0
  v_cvt_i32_f32 v190, v188
  v_sub_u32 v190, 0, v190
  v_ldexp_f32 v189, 1.0, v190
  v_sub_f32 v28, v28, v188
  v_sub_f32 v29, v29, v188
  v_sub_f32 v30, v30, v188
  v_sub_f32 v31, v31, v188
  v_sub_f32 v44, v44, v188
  v_sub_f32 v45, v45, v188
  v_sub_f32 v46, v46, v188
  v_sub_f32 v47, v47, v188
  v_sub_f32 v92, v92, v188
  v_sub_f32 v93, v93, v188
  v_sub_f32 v94, v94, v188
  v_sub_f32 v95, v95, v188
  v_sub_f32 v119, v119, v188
  v_accvgpr_read_b32 v190, a144
  s_nop 0
  v_mul_f32 v190, v190, v189
  s_nop 0
  v_accvgpr_write_b32 a144, v190
  v_accvgpr_read_b32 v190, a145
  s_nop 0
  v_mul_f32 v190, v190, v189
  s_nop 0
  v_accvgpr_write_b32 a145, v190
  v_accvgpr_read_b32 v190, a146
  s_nop 0
  v_mul_f32 v190, v190, v189
  s_nop 0
  v_accvgpr_write_b32 a146, v190
  v_accvgpr_read_b32 v190, a147
  s_nop 0
  v_mul_f32 v190, v190, v189
  s_nop 0
  v_accvgpr_write_b32 a147, v190
  v_accvgpr_read_b32 v190, a148
  s_nop 0
  v_mul_f32 v190, v190, v189
  s_nop 0
  v_accvgpr_write_b32 a148, v190
  v_accvgpr_read_b32 v190, a149
  s_nop 0
  v_mul_f32 v190, v190, v189
  s_nop 0
  v_accvgpr_write_b32 a149, v190
  v_accvgpr_read_b32 v190, a150
  s_nop 0
  v_mul_f32 v190, v190, v189
  s_nop 0
  v_accvgpr_write_b32 a150, v190
  v_accvgpr_read_b32 v190, a151
  s_nop 0
  v_mul_f32 v190, v190, v189
  s_nop 0
  v_accvgpr_write_b32 a151, v190
  v_accvgpr_read_b32 v190, a152
  s_nop 0
  v_mul_f32 v190, v190, v189
  s_nop 0
  v_accvgpr_write_b32 a152, v190
  v_accvgpr_read_b32 v190, a153
  s_nop 0
  v_mul_f32 v190, v190, v189
  s_nop 0
  v_accvgpr_write_b32 a153, v190
  v_accvgpr_read_b32 v190, a154
  s_nop 0
  v_mul_f32 v190, v190, v189
  s_nop 0
  v_accvgpr_write_b32 a154, v190
  v_accvgpr_read_b32 v190, a155
  s_nop 0
  v_mul_f32 v190, v190, v189
  s_nop 0
  v_accvgpr_write_b32 a155, v190
  v_accvgpr_read_b32 v190, a156
  s_nop 0
  v_mul_f32 v190, v190, v189
  s_nop 0
  v_accvgpr_write_b32 a156, v190
  v_accvgpr_read_b32 v190, a157
  s_nop 0
  v_mul_f32 v190, v190, v189
  s_nop 0
  v_accvgpr_write_b32 a157, v190
  v_accvgpr_read_b32 v190, a158
  s_nop 0
  v_mul_f32 v190, v190, v189
  s_nop 0
  v_accvgpr_write_b32 a158, v190
  v_accvgpr_read_b32 v190, a159
  s_nop 0
  v_mul_f32 v190, v190, v189
  s_nop 0
  v_accvgpr_write_b32 a159, v190
  v_accvgpr_read_b32 v190, a160
  s_nop 0
  v_mul_f32 v190, v190, v189
  s_nop 0
  v_accvgpr_write_b32 a160, v190
  v_accvgpr_read_b32 v190, a161
  s_nop 0
  v_mul_f32 v190, v190, v189
  s_nop 0
  v_accvgpr_write_b32 a161, v190
  v_accvgpr_read_b32 v190, a162
  s_nop 0
  v_mul_f32 v190, v190, v189
  s_nop 0
  v_accvgpr_write_b32 a162, v190
  v_accvgpr_read_b32 v190, a163
  s_nop 0
  v_mul_f32 v190, v190, v189
  s_nop 0
  v_accvgpr_write_b32 a163, v190
  v_accvgpr_read_b32 v190, a164
  s_nop 0
  v_mul_f32 v190, v190, v189
  s_nop 0
  v_accvgpr_write_b32 a164, v190
  v_accvgpr_read_b32 v190, a165
  s_nop 0
  v_mul_f32 v190, v190, v189
  s_nop 0
  v_accvgpr_write_b32 a165, v190
  v_accvgpr_read_b32 v190, a166
  s_nop 0
  v_mul_f32 v190, v190, v189
  s_nop 0
  v_accvgpr_write_b32 a166, v190
  v_accvgpr_read_b32 v190, a167
  s_nop 0
  v_mul_f32 v190, v190, v189
  s_nop 0
  v_accvgpr_write_b32 a167, v190
  v_accvgpr_read_b32 v190, a168
  s_nop 0
  v_mul_f32 v190, v190, v189
  s_nop 0
  v_accvgpr_write_b32 a168, v190
  v_accvgpr_read_b32 v190, a169
  s_nop 0
  v_mul_f32 v190, v190, v189
  s_nop 0
  v_accvgpr_write_b32 a169, v190
  v_accvgpr_read_b32 v190, a170
  s_nop 0
  v_mul_f32 v190, v190, v189
  s_nop 0
  v_accvgpr_write_b32 a170, v190
  v_accvgpr_read_b32 v190, a171
  s_nop 0
  v_mul_f32 v190, v190, v189
  s_nop 0
  v_accvgpr_write_b32 a171, v190
  v_accvgpr_read_b32 v190, a172
  s_nop 0
  v_mul_f32 v190, v190, v189
  s_nop 0
  v_accvgpr_write_b32 a172, v190
  v_accvgpr_read_b32 v190, a173
  s_nop 0
  v_mul_f32 v190, v190, v189
  s_nop 0
  v_accvgpr_write_b32 a173, v190
  v_accvgpr_read_b32 v190, a174
  s_nop 0
  v_mul_f32 v190, v190, v189
  s_nop 0
  v_accvgpr_write_b32 a174, v190
  v_accvgpr_read_b32 v190, a175
  s_nop 0
  v_mul_f32 v190, v190, v189
  s_nop 0
  v_accvgpr_write_b32 a175, v190
  v_accvgpr_read_b32 v190, a176
  s_nop 0
  v_mul_f32 v190, v190, v189
  s_nop 0
  v_accvgpr_write_b32 a176, v190
  v_accvgpr_read_b32 v190, a177
  s_nop 0
  v_mul_f32 v190, v190, v189
  s_nop 0
  v_accvgpr_write_b32 a177, v190
  v_accvgpr_read_b32 v190, a178
  s_nop 0
  v_mul_f32 v190, v190, v189
  s_nop 0
  v_accvgpr_write_b32 a178, v190
  v_accvgpr_read_b32 v190, a179
  s_nop 0
  v_mul_f32 v190, v190, v189
  s_nop 0
  v_accvgpr_write_b32 a179, v190
  v_accvgpr_read_b32 v190, a180
  s_nop 0
  v_mul_f32 v190, v190, v189
  s_nop 0
  v_accvgpr_write_b32 a180, v190
  v_accvgpr_read_b32 v190, a181
  s_nop 0
  v_mul_f32 v190, v190, v189
  s_nop 0
  v_accvgpr_write_b32 a181, v190
  v_accvgpr_read_b32 v190, a182
  s_nop 0
  v_mul_f32 v190, v190, v189
  s_nop 0
  v_accvgpr_write_b32 a182, v190
  v_accvgpr_read_b32 v190, a183
  s_nop 0
  v_mul_f32 v190, v190, v189
  s_nop 0
  v_accvgpr_write_b32 a183, v190
  v_accvgpr_read_b32 v190, a184
  s_nop 0
  v_mul_f32 v190, v190, v189
  s_nop 0
  v_accvgpr_write_b32 a184, v190
  v_accvgpr_read_b32 v190, a185
  s_nop 0
  v_mul_f32 v190, v190, v189
  s_nop 0
  v_accvgpr_write_b32 a185, v190
  v_accvgpr_read_b32 v190, a186
  s_nop 0
  v_mul_f32 v190, v190, v189
  s_nop 0
  v_accvgpr_write_b32 a186, v190
  v_accvgpr_read_b32 v190, a187
  s_nop 0
  v_mul_f32 v190, v190, v189
  s_nop 0
  v_accvgpr_write_b32 a187, v190
  v_accvgpr_read_b32 v190, a188
  s_nop 0
  v_mul_f32 v190, v190, v189
  s_nop 0
  v_accvgpr_write_b32 a188, v190
  v_accvgpr_read_b32 v190, a189
  s_nop 0
  v_mul_f32 v190, v190, v189
  s_nop 0
  v_accvgpr_write_b32 a189, v190
  v_accvgpr_read_b32 v190, a190
  s_nop 0
  v_mul_f32 v190, v190, v189
  s_nop 0
  v_accvgpr_write_b32 a190, v190
  v_accvgpr_read_b32 v190, a191
  s_nop 0
  v_mul_f32 v190, v190, v189
  s_nop 0
  v_accvgpr_write_b32 a191, v190
  v_exp_f32 v184, v28
  v_exp_f32 v185, v29
  s_nop 0
  v_cvt_pk_bf16_f32 v60, v184, v185
  v_exp_f32 v184, v30
  v_exp_f32 v185, v31
  s_nop 0
  v_cvt_pk_bf16_f32 v61, v184, v185
  v_exp_f32 v184, v44
  v_exp_f32 v185, v45
  s_nop 0
  v_cvt_pk_bf16_f32 v62, v184, v185
  v_exp_f32 v184, v46
  v_exp_f32 v185, v47
  s_nop 0
  v_cvt_pk_bf16_f32 v63, v184, v185
  s_nop 1
  v_mfma_f32_16x16x32_bf16 v[184:187], v[112:115], v[60:63], 0
  s_nop 7
  s_nop 1
  v_mov_b32 v191, 0x203
  v_cmp_class_f32 vcc, v108, v191
  v_mov_b32 v191, 0x42800000
  v_cmp_ge_f32 s[42:43], v188, v191
  v_mul_f32 v190, v108, v189
  s_nop 3
  s_or_b64 vcc, vcc, s[42:43]
  s_nop 1
  v_cndmask_b32 v190, v190, v184, vcc
  v_mov_b32 v108, v190
  v_mov_b32 v109, v190
  v_mov_b32 v110, v190
  v_mov_b32 v111, v190
  s_nop 3
  s_setpc_b64 s[72:73]
RARE_p1_1:
  s_nop 7
  s_nop 7
  v_max3_f32 v188, v16, v17, v18
  v_max3_f32 v188, v188, v19, v32
  v_max3_f32 v188, v188, v33, v34
  v_max_f32 v188, v188, v35
  v_mov_b32 v190, v188
  s_nop 1
  v_permlane16_swap_b32 v188, v190
  s_nop 1
  v_max_f32 v188, v188, v190
  v_mov_b32 v190, v188
  s_nop 1
  v_permlane32_swap_b32 v188, v190
  s_nop 1
  v_max_f32 v188, v188, v190
  v_ceil_f32 v188, v188
  v_frexp_exp_i32_f32 v190, v96
  v_add_u32 v190, -12, v190
  v_cvt_f32_i32 v190, v190
  v_max3_f32 v188, v188, v190, 0
  v_cvt_i32_f32 v190, v188
  v_sub_u32 v190, 0, v190
  v_ldexp_f32 v189, 1.0, v190
  v_sub_f32 v16, v16, v188
  v_sub_f32 v17, v17, v188
  v_sub_f32 v18, v18, v188
  v_sub_f32 v19, v19, v188
  v_sub_f32 v32, v32, v188
  v_sub_f32 v33, v33, v188
  v_sub_f32 v34, v34, v188
  v_sub_f32 v35, v35, v188
  v_sub_f32 v80, v80, v188
  v_sub_f32 v81, v81, v188
  v_sub_f32 v82, v82, v188
  v_sub_f32 v83, v83, v188
  v_sub_f32 v192, v192, v188
  v_sub_f32 v193, v193, v188
  v_sub_f32 v194, v194, v188
  v_sub_f32 v195, v195, v188
  v_sub_f32 v116, v116, v188
  v_accvgpr_read_b32 v190, a0
  s_nop 0
  v_mul_f32 v190, v190, v189
  s_nop 0
  v_accvgpr_write_b32 a0, v190
  v_accvgpr_read_b32 v190, a1
  s_nop 0
  v_mul_f32 v190, v190, v189
  s_nop 0
  v_accvgpr_write_b32 a1, v190
  v_accvgpr_read_b32 v190, a2
  s_nop 0
  v_mul_f32 v190, v190, v189
  s_nop 0
  v_accvgpr_write_b32 a2, v190
  v_accvgpr_read_b32 v190, a3
  s_nop 0
  v_mul_f32 v190, v190, v189
  s_nop 0
  v_accvgpr_write_b32 a3, v190
  v_accvgpr_read_b32 v190, a4
  s_nop 0
  v_mul_f32 v190, v190, v189
  s_nop 0
  v_accvgpr_write_b32 a4, v190
  v_accvgpr_read_b32 v190, a5
  s_nop 0
  v_mul_f32 v190, v190, v189
  s_nop 0
  v_accvgpr_write_b32 a5, v190
  v_accvgpr_read_b32 v190, a6
  s_nop 0
  v_mul_f32 v190, v190, v189
  s_nop 0
  v_accvgpr_write_b32 a6, v190
  v_accvgpr_read_b32 v190, a7
  s_nop 0
  v_mul_f32 v190, v190, v189
  s_nop 0
  v_accvgpr_write_b32 a7, v190
  v_accvgpr_read_b32 v190, a8
  s_nop 0
  v_mul_f32 v190, v190, v189
  s_nop 0
  v_accvgpr_write_b32 a8, v190
  v_accvgpr_read_b32 v190, a9
  s_nop 0
  v_mul_f32 v190, v190, v189
  s_nop 0
  v_accvgpr_write_b32 a9, v190
  v_accvgpr_read_b32 v190, a10
  s_nop 0
  v_mul_f32 v190, v190, v189
  s_nop 0
  v_accvgpr_write_b32 a10, v190
  v_accvgpr_read_b32 v190, a11
  s_nop 0
  v_mul_f32 v190, v190, v189
  s_nop 0
  v_accvgpr_write_b32 a11, v190
  v_accvgpr_read_b32 v190, a12
  s_nop 0
  v_mul_f32 v190, v190, v189
  s_nop 0
  v_accvgpr_write_b32 a12, v190
  v_accvgpr_read_b32 v190, a13
  s_nop 0
  v_mul_f32 v190, v190, v189
  s_nop 0
  v_accvgpr_write_b32 a13, v190
  v_accvgpr_read_b32 v190, a14
  s_nop 0
  v_mul_f32 v190, v190, v189
  s_nop 0
  v_accvgpr_write_b32 a14, v190
  v_accvgpr_read_b32 v190, a15
  s_nop 0
  v_mul_f32 v190, v190, v189
  s_nop 0
  v_accvgpr_write_b32 a15, v190
  v_accvgpr_read_b32 v190, a16
  s_nop 0
  v_mul_f32 v190, v190, v189
  s_nop 0
  v_accvgpr_write_b32 a16, v190
  v_accvgpr_read_b32 v190, a17
  s_nop 0
  v_mul_f32 v190, v190, v189
  s_nop 0
  v_accvgpr_write_b32 a17, v190
  v_accvgpr_read_b32 v190, a18
  s_nop 0
  v_mul_f32 v190, v190, v189
  s_nop 0
  v_accvgpr_write_b32 a18, v190
  v_accvgpr_read_b32 v190, a19
  s_nop 0
  v_mul_f32 v190, v190, v189
  s_nop 0
  v_accvgpr_write_b32 a19, v190
  v_accvgpr_read_b32 v190, a20
  s_nop 0
  v_mul_f32 v190, v190, v189
  s_nop 0
  v_accvgpr_write_b32 a20, v190
  v_accvgpr_read_b32 v190, a21
  s_nop 0
  v_mul_f32 v190, v190, v189
  s_nop 0
  v_accvgpr_write_b32 a21, v190
  v_accvgpr_read_b32 v190, a22
  s_nop 0
  v_mul_f32 v190, v190, v189
  s_nop 0
  v_accvgpr_write_b32 a22, v190
  v_accvgpr_read_b32 v190, a23
  s_nop 0
  v_mul_f32 v190, v190, v189
  s_nop 0
  v_accvgpr_write_b32 a23, v190
  v_accvgpr_read_b32 v190, a24
  s_nop 0
  v_mul_f32 v190, v190, v189
  s_nop 0
  v_accvgpr_write_b32 a24, v190
  v_accvgpr_read_b32 v190, a25
  s_nop 0
  v_mul_f32 v190, v190, v189
  s_nop 0
  v_accvgpr_write_b32 a25, v190
  v_accvgpr_read_b32 v190, a26
  s_nop 0
  v_mul_f32 v190, v190, v189
  s_nop 0
  v_accvgpr_write_b32 a26, v190
  v_accvgpr_read_b32 v190, a27
  s_nop 0
  v_mul_f32 v190, v190, v189
  s_nop 0
  v_accvgpr_write_b32 a27, v190
  v_accvgpr_read_b32 v190, a28
  s_nop 0
  v_mul_f32 v190, v190, v189
  s_nop 0
  v_accvgpr_write_b32 a28, v190
  v_accvgpr_read_b32 v190, a29
  s_nop 0
  v_mul_f32 v190, v190, v189
  s_nop 0
  v_accvgpr_write_b32 a29, v190
  v_accvgpr_read_b32 v190, a30
  s_nop 0
  v_mul_f32 v190, v190, v189
  s_nop 0
  v_accvgpr_write_b32 a30, v190
  v_accvgpr_read_b32 v190, a31
  s_nop 0
  v_mul_f32 v190, v190, v189
  s_nop 0
  v_accvgpr_write_b32 a31, v190
  v_accvgpr_read_b32 v190, a32
  s_nop 0
  v_mul_f32 v190, v190, v189
  s_nop 0
  v_accvgpr_write_b32 a32, v190
  v_accvgpr_read_b32 v190, a33
  s_nop 0
  v_mul_f32 v190, v190, v189
  s_nop 0
  v_accvgpr_write_b32 a33, v190
  v_accvgpr_read_b32 v190, a34
  s_nop 0
  v_mul_f32 v190, v190, v189
  s_nop 0
  v_accvgpr_write_b32 a34, v190
  v_accvgpr_read_b32 v190, a35
  s_nop 0
  v_mul_f32 v190, v190, v189
  s_nop 0
  v_accvgpr_write_b32 a35, v190
  v_accvgpr_read_b32 v190, a36
  s_nop 0
  v_mul_f32 v190, v190, v189
  s_nop 0
  v_accvgpr_write_b32 a36, v190
  v_accvgpr_read_b32 v190, a37
  s_nop 0
  v_mul_f32 v190, v190, v189
  s_nop 0
  v_accvgpr_write_b32 a37, v190
  v_accvgpr_read_b32 v190, a38
  s_nop 0
  v_mul_f32 v190, v190, v189
  s_nop 0
  v_accvgpr_write_b32 a38, v190
  v_accvgpr_read_b32 v190, a39
  s_nop 0
  v_mul_f32 v190, v190, v189
  s_nop 0
  v_accvgpr_write_b32 a39, v190
  v_accvgpr_read_b32 v190, a40
  s_nop 0
  v_mul_f32 v190, v190, v189
  s_nop 0
  v_accvgpr_write_b32 a40, v190
  v_accvgpr_read_b32 v190, a41
  s_nop 0
  v_mul_f32 v190, v190, v189
  s_nop 0
  v_accvgpr_write_b32 a41, v190
  v_accvgpr_read_b32 v190, a42
  s_nop 0
  v_mul_f32 v190, v190, v189
  s_nop 0
  v_accvgpr_write_b32 a42, v190
  v_accvgpr_read_b32 v190, a43
  s_nop 0
  v_mul_f32 v190, v190, v189
  s_nop 0
  v_accvgpr_write_b32 a43, v190
  v_accvgpr_read_b32 v190, a44
  s_nop 0
  v_mul_f32 v190, v190, v189
  s_nop 0
  v_accvgpr_write_b32 a44, v190
  v_accvgpr_read_b32 v190, a45
  s_nop 0
  v_mul_f32 v190, v190, v189
  s_nop 0
  v_accvgpr_write_b32 a45, v190
  v_accvgpr_read_b32 v190, a46
  s_nop 0
  v_mul_f32 v190, v190, v189
  s_nop 0
  v_accvgpr_write_b32 a46, v190
  v_accvgpr_read_b32 v190, a47
  s_nop 0
  v_mul_f32 v190, v190, v189
  s_nop 0
  v_accvgpr_write_b32 a47, v190
  v_exp_f32 v184, v16
  v_exp_f32 v185, v17
  s_nop 0
  v_cvt_pk_bf16_f32 v64, v184, v185
  v_exp_f32 v184, v18
  v_exp_f32 v185, v19
  s_nop 0
  v_cvt_pk_bf16_f32 v65, v184, v185
  v_exp_f32 v184, v32
  v_exp_f32 v185, v33
  s_nop 0
  v_cvt_pk_bf16_f32 v66, v184, v185
  v_exp_f32 v184, v34
  v_exp_f32 v185, v35
  s_nop 0
  v_cvt_pk_bf16_f32 v67, v184, v185
  s_nop 1
  v_mfma_f32_16x16x32_bf16 v[184:187], v[112:115], v[64:67], 0
  s_nop 7
  s_nop 1
  v_mov_b32 v191, 0x203
  v_cmp_class_f32 vcc, v96, v191
  v_mov_b32 v191, 0x42800000
  v_cmp_ge_f32 s[42:43], v188, v191
  v_mul_f32 v190, v96, v189
  s_nop 3
  s_or_b64 vcc, vcc, s[42:43]
  s_nop 1
  v_cndmask_b32 v190, v190, v184, vcc
  v_mov_b32 v96, v190
  v_mov_b32 v97, v190
  v_mov_b32 v98, v190
  v_mov_b32 v99, v190
  v_max3_f32 v188, v20, v21, v22
  v_max3_f32 v188, v188, v23, v36
  v_max3_f32 v188, v188, v37, v38
  v_max_f32 v188, v188, v39
  v_mov_b32 v190, v188
  s_nop 1
  v_permlane16_swap_b32 v188, v190
  s_nop 1
  v_max_f32 v188, v188, v190
  v_mov_b32 v190, v188
  s_nop 1
  v_permlane32_swap_b32 v188, v190
  s_nop 1
  v_max_f32 v188, v188, v190
  v_ceil_f32 v188, v188
  v_frexp_exp_i32_f32 v190, v100
  v_add_u32 v190, -12, v190
  v_cvt_f32_i32 v190, v190
  v_max3_f32 v188, v188, v190, 0
  v_cvt_i32_f32 v190, v188
  v_sub_u32 v190, 0, v190
  v_ldexp_f32 v189, 1.0, v190
  v_sub_f32 v20, v20, v188
  v_sub_f32 v21, v21, v188
  v_sub_f32 v22, v22, v188
  v_sub_f32 v23, v23, v188
  v_sub_f32 v36, v36, v188
  v_sub_f32 v37, v37, v188
  v_sub_f32 v38, v38, v188
  v_sub_f32 v39, v39, v188
  v_sub_f32 v84, v84, v188
  v_sub_f32 v85, v85, v188
  v_sub_f32 v86, v86, v188
  v_sub_f32 v87, v87, v188
  v_sub_f32 v196, v196, v188
  v_sub_f32 v197, v197, v188
  v_sub_f32 v198, v198, v188
  v_sub_f32 v199, v199, v188
  v_sub_f32 v117, v117, v188
  v_accvgpr_read_b32 v190, a48
  s_nop 0
  v_mul_f32 v190, v190, v189
  s_nop 0
  v_accvgpr_write_b32 a48, v190
  v_accvgpr_read_b32 v190, a49
  s_nop 0
  v_mul_f32 v190, v190, v189
  s_nop 0
  v_accvgpr_write_b32 a49, v190
  v_accvgpr_read_b32 v190, a50
  s_nop 0
  v_mul_f32 v190, v190, v189
  s_nop 0
  v_accvgpr_write_b32 a50, v190
  v_accvgpr_read_b32 v190, a51
  s_nop 0
  v_mul_f32 v190, v190, v189
  s_nop 0
  v_accvgpr_write_b32 a51, v190
  v_accvgpr_read_b32 v190, a52
  s_nop 0
  v_mul_f32 v190, v190, v189
  s_nop 0
  v_accvgpr_write_b32 a52, v190
  v_accvgpr_read_b32 v190, a53
  s_nop 0
  v_mul_f32 v190, v190, v189
  s_nop 0
  v_accvgpr_write_b32 a53, v190
  v_accvgpr_read_b32 v190, a54
  s_nop 0
  v_mul_f32 v190, v190, v189
  s_nop 0
  v_accvgpr_write_b32 a54, v190
  v_accvgpr_read_b32 v190, a55
  s_nop 0
  v_mul_f32 v190, v190, v189
  s_nop 0
  v_accvgpr_write_b32 a55, v190
  v_accvgpr_read_b32 v190, a56
  s_nop 0
  v_mul_f32 v190, v190, v189
  s_nop 0
  v_accvgpr_write_b32 a56, v190
  v_accvgpr_read_b32 v190, a57
  s_nop 0
  v_mul_f32 v190, v190, v189
  s_nop 0
  v_accvgpr_write_b32 a57, v190
  v_accvgpr_read_b32 v190, a58
  s_nop 0
  v_mul_f32 v190, v190, v189
  s_nop 0
  v_accvgpr_write_b32 a58, v190
  v_accvgpr_read_b32 v190, a59
  s_nop 0
  v_mul_f32 v190, v190, v189
  s_nop 0
  v_accvgpr_write_b32 a59, v190
  v_accvgpr_read_b32 v190, a60
  s_nop 0
  v_mul_f32 v190, v190, v189
  s_nop 0
  v_accvgpr_write_b32 a60, v190
  v_accvgpr_read_b32 v190, a61
  s_nop 0
  v_mul_f32 v190, v190, v189
  s_nop 0
  v_accvgpr_write_b32 a61, v190
  v_accvgpr_read_b32 v190, a62
  s_nop 0
  v_mul_f32 v190, v190, v189
  s_nop 0
  v_accvgpr_write_b32 a62, v190
  v_accvgpr_read_b32 v190, a63
  s_nop 0
  v_mul_f32 v190, v190, v189
  s_nop 0
  v_accvgpr_write_b32 a63, v190
  v_accvgpr_read_b32 v190, a64
  s_nop 0
  v_mul_f32 v190, v190, v189
  s_nop 0
  v_accvgpr_write_b32 a64, v190
  v_accvgpr_read_b32 v190, a65
  s_nop 0
  v_mul_f32 v190, v190, v189
  s_nop 0
  v_accvgpr_write_b32 a65, v190
  v_accvgpr_read_b32 v190, a66
  s_nop 0
  v_mul_f32 v190, v190, v189
  s_nop 0
  v_accvgpr_write_b32 a66, v190
  v_accvgpr_read_b32 v190, a67
  s_nop 0
  v_mul_f32 v190, v190, v189
  s_nop 0
  v_accvgpr_write_b32 a67, v190
  v_accvgpr_read_b32 v190, a68
  s_nop 0
  v_mul_f32 v190, v190, v189
  s_nop 0
  v_accvgpr_write_b32 a68, v190
  v_accvgpr_read_b32 v190, a69
  s_nop 0
  v_mul_f32 v190, v190, v189
  s_nop 0
  v_accvgpr_write_b32 a69, v190
  v_accvgpr_read_b32 v190, a70
  s_nop 0
  v_mul_f32 v190, v190, v189
  s_nop 0
  v_accvgpr_write_b32 a70, v190
  v_accvgpr_read_b32 v190, a71
  s_nop 0
  v_mul_f32 v190, v190, v189
  s_nop 0
  v_accvgpr_write_b32 a71, v190
  v_accvgpr_read_b32 v190, a72
  s_nop 0
  v_mul_f32 v190, v190, v189
  s_nop 0
  v_accvgpr_write_b32 a72, v190
  v_accvgpr_read_b32 v190, a73
  s_nop 0
  v_mul_f32 v190, v190, v189
  s_nop 0
  v_accvgpr_write_b32 a73, v190
  v_accvgpr_read_b32 v190, a74
  s_nop 0
  v_mul_f32 v190, v190, v189
  s_nop 0
  v_accvgpr_write_b32 a74, v190
  v_accvgpr_read_b32 v190, a75
  s_nop 0
  v_mul_f32 v190, v190, v189
  s_nop 0
  v_accvgpr_write_b32 a75, v190
  v_accvgpr_read_b32 v190, a76
  s_nop 0
  v_mul_f32 v190, v190, v189
  s_nop 0
  v_accvgpr_write_b32 a76, v190
  v_accvgpr_read_b32 v190, a77
  s_nop 0
  v_mul_f32 v190, v190, v189
  s_nop 0
  v_accvgpr_write_b32 a77, v190
  v_accvgpr_read_b32 v190, a78
  s_nop 0
  v_mul_f32 v190, v190, v189
  s_nop 0
  v_accvgpr_write_b32 a78, v190
  v_accvgpr_read_b32 v190, a79
  s_nop 0
  v_mul_f32 v190, v190, v189
  s_nop 0
  v_accvgpr_write_b32 a79, v190
  v_accvgpr_read_b32 v190, a80
  s_nop 0
  v_mul_f32 v190, v190, v189
  s_nop 0
  v_accvgpr_write_b32 a80, v190
  v_accvgpr_read_b32 v190, a81
  s_nop 0
  v_mul_f32 v190, v190, v189
  s_nop 0
  v_accvgpr_write_b32 a81, v190
  v_accvgpr_read_b32 v190, a82
  s_nop 0
  v_mul_f32 v190, v190, v189
  s_nop 0
  v_accvgpr_write_b32 a82, v190
  v_accvgpr_read_b32 v190, a83
  s_nop 0
  v_mul_f32 v190, v190, v189
  s_nop 0
  v_accvgpr_write_b32 a83, v190
  v_accvgpr_read_b32 v190, a84
  s_nop 0
  v_mul_f32 v190, v190, v189
  s_nop 0
  v_accvgpr_write_b32 a84, v190
  v_accvgpr_read_b32 v190, a85
  s_nop 0
  v_mul_f32 v190, v190, v189
  s_nop 0
  v_accvgpr_write_b32 a85, v190
  v_accvgpr_read_b32 v190, a86
  s_nop 0
  v_mul_f32 v190, v190, v189
  s_nop 0
  v_accvgpr_write_b32 a86, v190
  v_accvgpr_read_b32 v190, a87
  s_nop 0
  v_mul_f32 v190, v190, v189
  s_nop 0
  v_accvgpr_write_b32 a87, v190
  v_accvgpr_read_b32 v190, a88
  s_nop 0
  v_mul_f32 v190, v190, v189
  s_nop 0
  v_accvgpr_write_b32 a88, v190
  v_accvgpr_read_b32 v190, a89
  s_nop 0
  v_mul_f32 v190, v190, v189
  s_nop 0
  v_accvgpr_write_b32 a89, v190
  v_accvgpr_read_b32 v190, a90
  s_nop 0
  v_mul_f32 v190, v190, v189
  s_nop 0
  v_accvgpr_write_b32 a90, v190
  v_accvgpr_read_b32 v190, a91
  s_nop 0
  v_mul_f32 v190, v190, v189
  s_nop 0
  v_accvgpr_write_b32 a91, v190
  v_accvgpr_read_b32 v190, a92
  s_nop 0
  v_mul_f32 v190, v190, v189
  s_nop 0
  v_accvgpr_write_b32 a92, v190
  v_accvgpr_read_b32 v190, a93
  s_nop 0
  v_mul_f32 v190, v190, v189
  s_nop 0
  v_accvgpr_write_b32 a93, v190
  v_accvgpr_read_b32 v190, a94
  s_nop 0
  v_mul_f32 v190, v190, v189
  s_nop 0
  v_accvgpr_write_b32 a94, v190
  v_accvgpr_read_b32 v190, a95
  s_nop 0
  v_mul_f32 v190, v190, v189
  s_nop 0
  v_accvgpr_write_b32 a95, v190
  v_exp_f32 v184, v20
  v_exp_f32 v185, v21
  s_nop 0
  v_cvt_pk_bf16_f32 v68, v184, v185
  v_exp_f32 v184, v22
  v_exp_f32 v185, v23
  s_nop 0
  v_cvt_pk_bf16_f32 v69, v184, v185
  v_exp_f32 v184, v36
  v_exp_f32 v185, v37
  s_nop 0
  v_cvt_pk_bf16_f32 v70, v184, v185
  v_exp_f32 v184, v38
  v_exp_f32 v185, v39
  s_nop 0
  v_cvt_pk_bf16_f32 v71, v184, v185
  s_nop 1
  v_mfma_f32_16x16x32_bf16 v[184:187], v[112:115], v[68:71], 0
  s_nop 7
  s_nop 1
  v_mov_b32 v191, 0x203
  v_cmp_class_f32 vcc, v100, v191
  v_mov_b32 v191, 0x42800000
  v_cmp_ge_f32 s[42:43], v188, v191
  v_mul_f32 v190, v100, v189
  s_nop 3
  s_or_b64 vcc, vcc, s[42:43]
  s_nop 1
  v_cndmask_b32 v190, v190, v184, vcc
  v_mov_b32 v100, v190
  v_mov_b32 v101, v190
  v_mov_b32 v102, v190
  v_mov_b32 v103, v190
  v_max3_f32 v188, v24, v25, v26
  v_max3_f32 v188, v188, v27, v40
  v_max3_f32 v188, v188, v41, v42
  v_max_f32 v188, v188, v43
  v_mov_b32 v190, v188
  s_nop 1
  v_permlane16_swap_b32 v188, v190
  s_nop 1
  v_max_f32 v188, v188, v190
  v_mov_b32 v190, v188
  s_nop 1
  v_permlane32_swap_b32 v188, v190
  s_nop 1
  v_max_f32 v188, v188, v190
  v_ceil_f32 v188, v188
  v_frexp_exp_i32_f32 v190, v104
  v_add_u32 v190, -12, v190
  v_cvt_f32_i32 v190, v190
  v_max3_f32 v188, v188, v190, 0
  v_cvt_i32_f32 v190, v188
  v_sub_u32 v190, 0, v190
  v_ldexp_f32 v189, 1.0, v190
  v_sub_f32 v24, v24, v188
  v_sub_f32 v25, v25, v188
  v_sub_f32 v26, v26, v188
  v_sub_f32 v27, v27, v188
  v_sub_f32 v40, v40, v188
  v_sub_f32 v41, v41, v188
  v_sub_f32 v42, v42, v188
  v_sub_f32 v43, v43, v188
  v_sub_f32 v88, v88, v188
  v_sub_f32 v89, v89, v188
  v_sub_f32 v90, v90, v188
  v_sub_f32 v91, v91, v188
  v_sub_f32 v118, v118, v188
  v_accvgpr_read_b32 v190, a96
  s_nop 0
  v_mul_f32 v190, v190, v189
  s_nop 0
  v_accvgpr_write_b32 a96, v190
  v_accvgpr_read_b32 v190, a97
  s_nop 0
  v_mul_f32 v190, v190, v189
  s_nop 0
  v_accvgpr_write_b32 a97, v190
  v_accvgpr_read_b32 v190, a98
  s_nop 0
  v_mul_f32 v190, v190, v189
  s_nop 0
  v_accvgpr_write_b32 a98, v190
  v_accvgpr_read_b32 v190, a99
  s_nop 0
  v_mul_f32 v190, v190, v189
  s_nop 0
  v_accvgpr_write_b32 a99, v190
  v_accvgpr_read_b32 v190, a100
  s_nop 0
  v_mul_f32 v190, v190, v189
  s_nop 0
  v_accvgpr_write_b32 a100, v190
  v_accvgpr_read_b32 v190, a101
  s_nop 0
  v_mul_f32 v190, v190, v189
  s_nop 0
  v_accvgpr_write_b32 a101, v190
  v_accvgpr_read_b32 v190, a102
  s_nop 0
  v_mul_f32 v190, v190, v189
  s_nop 0
  v_accvgpr_write_b32 a102, v190
  v_accvgpr_read_b32 v190, a103
  s_nop 0
  v_mul_f32 v190, v190, v189
  s_nop 0
  v_accvgpr_write_b32 a103, v190
  v_accvgpr_read_b32 v190, a104
  s_nop 0
  v_mul_f32 v190, v190, v189
  s_nop 0
  v_accvgpr_write_b32 a104, v190
  v_accvgpr_read_b32 v190, a105
  s_nop 0
  v_mul_f32 v190, v190, v189
  s_nop 0
  v_accvgpr_write_b32 a105, v190
  v_accvgpr_read_b32 v190, a106
  s_nop 0
  v_mul_f32 v190, v190, v189
  s_nop 0
  v_accvgpr_write_b32 a106, v190
  v_accvgpr_read_b32 v190, a107
  s_nop 0
  v_mul_f32 v190, v190, v189
  s_nop 0
  v_accvgpr_write_b32 a107, v190
  v_accvgpr_read_b32 v190, a108
  s_nop 0
  v_mul_f32 v190, v190, v189
  s_nop 0
  v_accvgpr_write_b32 a108, v190
  v_accvgpr_read_b32 v190, a109
  s_nop 0
  v_mul_f32 v190, v190, v189
  s_nop 0
  v_accvgpr_write_b32 a109, v190
  v_accvgpr_read_b32 v190, a110
  s_nop 0
  v_mul_f32 v190, v190, v189
  s_nop 0
  v_accvgpr_write_b32 a110, v190
  v_accvgpr_read_b32 v190, a111
  s_nop 0
  v_mul_f32 v190, v190, v189
  s_nop 0
  v_accvgpr_write_b32 a111, v190
  v_accvgpr_read_b32 v190, a112
  s_nop 0
  v_mul_f32 v190, v190, v189
  s_nop 0
  v_accvgpr_write_b32 a112, v190
  v_accvgpr_read_b32 v190, a113
  s_nop 0
  v_mul_f32 v190, v190, v189
  s_nop 0
  v_accvgpr_write_b32 a113, v190
  v_accvgpr_read_b32 v190, a114
  s_nop 0
  v_mul_f32 v190, v190, v189
  s_nop 0
  v_accvgpr_write_b32 a114, v190
  v_accvgpr_read_b32 v190, a115
  s_nop 0
  v_mul_f32 v190, v190, v189
  s_nop 0
  v_accvgpr_write_b32 a115, v190
  v_accvgpr_read_b32 v190, a116
  s_nop 0
  v_mul_f32 v190, v190, v189
  s_nop 0
  v_accvgpr_write_b32 a116, v190
  v_accvgpr_read_b32 v190, a117
  s_nop 0
  v_mul_f32 v190, v190, v189
  s_nop 0
  v_accvgpr_write_b32 a117, v190
  v_accvgpr_read_b32 v190, a118
  s_nop 0
  v_mul_f32 v190, v190, v189
  s_nop 0
  v_accvgpr_write_b32 a118, v190
  v_accvgpr_read_b32 v190, a119
  s_nop 0
  v_mul_f32 v190, v190, v189
  s_nop 0
  v_accvgpr_write_b32 a119, v190
  v_accvgpr_read_b32 v190, a120
  s_nop 0
  v_mul_f32 v190, v190, v189
  s_nop 0
  v_accvgpr_write_b32 a120, v190
  v_accvgpr_read_b32 v190, a121
  s_nop 0
  v_mul_f32 v190, v190, v189
  s_nop 0
  v_accvgpr_write_b32 a121, v190
  v_accvgpr_read_b32 v190, a122
  s_nop 0
  v_mul_f32 v190, v190, v189
  s_nop 0
  v_accvgpr_write_b32 a122, v190
  v_accvgpr_read_b32 v190, a123
  s_nop 0
  v_mul_f32 v190, v190, v189
  s_nop 0
  v_accvgpr_write_b32 a123, v190
  v_accvgpr_read_b32 v190, a124
  s_nop 0
  v_mul_f32 v190, v190, v189
  s_nop 0
  v_accvgpr_write_b32 a124, v190
  v_accvgpr_read_b32 v190, a125
  s_nop 0
  v_mul_f32 v190, v190, v189
  s_nop 0
  v_accvgpr_write_b32 a125, v190
  v_accvgpr_read_b32 v190, a126
  s_nop 0
  v_mul_f32 v190, v190, v189
  s_nop 0
  v_accvgpr_write_b32 a126, v190
  v_accvgpr_read_b32 v190, a127
  s_nop 0
  v_mul_f32 v190, v190, v189
  s_nop 0
  v_accvgpr_write_b32 a127, v190
  v_accvgpr_read_b32 v190, a128
  s_nop 0
  v_mul_f32 v190, v190, v189
  s_nop 0
  v_accvgpr_write_b32 a128, v190
  v_accvgpr_read_b32 v190, a129
  s_nop 0
  v_mul_f32 v190, v190, v189
  s_nop 0
  v_accvgpr_write_b32 a129, v190
  v_accvgpr_read_b32 v190, a130
  s_nop 0
  v_mul_f32 v190, v190, v189
  s_nop 0
  v_accvgpr_write_b32 a130, v190
  v_accvgpr_read_b32 v190, a131
  s_nop 0
  v_mul_f32 v190, v190, v189
  s_nop 0
  v_accvgpr_write_b32 a131, v190
  v_accvgpr_read_b32 v190, a132
  s_nop 0
  v_mul_f32 v190, v190, v189
  s_nop 0
  v_accvgpr_write_b32 a132, v190
  v_accvgpr_read_b32 v190, a133
  s_nop 0
  v_mul_f32 v190, v190, v189
  s_nop 0
  v_accvgpr_write_b32 a133, v190
  v_accvgpr_read_b32 v190, a134
  s_nop 0
  v_mul_f32 v190, v190, v189
  s_nop 0
  v_accvgpr_write_b32 a134, v190
  v_accvgpr_read_b32 v190, a135
  s_nop 0
  v_mul_f32 v190, v190, v189
  s_nop 0
  v_accvgpr_write_b32 a135, v190
  v_accvgpr_read_b32 v190, a136
  s_nop 0
  v_mul_f32 v190, v190, v189
  s_nop 0
  v_accvgpr_write_b32 a136, v190
  v_accvgpr_read_b32 v190, a137
  s_nop 0
  v_mul_f32 v190, v190, v189
  s_nop 0
  v_accvgpr_write_b32 a137, v190
  v_accvgpr_read_b32 v190, a138
  s_nop 0
  v_mul_f32 v190, v190, v189
  s_nop 0
  v_accvgpr_write_b32 a138, v190
  v_accvgpr_read_b32 v190, a139
  s_nop 0
  v_mul_f32 v190, v190, v189
  s_nop 0
  v_accvgpr_write_b32 a139, v190
  v_accvgpr_read_b32 v190, a140
  s_nop 0
  v_mul_f32 v190, v190, v189
  s_nop 0
  v_accvgpr_write_b32 a140, v190
  v_accvgpr_read_b32 v190, a141
  s_nop 0
  v_mul_f32 v190, v190, v189
  s_nop 0
  v_accvgpr_write_b32 a141, v190
  v_accvgpr_read_b32 v190, a142
  s_nop 0
  v_mul_f32 v190, v190, v189
  s_nop 0
  v_accvgpr_write_b32 a142, v190
  v_accvgpr_read_b32 v190, a143
  s_nop 0
  v_mul_f32 v190, v190, v189
  s_nop 0
  v_accvgpr_write_b32 a143, v190
  v_exp_f32 v184, v24
  v_exp_f32 v185, v25
  s_nop 0
  v_cvt_pk_bf16_f32 v72, v184, v185
  v_exp_f32 v184, v26
  v_exp_f32 v185, v27
  s_nop 0
  v_cvt_pk_bf16_f32 v73, v184, v185
  v_exp_f32 v184, v40
  v_exp_f32 v185, v41
  s_nop 0
  v_cvt_pk_bf16_f32 v74, v184, v185
  v_exp_f32 v184, v42
  v_exp_f32 v185, v43
  s_nop 0
  v_cvt_pk_bf16_f32 v75, v184, v185
  s_nop 1
  v_mfma_f32_16x16x32_bf16 v[184:187], v[112:115], v[72:75], 0
  s_nop 7
  s_nop 1
  v_mov_b32 v191, 0x203
  v_cmp_class_f32 vcc, v104, v191
  v_mov_b32 v191, 0x42800000
  v_cmp_ge_f32 s[42:43], v188, v191
  v_mul_f32 v190, v104, v189
  s_nop 3
  s_or_b64 vcc, vcc, s[42:43]
  s_nop 1
  v_cndmask_b32 v190, v190, v184, vcc
  v_mov_b32 v104, v190
  v_mov_b32 v105, v190
  v_mov_b32 v106, v190
  v_mov_b32 v107, v190
  v_max3_f32 v188, v28, v29, v30
  v_max3_f32 v188, v188, v31, v44
  v_max3_f32 v188, v188, v45, v46
  v_max_f32 v188, v188, v47
  v_mov_b32 v190, v188
  s_nop 1
  v_permlane16_swap_b32 v188, v190
  s_nop 1
  v_max_f32 v188, v188, v190
  v_mov_b32 v190, v188
  s_nop 1
  v_permlane32_swap_b32 v188, v190
  s_nop 1
  v_max_f32 v188, v188, v190
  v_ceil_f32 v188, v188
  v_frexp_exp_i32_f32 v190, v108
  v_add_u32 v190, -12, v190
  v_cvt_f32_i32 v190, v190
  v_max3_f32 v188, v188, v190, 0
  v_cvt_i32_f32 v190, v188
  v_sub_u32 v190, 0, v190
  v_ldexp_f32 v189, 1.0, v190
  v_sub_f32 v28, v28, v188
  v_sub_f32 v29, v29, v188
  v_sub_f32 v30, v30, v188
  v_sub_f32 v31, v31, v188
  v_sub_f32 v44, v44, v188
  v_sub_f32 v45, v45, v188
  v_sub_f32 v46, v46, v188
  v_sub_f32 v47, v47, v188
  v_sub_f32 v92, v92, v188
  v_sub_f32 v93, v93, v188
  v_sub_f32 v94, v94, v188
  v_sub_f32 v95, v95, v188
  v_sub_f32 v119, v119, v188
  v_accvgpr_read_b32 v190, a144
  s_nop 0
  v_mul_f32 v190, v190, v189
  s_nop 0
  v_accvgpr_write_b32 a144, v190
  v_accvgpr_read_b32 v190, a145
  s_nop 0
  v_mul_f32 v190, v190, v189
  s_nop 0
  v_accvgpr_write_b32 a145, v190
  v_accvgpr_read_b32 v190, a146
  s_nop 0
  v_mul_f32 v190, v190, v189
  s_nop 0
  v_accvgpr_write_b32 a146, v190
  v_accvgpr_read_b32 v190, a147
  s_nop 0
  v_mul_f32 v190, v190, v189
  s_nop 0
  v_accvgpr_write_b32 a147, v190
  v_accvgpr_read_b32 v190, a148
  s_nop 0
  v_mul_f32 v190, v190, v189
  s_nop 0
  v_accvgpr_write_b32 a148, v190
  v_accvgpr_read_b32 v190, a149
  s_nop 0
  v_mul_f32 v190, v190, v189
  s_nop 0
  v_accvgpr_write_b32 a149, v190
  v_accvgpr_read_b32 v190, a150
  s_nop 0
  v_mul_f32 v190, v190, v189
  s_nop 0
  v_accvgpr_write_b32 a150, v190
  v_accvgpr_read_b32 v190, a151
  s_nop 0
  v_mul_f32 v190, v190, v189
  s_nop 0
  v_accvgpr_write_b32 a151, v190
  v_accvgpr_read_b32 v190, a152
  s_nop 0
  v_mul_f32 v190, v190, v189
  s_nop 0
  v_accvgpr_write_b32 a152, v190
  v_accvgpr_read_b32 v190, a153
  s_nop 0
  v_mul_f32 v190, v190, v189
  s_nop 0
  v_accvgpr_write_b32 a153, v190
  v_accvgpr_read_b32 v190, a154
  s_nop 0
  v_mul_f32 v190, v190, v189
  s_nop 0
  v_accvgpr_write_b32 a154, v190
  v_accvgpr_read_b32 v190, a155
  s_nop 0
  v_mul_f32 v190, v190, v189
  s_nop 0
  v_accvgpr_write_b32 a155, v190
  v_accvgpr_read_b32 v190, a156
  s_nop 0
  v_mul_f32 v190, v190, v189
  s_nop 0
  v_accvgpr_write_b32 a156, v190
  v_accvgpr_read_b32 v190, a157
  s_nop 0
  v_mul_f32 v190, v190, v189
  s_nop 0
  v_accvgpr_write_b32 a157, v190
  v_accvgpr_read_b32 v190, a158
  s_nop 0
  v_mul_f32 v190, v190, v189
  s_nop 0
  v_accvgpr_write_b32 a158, v190
  v_accvgpr_read_b32 v190, a159
  s_nop 0
  v_mul_f32 v190, v190, v189
  s_nop 0
  v_accvgpr_write_b32 a159, v190
  v_accvgpr_read_b32 v190, a160
  s_nop 0
  v_mul_f32 v190, v190, v189
  s_nop 0
  v_accvgpr_write_b32 a160, v190
  v_accvgpr_read_b32 v190, a161
  s_nop 0
  v_mul_f32 v190, v190, v189
  s_nop 0
  v_accvgpr_write_b32 a161, v190
  v_accvgpr_read_b32 v190, a162
  s_nop 0
  v_mul_f32 v190, v190, v189
  s_nop 0
  v_accvgpr_write_b32 a162, v190
  v_accvgpr_read_b32 v190, a163
  s_nop 0
  v_mul_f32 v190, v190, v189
  s_nop 0
  v_accvgpr_write_b32 a163, v190
  v_accvgpr_read_b32 v190, a164
  s_nop 0
  v_mul_f32 v190, v190, v189
  s_nop 0
  v_accvgpr_write_b32 a164, v190
  v_accvgpr_read_b32 v190, a165
  s_nop 0
  v_mul_f32 v190, v190, v189
  s_nop 0
  v_accvgpr_write_b32 a165, v190
  v_accvgpr_read_b32 v190, a166
  s_nop 0
  v_mul_f32 v190, v190, v189
  s_nop 0
  v_accvgpr_write_b32 a166, v190
  v_accvgpr_read_b32 v190, a167
  s_nop 0
  v_mul_f32 v190, v190, v189
  s_nop 0
  v_accvgpr_write_b32 a167, v190
  v_accvgpr_read_b32 v190, a168
  s_nop 0
  v_mul_f32 v190, v190, v189
  s_nop 0
  v_accvgpr_write_b32 a168, v190
  v_accvgpr_read_b32 v190, a169
  s_nop 0
  v_mul_f32 v190, v190, v189
  s_nop 0
  v_accvgpr_write_b32 a169, v190
  v_accvgpr_read_b32 v190, a170
  s_nop 0
  v_mul_f32 v190, v190, v189
  s_nop 0
  v_accvgpr_write_b32 a170, v190
  v_accvgpr_read_b32 v190, a171
  s_nop 0
  v_mul_f32 v190, v190, v189
  s_nop 0
  v_accvgpr_write_b32 a171, v190
  v_accvgpr_read_b32 v190, a172
  s_nop 0
  v_mul_f32 v190, v190, v189
  s_nop 0
  v_accvgpr_write_b32 a172, v190
  v_accvgpr_read_b32 v190, a173
  s_nop 0
  v_mul_f32 v190, v190, v189
  s_nop 0
  v_accvgpr_write_b32 a173, v190
  v_accvgpr_read_b32 v190, a174
  s_nop 0
  v_mul_f32 v190, v190, v189
  s_nop 0
  v_accvgpr_write_b32 a174, v190
  v_accvgpr_read_b32 v190, a175
  s_nop 0
  v_mul_f32 v190, v190, v189
  s_nop 0
  v_accvgpr_write_b32 a175, v190
  v_accvgpr_read_b32 v190, a176
  s_nop 0
  v_mul_f32 v190, v190, v189
  s_nop 0
  v_accvgpr_write_b32 a176, v190
  v_accvgpr_read_b32 v190, a177
  s_nop 0
  v_mul_f32 v190, v190, v189
  s_nop 0
  v_accvgpr_write_b32 a177, v190
  v_accvgpr_read_b32 v190, a178
  s_nop 0
  v_mul_f32 v190, v190, v189
  s_nop 0
  v_accvgpr_write_b32 a178, v190
  v_accvgpr_read_b32 v190, a179
  s_nop 0
  v_mul_f32 v190, v190, v189
  s_nop 0
  v_accvgpr_write_b32 a179, v190
  v_accvgpr_read_b32 v190, a180
  s_nop 0
  v_mul_f32 v190, v190, v189
  s_nop 0
  v_accvgpr_write_b32 a180, v190
  v_accvgpr_read_b32 v190, a181
  s_nop 0
  v_mul_f32 v190, v190, v189
  s_nop 0
  v_accvgpr_write_b32 a181, v190
  v_accvgpr_read_b32 v190, a182
  s_nop 0
  v_mul_f32 v190, v190, v189
  s_nop 0
  v_accvgpr_write_b32 a182, v190
  v_accvgpr_read_b32 v190, a183
  s_nop 0
  v_mul_f32 v190, v190, v189
  s_nop 0
  v_accvgpr_write_b32 a183, v190
  v_accvgpr_read_b32 v190, a184
  s_nop 0
  v_mul_f32 v190, v190, v189
  s_nop 0
  v_accvgpr_write_b32 a184, v190
  v_accvgpr_read_b32 v190, a185
  s_nop 0
  v_mul_f32 v190, v190, v189
  s_nop 0
  v_accvgpr_write_b32 a185, v190
  v_accvgpr_read_b32 v190, a186
  s_nop 0
  v_mul_f32 v190, v190, v189
  s_nop 0
  v_accvgpr_write_b32 a186, v190
  v_accvgpr_read_b32 v190, a187
  s_nop 0
  v_mul_f32 v190, v190, v189
  s_nop 0
  v_accvgpr_write_b32 a187, v190
  v_accvgpr_read_b32 v190, a188
  s_nop 0
  v_mul_f32 v190, v190, v189
  s_nop 0
  v_accvgpr_write_b32 a188, v190
  v_accvgpr_read_b32 v190, a189
  s_nop 0
  v_mul_f32 v190, v190, v189
  s_nop 0
  v_accvgpr_write_b32 a189, v190
  v_accvgpr_read_b32 v190, a190
  s_nop 0
  v_mul_f32 v190, v190, v189
  s_nop 0
  v_accvgpr_write_b32 a190, v190
  v_accvgpr_read_b32 v190, a191
  s_nop 0
  v_mul_f32 v190, v190, v189
  s_nop 0
  v_accvgpr_write_b32 a191, v190
  v_exp_f32 v184, v28
  v_exp_f32 v185, v29
  s_nop 0
  v_cvt_pk_bf16_f32 v76, v184, v185
  v_exp_f32 v184, v30
  v_exp_f32 v185, v31
  s_nop 0
  v_cvt_pk_bf16_f32 v77, v184, v185
  v_exp_f32 v184, v44
  v_exp_f32 v185, v45
  s_nop 0
  v_cvt_pk_bf16_f32 v78, v184, v185
  v_exp_f32 v184, v46
  v_exp_f32 v185, v47
  s_nop 0
  v_cvt_pk_bf16_f32 v79, v184, v185
  s_nop 1
  v_mfma_f32_16x16x32_bf16 v[184:187], v[112:115], v[76:79], 0
  s_nop 7
  s_nop 1
  v_mov_b32 v191, 0x203
  v_cmp_class_f32 vcc, v108, v191
  v_mov_b32 v191, 0x42800000
  v_cmp_ge_f32 s[42:43], v188, v191
  v_mul_f32 v190, v108, v189
  s_nop 3
  s_or_b64 vcc, vcc, s[42:43]
  s_nop 1
  v_cndmask_b32 v190, v190, v184, vcc
  v_mov_b32 v108, v190
  v_mov_b32 v109, v190
  v_mov_b32 v110, v190
  v_mov_b32 v111, v190
  s_nop 3
  s_setpc_b64 s[72:73]
MASK_p2:
  s_sub_i32 s40, s77, s37
  s_sub_i32 s40, s40, s28
  s_lshl_b32 s40, s40, 5
  v_subrev_u32 v191, s40, v11
  v_cmp_le_i32 s[42:43], 0, v191
  v_cmp_le_i32 s[44:45], 1, v191
  v_cmp_le_i32 s[46:47], 2, v191
  v_cmp_le_i32 s[48:49], 3, v191
  v_cndmask_b32 v88, v12, v118, s[42:43]
  v_cndmask_b32 v89, v12, v118, s[44:45]
  v_cndmask_b32 v90, v12, v118, s[46:47]
  v_cndmask_b32 v91, v12, v118, s[48:49]
  v_cmp_le_i32 s[42:43], -16, v191
  v_cmp_le_i32 s[44:45], -15, v191
  v_cmp_le_i32 s[46:47], -14, v191
  v_cmp_le_i32 s[48:49], -13, v191
  v_cndmask_b32 v92, v12, v119, s[42:43]
  v_cndmask_b32 v93, v12, v119, s[44:45]
  v_cndmask_b32 v94, v12, v119, s[46:47]
  v_cndmask_b32 v95, v12, v119, s[48:49]
  v_cmp_le_i32 s[42:43], 16, v191
  v_cmp_le_i32 s[44:45], 17, v191
  v_cmp_le_i32 s[46:47], 18, v191
  v_cmp_le_i32 s[48:49], 19, v191
  v_cndmask_b32 v192, v12, v118, s[42:43]
  v_cndmask_b32 v193, v12, v118, s[44:45]
  v_cndmask_b32 v194, v12, v118, s[46:47]
  v_cndmask_b32 v195, v12, v118, s[48:49]
  v_cmp_le_i32 s[42:43], 0, v191
  v_cmp_le_i32 s[44:45], 1, v191
  v_cmp_le_i32 s[46:47], 2, v191
  v_cmp_le_i32 s[48:49], 3, v191
  v_cndmask_b32 v196, v12, v119, s[42:43]
  v_cndmask_b32 v197, v12, v119, s[44:45]
  v_cndmask_b32 v198, v12, v119, s[46:47]
  v_cndmask_b32 v199, v12, v119, s[48:49]
  s_nop 0
  s_setpc_b64 s[72:73]
RARE_p2_0:
  s_nop 7
  s_nop 7
  v_max3_f32 v188, v24, v25, v26
  v_max3_f32 v188, v188, v27, v40
  v_max3_f32 v188, v188, v41, v42
  v_max_f32 v188, v188, v43
  v_mov_b32 v190, v188
  s_nop 1
  v_permlane16_swap_b32 v188, v190
  s_nop 1
  v_max_f32 v188, v188, v190
  v_mov_b32 v190, v188
  s_nop 1
  v_permlane32_swap_b32 v188, v190
  s_nop 1
  v_max_f32 v188, v188, v190
  v_ceil_f32 v188, v188
  v_frexp_exp_i32_f32 v190, v104
  v_add_u32 v190, -12, v190
  v_cvt_f32_i32 v190, v190
  v_max3_f32 v188, v188, v190, 0
  v_cvt_i32_f32 v190, v188
  v_sub_u32 v190, 0, v190
  v_ldexp_f32 v189, 1.0, v190
  v_sub_f32 v24, v24, v188
  v_sub_f32 v25, v25, v188
  v_sub_f32 v26, v26, v188
  v_sub_f32 v27, v27, v188
  v_sub_f32 v40, v40, v188
  v_sub_f32 v41, v41, v188
  v_sub_f32 v42, v42, v188
  v_sub_f32 v43, v43, v188
  v_sub_f32 v88, v88, v188
  v_sub_f32 v89, v89, v188
  v_sub_f32 v90, v90, v188
  v_sub_f32 v91, v91, v188
  v_sub_f32 v192, v192, v188
  v_sub_f32 v193, v193, v188
  v_sub_f32 v194, v194, v188
  v_sub_f32 v195, v195, v188
  v_sub_f32 v118, v118, v188
  v_accvgpr_read_b32 v190, a96
  s_nop 0
  v_mul_f32 v190, v190, v189
  s_nop 0
  v_accvgpr_write_b32 a96, v190
  v_accvgpr_read_b32 v190, a97
  s_nop 0
  v_mul_f32 v190, v190, v189
  s_nop 0
  v_accvgpr_write_b32 a97, v190
  v_accvgpr_read_b32 v190, a98
  s_nop 0
  v_mul_f32 v190, v190, v189
  s_nop 0
  v_accvgpr_write_b32 a98, v190
  v_accvgpr_read_b32 v190, a99
  s_nop 0
  v_mul_f32 v190, v190, v189
  s_nop 0
  v_accvgpr_write_b32 a99, v190
  v_accvgpr_read_b32 v190, a100
  s_nop 0
  v_mul_f32 v190, v190, v189
  s_nop 0
  v_accvgpr_write_b32 a100, v190
  v_accvgpr_read_b32 v190, a101
  s_nop 0
  v_mul_f32 v190, v190, v189
  s_nop 0
  v_accvgpr_write_b32 a101, v190
  v_accvgpr_read_b32 v190, a102
  s_nop 0
  v_mul_f32 v190, v190, v189
  s_nop 0
  v_accvgpr_write_b32 a102, v190
  v_accvgpr_read_b32 v190, a103
  s_nop 0
  v_mul_f32 v190, v190, v189
  s_nop 0
  v_accvgpr_write_b32 a103, v190
  v_accvgpr_read_b32 v190, a104
  s_nop 0
  v_mul_f32 v190, v190, v189
  s_nop 0
  v_accvgpr_write_b32 a104, v190
  v_accvgpr_read_b32 v190, a105
  s_nop 0
  v_mul_f32 v190, v190, v189
  s_nop 0
  v_accvgpr_write_b32 a105, v190
  v_accvgpr_read_b32 v190, a106
  s_nop 0
  v_mul_f32 v190, v190, v189
  s_nop 0
  v_accvgpr_write_b32 a106, v190
  v_accvgpr_read_b32 v190, a107
  s_nop 0
  v_mul_f32 v190, v190, v189
  s_nop 0
  v_accvgpr_write_b32 a107, v190
  v_accvgpr_read_b32 v190, a108
  s_nop 0
  v_mul_f32 v190, v190, v189
  s_nop 0
  v_accvgpr_write_b32 a108, v190
  v_accvgpr_read_b32 v190, a109
  s_nop 0
  v_mul_f32 v190, v190, v189
  s_nop 0
  v_accvgpr_write_b32 a109, v190
  v_accvgpr_read_b32 v190, a110
  s_nop 0
  v_mul_f32 v190, v190, v189
  s_nop 0
  v_accvgpr_write_b32 a110, v190
  v_accvgpr_read_b32 v190, a111
  s_nop 0
  v_mul_f32 v190, v190, v189
  s_nop 0
  v_accvgpr_write_b32 a111, v190
  v_accvgpr_read_b32 v190, a112
  s_nop 0
  v_mul_f32 v190, v190, v189
  s_nop 0
  v_accvgpr_write_b32 a112, v190
  v_accvgpr_read_b32 v190, a113
  s_nop 0
  v_mul_f32 v190, v190, v189
  s_nop 0
  v_accvgpr_write_b32 a113, v190
  v_accvgpr_read_b32 v190, a114
  s_nop 0
  v_mul_f32 v190, v190, v189
  s_nop 0
  v_accvgpr_write_b32 a114, v190
  v_accvgpr_read_b32 v190, a115
  s_nop 0
  v_mul_f32 v190, v190, v189
  s_nop 0
  v_accvgpr_write_b32 a115, v190
  v_accvgpr_read_b32 v190, a116
  s_nop 0
  v_mul_f32 v190, v190, v189
  s_nop 0
  v_accvgpr_write_b32 a116, v190
  v_accvgpr_read_b32 v190, a117
  s_nop 0
  v_mul_f32 v190, v190, v189
  s_nop 0
  v_accvgpr_write_b32 a117, v190
  v_accvgpr_read_b32 v190, a118
  s_nop 0
  v_mul_f32 v190, v190, v189
  s_nop 0
  v_accvgpr_write_b32 a118, v190
  v_accvgpr_read_b32 v190, a119
  s_nop 0
  v_mul_f32 v190, v190, v189
  s_nop 0
  v_accvgpr_write_b32 a119, v190
  v_accvgpr_read_b32 v190, a120
  s_nop 0
  v_mul_f32 v190, v190, v189
  s_nop 0
  v_accvgpr_write_b32 a120, v190
  v_accvgpr_read_b32 v190, a121
  s_nop 0
  v_mul_f32 v190, v190, v189
  s_nop 0
  v_accvgpr_write_b32 a121, v190
  v_accvgpr_read_b32 v190, a122
  s_nop 0
  v_mul_f32 v190, v190, v189
  s_nop 0
  v_accvgpr_write_b32 a122, v190
  v_accvgpr_read_b32 v190, a123
  s_nop 0
  v_mul_f32 v190, v190, v189
  s_nop 0
  v_accvgpr_write_b32 a123, v190
  v_accvgpr_read_b32 v190, a124
  s_nop 0
  v_mul_f32 v190, v190, v189
  s_nop 0
  v_accvgpr_write_b32 a124, v190
  v_accvgpr_read_b32 v190, a125
  s_nop 0
  v_mul_f32 v190, v190, v189
  s_nop 0
  v_accvgpr_write_b32 a125, v190
  v_accvgpr_read_b32 v190, a126
  s_nop 0
  v_mul_f32 v190, v190, v189
  s_nop 0
  v_accvgpr_write_b32 a126, v190
  v_accvgpr_read_b32 v190, a127
  s_nop 0
  v_mul_f32 v190, v190, v189
  s_nop 0
  v_accvgpr_write_b32 a127, v190
  v_accvgpr_read_b32 v190, a128
  s_nop 0
  v_mul_f32 v190, v190, v189
  s_nop 0
  v_accvgpr_write_b32 a128, v190
  v_accvgpr_read_b32 v190, a129
  s_nop 0
  v_mul_f32 v190, v190, v189
  s_nop 0
  v_accvgpr_write_b32 a129, v190
  v_accvgpr_read_b32 v190, a130
  s_nop 0
  v_mul_f32 v190, v190, v189
  s_nop 0
  v_accvgpr_write_b32 a130, v190
  v_accvgpr_read_b32 v190, a131
  s_nop 0
  v_mul_f32 v190, v190, v189
  s_nop 0
  v_accvgpr_write_b32 a131, v190
  v_accvgpr_read_b32 v190, a132
  s_nop 0
  v_mul_f32 v190, v190, v189
  s_nop 0
  v_accvgpr_write_b32 a132, v190
  v_accvgpr_read_b32 v190, a133
  s_nop 0
  v_mul_f32 v190, v190, v189
  s_nop 0
  v_accvgpr_write_b32 a133, v190
  v_accvgpr_read_b32 v190, a134
  s_nop 0
  v_mul_f32 v190, v190, v189
  s_nop 0
  v_accvgpr_write_b32 a134, v190
  v_accvgpr_read_b32 v190, a135
  s_nop 0
  v_mul_f32 v190, v190, v189
  s_nop 0
  v_accvgpr_write_b32 a135, v190
  v_accvgpr_read_b32 v190, a136
  s_nop 0
  v_mul_f32 v190, v190, v189
  s_nop 0
  v_accvgpr_write_b32 a136, v190
  v_accvgpr_read_b32 v190, a137
  s_nop 0
  v_mul_f32 v190, v190, v189
  s_nop 0
  v_accvgpr_write_b32 a137, v190
  v_accvgpr_read_b32 v190, a138
  s_nop 0
  v_mul_f32 v190, v190, v189
  s_nop 0
  v_accvgpr_write_b32 a138, v190
  v_accvgpr_read_b32 v190, a139
  s_nop 0
  v_mul_f32 v190, v190, v189
  s_nop 0
  v_accvgpr_write_b32 a139, v190
  v_accvgpr_read_b32 v190, a140
  s_nop 0
  v_mul_f32 v190, v190, v189
  s_nop 0
  v_accvgpr_write_b32 a140, v190
  v_accvgpr_read_b32 v190, a141
  s_nop 0
  v_mul_f32 v190, v190, v189
  s_nop 0
  v_accvgpr_write_b32 a141, v190
  v_accvgpr_read_b32 v190, a142
  s_nop 0
  v_mul_f32 v190, v190, v189
  s_nop 0
  v_accvgpr_write_b32 a142, v190
  v_accvgpr_read_b32 v190, a143
  s_nop 0
  v_mul_f32 v190, v190, v189
  s_nop 0
  v_accvgpr_write_b32 a143, v190
  v_exp_f32 v184, v24
  v_exp_f32 v185, v25
  s_nop 0
  v_cvt_pk_bf16_f32 v56, v184, v185
  v_exp_f32 v184, v26
  v_exp_f32 v185, v27
  s_nop 0
  v_cvt_pk_bf16_f32 v57, v184, v185
  v_exp_f32 v184, v40
  v_exp_f32 v185, v41
  s_nop 0
  v_cvt_pk_bf16_f32 v58, v184, v185
  v_exp_f32 v184, v42
  v_exp_f32 v185, v43
  s_nop 0
  v_cvt_pk_bf16_f32 v59, v184, v185
  s_nop 1
  v_mfma_f32_16x16x32_bf16 v[184:187], v[112:115], v[56:59], 0
  s_nop 7
  s_nop 1
  v_mov_b32 v191, 0x203
  v_cmp_class_f32 vcc, v104, v191
  v_mov_b32 v191, 0x42800000
  v_cmp_ge_f32 s[42:43], v188, v191
  v_mul_f32 v190, v104, v189
  s_nop 3
  s_or_b64 vcc, vcc, s[42:43]
  s_nop 1
  v_cndmask_b32 v190, v190, v184, vcc
  v_mov_b32 v104, v190
  v_mov_b32 v105, v190
  v_mov_b32 v106, v190
  v_mov_b32 v107, v190
  v_max3_f32 v188, v28, v29, v30
  v_max3_f32 v188, v188, v31, v44
  v_max3_f32 v188, v188, v45, v46
  v_max_f32 v188, v188, v47
  v_mov_b32 v190, v188
  s_nop 1
  v_permlane16_swap_b32 v188, v190
  s_nop 1
  v_max_f32 v188, v188, v190
  v_mov_b32 v190, v188
  s_nop 1
  v_permlane32_swap_b32 v188, v190
  s_nop 1
  v_max_f32 v188, v188, v190
  v_ceil_f32 v188, v188
  v_frexp_exp_i32_f32 v190, v108
  v_add_u32 v190, -12, v190
  v_cvt_f32_i32 v190, v190
  v_max3_f32 v188, v188, v190, 0
  v_cvt_i32_f32 v190, v188
  v_sub_u32 v190, 0, v190
  v_ldexp_f32 v189, 1.0, v190
  v_sub_f32 v28, v28, v188
  v_sub_f32 v29, v29, v188
  v_sub_f32 v30, v30, v188
  v_sub_f32 v31, v31, v188
  v_sub_f32 v44, v44, v188
  v_sub_f32 v45, v45, v188
  v_sub_f32 v46, v46, v188
  v_sub_f32 v47, v47, v188
  v_sub_f32 v92, v92, v188
  v_sub_f32 v93, v93, v188
  v_sub_f32 v94, v94, v188
  v_sub_f32 v95, v95, v188
  v_sub_f32 v196, v196, v188
  v_sub_f32 v197, v197, v188
  v_sub_f32 v198, v198, v188
  v_sub_f32 v199, v199, v188
  v_sub_f32 v119, v119, v188
  v_accvgpr_read_b32 v190, a144
  s_nop 0
  v_mul_f32 v190, v190, v189
  s_nop 0
  v_accvgpr_write_b32 a144, v190
  v_accvgpr_read_b32 v190, a145
  s_nop 0
  v_mul_f32 v190, v190, v189
  s_nop 0
  v_accvgpr_write_b32 a145, v190
  v_accvgpr_read_b32 v190, a146
  s_nop 0
  v_mul_f32 v190, v190, v189
  s_nop 0
  v_accvgpr_write_b32 a146, v190
  v_accvgpr_read_b32 v190, a147
  s_nop 0
  v_mul_f32 v190, v190, v189
  s_nop 0
  v_accvgpr_write_b32 a147, v190
  v_accvgpr_read_b32 v190, a148
  s_nop 0
  v_mul_f32 v190, v190, v189
  s_nop 0
  v_accvgpr_write_b32 a148, v190
  v_accvgpr_read_b32 v190, a149
  s_nop 0
  v_mul_f32 v190, v190, v189
  s_nop 0
  v_accvgpr_write_b32 a149, v190
  v_accvgpr_read_b32 v190, a150
  s_nop 0
  v_mul_f32 v190, v190, v189
  s_nop 0
  v_accvgpr_write_b32 a150, v190
  v_accvgpr_read_b32 v190, a151
  s_nop 0
  v_mul_f32 v190, v190, v189
  s_nop 0
  v_accvgpr_write_b32 a151, v190
  v_accvgpr_read_b32 v190, a152
  s_nop 0
  v_mul_f32 v190, v190, v189
  s_nop 0
  v_accvgpr_write_b32 a152, v190
  v_accvgpr_read_b32 v190, a153
  s_nop 0
  v_mul_f32 v190, v190, v189
  s_nop 0
  v_accvgpr_write_b32 a153, v190
  v_accvgpr_read_b32 v190, a154
  s_nop 0
  v_mul_f32 v190, v190, v189
  s_nop 0
  v_accvgpr_write_b32 a154, v190
  v_accvgpr_read_b32 v190, a155
  s_nop 0
  v_mul_f32 v190, v190, v189
  s_nop 0
  v_accvgpr_write_b32 a155, v190
  v_accvgpr_read_b32 v190, a156
  s_nop 0
  v_mul_f32 v190, v190, v189
  s_nop 0
  v_accvgpr_write_b32 a156, v190
  v_accvgpr_read_b32 v190, a157
  s_nop 0
  v_mul_f32 v190, v190, v189
  s_nop 0
  v_accvgpr_write_b32 a157, v190
  v_accvgpr_read_b32 v190, a158
  s_nop 0
  v_mul_f32 v190, v190, v189
  s_nop 0
  v_accvgpr_write_b32 a158, v190
  v_accvgpr_read_b32 v190, a159
  s_nop 0
  v_mul_f32 v190, v190, v189
  s_nop 0
  v_accvgpr_write_b32 a159, v190
  v_accvgpr_read_b32 v190, a160
  s_nop 0
  v_mul_f32 v190, v190, v189
  s_nop 0
  v_accvgpr_write_b32 a160, v190
  v_accvgpr_read_b32 v190, a161
  s_nop 0
  v_mul_f32 v190, v190, v189
  s_nop 0
  v_accvgpr_write_b32 a161, v190
  v_accvgpr_read_b32 v190, a162
  s_nop 0
  v_mul_f32 v190, v190, v189
  s_nop 0
  v_accvgpr_write_b32 a162, v190
  v_accvgpr_read_b32 v190, a163
  s_nop 0
  v_mul_f32 v190, v190, v189
  s_nop 0
  v_accvgpr_write_b32 a163, v190
  v_accvgpr_read_b32 v190, a164
  s_nop 0
  v_mul_f32 v190, v190, v189
  s_nop 0
  v_accvgpr_write_b32 a164, v190
  v_accvgpr_read_b32 v190, a165
  s_nop 0
  v_mul_f32 v190, v190, v189
  s_nop 0
  v_accvgpr_write_b32 a165, v190
  v_accvgpr_read_b32 v190, a166
  s_nop 0
  v_mul_f32 v190, v190, v189
  s_nop 0
  v_accvgpr_write_b32 a166, v190
  v_accvgpr_read_b32 v190, a167
  s_nop 0
  v_mul_f32 v190, v190, v189
  s_nop 0
  v_accvgpr_write_b32 a167, v190
  v_accvgpr_read_b32 v190, a168
  s_nop 0
  v_mul_f32 v190, v190, v189
  s_nop 0
  v_accvgpr_write_b32 a168, v190
  v_accvgpr_read_b32 v190, a169
  s_nop 0
  v_mul_f32 v190, v190, v189
  s_nop 0
  v_accvgpr_write_b32 a169, v190
  v_accvgpr_read_b32 v190, a170
  s_nop 0
  v_mul_f32 v190, v190, v189
  s_nop 0
  v_accvgpr_write_b32 a170, v190
  v_accvgpr_read_b32 v190, a171
  s_nop 0
  v_mul_f32 v190, v190, v189
  s_nop 0
  v_accvgpr_write_b32 a171, v190
  v_accvgpr_read_b32 v190, a172
  s_nop 0
  v_mul_f32 v190, v190, v189
  s_nop 0
  v_accvgpr_write_b32 a172, v190
  v_accvgpr_read_b32 v190, a173
  s_nop 0
  v_mul_f32 v190, v190, v189
  s_nop 0
  v_accvgpr_write_b32 a173, v190
  v_accvgpr_read_b32 v190, a174
  s_nop 0
  v_mul_f32 v190, v190, v189
  s_nop 0
  v_accvgpr_write_b32 a174, v190
  v_accvgpr_read_b32 v190, a175
  s_nop 0
  v_mul_f32 v190, v190, v189
  s_nop 0
  v_accvgpr_write_b32 a175, v190
  v_accvgpr_read_b32 v190, a176
  s_nop 0
  v_mul_f32 v190, v190, v189
  s_nop 0
  v_accvgpr_write_b32 a176, v190
  v_accvgpr_read_b32 v190, a177
  s_nop 0
  v_mul_f32 v190, v190, v189
  s_nop 0
  v_accvgpr_write_b32 a177, v190
  v_accvgpr_read_b32 v190, a178
  s_nop 0
  v_mul_f32 v190, v190, v189
  s_nop 0
  v_accvgpr_write_b32 a178, v190
  v_accvgpr_read_b32 v190, a179
  s_nop 0
  v_mul_f32 v190, v190, v189
  s_nop 0
  v_accvgpr_write_b32 a179, v190
  v_accvgpr_read_b32 v190, a180
  s_nop 0
  v_mul_f32 v190, v190, v189
  s_nop 0
  v_accvgpr_write_b32 a180, v190
  v_accvgpr_read_b32 v190, a181
  s_nop 0
  v_mul_f32 v190, v190, v189
  s_nop 0
  v_accvgpr_write_b32 a181, v190
  v_accvgpr_read_b32 v190, a182
  s_nop 0
  v_mul_f32 v190, v190, v189
  s_nop 0
  v_accvgpr_write_b32 a182, v190
  v_accvgpr_read_b32 v190, a183
  s_nop 0
  v_mul_f32 v190, v190, v189
  s_nop 0
  v_accvgpr_write_b32 a183, v190
  v_accvgpr_read_b32 v190, a184
  s_nop 0
  v_mul_f32 v190, v190, v189
  s_nop 0
  v_accvgpr_write_b32 a184, v190
  v_accvgpr_read_b32 v190, a185
  s_nop 0
  v_mul_f32 v190, v190, v189
  s_nop 0
  v_accvgpr_write_b32 a185, v190
  v_accvgpr_read_b32 v190, a186
  s_nop 0
  v_mul_f32 v190, v190, v189
  s_nop 0
  v_accvgpr_write_b32 a186, v190
  v_accvgpr_read_b32 v190, a187
  s_nop 0
  v_mul_f32 v190, v190, v189
  s_nop 0
  v_accvgpr_write_b32 a187, v190
  v_accvgpr_read_b32 v190, a188
  s_nop 0
  v_mul_f32 v190, v190, v189
  s_nop 0
  v_accvgpr_write_b32 a188, v190
  v_accvgpr_read_b32 v190, a189
  s_nop 0
  v_mul_f32 v190, v190, v189
  s_nop 0
  v_accvgpr_write_b32 a189, v190
  v_accvgpr_read_b32 v190, a190
  s_nop 0
  v_mul_f32 v190, v190, v189
  s_nop 0
  v_accvgpr_write_b32 a190, v190
  v_accvgpr_read_b32 v190, a191
  s_nop 0
  v_mul_f32 v190, v190, v189
  s_nop 0
  v_accvgpr_write_b32 a191, v190
  v_exp_f32 v184, v28
  v_exp_f32 v185, v29
  s_nop 0
  v_cvt_pk_bf16_f32 v60, v184, v185
  v_exp_f32 v184, v30
  v_exp_f32 v185, v31
  s_nop 0
  v_cvt_pk_bf16_f32 v61, v184, v185
  v_exp_f32 v184, v44
  v_exp_f32 v185, v45
  s_nop 0
  v_cvt_pk_bf16_f32 v62, v184, v185
  v_exp_f32 v184, v46
  v_exp_f32 v185, v47
  s_nop 0
  v_cvt_pk_bf16_f32 v63, v184, v185
  s_nop 1
  v_mfma_f32_16x16x32_bf16 v[184:187], v[112:115], v[60:63], 0
  s_nop 7
  s_nop 1
  v_mov_b32 v191, 0x203
  v_cmp_class_f32 vcc, v108, v191
  v_mov_b32 v191, 0x42800000
  v_cmp_ge_f32 s[42:43], v188, v191
  v_mul_f32 v190, v108, v189
  s_nop 3
  s_or_b64 vcc, vcc, s[42:43]
  s_nop 1
  v_cndmask_b32 v190, v190, v184, vcc
  v_mov_b32 v108, v190
  v_mov_b32 v109, v190
  v_mov_b32 v110, v190
  v_mov_b32 v111, v190
  s_nop 3
  s_setpc_b64 s[72:73]
RARE_p2_1:
  s_nop 7
  s_nop 7
  v_max3_f32 v188, v24, v25, v26
  v_max3_f32 v188, v188, v27, v40
  v_max3_f32 v188, v188, v41, v42
  v_max_f32 v188, v188, v43
  v_mov_b32 v190, v188
  s_nop 1
  v_permlane16_swap_b32 v188, v190
  s_nop 1
  v_max_f32 v188, v188, v190
  v_mov_b32 v190, v188
  s_nop 1
  v_permlane32_swap_b32 v188, v190
  s_nop 1
  v_max_f32 v188, v188, v190
  v_ceil_f32 v188, v188
  v_frexp_exp_i32_f32 v190, v104
  v_add_u32 v190, -12, v190
  v_cvt_f32_i32 v190, v190
  v_max3_f32 v188, v188, v190, 0
  v_cvt_i32_f32 v190, v188
  v_sub_u32 v190, 0, v190
  v_ldexp_f32 v189, 1.0, v190
  v_sub_f32 v24, v24, v188
  v_sub_f32 v25, v25, v188
  v_sub_f32 v26, v26, v188
  v_sub_f32 v27, v27, v188
  v_sub_f32 v40, v40, v188
  v_sub_f32 v41, v41, v188
  v_sub_f32 v42, v42, v188
  v_sub_f32 v43, v43, v188
  v_sub_f32 v88, v88, v188
  v_sub_f32 v89, v89, v188
  v_sub_f32 v90, v90, v188
  v_sub_f32 v91, v91, v188
  v_sub_f32 v192, v192, v188
  v_sub_f32 v193, v193, v188
  v_sub_f32 v194, v194, v188
  v_sub_f32 v195, v195, v188
  v_sub_f32 v118, v118, v188
  v_accvgpr_read_b32 v190, a96
  s_nop 0
  v_mul_f32 v190, v190, v189
  s_nop 0
  v_accvgpr_write_b32 a96, v190
  v_accvgpr_read_b32 v190, a97
  s_nop 0
  v_mul_f32 v190, v190, v189
  s_nop 0
  v_accvgpr_write_b32 a97, v190
  v_accvgpr_read_b32 v190, a98
  s_nop 0
  v_mul_f32 v190, v190, v189
  s_nop 0
  v_accvgpr_write_b32 a98, v190
  v_accvgpr_read_b32 v190, a99
  s_nop 0
  v_mul_f32 v190, v190, v189
  s_nop 0
  v_accvgpr_write_b32 a99, v190
  v_accvgpr_read_b32 v190, a100
  s_nop 0
  v_mul_f32 v190, v190, v189
  s_nop 0
  v_accvgpr_write_b32 a100, v190
  v_accvgpr_read_b32 v190, a101
  s_nop 0
  v_mul_f32 v190, v190, v189
  s_nop 0
  v_accvgpr_write_b32 a101, v190
  v_accvgpr_read_b32 v190, a102
  s_nop 0
  v_mul_f32 v190, v190, v189
  s_nop 0
  v_accvgpr_write_b32 a102, v190
  v_accvgpr_read_b32 v190, a103
  s_nop 0
  v_mul_f32 v190, v190, v189
  s_nop 0
  v_accvgpr_write_b32 a103, v190
  v_accvgpr_read_b32 v190, a104
  s_nop 0
  v_mul_f32 v190, v190, v189
  s_nop 0
  v_accvgpr_write_b32 a104, v190
  v_accvgpr_read_b32 v190, a105
  s_nop 0
  v_mul_f32 v190, v190, v189
  s_nop 0
  v_accvgpr_write_b32 a105, v190
  v_accvgpr_read_b32 v190, a106
  s_nop 0
  v_mul_f32 v190, v190, v189
  s_nop 0
  v_accvgpr_write_b32 a106, v190
  v_accvgpr_read_b32 v190, a107
  s_nop 0
  v_mul_f32 v190, v190, v189
  s_nop 0
  v_accvgpr_write_b32 a107, v190
  v_accvgpr_read_b32 v190, a108
  s_nop 0
  v_mul_f32 v190, v190, v189
  s_nop 0
  v_accvgpr_write_b32 a108, v190
  v_accvgpr_read_b32 v190, a109
  s_nop 0
  v_mul_f32 v190, v190, v189
  s_nop 0
  v_accvgpr_write_b32 a109, v190
  v_accvgpr_read_b32 v190, a110
  s_nop 0
  v_mul_f32 v190, v190, v189
  s_nop 0
  v_accvgpr_write_b32 a110, v190
  v_accvgpr_read_b32 v190, a111
  s_nop 0
  v_mul_f32 v190, v190, v189
  s_nop 0
  v_accvgpr_write_b32 a111, v190
  v_accvgpr_read_b32 v190, a112
  s_nop 0
  v_mul_f32 v190, v190, v189
  s_nop 0
  v_accvgpr_write_b32 a112, v190
  v_accvgpr_read_b32 v190, a113
  s_nop 0
  v_mul_f32 v190, v190, v189
  s_nop 0
  v_accvgpr_write_b32 a113, v190
  v_accvgpr_read_b32 v190, a114
  s_nop 0
  v_mul_f32 v190, v190, v189
  s_nop 0
  v_accvgpr_write_b32 a114, v190
  v_accvgpr_read_b32 v190, a115
  s_nop 0
  v_mul_f32 v190, v190, v189
  s_nop 0
  v_accvgpr_write_b32 a115, v190
  v_accvgpr_read_b32 v190, a116
  s_nop 0
  v_mul_f32 v190, v190, v189
  s_nop 0
  v_accvgpr_write_b32 a116, v190
  v_accvgpr_read_b32 v190, a117
  s_nop 0
  v_mul_f32 v190, v190, v189
  s_nop 0
  v_accvgpr_write_b32 a117, v190
  v_accvgpr_read_b32 v190, a118
  s_nop 0
  v_mul_f32 v190, v190, v189
  s_nop 0
  v_accvgpr_write_b32 a118, v190
  v_accvgpr_read_b32 v190, a119
  s_nop 0
  v_mul_f32 v190, v190, v189
  s_nop 0
  v_accvgpr_write_b32 a119, v190
  v_accvgpr_read_b32 v190, a120
  s_nop 0
  v_mul_f32 v190, v190, v189
  s_nop 0
  v_accvgpr_write_b32 a120, v190
  v_accvgpr_read_b32 v190, a121
  s_nop 0
  v_mul_f32 v190, v190, v189
  s_nop 0
  v_accvgpr_write_b32 a121, v190
  v_accvgpr_read_b32 v190, a122
  s_nop 0
  v_mul_f32 v190, v190, v189
  s_nop 0
  v_accvgpr_write_b32 a122, v190
  v_accvgpr_read_b32 v190, a123
  s_nop 0
  v_mul_f32 v190, v190, v189
  s_nop 0
  v_accvgpr_write_b32 a123, v190
  v_accvgpr_read_b32 v190, a124
  s_nop 0
  v_mul_f32 v190, v190, v189
  s_nop 0
  v_accvgpr_write_b32 a124, v190
  v_accvgpr_read_b32 v190, a125
  s_nop 0
  v_mul_f32 v190, v190, v189
  s_nop 0
  v_accvgpr_write_b32 a125, v190
  v_accvgpr_read_b32 v190, a126
  s_nop 0
  v_mul_f32 v190, v190, v189
  s_nop 0
  v_accvgpr_write_b32 a126, v190
  v_accvgpr_read_b32 v190, a127
  s_nop 0
  v_mul_f32 v190, v190, v189
  s_nop 0
  v_accvgpr_write_b32 a127, v190
  v_accvgpr_read_b32 v190, a128
  s_nop 0
  v_mul_f32 v190, v190, v189
  s_nop 0
  v_accvgpr_write_b32 a128, v190
  v_accvgpr_read_b32 v190, a129
  s_nop 0
  v_mul_f32 v190, v190, v189
  s_nop 0
  v_accvgpr_write_b32 a129, v190
  v_accvgpr_read_b32 v190, a130
  s_nop 0
  v_mul_f32 v190, v190, v189
  s_nop 0
  v_accvgpr_write_b32 a130, v190
  v_accvgpr_read_b32 v190, a131
  s_nop 0
  v_mul_f32 v190, v190, v189
  s_nop 0
  v_accvgpr_write_b32 a131, v190
  v_accvgpr_read_b32 v190, a132
  s_nop 0
  v_mul_f32 v190, v190, v189
  s_nop 0
  v_accvgpr_write_b32 a132, v190
  v_accvgpr_read_b32 v190, a133
  s_nop 0
  v_mul_f32 v190, v190, v189
  s_nop 0
  v_accvgpr_write_b32 a133, v190
  v_accvgpr_read_b32 v190, a134
  s_nop 0
  v_mul_f32 v190, v190, v189
  s_nop 0
  v_accvgpr_write_b32 a134, v190
  v_accvgpr_read_b32 v190, a135
  s_nop 0
  v_mul_f32 v190, v190, v189
  s_nop 0
  v_accvgpr_write_b32 a135, v190
  v_accvgpr_read_b32 v190, a136
  s_nop 0
  v_mul_f32 v190, v190, v189
  s_nop 0
  v_accvgpr_write_b32 a136, v190
  v_accvgpr_read_b32 v190, a137
  s_nop 0
  v_mul_f32 v190, v190, v189
  s_nop 0
  v_accvgpr_write_b32 a137, v190
  v_accvgpr_read_b32 v190, a138
  s_nop 0
  v_mul_f32 v190, v190, v189
  s_nop 0
  v_accvgpr_write_b32 a138, v190
  v_accvgpr_read_b32 v190, a139
  s_nop 0
  v_mul_f32 v190, v190, v189
  s_nop 0
  v_accvgpr_write_b32 a139, v190
  v_accvgpr_read_b32 v190, a140
  s_nop 0
  v_mul_f32 v190, v190, v189
  s_nop 0
  v_accvgpr_write_b32 a140, v190
  v_accvgpr_read_b32 v190, a141
  s_nop 0
  v_mul_f32 v190, v190, v189
  s_nop 0
  v_accvgpr_write_b32 a141, v190
  v_accvgpr_read_b32 v190, a142
  s_nop 0
  v_mul_f32 v190, v190, v189
  s_nop 0
  v_accvgpr_write_b32 a142, v190
  v_accvgpr_read_b32 v190, a143
  s_nop 0
  v_mul_f32 v190, v190, v189
  s_nop 0
  v_accvgpr_write_b32 a143, v190
  v_exp_f32 v184, v24
  v_exp_f32 v185, v25
  s_nop 0
  v_cvt_pk_bf16_f32 v72, v184, v185
  v_exp_f32 v184, v26
  v_exp_f32 v185, v27
  s_nop 0
  v_cvt_pk_bf16_f32 v73, v184, v185
  v_exp_f32 v184, v40
  v_exp_f32 v185, v41
  s_nop 0
  v_cvt_pk_bf16_f32 v74, v184, v185
  v_exp_f32 v184, v42
  v_exp_f32 v185, v43
  s_nop 0
  v_cvt_pk_bf16_f32 v75, v184, v185
  s_nop 1
  v_mfma_f32_16x16x32_bf16 v[184:187], v[112:115], v[72:75], 0
  s_nop 7
  s_nop 1
  v_mov_b32 v191, 0x203
  v_cmp_class_f32 vcc, v104, v191
  v_mov_b32 v191, 0x42800000
  v_cmp_ge_f32 s[42:43], v188, v191
  v_mul_f32 v190, v104, v189
  s_nop 3
  s_or_b64 vcc, vcc, s[42:43]
  s_nop 1
  v_cndmask_b32 v190, v190, v184, vcc
  v_mov_b32 v104, v190
  v_mov_b32 v105, v190
  v_mov_b32 v106, v190
  v_mov_b32 v107, v190
  v_max3_f32 v188, v28, v29, v30
  v_max3_f32 v188, v188, v31, v44
  v_max3_f32 v188, v188, v45, v46
  v_max_f32 v188, v188, v47
  v_mov_b32 v190, v188
  s_nop 1
  v_permlane16_swap_b32 v188, v190
  s_nop 1
  v_max_f32 v188, v188, v190
  v_mov_b32 v190, v188
  s_nop 1
  v_permlane32_swap_b32 v188, v190
  s_nop 1
  v_max_f32 v188, v188, v190
  v_ceil_f32 v188, v188
  v_frexp_exp_i32_f32 v190, v108
  v_add_u32 v190, -12, v190
  v_cvt_f32_i32 v190, v190
  v_max3_f32 v188, v188, v190, 0
  v_cvt_i32_f32 v190, v188
  v_sub_u32 v190, 0, v190
  v_ldexp_f32 v189, 1.0, v190
  v_sub_f32 v28, v28, v188
  v_sub_f32 v29, v29, v188
  v_sub_f32 v30, v30, v188
  v_sub_f32 v31, v31, v188
  v_sub_f32 v44, v44, v188
  v_sub_f32 v45, v45, v188
  v_sub_f32 v46, v46, v188
  v_sub_f32 v47, v47, v188
  v_sub_f32 v92, v92, v188
  v_sub_f32 v93, v93, v188
  v_sub_f32 v94, v94, v188
  v_sub_f32 v95, v95, v188
  v_sub_f32 v196, v196, v188
  v_sub_f32 v197, v197, v188
  v_sub_f32 v198, v198, v188
  v_sub_f32 v199, v199, v188
  v_sub_f32 v119, v119, v188
  v_accvgpr_read_b32 v190, a144
  s_nop 0
  v_mul_f32 v190, v190, v189
  s_nop 0
  v_accvgpr_write_b32 a144, v190
  v_accvgpr_read_b32 v190, a145
  s_nop 0
  v_mul_f32 v190, v190, v189
  s_nop 0
  v_accvgpr_write_b32 a145, v190
  v_accvgpr_read_b32 v190, a146
  s_nop 0
  v_mul_f32 v190, v190, v189
  s_nop 0
  v_accvgpr_write_b32 a146, v190
  v_accvgpr_read_b32 v190, a147
  s_nop 0
  v_mul_f32 v190, v190, v189
  s_nop 0
  v_accvgpr_write_b32 a147, v190
  v_accvgpr_read_b32 v190, a148
  s_nop 0
  v_mul_f32 v190, v190, v189
  s_nop 0
  v_accvgpr_write_b32 a148, v190
  v_accvgpr_read_b32 v190, a149
  s_nop 0
  v_mul_f32 v190, v190, v189
  s_nop 0
  v_accvgpr_write_b32 a149, v190
  v_accvgpr_read_b32 v190, a150
  s_nop 0
  v_mul_f32 v190, v190, v189
  s_nop 0
  v_accvgpr_write_b32 a150, v190
  v_accvgpr_read_b32 v190, a151
  s_nop 0
  v_mul_f32 v190, v190, v189
  s_nop 0
  v_accvgpr_write_b32 a151, v190
  v_accvgpr_read_b32 v190, a152
  s_nop 0
  v_mul_f32 v190, v190, v189
  s_nop 0
  v_accvgpr_write_b32 a152, v190
  v_accvgpr_read_b32 v190, a153
  s_nop 0
  v_mul_f32 v190, v190, v189
  s_nop 0
  v_accvgpr_write_b32 a153, v190
  v_accvgpr_read_b32 v190, a154
  s_nop 0
  v_mul_f32 v190, v190, v189
  s_nop 0
  v_accvgpr_write_b32 a154, v190
  v_accvgpr_read_b32 v190, a155
  s_nop 0
  v_mul_f32 v190, v190, v189
  s_nop 0
  v_accvgpr_write_b32 a155, v190
  v_accvgpr_read_b32 v190, a156
  s_nop 0
  v_mul_f32 v190, v190, v189
  s_nop 0
  v_accvgpr_write_b32 a156, v190
  v_accvgpr_read_b32 v190, a157
  s_nop 0
  v_mul_f32 v190, v190, v189
  s_nop 0
  v_accvgpr_write_b32 a157, v190
  v_accvgpr_read_b32 v190, a158
  s_nop 0
  v_mul_f32 v190, v190, v189
  s_nop 0
  v_accvgpr_write_b32 a158, v190
  v_accvgpr_read_b32 v190, a159
  s_nop 0
  v_mul_f32 v190, v190, v189
  s_nop 0
  v_accvgpr_write_b32 a159, v190
  v_accvgpr_read_b32 v190, a160
  s_nop 0
  v_mul_f32 v190, v190, v189
  s_nop 0
  v_accvgpr_write_b32 a160, v190
  v_accvgpr_read_b32 v190, a161
  s_nop 0
  v_mul_f32 v190, v190, v189
  s_nop 0
  v_accvgpr_write_b32 a161, v190
  v_accvgpr_read_b32 v190, a162
  s_nop 0
  v_mul_f32 v190, v190, v189
  s_nop 0
  v_accvgpr_write_b32 a162, v190
  v_accvgpr_read_b32 v190, a163
  s_nop 0
  v_mul_f32 v190, v190, v189
  s_nop 0
  v_accvgpr_write_b32 a163, v190
  v_accvgpr_read_b32 v190, a164
  s_nop 0
  v_mul_f32 v190, v190, v189
  s_nop 0
  v_accvgpr_write_b32 a164, v190
  v_accvgpr_read_b32 v190, a165
  s_nop 0
  v_mul_f32 v190, v190, v189
  s_nop 0
  v_accvgpr_write_b32 a165, v190
  v_accvgpr_read_b32 v190, a166
  s_nop 0
  v_mul_f32 v190, v190, v189
  s_nop 0
  v_accvgpr_write_b32 a166, v190
  v_accvgpr_read_b32 v190, a167
  s_nop 0
  v_mul_f32 v190, v190, v189
  s_nop 0
  v_accvgpr_write_b32 a167, v190
  v_accvgpr_read_b32 v190, a168
  s_nop 0
  v_mul_f32 v190, v190, v189
  s_nop 0
  v_accvgpr_write_b32 a168, v190
  v_accvgpr_read_b32 v190, a169
  s_nop 0
  v_mul_f32 v190, v190, v189
  s_nop 0
  v_accvgpr_write_b32 a169, v190
  v_accvgpr_read_b32 v190, a170
  s_nop 0
  v_mul_f32 v190, v190, v189
  s_nop 0
  v_accvgpr_write_b32 a170, v190
  v_accvgpr_read_b32 v190, a171
  s_nop 0
  v_mul_f32 v190, v190, v189
  s_nop 0
  v_accvgpr_write_b32 a171, v190
  v_accvgpr_read_b32 v190, a172
  s_nop 0
  v_mul_f32 v190, v190, v189
  s_nop 0
  v_accvgpr_write_b32 a172, v190
  v_accvgpr_read_b32 v190, a173
  s_nop 0
  v_mul_f32 v190, v190, v189
  s_nop 0
  v_accvgpr_write_b32 a173, v190
  v_accvgpr_read_b32 v190, a174
  s_nop 0
  v_mul_f32 v190, v190, v189
  s_nop 0
  v_accvgpr_write_b32 a174, v190
  v_accvgpr_read_b32 v190, a175
  s_nop 0
  v_mul_f32 v190, v190, v189
  s_nop 0
  v_accvgpr_write_b32 a175, v190
  v_accvgpr_read_b32 v190, a176
  s_nop 0
  v_mul_f32 v190, v190, v189
  s_nop 0
  v_accvgpr_write_b32 a176, v190
  v_accvgpr_read_b32 v190, a177
  s_nop 0
  v_mul_f32 v190, v190, v189
  s_nop 0
  v_accvgpr_write_b32 a177, v190
  v_accvgpr_read_b32 v190, a178
  s_nop 0
  v_mul_f32 v190, v190, v189
  s_nop 0
  v_accvgpr_write_b32 a178, v190
  v_accvgpr_read_b32 v190, a179
  s_nop 0
  v_mul_f32 v190, v190, v189
  s_nop 0
  v_accvgpr_write_b32 a179, v190
  v_accvgpr_read_b32 v190, a180
  s_nop 0
  v_mul_f32 v190, v190, v189
  s_nop 0
  v_accvgpr_write_b32 a180, v190
  v_accvgpr_read_b32 v190, a181
  s_nop 0
  v_mul_f32 v190, v190, v189
  s_nop 0
  v_accvgpr_write_b32 a181, v190
  v_accvgpr_read_b32 v190, a182
  s_nop 0
  v_mul_f32 v190, v190, v189
  s_nop 0
  v_accvgpr_write_b32 a182, v190
  v_accvgpr_read_b32 v190, a183
  s_nop 0
  v_mul_f32 v190, v190, v189
  s_nop 0
  v_accvgpr_write_b32 a183, v190
  v_accvgpr_read_b32 v190, a184
  s_nop 0
  v_mul_f32 v190, v190, v189
  s_nop 0
  v_accvgpr_write_b32 a184, v190
  v_accvgpr_read_b32 v190, a185
  s_nop 0
  v_mul_f32 v190, v190, v189
  s_nop 0
  v_accvgpr_write_b32 a185, v190
  v_accvgpr_read_b32 v190, a186
  s_nop 0
  v_mul_f32 v190, v190, v189
  s_nop 0
  v_accvgpr_write_b32 a186, v190
  v_accvgpr_read_b32 v190, a187
  s_nop 0
  v_mul_f32 v190, v190, v189
  s_nop 0
  v_accvgpr_write_b32 a187, v190
  v_accvgpr_read_b32 v190, a188
  s_nop 0
  v_mul_f32 v190, v190, v189
  s_nop 0
  v_accvgpr_write_b32 a188, v190
  v_accvgpr_read_b32 v190, a189
  s_nop 0
  v_mul_f32 v190, v190, v189
  s_nop 0
  v_accvgpr_write_b32 a189, v190
  v_accvgpr_read_b32 v190, a190
  s_nop 0
  v_mul_f32 v190, v190, v189
  s_nop 0
  v_accvgpr_write_b32 a190, v190
  v_accvgpr_read_b32 v190, a191
  s_nop 0
  v_mul_f32 v190, v190, v189
  s_nop 0
  v_accvgpr_write_b32 a191, v190
  v_exp_f32 v184, v28
  v_exp_f32 v185, v29
  s_nop 0
  v_cvt_pk_bf16_f32 v76, v184, v185
  v_exp_f32 v184, v30
  v_exp_f32 v185, v31
  s_nop 0
  v_cvt_pk_bf16_f32 v77, v184, v185
  v_exp_f32 v184, v44
  v_exp_f32 v185, v45
  s_nop 0
  v_cvt_pk_bf16_f32 v78, v184, v185
  v_exp_f32 v184, v46
  v_exp_f32 v185, v47
  s_nop 0
  v_cvt_pk_bf16_f32 v79, v184, v185
  s_nop 1
  v_mfma_f32_16x16x32_bf16 v[184:187], v[112:115], v[76:79], 0
  s_nop 7
  s_nop 1
  v_mov_b32 v191, 0x203
  v_cmp_class_f32 vcc, v108, v191
  v_mov_b32 v191, 0x42800000
  v_cmp_ge_f32 s[42:43], v188, v191
  v_mul_f32 v190, v108, v189
  s_nop 3
  s_or_b64 vcc, vcc, s[42:43]
  s_nop 1
  v_cndmask_b32 v190, v190, v184, vcc
  v_mov_b32 v108, v190
  v_mov_b32 v109, v190
  v_mov_b32 v110, v190
  v_mov_b32 v111, v190
  s_nop 3
  s_setpc_b64 s[72:73]
INIT_A:
  s_nop 7
  s_nop 7
  v_max3_f32 v188, v16, v17, v18
  v_max3_f32 v188, v188, v19, v32
  v_max3_f32 v188, v188, v33, v34
  v_max_f32 v188, v188, v35
  v_mov_b32 v190, v188
  s_nop 1
  v_permlane16_swap_b32 v188, v190
  s_nop 1
  v_max_f32 v188, v188, v190
  v_mov_b32 v190, v188
  s_nop 1
  v_permlane32_swap_b32 v188, v190
  s_nop 1
  v_max_f32 v188, v188, v190
  v_ceil_f32 v188, v188
  v_sub_f32 v16, v16, v188
  v_sub_f32 v17, v17, v188
  v_sub_f32 v18, v18, v188
  v_sub_f32 v19, v19, v188
  v_sub_f32 v32, v32, v188
  v_sub_f32 v33, v33, v188
  v_sub_f32 v34, v34, v188
  v_sub_f32 v35, v35, v188
  v_sub_f32 v116, v116, v188
  v_exp_f32 v184, v16
  v_exp_f32 v185, v17
  s_nop 0
  v_cvt_pk_bf16_f32 v48, v184, v185
  v_exp_f32 v184, v18
  v_exp_f32 v185, v19
  s_nop 0
  v_cvt_pk_bf16_f32 v49, v184, v185
  v_exp_f32 v184, v32
  v_exp_f32 v185, v33
  s_nop 0
  v_cvt_pk_bf16_f32 v50, v184, v185
  v_exp_f32 v184, v34
  v_exp_f32 v185, v35
  s_nop 0
  v_cvt_pk_bf16_f32 v51, v184, v185
  s_nop 1
  v_mfma_f32_16x16x32_bf16 v[96:99], v[112:115], v[48:51], 0
  v_max3_f32 v188, v20, v21, v22
  v_max3_f32 v188, v188, v23, v36
  v_max3_f32 v188, v188, v37, v38
  v_max_f32 v188, v188, v39
  v_mov_b32 v190, v188
  s_nop 1
  v_permlane16_swap_b32 v188, v190
  s_nop 1
  v_max_f32 v188, v188, v190
  v_mov_b32 v190, v188
  s_nop 1
  v_permlane32_swap_b32 v188, v190
  s_nop 1
  v_max_f32 v188, v188, v190
  v_ceil_f32 v188, v188
  v_sub_f32 v20, v20, v188
  v_sub_f32 v21, v21, v188
  v_sub_f32 v22, v22, v188
  v_sub_f32 v23, v23, v188
  v_sub_f32 v36, v36, v188
  v_sub_f32 v37, v37, v188
  v_sub_f32 v38, v38, v188
  v_sub_f32 v39, v39, v188
  v_sub_f32 v117, v117, v188
  v_exp_f32 v184, v20
  v_exp_f32 v185, v21
  s_nop 0
  v_cvt_pk_bf16_f32 v52, v184, v185
  v_exp_f32 v184, v22
  v_exp_f32 v185, v23
  s_nop 0
  v_cvt_pk_bf16_f32 v53, v184, v185
  v_exp_f32 v184, v36
  v_exp_f32 v185, v37
  s_nop 0
  v_cvt_pk_bf16_f32 v54, v184, v185
  v_exp_f32 v184, v38
  v_exp_f32 v185, v39
  s_nop 0
  v_cvt_pk_bf16_f32 v55, v184, v185
  s_nop 1
  v_mfma_f32_16x16x32_bf16 v[100:103], v[112:115], v[52:55], 0
  s_nop 7
  s_setpc_b64 s[72:73]
VSET_0:
  s_mov_b32 s80, 0
  s_mov_b32 s81, 0
  s_mov_b32 s82, 0
  s_mov_b32 s83, 0
  s_mov_b32 s84, 512
  s_mov_b32 s87, 256
  s_mov_b32 s85, 512
  s_mov_b32 s88, 256
  s_mov_b32 s86, 512
  s_mov_b32 s89, 256
  s_add_u32 s90, s58, 0
  s_add_u32 s91, s58, 6144
  s_add_u32 s92, s59, 0
  s_setpc_b64 s[72:73]
VSET_1:
  s_mov_b32 s80, 0
  s_mov_b32 s81, 128
  s_mov_b32 s82, 128
  s_mov_b32 s83, 128
  s_mov_b32 s84, -1536
  s_mov_b32 s87, -768
  s_mov_b32 s85, 512
  s_mov_b32 s88, 256
  s_mov_b32 s86, 512
  s_mov_b32 s89, 256
  s_add_u32 s90, s59, 6144
  s_add_u32 s91, s58, 2048
  s_add_u32 s92, s58, 8192
  s_setpc_b64 s[72:73]
VSET_2:
  s_mov_b32 s80, 128
  s_mov_b32 s81, 128
  s_mov_b32 s82, 256
  s_mov_b32 s83, 256
  s_mov_b32 s84, 512
  s_mov_b32 s87, 256
  s_mov_b32 s85, -1536
  s_mov_b32 s88, -768
  s_mov_b32 s86, 512
  s_mov_b32 s89, 256
  s_add_u32 s90, s59, 2048
  s_add_u32 s91, s59, 8192
  s_add_u32 s92, s58, 4096
  s_setpc_b64 s[72:73]
VSET_3:
  s_mov_b32 s80, 256
  s_mov_b32 s81, 256
  s_mov_b32 s82, 256
  s_mov_b32 s83, 256
  s_mov_b32 s84, 512
  s_mov_b32 s87, 256
  s_mov_b32 s85, 512
  s_mov_b32 s88, 256
  s_mov_b32 s86, 0
  s_mov_b32 s89, 0
  s_add_u32 s90, s58, 10240
  s_add_u32 s91, s59, 4096
  s_add_u32 s92, s59, 10240
  s_setpc_b64 s[72:73]
CPQ_0:
  v_accvgpr_read_b32 v216, a240
  v_accvgpr_read_b32 v217, a241
  v_accvgpr_read_b32 v218, a242
  v_accvgpr_read_b32 v219, a243
  v_accvgpr_read_b32 v220, a244
  v_accvgpr_read_b32 v221, a245
  v_accvgpr_read_b32 v222, a246
  v_accvgpr_read_b32 v223, a247
  v_accvgpr_read_b32 v224, a248
  v_accvgpr_read_b32 v225, a249
  v_accvgpr_read_b32 v226, a250
  v_accvgpr_read_b32 v227, a251
  v_accvgpr_read_b32 v228, a252
  v_accvgpr_read_b32 v229, a253
  v_accvgpr_read_b32 v230, a254
  v_accvgpr_read_b32 v231, a255
  v_mov_b32 v232, v120
  v_mov_b32 v233, v121
  v_mov_b32 v234, v122
  v_mov_b32 v235, v123
  v_mov_b32 v236, v124
  v_mov_b32 v237, v125
  v_mov_b32 v238, v126
  v_mov_b32 v239, v127
  s_nop 1
  s_setpc_b64 s[72:73]
KEND_0:
  v_mov_b32 v216, v128
  v_mov_b32 v217, v129
  v_mov_b32 v184, v248
  v_mov_b32 v185, v249
  v_mov_b32 v218, v130
  v_max_f32_dpp v184, v184, v184 quad_perm:[1,0,3,2] row_mask:0xf bank_mask:0xf
  v_max_f32_dpp v185, v185, v185 quad_perm:[1,0,3,2] row_mask:0xf bank_mask:0xf
  v_mov_b32 v219, v131
  v_max_f32_dpp v184, v184, v184 quad_perm:[2,3,0,1] row_mask:0xf bank_mask:0xf
  v_max_f32_dpp v185, v185, v185 quad_perm:[2,3,0,1] row_mask:0xf bank_mask:0xf
  v_mov_b32 v220, v132
  v_max_f32_dpp v184, v184, v184 row_half_mirror row_mask:0xf bank_mask:0xf
  v_max_f32_dpp v185, v185, v185 row_half_mirror row_mask:0xf bank_mask:0xf
  v_mov_b32 v221, v133
  v_sub_f32 v248, v248, v184
  v_sub_f32 v249, v249, v185
  v_exp_f32 v248, v248
  v_exp_f32 v249, v249
  v_mov_b32 v222, v134
  v_mov_b32 v184, v248
  v_mov_b32 v185, v249
  v_mov_b32 v223, v135
  v_add_f32_dpp v184, v184, v184 quad_perm:[1,0,3,2] row_mask:0xf bank_mask:0xf
  v_add_f32_dpp v185, v185, v185 quad_perm:[1,0,3,2] row_mask:0xf bank_mask:0xf
  v_mov_b32 v224, v136
  v_add_f32_dpp v184, v184, v184 quad_perm:[2,3,0,1] row_mask:0xf bank_mask:0xf
  v_add_f32_dpp v185, v185, v185 quad_perm:[2,3,0,1] row_mask:0xf bank_mask:0xf
  v_mov_b32 v225, v137
  v_add_f32_dpp v184, v184, v184 row_half_mirror row_mask:0xf bank_mask:0xf
  v_add_f32_dpp v185, v185, v185 row_half_mirror row_mask:0xf bank_mask:0xf
  v_mov_b32 v226, v138
  v_rcp_f32 v184, v184
  v_rcp_f32 v185, v185
  v_mov_b32 v227, v139
  v_mul_f32 v184, s57, v184
  v_mul_f32 v185, s57, v185
  v_mul_f32 v248, v248, v184
  v_mul_f32 v249, v249, v185
  v_cvt_pk_bf16_f32 v248, v248, v249
  v_mov_b32 v228, v140
  ds_write_b16 v252, v248 offset:0
  ds_write_b16_d16_hi v252, v248 offset:32
  v_mov_b32 v229, v141
  v_mov_b32 v230, v142
  v_mov_b32 v231, v143
  v_mov_b32 v232, v144
  v_mov_b32 v233, v145
  v_mov_b32 v234, v146
  v_mov_b32 v235, v147
  v_mov_b32 v236, v148
  v_mov_b32 v237, v149
  v_mov_b32 v238, v150
  v_mov_b32 v239, v151
  s_nop 1
  s_setpc_b64 s[72:73]
KEND_1:
  v_accvgpr_read_b32 v216, a192
  v_accvgpr_read_b32 v217, a193
  v_mov_b32 v184, v248
  v_mov_b32 v185, v249
  v_accvgpr_read_b32 v218, a194
  v_max_f32_dpp v184, v184, v184 quad_perm:[1,0,3,2] row_mask:0xf bank_mask:0xf
  v_max_f32_dpp v185, v185, v185 quad_perm:[1,0,3,2] row_mask:0xf bank_mask:0xf
  v_accvgpr_read_b32 v219, a195
  v_max_f32_dpp v184, v184, v184 quad_perm:[2,3,0,1] row_mask:0xf bank_mask:0xf
  v_max_f32_dpp v185, v185, v185 quad_perm:[2,3,0,1] row_mask:0xf bank_mask:0xf
  v_accvgpr_read_b32 v220, a196
  v_max_f32_dpp v184, v184, v184 row_half_mirror row_mask:0xf bank_mask:0xf
  v_max_f32_dpp v185, v185, v185 row_half_mirror row_mask:0xf bank_mask:0xf
  v_accvgpr_read_b32 v221, a197
  v_sub_f32 v248, v248, v184
  v_sub_f32 v249, v249, v185
  v_exp_f32 v248, v248
  v_exp_f32 v249, v249
  v_accvgpr_read_b32 v222, a198
  v_mov_b32 v184, v248
  v_mov_b32 v185, v249
  v_accvgpr_read_b32 v223, a199
  v_add_f32_dpp v184, v184, v184 quad_perm:[1,0,3,2] row_mask:0xf bank_mask:0xf
  v_add_f32_dpp v185, v185, v185 quad_perm:[1,0,3,2] row_mask:0xf bank_mask:0xf
  v_accvgpr_read_b32 v224, a200
  v_add_f32_dpp v184, v184, v184 quad_perm:[2,3,0,1] row_mask:0xf bank_mask:0xf
  v_add_f32_dpp v185, v185, v185 quad_perm:[2,3,0,1] row_mask:0xf bank_mask:0xf
  v_accvgpr_read_b32 v225, a201
  v_add_f32_dpp v184, v184, v184 row_half_mirror row_mask:0xf bank_mask:0xf
  v_add_f32_dpp v185, v185, v185 row_half_mirror row_mask:0xf bank_mask:0xf
  v_accvgpr_read_b32 v226, a202
  v_rcp_f32 v184, v184
  v_rcp_f32 v185, v185
  v_accvgpr_read_b32 v227, a203
  v_mul_f32 v184, s57, v184
  v_mul_f32 v185, s57, v185
  v_mul_f32 v248, v248, v184
  v_mul_f32 v249, v249, v185
  v_cvt_pk_bf16_f32 v248, v248, v249
  v_accvgpr_read_b32 v228, a204
  ds_write_b16 v252, v248 offset:256
  ds_write_b16_d16_hi v252, v248 offset:288
  v_accvgpr_read_b32 v229, a205
  v_accvgpr_read_b32 v230, a206
  v_accvgpr_read_b32 v231, a207
  v_accvgpr_read_b32 v232, a208
  v_accvgpr_read_b32 v233, a209
  v_accvgpr_read_b32 v234, a210
  v_accvgpr_read_b32 v235, a211
  v_accvgpr_read_b32 v236, a212
  v_accvgpr_read_b32 v237, a213
  v_accvgpr_read_b32 v238, a214
  v_accvgpr_read_b32 v239, a215
  s_nop 1
  s_setpc_b64 s[72:73]
KEND_2:
  v_accvgpr_read_b32 v216, a216
  v_accvgpr_read_b32 v217, a217
  v_mov_b32 v184, v248
  v_mov_b32 v185, v249
  v_accvgpr_read_b32 v218, a218
  v_max_f32_dpp v184, v184, v184 quad_perm:[1,0,3,2] row_mask:0xf bank_mask:0xf
  v_max_f32_dpp v185, v185, v185 quad_perm:[1,0,3,2] row_mask:0xf bank_mask:0xf
  v_accvgpr_read_b32 v219, a219
  v_max_f32_dpp v184, v184, v184 quad_perm:[2,3,0,1] row_mask:0xf bank_mask:0xf
  v_max_f32_dpp v185, v185, v185 quad_perm:[2,3,0,1] row_mask:0xf bank_mask:0xf
  v_accvgpr_read_b32 v220, a220
  v_max_f32_dpp v184, v184, v184 row_half_mirror row_mask:0xf bank_mask:0xf
  v_max_f32_dpp v185, v185, v185 row_half_mirror row_mask:0xf bank_mask:0xf
  v_accvgpr_read_b32 v221, a221
  v_sub_f32 v248, v248, v184
  v_sub_f32 v249, v249, v185
  v_exp_f32 v248, v248
  v_exp_f32 v249, v249
  v_accvgpr_read_b32 v222, a222
  v_mov_b32 v184, v248
  v_mov_b32 v185, v249
  v_accvgpr_read_b32 v223, a223
  v_add_f32_dpp v184, v184, v184 quad_perm:[1,0,3,2] row_mask:0xf bank_mask:0xf
  v_add_f32_dpp v185, v185, v185 quad_perm:[1,0,3,2] row_mask:0xf bank_mask:0xf
  v_accvgpr_read_b32 v224, a224
  v_add_f32_dpp v184, v184, v184 quad_perm:[2,3,0,1] row_mask:0xf bank_mask:0xf
  v_add_f32_dpp v185, v185, v185 quad_perm:[2,3,0,1] row_mask:0xf bank_mask:0xf
  v_accvgpr_read_b32 v225, a225
  v_add_f32_dpp v184, v184, v184 row_half_mirror row_mask:0xf bank_mask:0xf
  v_add_f32_dpp v185, v185, v185 row_half_mirror row_mask:0xf bank_mask:0xf
  v_accvgpr_read_b32 v226, a226
  v_rcp_f32 v184, v184
  v_rcp_f32 v185, v185
  v_accvgpr_read_b32 v227, a227
  v_mul_f32 v184, s57, v184
  v_mul_f32 v185, s57, v185
  v_mul_f32 v248, v248, v184
  v_mul_f32 v249, v249, v185
  v_cvt_pk_bf16_f32 v248, v248, v249
  v_accvgpr_read_b32 v228, a228
  ds_write_b16 v252, v248 offset:512
  ds_write_b16_d16_hi v252, v248 offset:544
  v_accvgpr_read_b32 v229, a229
  v_accvgpr_read_b32 v230, a230
  v_accvgpr_read_b32 v231, a231
  v_accvgpr_read_b32 v232, a232
  v_accvgpr_read_b32 v233, a233
  v_accvgpr_read_b32 v234, a234
  v_accvgpr_read_b32 v235, a235
  v_accvgpr_read_b32 v236, a236
  v_accvgpr_read_b32 v237, a237
  v_accvgpr_read_b32 v238, a238
  v_accvgpr_read_b32 v239, a239
  s_nop 1
  s_setpc_b64 s[72:73]
KEND_3:
  s_nop 0
  s_nop 0
  v_mov_b32 v184, v248
  v_mov_b32 v185, v249
  s_nop 0
  v_max_f32_dpp v184, v184, v184 quad_perm:[1,0,3,2] row_mask:0xf bank_mask:0xf
  v_max_f32_dpp v185, v185, v185 quad_perm:[1,0,3,2] row_mask:0xf bank_mask:0xf
  s_nop 0
  v_max_f32_dpp v184, v184, v184 quad_perm:[2,3,0,1] row_mask:0xf bank_mask:0xf
  v_max_f32_dpp v185, v185, v185 quad_perm:[2,3,0,1] row_mask:0xf bank_mask:0xf
  s_nop 0
  v_max_f32_dpp v184, v184, v184 row_half_mirror row_mask:0xf bank_mask:0xf
  v_max_f32_dpp v185, v185, v185 row_half_mirror row_mask:0xf bank_mask:0xf
  s_nop 0
  v_sub_f32 v248, v248, v184
  v_sub_f32 v249, v249, v185
  v_exp_f32 v248, v248
  v_exp_f32 v249, v249
  s_nop 0
  v_mov_b32 v184, v248
  v_mov_b32 v185, v249
  s_nop 0
  v_add_f32_dpp v184, v184, v184 quad_perm:[1,0,3,2] row_mask:0xf bank_mask:0xf
  v_add_f32_dpp v185, v185, v185 quad_perm:[1,0,3,2] row_mask:0xf bank_mask:0xf
  s_nop 0
  v_add_f32_dpp v184, v184, v184 quad_perm:[2,3,0,1] row_mask:0xf bank_mask:0xf
  v_add_f32_dpp v185, v185, v185 quad_perm:[2,3,0,1] row_mask:0xf bank_mask:0xf
  s_nop 0
  v_add_f32_dpp v184, v184, v184 row_half_mirror row_mask:0xf bank_mask:0xf
  v_add_f32_dpp v185, v185, v185 row_half_mirror row_mask:0xf bank_mask:0xf
  s_nop 0
  v_rcp_f32 v184, v184
  v_rcp_f32 v185, v185
  s_nop 0
  v_mul_f32 v184, s57, v184
  v_mul_f32 v185, s57, v185
  v_mul_f32 v248, v248, v184
  v_mul_f32 v249, v249, v185
  v_cvt_pk_bf16_f32 v248, v248, v249
  s_nop 0
  ds_write_b16 v252, v248 offset:768
  ds_write_b16_d16_hi v252, v248 offset:800
  s_nop 1
  s_setpc_b64 s[72:73]
P2N0s0_SLOW:
  s_cmp_eq_u64 s[64:65], 0
  s_cbranch_scc1 P2N0s0_SLOW_M
  s_call_b64 s[72:73], RARE_p2_1
P2N0s0_SLOW_M:
  s_call_b64 s[72:73], MASK_p2
  s_branch P2N0s0_SLOWB
P2N0s1_SLOW:
  s_cmp_eq_u64 s[64:65], 0
  s_cbranch_scc1 P2N0s1_SLOW_M
  s_call_b64 s[72:73], RARE_p2_0
P2N0s1_SLOW_M:
  s_call_b64 s[72:73], MASK_p2
  s_branch P2N0s1_SLOWB
P2N1s0_SLOW:
  s_cmp_eq_u64 s[64:65], 0
  s_cbranch_scc1 P2N1s0_SLOW_M
  s_call_b64 s[72:73], RARE_p2_1
P2N1s0_SLOW_M:
  s_call_b64 s[72:73], MASK_p2
  s_branch P2N1s0_SLOWB
P1K0s0_SLOW:
  s_cmp_eq_u64 s[64:65], 0
  s_cbranch_scc1 P1K0s0_SLOW_M
  s_call_b64 s[72:73], RARE_p1_0
P1K0s0_SLOW_M:
  s_cmp_eq_u32 s32, 5
  s_cbranch_scc0 P1K0s0_SLOW_N
  s_call_b64 s[72:73], INIT_A
P1K0s0_SLOW_N:
  s_call_b64 s[72:73], MASK_p1
  s_branch P1K0s0_SLOWB
P1K0s1_SLOW:
  s_cmp_eq_u64 s[64:65], 0
  s_cbranch_scc1 P1K0s1_SLOW_M
  s_call_b64 s[72:73], RARE_p1_1
P1K0s1_SLOW_M:
  s_call_b64 s[72:73], MASK_p1
  s_branch P1K0s1_SLOWB
P1K1s0_SLOW:
  s_cmp_eq_u64 s[64:65], 0
  s_cbranch_scc1 P1K1s0_SLOW_M
  s_call_b64 s[72:73], RARE_p1_0
P1K1s0_SLOW_M:
  s_call_b64 s[72:73], MASK_p1
  s_branch P1K1s0_SLOWB
P1K1s1_SLOW:
  s_cmp_eq_u64 s[64:65], 0
  s_cbranch_scc1 P1K1s1_SLOW_M
  s_call_b64 s[72:73], RARE_p1_1
P1K1s1_SLOW_M:
  s_call_b64 s[72:73], MASK_p1
  s_branch P1K1s1_SLOWB
P1V0s0_SLOW:
  s_cmp_eq_u64 s[64:65], 0
  s_cbranch_scc1 P1V0s0_SLOW_M
  s_call_b64 s[72:73], RARE_p1_0
P1V0s0_SLOW_M:
  s_call_b64 s[72:73], MASK_p1
  s_branch P1V0s0_SLOWB
P1V0s1_SLOW:
  s_cmp_eq_u64 s[64:65], 0
  s_cbranch_scc1 P1V0s1_SLOW_M
  s_call_b64 s[72:73], RARE_p1_1
P1V0s1_SLOW_M:
  s_call_b64 s[72:73], MASK_p1
  s_branch P1V0s1_SLOWB
P1V1s0_SLOW:
  s_cmp_eq_u64 s[64:65], 0
  s_cbranch_scc1 P1V1s0_SLOW_M
  s_call_b64 s[72:73], RARE_p1_0
P1V1s0_SLOW_M:
  s_call_b64 s[72:73], MASK_p1
  s_branch P1V1s0_SLOWB
P1V1s1_SLOW:
  s_cmp_eq_u64 s[64:65], 0
  s_cbranch_scc1 P1V1s1_SLOW_M
  s_call_b64 s[72:73], RARE_p1_1
P1V1s1_SLOW_M:
  s_call_b64 s[72:73], MASK_p1
  s_branch P1V1s1_SLOWB
P2K0s0_SLOW:
  s_cmp_eq_u64 s[64:65], 0
  s_cbranch_scc1 P2K0s0_SLOW_M
  s_call_b64 s[72:73], RARE_p2_0
P2K0s0_SLOW_M:
  s_call_b64 s[72:73], MASK_p2
  s_branch P2K0s0_SLOWB
P2K0s1_SLOW:
  s_cmp_eq_u64 s[64:65], 0
  s_cbranch_scc1 P2K0s1_SLOW_M
  s_call_b64 s[72:73], RARE_p2_1
P2K0s1_SLOW_M:
  s_call_b64 s[72:73], MASK_p2
  s_branch P2K0s1_SLOWB
P2K0s2_SLOW:
  s_cmp_eq_u64 s[64:65], 0
  s_cbranch_scc1 P2K0s2_SLOW_M
  s_call_b64 s[72:73], RARE_p2_0
P2K0s2_SLOW_M:
  s_call_b64 s[72:73], MASK_p2
  s_branch P2K0s2_SLOWB
P2K0s3_SLOW:
  s_cmp_eq_u64 s[64:65], 0
  s_cbranch_scc1 P2K0s3_SLOW_M
  s_call_b64 s[72:73], RARE_p2_1
P2K0s3_SLOW_M:
  s_call_b64 s[72:73], MASK_p2
  s_branch P2K0s3_SLOWB
P2K1s0_SLOW:
  s_cmp_eq_u64 s[64:65], 0
  s_cbranch_scc1 P2K1s0_SLOW_M
  s_call_b64 s[72:73], RARE_p2_0
P2K1s0_SLOW_M:
  s_call_b64 s[72:73], MASK_p2
  s_branch P2K1s0_SLOWB
P2K1s1_SLOW:
  s_cmp_eq_u64 s[64:65], 0
  s_cbranch_scc1 P2K1s1_SLOW_M
  s_call_b64 s[72:73], RARE_p2_1
P2K1s1_SLOW_M:
  s_call_b64 s[72:73], MASK_p2
  s_branch P2K1s1_SLOWB
P2K1s2_SLOW:
  s_cmp_eq_u64 s[64:65], 0
  s_cbranch_scc1 P2K1s2_SLOW_M
  s_call_b64 s[72:73], RARE_p2_0
P2K1s2_SLOW_M:
  s_call_b64 s[72:73], MASK_p2
  s_branch P2K1s2_SLOWB
P2K1s3_SLOW:
  s_cmp_eq_u64 s[64:65], 0
  s_cbranch_scc1 P2K1s3_SLOW_M
  s_call_b64 s[72:73], RARE_p2_1
P2K1s3_SLOW_M:
  s_call_b64 s[72:73], MASK_p2
  s_branch P2K1s3_SLOWB
P2V0s0_SLOW:
  s_cmp_eq_u64 s[64:65], 0
  s_cbranch_scc1 P2V0s0_SLOW_M
  s_call_b64 s[72:73], RARE_p2_0
P2V0s0_SLOW_M:
  s_call_b64 s[72:73], MASK_p2
  s_branch P2V0s0_SLOWB
P2V0s1_SLOW:
  s_cmp_eq_u64 s[64:65], 0
  s_cbranch_scc1 P2V0s1_SLOW_M
  s_call_b64 s[72:73], RARE_p2_1
P2V0s1_SLOW_M:
  s_call_b64 s[72:73], MASK_p2
  s_branch P2V0s1_SLOWB
P2V0s2_SLOW:
  s_cmp_eq_u64 s[64:65], 0
  s_cbranch_scc1 P2V0s2_SLOW_M
  s_call_b64 s[72:73], RARE_p2_0
P2V0s2_SLOW_M:
  s_call_b64 s[72:73], MASK_p2
  s_branch P2V0s2_SLOWB
P2V0s3_SLOW:
  s_cmp_eq_u64 s[64:65], 0
  s_cbranch_scc1 P2V0s3_SLOW_M
  s_call_b64 s[72:73], RARE_p2_1
P2V0s3_SLOW_M:
  s_call_b64 s[72:73], MASK_p2
  s_branch P2V0s3_SLOWB
P2V1s0_SLOW:
  s_cmp_eq_u64 s[64:65], 0
  s_cbranch_scc1 P2V1s0_SLOW_M
  s_call_b64 s[72:73], RARE_p2_0
P2V1s0_SLOW_M:
  s_call_b64 s[72:73], MASK_p2
  s_branch P2V1s0_SLOWB
P2V1s1_SLOW:
  s_cmp_eq_u64 s[64:65], 0
  s_cbranch_scc1 P2V1s1_SLOW_M
  s_call_b64 s[72:73], RARE_p2_1
P2V1s1_SLOW_M:
  s_call_b64 s[72:73], MASK_p2
  s_branch P2V1s1_SLOWB
P2V1s2_SLOW:
  s_cmp_eq_u64 s[64:65], 0
  s_cbranch_scc1 P2V1s2_SLOW_M
  s_call_b64 s[72:73], RARE_p2_0
P2V1s2_SLOW_M:
  s_call_b64 s[72:73], MASK_p2
  s_branch P2V1s2_SLOWB
P2V1s3_SLOW:
  s_cmp_eq_u64 s[64:65], 0
  s_cbranch_scc1 P2V1s3_SLOW_M
  s_call_b64 s[72:73], RARE_p2_1
P2V1s3_SLOW_M:
  s_call_b64 s[72:73], MASK_p2
  s_branch P2V1s3_SLOWB
.p2align 6
.type TILETAB,@object
TILETAB:
  .byte 32, 33, 34, 35, 0, 1, 2, 3, 63, 62, 61, 6, 7, 5, 8, 59, 9, 58, 10, 57, 11, 4, 12, 55, 13, 54, 14, 53, 56, 15, 16, 51, 17, 50, 18, 49, 19, 52, 20, 47, 21, 46, 22, 45, 48, 23, 24, 43, 25, 42, 26, 41, 29, 38, 30, 37, 31, 28, 39, 27, 44, 60, 36, 40
  .byte 32, 33, 34, 35, 0, 1, 2, 3, 4, 5, 6, 7, 59, 58, 57, 10, 11, 9, 12, 55, 13, 54, 56, 14, 15, 52, 16, 51, 17, 50, 18, 49, 19, 53, 20, 47, 21, 46, 22, 45, 48, 23, 24, 43, 25, 42, 26, 41, 29, 38, 30, 37, 31, 28, 39, 27, 44, 8, 36, 40, 255, 255, 255, 255
  .byte 32, 33, 34, 35, 0, 1, 2, 3, 4, 5, 6, 7, 8, 9, 10, 11, 55, 54, 53, 52, 15, 14, 16, 51, 17, 50, 18, 49, 19, 13, 20, 47, 21, 46, 22, 45, 48, 23, 24, 43, 25, 42, 26, 41, 29, 38, 30, 37, 31, 28, 39, 27, 44, 12, 36, 40, 255, 255, 255, 255, 255, 255, 255, 255
  .byte 32, 33, 34, 35, 0, 1, 2, 3, 4, 5, 6, 7, 8, 9, 10, 11, 12, 13, 14, 15, 51, 50, 49, 18, 19, 17, 20, 47, 21, 46, 48, 22, 23, 44, 24, 43, 25, 42, 26, 41, 29, 38, 30, 37, 31, 28, 39, 27, 45, 16, 36, 40, 255, 255, 255, 255, 255, 255, 255, 255, 255, 255, 255, 255
  .byte 32, 33, 34, 35, 0, 1, 2, 3, 4, 5, 6, 7, 8, 9, 10, 11, 12, 13, 14, 15, 16, 17, 18, 19, 47, 46, 45, 44, 23, 22, 24, 43, 25, 42, 26, 41, 29, 38, 30, 37, 31, 28, 39, 27, 21, 20, 36, 40, 255, 255, 255, 255, 255, 255, 255, 255, 255, 255, 255, 255, 255, 255, 255, 255
  .byte 32, 33, 34, 35, 0, 1, 2, 3, 4, 5, 6, 7, 8, 9, 10, 11, 12, 13, 14, 15, 16, 17, 18, 19, 20, 21, 22, 23, 43, 42, 41, 26, 38, 29, 37, 30, 31, 39, 28, 27, 25, 40, 36, 24, 255, 255, 255, 255, 255, 255, 255, 255, 255, 255, 255, 255, 255, 255, 255, 255, 255, 255, 255, 255
  .byte 32, 33, 34, 35, 0, 1, 2, 3, 4, 5, 6, 7, 8, 9, 10, 11, 12, 13, 14, 15, 16, 17, 18, 19, 20, 21, 22, 23, 24, 25, 26, 27, 39, 38, 37, 30, 36, 31, 29, 28, 255, 255, 255, 255, 255, 255, 255, 255, 255, 255, 255, 255, 255, 255, 255, 255, 255, 255, 255, 255, 255, 255, 255, 255
  .byte 32, 33, 34, 35, 0, 1, 2, 3, 4, 5, 6, 7, 8, 9, 10, 11, 12, 13, 14, 15, 16, 17, 18, 19, 20, 21, 22, 23, 24, 25, 26, 27, 28, 29, 30, 31, 255, 255, 255, 255, 255, 255, 255, 255, 255, 255, 255, 255, 255, 255, 255, 255, 255, 255, 255, 255, 255, 255, 255, 255, 255, 255, 255, 255
.size TILETAB, 512
.section .rodata,"a"
.p2align 6
.amdhsa_kernel standalone__memory_aug_memorizing_tr__prompt_kernel
  .amdhsa_next_free_vgpr 512
  .amdhsa_next_free_sgpr 102
  .amdhsa_accum_offset 256
  .amdhsa_group_segment_fixed_size 0
  .amdhsa_kernarg_size 80
  .amdhsa_user_sgpr_count 2
  .amdhsa_user_sgpr_kernarg_segment_ptr 1
  .amdhsa_system_sgpr_workgroup_id_x 1
.end_amdhsa_kernel
```
